```python
import torch

def _softmax(x, axis=-1):
    return torch.softmax(x, dim=axis)

def _gelu(x):
    return torch.nn.functional.gelu(x, approximate='tanh')

def _silu(x):
    return torch.nn.functional.silu(x)

def _sigmoid(x):
    return torch.sigmoid(x)

def _layernorm(x, axis=-1, eps=1e-05):
    m = x.mean(dim=axis, keepdim=True)
    v = x.var(dim=axis, keepdim=True, unbiased=False)
    return (x - m) / torch.sqrt(v + eps)

def _scatter_add(tgt, idx, src, axis=0):
    return tgt.clone().index_add_(axis, idx, src)

def _segment_sum(src, seg, n):
    out = torch.zeros((n,) + src.shape[1:], dtype=src.dtype)
    return out.index_add_(0, seg, src)

def _pad(x, pw):
    flat = tuple((v for pair in reversed(pw) for v in pair))
    return torch.nn.functional.pad(x, flat)
kernel_name = 'adaLN_cond__gqa_block_cached__dense_activation_relu__prompt'

def setup_inputs():

    _w = lambda a: (lambda t: t.to(torch.bfloat16) if t.is_floating_point() else t)(torch.as_tensor(a))

    def _A_setup():
        B, Sq, D = (1, 2048, 448)
        Hq, Hkv, Sk, Dh = (16, 8, 2048, 256)
        assert Hq % Hkv == 0, (Hq, Hkv)
        return {'x': _w((lambda *s: torch.randn(*s, dtype=torch.bfloat16) * 0.1)(B, Sq, D)), 'k_cache': _w((lambda *s: torch.randn(*s, dtype=torch.bfloat16) * 0.8)(B, Hkv, Sk, Dh)), 'v_cache': _w((lambda *s: torch.randn(*s, dtype=torch.bfloat16) * 1.6)(B, Hkv, Sk, Dh)), 'wq': _w((lambda *s: torch.randn(*s, dtype=torch.bfloat16) * 0.8)(D, Hq * Dh) * D ** (-0.5)), 'wo': _w((lambda *s: torch.randn(*s, dtype=torch.bfloat16) * 1.6)(Hq * Dh, D) * (Hq * Dh) ** (-0.5))}
    _A_in = _A_setup()

    def _B_setup():
        B, S, D, Dff = (1, 2048, 448, 1792)
        return {'x': _w((lambda *s: torch.randn(*s, dtype=torch.bfloat16) * 0.1)(B, S, D)), 'w1': _w((lambda *s: torch.randn(*s, dtype=torch.bfloat16) * 0.2)(D, Dff)), 'w2': _w((lambda *s: torch.randn(*s, dtype=torch.bfloat16) * 0.2)(Dff, D))}
    _B_in = _B_setup()
    return {'A_x': _A_in['x'], 'A_k_cache': _A_in['k_cache'], 'A_v_cache': _A_in['v_cache'], 'A_wq': _A_in['wq'], 'A_wo': _A_in['wo'], 'B_x': _B_in['x'], 'B_w1': _B_in['w1'], 'B_w2': _B_in['w2'], 'c': _w((lambda *s: torch.randn(*s, dtype=torch.bfloat16) * 0.8)(1, 448) * 8.0), 'w_mod': _w((lambda *s: torch.randn(*s, dtype=torch.bfloat16) * 0.8)(448, 6 * 448) * 448 ** (-0.5) * 8.0)}

def reference(A_x, A_k_cache, A_v_cache, A_wq, A_wo, B_x, B_w1, B_w2, c, w_mod):

    def _A_ref(x, k_cache, v_cache, wq, wo):
        B, Sq, D = x.shape
        Hq, Dh = (16, 256)
        Hkv = k_cache.shape[1]
        rep = Hq // Hkv
        q = (lambda x, *d: x.permute(*d))((x @ wq).reshape(B, Sq, Hq, Dh), 0, 2, 1, 3)
        k = (lambda x, n, axis: torch.repeat_interleave(x, n, dim=axis))(k_cache, rep, axis=1)
        v = (lambda x, n, axis: torch.repeat_interleave(x, n, dim=axis))(v_cache, rep, axis=1)
        scores = torch.einsum('bhqd,bhkd->bhqk', q, k) * Dh ** (-0.5)
        p = _softmax(scores, axis=-1)
        o = torch.einsum('bhqk,bhkd->bhqd', p, v)
        return (lambda x, *d: x.permute(*d))(o, 0, 2, 1, 3).reshape(B, Sq, Hq * Dh) @ wo

    def _B_ref(x, w1, w2):
        h = torch.einsum('bsd,df->bsf', x, w1)
        zero = torch.zeros_like(h)
        h = torch.maximum(h, zero)
        return torch.einsum('bsf,fd->bsd', h, w2)
    x = A_x
    mod = (_silu(c) @ w_mod).reshape(c.shape[0], 6, 1, -1)
    sa, ca, ga, sb, cb, gb = (mod[:, 0].clone(), mod[:, 1].clone(), mod[:, 2].clone(), mod[:, 3].clone(), mod[:, 4].clone(), mod[:, 5].clone())
    h = _layernorm(x, axis=-1) * (1 + ca) + sa
    x = x + ga * _A_ref(h, A_k_cache, A_v_cache, A_wq, A_wo)
    h = _layernorm(x, axis=-1) * (1 + cb) + sb
    x = x + gb * _B_ref(h, B_w1, B_w2)
    return x
```

```asm
; @launch kernel=k0_mod_kernel grid=(368,1,1) block=(448,1,1) lds=8192
; @launch kernel=k1_attn_kernel grid=(256,1,1) block=(256,1,1) lds=163840
; @launch kernel=k2_reduce_kernel grid=(256,1,1) block=(448,1,1) lds=1024
; @launch kernel=k3_mlp1_kernel grid=(224,1,1) block=(256,1,1) lds=114688
; @launch kernel=k4_mlp2_kernel grid=(224,1,1) block=(256,1,1) lds=131072
.amdgcn_target "amdgcn-amd-amdhsa--gfx950"
.text
.globl k0_mod_kernel
.p2align 8
.type k0_mod_kernel,@function
k0_mod_kernel:
    s_cmp_ge_u32 s2, 368
    s_cbranch_scc1 K0_END
    s_cmp_ge_u32 s2, 304
    s_cbranch_scc1 K0_PFW
    s_cmp_ge_u32 s2, 298
    s_cbranch_scc1 K0_END
    s_load_dwordx2 s[4:5], s[0:1], 96
    s_cmp_ge_u32 s2, 42
    s_cbranch_scc1 K0_Y
    v_cmp_gt_u32 vcc, 256, v0
    s_cbranch_vccz K0_END
    s_load_dwordx4 s[8:11], s[0:1], 64
    v_and_b32 v3, 7, v0
    v_lshrrev_b32 v4, 3, v0
    v_lshlrev_b32 v2, 1, v4
    s_movk_i32 s6, 5376
    v_mul_lo_u32 v1, v4, s6
    v_lshl_add_u32 v1, v3, 4, v1
    s_lshl_b32 s7, s2, 7
    v_add_u32 v1, s7, v1
    s_waitcnt lgkmcnt(0)
    s_mov_b32 s12, s8
    s_and_b32 s13, s9, 0xffff
    s_mov_b32 s14, 896
    s_mov_b32 s15, 0x00020000
    s_mov_b32 s16, s10
    s_and_b32 s17, s11, 0xffff
    s_mov_b32 s18, 2408448
    s_mov_b32 s19, 0x00020000
    buffer_load_ushort v72, v2, s[12:15], 0 offen offset:0
    buffer_load_ushort v73, v2, s[12:15], 0 offen offset:64
    buffer_load_ushort v74, v2, s[12:15], 0 offen offset:128
    buffer_load_ushort v75, v2, s[12:15], 0 offen offset:192
    buffer_load_ushort v76, v2, s[12:15], 0 offen offset:256
    buffer_load_ushort v77, v2, s[12:15], 0 offen offset:320
    buffer_load_ushort v78, v2, s[12:15], 0 offen offset:384
    buffer_load_ushort v79, v2, s[12:15], 0 offen offset:448
    buffer_load_ushort v80, v2, s[12:15], 0 offen offset:512
    buffer_load_ushort v81, v2, s[12:15], 0 offen offset:576
    buffer_load_ushort v82, v2, s[12:15], 0 offen offset:640
    buffer_load_ushort v83, v2, s[12:15], 0 offen offset:704
    buffer_load_ushort v84, v2, s[12:15], 0 offen offset:768
    buffer_load_ushort v85, v2, s[12:15], 0 offen offset:832
    s_mov_b32 s20, 0
    buffer_load_dwordx4 v[16:19], v1, s[16:19], s20 offen
    s_mov_b32 s20, 172032
    buffer_load_dwordx4 v[20:23], v1, s[16:19], s20 offen
    s_mov_b32 s20, 344064
    buffer_load_dwordx4 v[24:27], v1, s[16:19], s20 offen
    s_mov_b32 s20, 516096
    buffer_load_dwordx4 v[28:31], v1, s[16:19], s20 offen
    s_mov_b32 s20, 688128
    buffer_load_dwordx4 v[32:35], v1, s[16:19], s20 offen
    s_mov_b32 s20, 860160
    buffer_load_dwordx4 v[36:39], v1, s[16:19], s20 offen
    s_mov_b32 s20, 1032192
    buffer_load_dwordx4 v[40:43], v1, s[16:19], s20 offen
    s_mov_b32 s20, 1204224
    buffer_load_dwordx4 v[44:47], v1, s[16:19], s20 offen
    s_mov_b32 s20, 1376256
    buffer_load_dwordx4 v[48:51], v1, s[16:19], s20 offen
    s_mov_b32 s20, 1548288
    buffer_load_dwordx4 v[52:55], v1, s[16:19], s20 offen
    s_mov_b32 s20, 1720320
    buffer_load_dwordx4 v[56:59], v1, s[16:19], s20 offen
    s_mov_b32 s20, 1892352
    buffer_load_dwordx4 v[60:63], v1, s[16:19], s20 offen
    s_mov_b32 s20, 2064384
    buffer_load_dwordx4 v[64:67], v1, s[16:19], s20 offen
    s_mov_b32 s20, 2236416
    buffer_load_dwordx4 v[68:71], v1, s[16:19], s20 offen
    v_mov_b32 v88, 0
    v_mov_b32 v89, 0
    v_mov_b32 v90, 0
    v_mov_b32 v91, 0
    v_mov_b32 v92, 0
    v_mov_b32 v93, 0
    v_mov_b32 v94, 0
    v_mov_b32 v95, 0
    s_mov_b32 s21, 0xbfb8aa3b
    s_waitcnt vmcnt(14)
    v_lshlrev_b32 v72, 16, v72
    v_mul_f32 v5, s21, v72
    v_exp_f32 v5, v5
    s_nop 0
    v_add_f32 v5, 1.0, v5
    v_rcp_f32 v5, v5
    s_nop 0
    v_mul_f32 v5, v5, v72
    v_cvt_pk_bf16_f32 v5, v5, v5
    v_lshlrev_b32 v72, 16, v5
    v_lshlrev_b32 v73, 16, v73
    v_mul_f32 v5, s21, v73
    v_exp_f32 v5, v5
    s_nop 0
    v_add_f32 v5, 1.0, v5
    v_rcp_f32 v5, v5
    s_nop 0
    v_mul_f32 v5, v5, v73
    v_cvt_pk_bf16_f32 v5, v5, v5
    v_lshlrev_b32 v73, 16, v5
    v_lshlrev_b32 v74, 16, v74
    v_mul_f32 v5, s21, v74
    v_exp_f32 v5, v5
    s_nop 0
    v_add_f32 v5, 1.0, v5
    v_rcp_f32 v5, v5
    s_nop 0
    v_mul_f32 v5, v5, v74
    v_cvt_pk_bf16_f32 v5, v5, v5
    v_lshlrev_b32 v74, 16, v5
    v_lshlrev_b32 v75, 16, v75
    v_mul_f32 v5, s21, v75
    v_exp_f32 v5, v5
    s_nop 0
    v_add_f32 v5, 1.0, v5
    v_rcp_f32 v5, v5
    s_nop 0
    v_mul_f32 v5, v5, v75
    v_cvt_pk_bf16_f32 v5, v5, v5
    v_lshlrev_b32 v75, 16, v5
    v_lshlrev_b32 v76, 16, v76
    v_mul_f32 v5, s21, v76
    v_exp_f32 v5, v5
    s_nop 0
    v_add_f32 v5, 1.0, v5
    v_rcp_f32 v5, v5
    s_nop 0
    v_mul_f32 v5, v5, v76
    v_cvt_pk_bf16_f32 v5, v5, v5
    v_lshlrev_b32 v76, 16, v5
    v_lshlrev_b32 v77, 16, v77
    v_mul_f32 v5, s21, v77
    v_exp_f32 v5, v5
    s_nop 0
    v_add_f32 v5, 1.0, v5
    v_rcp_f32 v5, v5
    s_nop 0
    v_mul_f32 v5, v5, v77
    v_cvt_pk_bf16_f32 v5, v5, v5
    v_lshlrev_b32 v77, 16, v5
    v_lshlrev_b32 v78, 16, v78
    v_mul_f32 v5, s21, v78
    v_exp_f32 v5, v5
    s_nop 0
    v_add_f32 v5, 1.0, v5
    v_rcp_f32 v5, v5
    s_nop 0
    v_mul_f32 v5, v5, v78
    v_cvt_pk_bf16_f32 v5, v5, v5
    v_lshlrev_b32 v78, 16, v5
    v_lshlrev_b32 v79, 16, v79
    v_mul_f32 v5, s21, v79
    v_exp_f32 v5, v5
    s_nop 0
    v_add_f32 v5, 1.0, v5
    v_rcp_f32 v5, v5
    s_nop 0
    v_mul_f32 v5, v5, v79
    v_cvt_pk_bf16_f32 v5, v5, v5
    v_lshlrev_b32 v79, 16, v5
    v_lshlrev_b32 v80, 16, v80
    v_mul_f32 v5, s21, v80
    v_exp_f32 v5, v5
    s_nop 0
    v_add_f32 v5, 1.0, v5
    v_rcp_f32 v5, v5
    s_nop 0
    v_mul_f32 v5, v5, v80
    v_cvt_pk_bf16_f32 v5, v5, v5
    v_lshlrev_b32 v80, 16, v5
    v_lshlrev_b32 v81, 16, v81
    v_mul_f32 v5, s21, v81
    v_exp_f32 v5, v5
    s_nop 0
    v_add_f32 v5, 1.0, v5
    v_rcp_f32 v5, v5
    s_nop 0
    v_mul_f32 v5, v5, v81
    v_cvt_pk_bf16_f32 v5, v5, v5
    v_lshlrev_b32 v81, 16, v5
    v_lshlrev_b32 v82, 16, v82
    v_mul_f32 v5, s21, v82
    v_exp_f32 v5, v5
    s_nop 0
    v_add_f32 v5, 1.0, v5
    v_rcp_f32 v5, v5
    s_nop 0
    v_mul_f32 v5, v5, v82
    v_cvt_pk_bf16_f32 v5, v5, v5
    v_lshlrev_b32 v82, 16, v5
    v_lshlrev_b32 v83, 16, v83
    v_mul_f32 v5, s21, v83
    v_exp_f32 v5, v5
    s_nop 0
    v_add_f32 v5, 1.0, v5
    v_rcp_f32 v5, v5
    s_nop 0
    v_mul_f32 v5, v5, v83
    v_cvt_pk_bf16_f32 v5, v5, v5
    v_lshlrev_b32 v83, 16, v5
    v_lshlrev_b32 v84, 16, v84
    v_mul_f32 v5, s21, v84
    v_exp_f32 v5, v5
    s_nop 0
    v_add_f32 v5, 1.0, v5
    v_rcp_f32 v5, v5
    s_nop 0
    v_mul_f32 v5, v5, v84
    v_cvt_pk_bf16_f32 v5, v5, v5
    v_lshlrev_b32 v84, 16, v5
    v_lshlrev_b32 v85, 16, v85
    v_mul_f32 v5, s21, v85
    v_exp_f32 v5, v5
    s_nop 0
    v_add_f32 v5, 1.0, v5
    v_rcp_f32 v5, v5
    s_nop 0
    v_mul_f32 v5, v5, v85
    v_cvt_pk_bf16_f32 v5, v5, v5
    v_lshlrev_b32 v85, 16, v5
    s_waitcnt vmcnt(13)
    v_lshlrev_b32 v5, 16, v16
    v_and_b32 v6, 0xffff0000, v16
    v_fmac_f32 v88, v5, v72
    v_fmac_f32 v89, v6, v72
    v_lshlrev_b32 v5, 16, v17
    v_and_b32 v6, 0xffff0000, v17
    v_fmac_f32 v90, v5, v72
    v_fmac_f32 v91, v6, v72
    v_lshlrev_b32 v5, 16, v18
    v_and_b32 v6, 0xffff0000, v18
    v_fmac_f32 v92, v5, v72
    v_fmac_f32 v93, v6, v72
    v_lshlrev_b32 v5, 16, v19
    v_and_b32 v6, 0xffff0000, v19
    v_fmac_f32 v94, v5, v72
    v_fmac_f32 v95, v6, v72
    s_waitcnt vmcnt(12)
    v_lshlrev_b32 v5, 16, v20
    v_and_b32 v6, 0xffff0000, v20
    v_fmac_f32 v88, v5, v73
    v_fmac_f32 v89, v6, v73
    v_lshlrev_b32 v5, 16, v21
    v_and_b32 v6, 0xffff0000, v21
    v_fmac_f32 v90, v5, v73
    v_fmac_f32 v91, v6, v73
    v_lshlrev_b32 v5, 16, v22
    v_and_b32 v6, 0xffff0000, v22
    v_fmac_f32 v92, v5, v73
    v_fmac_f32 v93, v6, v73
    v_lshlrev_b32 v5, 16, v23
    v_and_b32 v6, 0xffff0000, v23
    v_fmac_f32 v94, v5, v73
    v_fmac_f32 v95, v6, v73
    s_waitcnt vmcnt(11)
    v_lshlrev_b32 v5, 16, v24
    v_and_b32 v6, 0xffff0000, v24
    v_fmac_f32 v88, v5, v74
    v_fmac_f32 v89, v6, v74
    v_lshlrev_b32 v5, 16, v25
    v_and_b32 v6, 0xffff0000, v25
    v_fmac_f32 v90, v5, v74
    v_fmac_f32 v91, v6, v74
    v_lshlrev_b32 v5, 16, v26
    v_and_b32 v6, 0xffff0000, v26
    v_fmac_f32 v92, v5, v74
    v_fmac_f32 v93, v6, v74
    v_lshlrev_b32 v5, 16, v27
    v_and_b32 v6, 0xffff0000, v27
    v_fmac_f32 v94, v5, v74
    v_fmac_f32 v95, v6, v74
    s_waitcnt vmcnt(10)
    v_lshlrev_b32 v5, 16, v28
    v_and_b32 v6, 0xffff0000, v28
    v_fmac_f32 v88, v5, v75
    v_fmac_f32 v89, v6, v75
    v_lshlrev_b32 v5, 16, v29
    v_and_b32 v6, 0xffff0000, v29
    v_fmac_f32 v90, v5, v75
    v_fmac_f32 v91, v6, v75
    v_lshlrev_b32 v5, 16, v30
    v_and_b32 v6, 0xffff0000, v30
    v_fmac_f32 v92, v5, v75
    v_fmac_f32 v93, v6, v75
    v_lshlrev_b32 v5, 16, v31
    v_and_b32 v6, 0xffff0000, v31
    v_fmac_f32 v94, v5, v75
    v_fmac_f32 v95, v6, v75
    s_waitcnt vmcnt(9)
    v_lshlrev_b32 v5, 16, v32
    v_and_b32 v6, 0xffff0000, v32
    v_fmac_f32 v88, v5, v76
    v_fmac_f32 v89, v6, v76
    v_lshlrev_b32 v5, 16, v33
    v_and_b32 v6, 0xffff0000, v33
    v_fmac_f32 v90, v5, v76
    v_fmac_f32 v91, v6, v76
    v_lshlrev_b32 v5, 16, v34
    v_and_b32 v6, 0xffff0000, v34
    v_fmac_f32 v92, v5, v76
    v_fmac_f32 v93, v6, v76
    v_lshlrev_b32 v5, 16, v35
    v_and_b32 v6, 0xffff0000, v35
    v_fmac_f32 v94, v5, v76
    v_fmac_f32 v95, v6, v76
    s_waitcnt vmcnt(8)
    v_lshlrev_b32 v5, 16, v36
    v_and_b32 v6, 0xffff0000, v36
    v_fmac_f32 v88, v5, v77
    v_fmac_f32 v89, v6, v77
    v_lshlrev_b32 v5, 16, v37
    v_and_b32 v6, 0xffff0000, v37
    v_fmac_f32 v90, v5, v77
    v_fmac_f32 v91, v6, v77
    v_lshlrev_b32 v5, 16, v38
    v_and_b32 v6, 0xffff0000, v38
    v_fmac_f32 v92, v5, v77
    v_fmac_f32 v93, v6, v77
    v_lshlrev_b32 v5, 16, v39
    v_and_b32 v6, 0xffff0000, v39
    v_fmac_f32 v94, v5, v77
    v_fmac_f32 v95, v6, v77
    s_waitcnt vmcnt(7)
    v_lshlrev_b32 v5, 16, v40
    v_and_b32 v6, 0xffff0000, v40
    v_fmac_f32 v88, v5, v78
    v_fmac_f32 v89, v6, v78
    v_lshlrev_b32 v5, 16, v41
    v_and_b32 v6, 0xffff0000, v41
    v_fmac_f32 v90, v5, v78
    v_fmac_f32 v91, v6, v78
    v_lshlrev_b32 v5, 16, v42
    v_and_b32 v6, 0xffff0000, v42
    v_fmac_f32 v92, v5, v78
    v_fmac_f32 v93, v6, v78
    v_lshlrev_b32 v5, 16, v43
    v_and_b32 v6, 0xffff0000, v43
    v_fmac_f32 v94, v5, v78
    v_fmac_f32 v95, v6, v78
    s_waitcnt vmcnt(6)
    v_lshlrev_b32 v5, 16, v44
    v_and_b32 v6, 0xffff0000, v44
    v_fmac_f32 v88, v5, v79
    v_fmac_f32 v89, v6, v79
    v_lshlrev_b32 v5, 16, v45
    v_and_b32 v6, 0xffff0000, v45
    v_fmac_f32 v90, v5, v79
    v_fmac_f32 v91, v6, v79
    v_lshlrev_b32 v5, 16, v46
    v_and_b32 v6, 0xffff0000, v46
    v_fmac_f32 v92, v5, v79
    v_fmac_f32 v93, v6, v79
    v_lshlrev_b32 v5, 16, v47
    v_and_b32 v6, 0xffff0000, v47
    v_fmac_f32 v94, v5, v79
    v_fmac_f32 v95, v6, v79
    s_waitcnt vmcnt(5)
    v_lshlrev_b32 v5, 16, v48
    v_and_b32 v6, 0xffff0000, v48
    v_fmac_f32 v88, v5, v80
    v_fmac_f32 v89, v6, v80
    v_lshlrev_b32 v5, 16, v49
    v_and_b32 v6, 0xffff0000, v49
    v_fmac_f32 v90, v5, v80
    v_fmac_f32 v91, v6, v80
    v_lshlrev_b32 v5, 16, v50
    v_and_b32 v6, 0xffff0000, v50
    v_fmac_f32 v92, v5, v80
    v_fmac_f32 v93, v6, v80
    v_lshlrev_b32 v5, 16, v51
    v_and_b32 v6, 0xffff0000, v51
    v_fmac_f32 v94, v5, v80
    v_fmac_f32 v95, v6, v80
    s_waitcnt vmcnt(4)
    v_lshlrev_b32 v5, 16, v52
    v_and_b32 v6, 0xffff0000, v52
    v_fmac_f32 v88, v5, v81
    v_fmac_f32 v89, v6, v81
    v_lshlrev_b32 v5, 16, v53
    v_and_b32 v6, 0xffff0000, v53
    v_fmac_f32 v90, v5, v81
    v_fmac_f32 v91, v6, v81
    v_lshlrev_b32 v5, 16, v54
    v_and_b32 v6, 0xffff0000, v54
    v_fmac_f32 v92, v5, v81
    v_fmac_f32 v93, v6, v81
    v_lshlrev_b32 v5, 16, v55
    v_and_b32 v6, 0xffff0000, v55
    v_fmac_f32 v94, v5, v81
    v_fmac_f32 v95, v6, v81
    s_waitcnt vmcnt(3)
    v_lshlrev_b32 v5, 16, v56
    v_and_b32 v6, 0xffff0000, v56
    v_fmac_f32 v88, v5, v82
    v_fmac_f32 v89, v6, v82
    v_lshlrev_b32 v5, 16, v57
    v_and_b32 v6, 0xffff0000, v57
    v_fmac_f32 v90, v5, v82
    v_fmac_f32 v91, v6, v82
    v_lshlrev_b32 v5, 16, v58
    v_and_b32 v6, 0xffff0000, v58
    v_fmac_f32 v92, v5, v82
    v_fmac_f32 v93, v6, v82
    v_lshlrev_b32 v5, 16, v59
    v_and_b32 v6, 0xffff0000, v59
    v_fmac_f32 v94, v5, v82
    v_fmac_f32 v95, v6, v82
    s_waitcnt vmcnt(2)
    v_lshlrev_b32 v5, 16, v60
    v_and_b32 v6, 0xffff0000, v60
    v_fmac_f32 v88, v5, v83
    v_fmac_f32 v89, v6, v83
    v_lshlrev_b32 v5, 16, v61
    v_and_b32 v6, 0xffff0000, v61
    v_fmac_f32 v90, v5, v83
    v_fmac_f32 v91, v6, v83
    v_lshlrev_b32 v5, 16, v62
    v_and_b32 v6, 0xffff0000, v62
    v_fmac_f32 v92, v5, v83
    v_fmac_f32 v93, v6, v83
    v_lshlrev_b32 v5, 16, v63
    v_and_b32 v6, 0xffff0000, v63
    v_fmac_f32 v94, v5, v83
    v_fmac_f32 v95, v6, v83
    s_waitcnt vmcnt(1)
    v_lshlrev_b32 v5, 16, v64
    v_and_b32 v6, 0xffff0000, v64
    v_fmac_f32 v88, v5, v84
    v_fmac_f32 v89, v6, v84
    v_lshlrev_b32 v5, 16, v65
    v_and_b32 v6, 0xffff0000, v65
    v_fmac_f32 v90, v5, v84
    v_fmac_f32 v91, v6, v84
    v_lshlrev_b32 v5, 16, v66
    v_and_b32 v6, 0xffff0000, v66
    v_fmac_f32 v92, v5, v84
    v_fmac_f32 v93, v6, v84
    v_lshlrev_b32 v5, 16, v67
    v_and_b32 v6, 0xffff0000, v67
    v_fmac_f32 v94, v5, v84
    v_fmac_f32 v95, v6, v84
    s_waitcnt vmcnt(0)
    v_lshlrev_b32 v5, 16, v68
    v_and_b32 v6, 0xffff0000, v68
    v_fmac_f32 v88, v5, v85
    v_fmac_f32 v89, v6, v85
    v_lshlrev_b32 v5, 16, v69
    v_and_b32 v6, 0xffff0000, v69
    v_fmac_f32 v90, v5, v85
    v_fmac_f32 v91, v6, v85
    v_lshlrev_b32 v5, 16, v70
    v_and_b32 v6, 0xffff0000, v70
    v_fmac_f32 v92, v5, v85
    v_fmac_f32 v93, v6, v85
    v_lshlrev_b32 v5, 16, v71
    v_and_b32 v6, 0xffff0000, v71
    v_fmac_f32 v94, v5, v85
    v_fmac_f32 v95, v6, v85
    v_lshlrev_b32 v7, 8, v4
    v_lshl_add_u32 v7, v3, 5, v7
    ds_write_b128 v7, v[88:91]
    ds_write_b128 v7, v[92:95] offset:16
    s_waitcnt lgkmcnt(0)
    s_barrier
    v_cmp_gt_u32 vcc, 64, v0
    s_and_saveexec_b64 s[22:23], vcc
    s_cbranch_execz K0_END
    v_lshlrev_b32 v7, 2, v0
    ds_read_b32 v16, v7 offset:0
    ds_read_b32 v17, v7 offset:256
    ds_read_b32 v18, v7 offset:512
    ds_read_b32 v19, v7 offset:768
    ds_read_b32 v20, v7 offset:1024
    ds_read_b32 v21, v7 offset:1280
    ds_read_b32 v22, v7 offset:1536
    ds_read_b32 v23, v7 offset:1792
    ds_read_b32 v24, v7 offset:2048
    ds_read_b32 v25, v7 offset:2304
    ds_read_b32 v26, v7 offset:2560
    ds_read_b32 v27, v7 offset:2816
    ds_read_b32 v28, v7 offset:3072
    ds_read_b32 v29, v7 offset:3328
    ds_read_b32 v30, v7 offset:3584
    ds_read_b32 v31, v7 offset:3840
    ds_read_b32 v32, v7 offset:4096
    ds_read_b32 v33, v7 offset:4352
    ds_read_b32 v34, v7 offset:4608
    ds_read_b32 v35, v7 offset:4864
    ds_read_b32 v36, v7 offset:5120
    ds_read_b32 v37, v7 offset:5376
    ds_read_b32 v38, v7 offset:5632
    ds_read_b32 v39, v7 offset:5888
    ds_read_b32 v40, v7 offset:6144
    ds_read_b32 v41, v7 offset:6400
    ds_read_b32 v42, v7 offset:6656
    ds_read_b32 v43, v7 offset:6912
    ds_read_b32 v44, v7 offset:7168
    ds_read_b32 v45, v7 offset:7424
    ds_read_b32 v46, v7 offset:7680
    ds_read_b32 v47, v7 offset:7936
    s_waitcnt lgkmcnt(0)
    v_add_f32 v16, v16, v17
    v_add_f32 v16, v16, v18
    v_add_f32 v16, v16, v19
    v_add_f32 v16, v16, v20
    v_add_f32 v16, v16, v21
    v_add_f32 v16, v16, v22
    v_add_f32 v16, v16, v23
    v_add_f32 v16, v16, v24
    v_add_f32 v16, v16, v25
    v_add_f32 v16, v16, v26
    v_add_f32 v16, v16, v27
    v_add_f32 v16, v16, v28
    v_add_f32 v16, v16, v29
    v_add_f32 v16, v16, v30
    v_add_f32 v16, v16, v31
    v_add_f32 v16, v16, v32
    v_add_f32 v16, v16, v33
    v_add_f32 v16, v16, v34
    v_add_f32 v16, v16, v35
    v_add_f32 v16, v16, v36
    v_add_f32 v16, v16, v37
    v_add_f32 v16, v16, v38
    v_add_f32 v16, v16, v39
    v_add_f32 v16, v16, v40
    v_add_f32 v16, v16, v41
    v_add_f32 v16, v16, v42
    v_add_f32 v16, v16, v43
    v_add_f32 v16, v16, v44
    v_add_f32 v16, v16, v45
    v_add_f32 v16, v16, v46
    v_add_f32 v16, v16, v47
    v_cvt_pk_bf16_f32 v16, v16, v16
    v_lshlrev_b32 v16, 16, v16
    s_mul_i32 s24, s2, 9363
    s_lshr_b32 s24, s24, 16
    s_mov_b32 s25, 0
    s_cmp_eq_u32 s24, 1
    s_cselect_b32 s25, 1.0, s25
    s_cmp_eq_u32 s24, 4
    s_cselect_b32 s25, 1.0, s25
    v_add_f32 v16, s25, v16
    v_cvt_pk_bf16_f32 v16, v16, v16
    v_lshlrev_b32 v16, 16, v16
    s_mov_b32 s26, 0x3db8aa3b
    s_cmp_le_u32 s24, 1
    s_cselect_b32 s26, s26, 1.0
    v_mul_f32 v16, s26, v16
    s_mov_b32 s12, s4
    s_and_b32 s13, s5, 0xffff
    s_mov_b32 s14, 10752
    s_mov_b32 s15, 0x00020000
    s_lshl_b32 s7, s2, 8
    v_add_u32 v7, s7, v7
    buffer_store_dword v16, v7, s[12:15], 0 offen
    s_endpgm
K0_Y:
    s_load_dwordx2 s[8:9], s[0:1], 0
    s_sub_u32 s6, s2, 42
    s_lshr_b32 s29, s6, 2
    s_and_b32 s30, s6, 3
    v_and_b32 v2, 7, v0
    v_bfe_u32 v3, v0, 3, 1
    v_lshrrev_b32 v4, 4, v0
    v_lshlrev_b32 v5, 10, v4
    v_lshl_add_u32 v5, v3, 9, v5
    v_lshl_add_u32 v5, v2, 4, v5
    s_lshl_b32 s31, s30, 7
    v_add_u32 v5, s31, v5
    s_lshl_b32 s33, s29, 5
    s_lshl_b32 s34, s30, 3
    s_add_u32 s33, s33, s34
    v_add_u32 v13, s33, v2
    v_mul_u32_u24 v13, 896, v13
    v_lshl_add_u32 v13, v4, 5, v13
    v_lshl_add_u32 v13, v3, 3, v13
    v_lshrrev_b32 v9, 6, v0
    v_lshlrev_b32 v7, 5, v2
    v_lshl_add_u32 v8, v9, 2, v7
    v_and_b32 v10, 63, v0
    s_mul_i32 s32, s29, 28672
    s_waitcnt lgkmcnt(0)
    s_mov_b32 s12, s8
    s_and_b32 s13, s9, 0xffff
    s_mov_b32 s14, 1835008
    s_mov_b32 s15, 0x00020000
    buffer_load_dwordx2 v[48:49], v13, s[12:15], 0 offen
    buffer_load_dwordx2 v[50:51], v13, s[12:15], 0 offen offset:16
    s_add_u32 s8, s4, 16384
    s_addc_u32 s9, s5, 0
    s_mov_b32 s16, s8
    s_and_b32 s17, s9, 0xffff
    s_mov_b32 s18, 1835008
    s_mov_b32 s19, 0x00020000
    s_add_u32 s8, s4, 31457280
    s_addc_u32 s9, s5, 0
    s_mov_b32 s20, s8
    s_and_b32 s21, s9, 0xffff
    s_mov_b32 s22, 1835008
    s_mov_b32 s23, 0x00020000
    s_waitcnt vmcnt(0)
    buffer_store_dwordx4 v[48:51], v5, s[20:23], s32 offen
    v_lshlrev_b32 v80, 16, v48
    v_and_b32 v81, 0xffff0000, v48
    v_lshlrev_b32 v82, 16, v49
    v_and_b32 v83, 0xffff0000, v49
    v_lshlrev_b32 v84, 16, v50
    v_and_b32 v85, 0xffff0000, v50
    v_lshlrev_b32 v86, 16, v51
    v_and_b32 v87, 0xffff0000, v51
    v_add_f32 v20, v80, v81
    v_add_f32 v20, v20, v82
    v_add_f32 v20, v20, v83
    v_add_f32 v20, v20, v84
    v_add_f32 v20, v20, v85
    v_add_f32 v20, v20, v86
    v_add_f32 v20, v20, v87
    s_nop 1
    v_add_f32_dpp v20, v20, v20 row_ror:8 row_mask:0xf bank_mask:0xf
    s_nop 0
    ds_swizzle_b32 v21, v20 offset:0x401F
    s_waitcnt lgkmcnt(0)
    v_add_f32 v20, v20, v21
    v_mov_b32 v21, v20
    s_nop 1
    v_permlane32_swap_b32 v20, v21
    s_nop 1
    v_add_f32 v20, v20, v21
    v_cmp_gt_u32 vcc, 8, v10
    s_and_saveexec_b64 s[44:45], vcc
    ds_write_b32 v8, v20 offset:0
    s_mov_b64 exec, s[44:45]
    s_waitcnt lgkmcnt(0)
    s_barrier
    ds_read_b128 v[24:27], v7 offset:0
    ds_read_b128 v[28:31], v7 offset:16
    s_waitcnt lgkmcnt(0)
    v_add_f32 v24, v24, v25
    v_add_f32 v26, v26, v27
    v_add_f32 v28, v28, v29
    v_add_f32 v24, v24, v26
    v_add_f32 v28, v28, v30
    v_add_f32 v20, v24, v28
    v_mul_f32 v22, 0x3b124925, v20
    v_sub_f32 v80, v80, v22
    v_sub_f32 v81, v81, v22
    v_sub_f32 v82, v82, v22
    v_sub_f32 v83, v83, v22
    v_sub_f32 v84, v84, v22
    v_sub_f32 v85, v85, v22
    v_sub_f32 v86, v86, v22
    v_sub_f32 v87, v87, v22
    v_mul_f32 v20, v80, v80
    v_fmac_f32 v20, v81, v81
    v_fmac_f32 v20, v82, v82
    v_fmac_f32 v20, v83, v83
    v_fmac_f32 v20, v84, v84
    v_fmac_f32 v20, v85, v85
    v_fmac_f32 v20, v86, v86
    v_fmac_f32 v20, v87, v87
    s_nop 1
    v_add_f32_dpp v20, v20, v20 row_ror:8 row_mask:0xf bank_mask:0xf
    s_nop 0
    ds_swizzle_b32 v21, v20 offset:0x401F
    s_waitcnt lgkmcnt(0)
    v_add_f32 v20, v20, v21
    v_mov_b32 v21, v20
    s_nop 1
    v_permlane32_swap_b32 v20, v21
    s_nop 1
    v_add_f32 v20, v20, v21
    v_cmp_gt_u32 vcc, 8, v10
    s_and_saveexec_b64 s[44:45], vcc
    ds_write_b32 v8, v20 offset:256
    s_mov_b64 exec, s[44:45]
    s_waitcnt lgkmcnt(0)
    s_barrier
    ds_read_b128 v[24:27], v7 offset:256
    ds_read_b128 v[28:31], v7 offset:272
    s_waitcnt lgkmcnt(0)
    v_add_f32 v24, v24, v25
    v_add_f32 v26, v26, v27
    v_add_f32 v28, v28, v29
    v_add_f32 v24, v24, v26
    v_add_f32 v28, v28, v30
    v_add_f32 v20, v24, v28
    v_mul_f32 v20, 0x3b124925, v20
    v_add_f32 v20, 0x3727c5ac, v20
    v_rsq_f32 v20, v20
    s_nop 0
    v_mul_f32 v80, v80, v20
    v_mul_f32 v81, v81, v20
    v_mul_f32 v82, v82, v20
    v_mul_f32 v83, v83, v20
    v_mul_f32 v84, v84, v20
    v_mul_f32 v85, v85, v20
    v_mul_f32 v86, v86, v20
    v_mul_f32 v87, v87, v20
    v_cvt_pk_bf16_f32 v16, v80, v81
    v_cvt_pk_bf16_f32 v17, v82, v83
    v_cvt_pk_bf16_f32 v18, v84, v85
    v_cvt_pk_bf16_f32 v19, v86, v87
    buffer_store_dwordx4 v[16:19], v5, s[16:19], s32 offen sc1
K0_END:
    s_endpgm
K0_PFW:
    s_load_dwordx4 s[8:11], s[0:1], 8
    s_load_dwordx2 s[12:13], s[0:1], 24
    s_and_b32 s6, s2, 7
    s_sub_u32 s7, s2, 304
    v_cmp_gt_u32 vcc, 256, v0
    s_cbranch_vccz K0_END
    s_lshr_b32 s7, s7, 3
    v_and_b32 v1, 63, v0
    v_lshrrev_b32 v2, 6, v0
    v_lshrrev_b32 v3, 3, v1
    v_lshl_add_u32 v3, v2, 4, v3
    s_mul_i32 s14, s7, 56
    v_add_u32 v3, s14, v3
    v_lshlrev_b32 v3, 13, v3
    v_and_b32 v4, 7, v1
    v_lshl_add_u32 v3, v4, 7, v3
    s_lshl_b32 s15, s6, 10
    v_add_u32 v3, s15, v3
    v_lshlrev_b32 v5, 7, v0
    v_min_u32 v5, 24448, v5
    s_waitcnt lgkmcnt(0)
    s_mov_b32 s16, s12
    s_and_b32 s17, s13, 0xffff
    s_mov_b32 s18, 3670016
    s_mov_b32 s19, 0x00020000
    buffer_load_dword v6, v3, s[16:19], 0 offen
    s_mov_b32 s20, 65536
    buffer_load_dword v7, v3, s[16:19], s20 offen
    s_mul_i32 s21, s7, 24576
    s_lshl_b32 s22, s6, 20
    s_add_u32 s21, s21, s22
    s_mov_b32 s24, s8
    s_and_b32 s25, s9, 0xffff
    s_mov_b32 s26, 8388608
    s_mov_b32 s27, 0x00020000
    buffer_load_dword v8, v5, s[24:27], s21 offen
    s_mov_b32 s28, s10
    s_and_b32 s29, s11, 0xffff
    s_mov_b32 s30, 8388608
    s_mov_b32 s31, 0x00020000
    buffer_load_dword v9, v5, s[28:31], s21 offen
    s_waitcnt vmcnt(0)
    s_endpgm
.globl k1_attn_kernel
.p2align 8
.type k1_attn_kernel,@function
k1_attn_kernel:
    s_cmp_ge_u32 s2, 256
    s_cbranch_scc1 K1_END
    s_load_dwordx4 s[36:39], s[0:1], 8
    s_load_dwordx4 s[40:43], s[0:1], 24
    s_load_dwordx2 s[60:61], s[0:1], 96
    v_and_b32 v1, 63, v0
    v_lshrrev_b32 v14, 6, v0
    s_nop 0
    v_readfirstlane_b32 s28, v14
    s_and_b32 s44, s2, 7
    s_lshr_b32 s45, s2, 3
    s_lshl_b32 s45, s45, 1
    s_and_b32 s46, s28, 1
    s_add_u32 s45, s45, s46
    s_lshr_b32 s47, s28, 1
    v_bfe_u32 v14, v1, 2, 1
    v_bfe_u32 v15, v1, 3, 1
    v_and_b32 v12, 3, v1
    v_lshlrev_b32 v12, 4, v12
    v_lshrrev_b32 v13, 4, v1
    v_lshl_add_u32 v12, v13, 7, v12
    v_xor_b32 v13, 0, v14
    v_lshl_add_u32 v13, v13, 6, v12
    v_lshl_add_u32 v13, v15, 13, v13
    v_add_u32 v2, 0, v13
    v_xor_b32 v13, 1, v14
    v_lshl_add_u32 v13, v13, 6, v12
    v_lshl_add_u32 v13, v15, 13, v13
    v_add_u32 v3, 15360, v13
    v_xor_b32 v13, 0, v14
    v_lshl_add_u32 v13, v13, 6, v12
    v_lshl_add_u32 v13, v15, 13, v13
    v_add_u32 v4, 30720, v13
    v_xor_b32 v13, 1, v14
    v_lshl_add_u32 v13, v13, 6, v12
    v_lshl_add_u32 v13, v15, 13, v13
    v_add_u32 v5, 46080, v13
    s_lshl_b32 s48, s47, 14
    v_lshrrev_b32 v14, 5, v1
    v_lshlrev_b32 v13, 11, v14
    v_bfe_u32 v14, v1, 3, 1
    v_lshl_add_u32 v13, v14, 10, v13
    v_bfe_u32 v15, v1, 2, 1
    v_lshl_add_u32 v13, v15, 7, v13
    v_bfe_u32 v15, v1, 4, 1
    v_lshl_add_u32 v13, v15, 5, v13
    v_and_b32 v15, 1, v1
    v_lshl_add_u32 v13, v15, 4, v13
    v_bfe_u32 v15, v1, 1, 1
    v_lshl_add_u32 v13, v15, 3, v13
    v_add_u32 v13, s48, v13
    v_lshl_add_u32 v6, v14, 6, v13
    v_xor_b32 v14, 1, v14
    v_lshl_add_u32 v7, v14, 6, v13
    v_add_u32 v8, 0x10000, v6
    v_add_u32 v9, 0x10000, v7
    v_lshlrev_b32 v12, 4, v1
    v_lshrrev_b32 v13, 5, v1
    v_lshlrev_b32 v13, 4, v13
    v_add_u32 v13, 133120, v13
    s_lshl_b32 s49, s46, 17
    s_lshl_b32 s50, s47, 9
    s_add_u32 s49, s49, s50
    s_lshl_b32 s48, s28, 13
    s_waitcnt lgkmcnt(0)
    s_lshl_b32 s50, s44, 20
    s_add_u32 s36, s36, s50
    s_addc_u32 s37, s37, 0
    s_sub_u32 s52, s36, 128
    s_subb_u32 s53, s37, 0
    s_mov_b32 s8, s52
    s_and_b32 s9, s53, 0xffff
    s_mov_b32 s10, 1048704
    s_mov_b32 s11, 0x00020000
    s_add_u32 s38, s38, s50
    s_addc_u32 s39, s39, 0
    s_sub_u32 s52, s38, 32768
    s_subb_u32 s53, s39, 0
    s_mov_b32 s12, s52
    s_and_b32 s13, s53, 0xffff
    s_mov_b32 s14, 1081344
    s_mov_b32 s15, 0x00020000
    s_lshl_b32 s50, s44, 10
    s_add_u32 s40, s40, s50
    s_addc_u32 s41, s41, 0
    s_sub_u32 s51, 3670016, s50
    s_mov_b32 s16, s40
    s_and_b32 s17, s41, 0xffff
    s_mov_b32 s18, s51
    s_mov_b32 s19, 0x00020000
    s_mul_i32 s50, s45, 28672
    s_add_u32 s50, s50, 16384
    s_add_u32 s52, s60, s50
    s_addc_u32 s53, s61, 0
    s_mov_b32 s20, s52
    s_and_b32 s21, s53, 0xffff
    s_mov_b32 s22, 28672
    s_mov_b32 s23, 0x00020000
    s_mov_b32 s24, s60
    s_and_b32 s25, s61, 0xffff
    s_mov_b32 s26, 3584
    s_mov_b32 s27, 0x00020000
    s_lshl_b32 s50, s47, 10
    v_add_u32 v14, s50, v12
    s_lshl_b32 s51, s47, 6
    v_add_u32 v13, s51, v13
    s_mul_i32 s51, s46, 6144
    s_add_u32 s51, s51, 137216
    v_add_u32 v10, s51, v12
    v_add_u32 v15, s50, v10
    s_mov_b32 s50, 0
    buffer_load_dwordx4 v[16:19], v14, s[20:23], s50 offen offset:0
    s_mov_b32 s50, 0
    buffer_load_dwordx4 v[20:23], v14, s[20:23], s50 offen offset:2048
    s_lshl_b32 s50, s28, 10
    s_add_u32 m0, s50, 133120
    s_nop 0
    buffer_load_dwordx4 v12, s[24:27], s50 offen lds
    s_add_u32 m0, s48, 65536
    s_add_u32 s50, s49, 0
    buffer_load_dwordx4 v2, s[16:19], s50 offen offset:0 lds
    buffer_load_dwordx4 v3, s[16:19], s50 offen offset:1024 lds
    buffer_load_dwordx4 v4, s[16:19], s50 offen offset:2048 lds
    buffer_load_dwordx4 v5, s[16:19], s50 offen offset:3072 lds
    s_add_u32 m0, s48, 69632
    s_add_u32 s50, s49, 65536
    buffer_load_dwordx4 v2, s[16:19], s50 offen offset:0 lds
    buffer_load_dwordx4 v3, s[16:19], s50 offen offset:1024 lds
    buffer_load_dwordx4 v4, s[16:19], s50 offen offset:2048 lds
    buffer_load_dwordx4 v5, s[16:19], s50 offen offset:3072 lds
    s_mov_b32 s50, 4096
    buffer_load_dwordx4 v[24:27], v14, s[20:23], s50 offen offset:0
    s_add_u32 m0, s48, 98304
    s_add_u32 s50, s49, 262144
    buffer_load_dwordx4 v2, s[16:19], s50 offen offset:0 lds
    buffer_load_dwordx4 v3, s[16:19], s50 offen offset:1024 lds
    buffer_load_dwordx4 v4, s[16:19], s50 offen offset:2048 lds
    buffer_load_dwordx4 v5, s[16:19], s50 offen offset:3072 lds
    s_add_u32 m0, s48, 102400
    s_add_u32 s50, s49, 327680
    buffer_load_dwordx4 v2, s[16:19], s50 offen offset:0 lds
    buffer_load_dwordx4 v3, s[16:19], s50 offen offset:1024 lds
    buffer_load_dwordx4 v4, s[16:19], s50 offen offset:2048 lds
    buffer_load_dwordx4 v5, s[16:19], s50 offen offset:3072 lds
    s_mov_b32 s50, 4096
    buffer_load_dwordx4 v[28:31], v14, s[20:23], s50 offen offset:2048
    s_add_u32 m0, s48, 0
    s_add_u32 s50, s49, 524288
    buffer_load_dwordx4 v2, s[16:19], s50 offen offset:0 lds
    buffer_load_dwordx4 v3, s[16:19], s50 offen offset:1024 lds
    buffer_load_dwordx4 v4, s[16:19], s50 offen offset:2048 lds
    buffer_load_dwordx4 v5, s[16:19], s50 offen offset:3072 lds
    s_add_u32 m0, s48, 4096
    s_add_u32 s50, s49, 589824
    buffer_load_dwordx4 v2, s[16:19], s50 offen offset:0 lds
    buffer_load_dwordx4 v3, s[16:19], s50 offen offset:1024 lds
    buffer_load_dwordx4 v4, s[16:19], s50 offen offset:2048 lds
    buffer_load_dwordx4 v5, s[16:19], s50 offen offset:3072 lds
    s_waitcnt vmcnt(18)
    s_barrier
    ds_read_b128 v[64:67], v13 offset:1792
    ds_read_b128 v[68:71], v13 offset:1824
    ds_read_b128 v[72:75], v13 offset:0
    ds_read_b128 v[76:79], v13 offset:32
    v_lshlrev_b32 v96, 16, v16
    v_and_b32 v97, 0xffff0000, v16
    v_lshlrev_b32 v98, 16, v17
    v_and_b32 v99, 0xffff0000, v17
    v_lshlrev_b32 v100, 16, v18
    v_and_b32 v101, 0xffff0000, v18
    v_lshlrev_b32 v102, 16, v19
    v_and_b32 v103, 0xffff0000, v19
    s_waitcnt lgkmcnt(0)
    v_pk_fma_f32 v[96:97], v[96:97], v[64:65], v[72:73]
    v_pk_fma_f32 v[98:99], v[98:99], v[66:67], v[74:75]
    v_pk_fma_f32 v[100:101], v[100:101], v[68:69], v[76:77]
    v_pk_fma_f32 v[102:103], v[102:103], v[70:71], v[78:79]
    v_cvt_pk_bf16_f32 v16, v96, v97
    v_cvt_pk_bf16_f32 v17, v98, v99
    v_cvt_pk_bf16_f32 v18, v100, v101
    v_cvt_pk_bf16_f32 v19, v102, v103
    ds_write_b128 v15, v[16:19] offset:0
    ds_read_b128 v[80:83], v13 offset:1920
    ds_read_b128 v[84:87], v13 offset:1952
    ds_read_b128 v[88:91], v13 offset:128
    ds_read_b128 v[92:95], v13 offset:160
    v_lshlrev_b32 v104, 16, v20
    v_and_b32 v105, 0xffff0000, v20
    v_lshlrev_b32 v106, 16, v21
    v_and_b32 v107, 0xffff0000, v21
    v_lshlrev_b32 v108, 16, v22
    v_and_b32 v109, 0xffff0000, v22
    v_lshlrev_b32 v110, 16, v23
    v_and_b32 v111, 0xffff0000, v23
    s_waitcnt lgkmcnt(0)
    v_pk_fma_f32 v[104:105], v[104:105], v[80:81], v[88:89]
    v_pk_fma_f32 v[106:107], v[106:107], v[82:83], v[90:91]
    v_pk_fma_f32 v[108:109], v[108:109], v[84:85], v[92:93]
    v_pk_fma_f32 v[110:111], v[110:111], v[86:87], v[94:95]
    v_cvt_pk_bf16_f32 v20, v104, v105
    v_cvt_pk_bf16_f32 v21, v106, v107
    v_cvt_pk_bf16_f32 v22, v108, v109
    v_cvt_pk_bf16_f32 v23, v110, v111
    ds_write_b128 v15, v[20:23] offset:2048
    s_waitcnt lgkmcnt(0)
    s_barrier
    ds_read_b128 v[40:43], v10 offset:0
    ds_read_b128 v[44:47], v10 offset:1024
    ds_read_b64_tr_b16 a[96:97], v8 offset:0
    ds_read_b64_tr_b16 a[98:99], v8 offset:4096
    ds_read_b64_tr_b16 a[100:101], v8 offset:8192
    ds_read_b64_tr_b16 a[102:103], v8 offset:12288
    ds_read_b64_tr_b16 a[104:105], v9 offset:0
    ds_read_b64_tr_b16 a[106:107], v9 offset:4096
    ds_read_b64_tr_b16 a[108:109], v9 offset:8192
    ds_read_b64_tr_b16 a[110:111], v9 offset:12288
    v_lshrrev_b32 v120, 5, v1
    v_and_b32 v121, 31, v1
    v_lshlrev_b32 v122, 3, v120
    v_xor_b32 v121, v121, v122
    v_lshlrev_b32 v121, 4, v121
    v_lshl_add_u32 v121, v120, 9, v121
    s_lshl_b32 s51, s28, 12
    s_add_u32 s54, s51, 128
    v_add_u32 v112, s54, v121
    v_subrev_u32 v113, 32, v112
    v_subrev_u32 v114, 64, v112
    v_subrev_u32 v115, 96, v112
    v_bfe_u32 v120, v1, 3, 1
    v_lshlrev_b32 v121, 9, v120
    v_lshrrev_b32 v120, 4, v1
    v_lshl_add_u32 v121, v120, 7, v121
    v_add_u32 v121, s51, v121
    v_and_b32 v120, 7, v1
    v_xor_b32 v122, 0, v120
    v_lshl_add_u32 v116, v122, 4, v121
    v_xor_b32 v122, 2, v120
    v_lshl_add_u32 v117, v122, 4, v121
    v_xor_b32 v122, 4, v120
    v_lshl_add_u32 v118, v122, 4, v121
    v_xor_b32 v122, 6, v120
    v_lshl_add_u32 v119, v122, 4, v121
    s_add_u32 s31, s51, 67584
    s_mul_i32 s30, s28, 4224
    s_waitcnt lgkmcnt(6)
    v_mfma_f32_32x32x16_bf16 v[128:143], a[96:99], v[40:43], 0
    ds_read_b64_tr_b16 a[112:113], v8 offset:256
    ds_read_b64_tr_b16 a[114:115], v8 offset:4352
    s_waitcnt vmcnt(9)
    s_barrier
    s_waitcnt lgkmcnt(6)
    v_mfma_f32_32x32x16_bf16 v[128:143], a[100:103], v[44:47], v[128:143]
    ds_read_b64_tr_b16 a[116:117], v8 offset:8448
    ds_read_b64_tr_b16 a[118:119], v8 offset:12544
    s_mov_b32 s50, 8192
    ds_read_b128 v[48:51], v10 offset:2048
    ds_read_b128 v[52:55], v10 offset:3072
    s_waitcnt lgkmcnt(8)
    v_mfma_f32_32x32x16_bf16 v[144:159], a[104:107], v[40:43], 0
    ds_read_b64_tr_b16 a[120:121], v9 offset:256
    ds_read_b64_tr_b16 a[122:123], v9 offset:4352
    buffer_load_dwordx4 v[32:35], v14, s[20:23], s50 offen offset:0
    ds_read_b128 v[64:67], v13 offset:2048
    ds_read_b128 v[68:71], v13 offset:2080
    s_waitcnt lgkmcnt(10)
    v_mfma_f32_32x32x16_bf16 v[144:159], a[108:111], v[44:47], v[144:159]
    ds_read_b64_tr_b16 a[124:125], v9 offset:8448
    ds_read_b64_tr_b16 a[126:127], v9 offset:12544
    s_add_u32 m0, s48, 32768
    ds_read_b128 v[72:75], v13 offset:256
    ds_read_b128 v[76:79], v13 offset:288
    s_waitcnt lgkmcnt(12)
    v_mfma_f32_32x32x16_bf16 v[160:175], a[112:115], v[40:43], 0
    ds_read_b64_tr_b16 a[96:97], v8 offset:512
    ds_read_b64_tr_b16 a[98:99], v8 offset:4608
    s_add_u32 s50, s49, 786432
    v_lshlrev_b32 v96, 16, v24
    v_and_b32 v97, 0xffff0000, v24
    s_waitcnt lgkmcnt(12)
    v_mfma_f32_32x32x16_bf16 v[160:175], a[116:119], v[44:47], v[160:175]
    ds_read_b64_tr_b16 a[100:101], v8 offset:8704
    ds_read_b64_tr_b16 a[102:103], v8 offset:12800
    buffer_load_dwordx4 v2, s[16:19], s50 offen offset:0 lds
    v_lshlrev_b32 v98, 16, v25
    v_and_b32 v99, 0xffff0000, v25
    s_waitcnt lgkmcnt(10)
    v_mfma_f32_32x32x16_bf16 v[176:191], a[120:123], v[40:43], 0
    ds_read_b64_tr_b16 a[104:105], v9 offset:512
    ds_read_b64_tr_b16 a[106:107], v9 offset:4608
    buffer_load_dwordx4 v3, s[16:19], s50 offen offset:1024 lds
    v_lshlrev_b32 v100, 16, v26
    v_and_b32 v101, 0xffff0000, v26
    s_waitcnt lgkmcnt(8)
    v_mfma_f32_32x32x16_bf16 v[176:191], a[124:127], v[44:47], v[176:191]
    ds_read_b64_tr_b16 a[108:109], v9 offset:8704
    ds_read_b64_tr_b16 a[110:111], v9 offset:12800
    buffer_load_dwordx4 v4, s[16:19], s50 offen offset:2048 lds
    v_lshlrev_b32 v102, 16, v27
    s_waitcnt lgkmcnt(6)
    v_mfma_f32_32x32x16_bf16 v[192:207], a[96:99], v[40:43], 0
    ds_read_b64_tr_b16 a[112:113], v8 offset:768
    ds_read_b64_tr_b16 a[114:115], v8 offset:4864
    buffer_load_dwordx4 v5, s[16:19], s50 offen offset:3072 lds
    v_and_b32 v103, 0xffff0000, v27
    s_waitcnt lgkmcnt(6)
    v_mfma_f32_32x32x16_bf16 v[192:207], a[100:103], v[44:47], v[192:207]
    ds_read_b64_tr_b16 a[116:117], v8 offset:8960
    ds_read_b64_tr_b16 a[118:119], v8 offset:13056
    s_add_u32 m0, s48, 36864
    v_pk_fma_f32 v[96:97], v[96:97], v[64:65], v[72:73]
    v_pk_fma_f32 v[98:99], v[98:99], v[66:67], v[74:75]
    s_waitcnt lgkmcnt(6)
    v_mfma_f32_32x32x16_bf16 v[208:223], a[104:107], v[40:43], 0
    ds_read_b64_tr_b16 a[120:121], v9 offset:768
    ds_read_b64_tr_b16 a[122:123], v9 offset:4864
    s_add_u32 s50, s49, 851968
    v_pk_fma_f32 v[100:101], v[100:101], v[68:69], v[76:77]
    v_pk_fma_f32 v[102:103], v[102:103], v[70:71], v[78:79]
    s_waitcnt lgkmcnt(6)
    v_mfma_f32_32x32x16_bf16 v[208:223], a[108:111], v[44:47], v[208:223]
    ds_read_b64_tr_b16 a[124:125], v9 offset:8960
    ds_read_b64_tr_b16 a[126:127], v9 offset:13056
    buffer_load_dwordx4 v2, s[16:19], s50 offen offset:0 lds
    v_cvt_pk_bf16_f32 v24, v96, v97
    v_cvt_pk_bf16_f32 v25, v98, v99
    s_waitcnt lgkmcnt(6)
    v_mfma_f32_32x32x16_bf16 v[224:239], a[112:115], v[40:43], 0
    ds_read_b64_tr_b16 a[96:97], v8 offset:32768
    ds_read_b64_tr_b16 a[98:99], v8 offset:36864
    buffer_load_dwordx4 v3, s[16:19], s50 offen offset:1024 lds
    v_cvt_pk_bf16_f32 v26, v100, v101
    v_cvt_pk_bf16_f32 v27, v102, v103
    s_waitcnt lgkmcnt(6)
    v_mfma_f32_32x32x16_bf16 v[224:239], a[116:119], v[44:47], v[224:239]
    ds_read_b64_tr_b16 a[100:101], v8 offset:40960
    ds_read_b64_tr_b16 a[102:103], v8 offset:45056
    buffer_load_dwordx4 v4, s[16:19], s50 offen offset:2048 lds
    ds_write_b128 v15, v[24:27] offset:4096
    s_waitcnt lgkmcnt(7)
    v_mfma_f32_32x32x16_bf16 v[240:255], a[120:123], v[40:43], 0
    ds_read_b64_tr_b16 a[104:105], v9 offset:32768
    ds_read_b64_tr_b16 a[106:107], v9 offset:36864
    buffer_load_dwordx4 v5, s[16:19], s50 offen offset:3072 lds
    s_waitcnt lgkmcnt(7)
    v_mfma_f32_32x32x16_bf16 v[240:255], a[124:127], v[44:47], v[240:255]
    ds_read_b64_tr_b16 a[108:109], v9 offset:40960
    ds_read_b64_tr_b16 a[110:111], v9 offset:45056
    s_waitcnt lgkmcnt(7)
    v_mfma_f32_32x32x16_bf16 v[128:143], a[96:99], v[48:51], v[128:143]
    ds_read_b64_tr_b16 a[112:113], v8 offset:33024
    ds_read_b64_tr_b16 a[114:115], v8 offset:37120
    s_waitcnt vmcnt(9)
    s_waitcnt lgkmcnt(6)
    s_barrier
    v_mfma_f32_32x32x16_bf16 v[128:143], a[100:103], v[52:55], v[128:143]
    ds_read_b64_tr_b16 a[116:117], v8 offset:41216
    ds_read_b64_tr_b16 a[118:119], v8 offset:45312
    s_mov_b32 s50, 8192
    ds_read_b128 v[40:43], v10 offset:4096
    ds_read_b128 v[44:47], v10 offset:5120
    s_waitcnt lgkmcnt(8)
    v_mfma_f32_32x32x16_bf16 v[144:159], a[104:107], v[48:51], v[144:159]
    ds_read_b64_tr_b16 a[120:121], v9 offset:33024
    ds_read_b64_tr_b16 a[122:123], v9 offset:37120
    buffer_load_dwordx4 v[36:39], v14, s[20:23], s50 offen offset:2048
    ds_read_b128 v[80:83], v13 offset:2176
    ds_read_b128 v[84:87], v13 offset:2208
    s_waitcnt lgkmcnt(10)
    v_mfma_f32_32x32x16_bf16 v[144:159], a[108:111], v[52:55], v[144:159]
    ds_read_b64_tr_b16 a[124:125], v9 offset:41216
    ds_read_b64_tr_b16 a[126:127], v9 offset:45312
    s_add_u32 m0, s48, 65536
    ds_read_b128 v[88:91], v13 offset:384
    ds_read_b128 v[92:95], v13 offset:416
    s_waitcnt lgkmcnt(12)
    v_mfma_f32_32x32x16_bf16 v[160:175], a[112:115], v[48:51], v[160:175]
    ds_read_b64_tr_b16 a[96:97], v8 offset:33280
    ds_read_b64_tr_b16 a[98:99], v8 offset:37376
    s_add_u32 s50, s49, 1048576
    v_lshlrev_b32 v104, 16, v28
    v_and_b32 v105, 0xffff0000, v28
    s_waitcnt lgkmcnt(12)
    v_mfma_f32_32x32x16_bf16 v[160:175], a[116:119], v[52:55], v[160:175]
    ds_read_b64_tr_b16 a[100:101], v8 offset:41472
    ds_read_b64_tr_b16 a[102:103], v8 offset:45568
    buffer_load_dwordx4 v2, s[16:19], s50 offen offset:0 lds
    v_lshlrev_b32 v106, 16, v29
    v_and_b32 v107, 0xffff0000, v29
    s_waitcnt lgkmcnt(10)
    v_mfma_f32_32x32x16_bf16 v[176:191], a[120:123], v[48:51], v[176:191]
    ds_read_b64_tr_b16 a[104:105], v9 offset:33280
    ds_read_b64_tr_b16 a[106:107], v9 offset:37376
    buffer_load_dwordx4 v3, s[16:19], s50 offen offset:1024 lds
    v_lshlrev_b32 v108, 16, v30
    v_and_b32 v109, 0xffff0000, v30
    s_waitcnt lgkmcnt(8)
    v_mfma_f32_32x32x16_bf16 v[176:191], a[124:127], v[52:55], v[176:191]
    ds_read_b64_tr_b16 a[108:109], v9 offset:41472
    ds_read_b64_tr_b16 a[110:111], v9 offset:45568
    buffer_load_dwordx4 v4, s[16:19], s50 offen offset:2048 lds
    v_lshlrev_b32 v110, 16, v31
    s_waitcnt lgkmcnt(6)
    v_mfma_f32_32x32x16_bf16 v[192:207], a[96:99], v[48:51], v[192:207]
    ds_read_b64_tr_b16 a[112:113], v8 offset:33536
    ds_read_b64_tr_b16 a[114:115], v8 offset:37632
    buffer_load_dwordx4 v5, s[16:19], s50 offen offset:3072 lds
    v_and_b32 v111, 0xffff0000, v31
    s_waitcnt lgkmcnt(6)
    v_mfma_f32_32x32x16_bf16 v[192:207], a[100:103], v[52:55], v[192:207]
    ds_read_b64_tr_b16 a[116:117], v8 offset:41728
    ds_read_b64_tr_b16 a[118:119], v8 offset:45824
    s_add_u32 m0, s48, 69632
    v_pk_fma_f32 v[104:105], v[104:105], v[80:81], v[88:89]
    v_pk_fma_f32 v[106:107], v[106:107], v[82:83], v[90:91]
    s_waitcnt lgkmcnt(6)
    v_mfma_f32_32x32x16_bf16 v[208:223], a[104:107], v[48:51], v[208:223]
    ds_read_b64_tr_b16 a[120:121], v9 offset:33536
    ds_read_b64_tr_b16 a[122:123], v9 offset:37632
    s_add_u32 s50, s49, 1114112
    v_pk_fma_f32 v[108:109], v[108:109], v[84:85], v[92:93]
    v_pk_fma_f32 v[110:111], v[110:111], v[86:87], v[94:95]
    s_waitcnt lgkmcnt(6)
    v_mfma_f32_32x32x16_bf16 v[208:223], a[108:111], v[52:55], v[208:223]
    ds_read_b64_tr_b16 a[124:125], v9 offset:41728
    ds_read_b64_tr_b16 a[126:127], v9 offset:45824
    buffer_load_dwordx4 v2, s[16:19], s50 offen offset:0 lds
    v_cvt_pk_bf16_f32 v28, v104, v105
    v_cvt_pk_bf16_f32 v29, v106, v107
    s_waitcnt lgkmcnt(6)
    v_mfma_f32_32x32x16_bf16 v[224:239], a[112:115], v[48:51], v[224:239]
    ds_read_b64_tr_b16 a[96:97], v6 offset:0
    ds_read_b64_tr_b16 a[98:99], v6 offset:4096
    buffer_load_dwordx4 v3, s[16:19], s50 offen offset:1024 lds
    v_cvt_pk_bf16_f32 v30, v108, v109
    v_cvt_pk_bf16_f32 v31, v110, v111
    s_waitcnt lgkmcnt(6)
    v_mfma_f32_32x32x16_bf16 v[224:239], a[116:119], v[52:55], v[224:239]
    ds_read_b64_tr_b16 a[100:101], v6 offset:8192
    ds_read_b64_tr_b16 a[102:103], v6 offset:12288
    buffer_load_dwordx4 v4, s[16:19], s50 offen offset:2048 lds
    ds_write_b128 v15, v[28:31] offset:0
    s_waitcnt lgkmcnt(7)
    v_mfma_f32_32x32x16_bf16 v[240:255], a[120:123], v[48:51], v[240:255]
    ds_read_b64_tr_b16 a[104:105], v7 offset:0
    ds_read_b64_tr_b16 a[106:107], v7 offset:4096
    buffer_load_dwordx4 v5, s[16:19], s50 offen offset:3072 lds
    s_waitcnt lgkmcnt(7)
    v_mfma_f32_32x32x16_bf16 v[240:255], a[124:127], v[52:55], v[240:255]
    ds_read_b64_tr_b16 a[108:109], v7 offset:8192
    ds_read_b64_tr_b16 a[110:111], v7 offset:12288
    s_waitcnt lgkmcnt(7)
    v_mfma_f32_32x32x16_bf16 v[128:143], a[96:99], v[40:43], v[128:143]
    ds_read_b64_tr_b16 a[112:113], v6 offset:256
    ds_read_b64_tr_b16 a[114:115], v6 offset:4352
    s_waitcnt vmcnt(9)
    s_waitcnt lgkmcnt(6)
    s_barrier
    v_mfma_f32_32x32x16_bf16 v[128:143], a[100:103], v[44:47], v[128:143]
    ds_read_b64_tr_b16 a[116:117], v6 offset:8448
    ds_read_b64_tr_b16 a[118:119], v6 offset:12544
    s_mov_b32 s50, 12288
    ds_read_b128 v[48:51], v10 offset:0
    ds_read_b128 v[52:55], v10 offset:1024
    s_waitcnt lgkmcnt(8)
    v_mfma_f32_32x32x16_bf16 v[144:159], a[104:107], v[40:43], v[144:159]
    ds_read_b64_tr_b16 a[120:121], v7 offset:256
    ds_read_b64_tr_b16 a[122:123], v7 offset:4352
    buffer_load_dwordx4 v[16:19], v14, s[20:23], s50 offen offset:0
    ds_read_b128 v[64:67], v13 offset:2304
    ds_read_b128 v[68:71], v13 offset:2336
    s_waitcnt lgkmcnt(10)
    v_mfma_f32_32x32x16_bf16 v[144:159], a[108:111], v[44:47], v[144:159]
    ds_read_b64_tr_b16 a[124:125], v7 offset:8448
    ds_read_b64_tr_b16 a[126:127], v7 offset:12544
    s_add_u32 m0, s48, 98304
    ds_read_b128 v[72:75], v13 offset:512
    ds_read_b128 v[76:79], v13 offset:544
    s_waitcnt lgkmcnt(12)
    v_mfma_f32_32x32x16_bf16 v[160:175], a[112:115], v[40:43], v[160:175]
    ds_read_b64_tr_b16 a[96:97], v6 offset:512
    ds_read_b64_tr_b16 a[98:99], v6 offset:4608
    s_add_u32 s50, s49, 1310720
    v_lshlrev_b32 v96, 16, v32
    v_and_b32 v97, 0xffff0000, v32
    s_waitcnt lgkmcnt(12)
    v_mfma_f32_32x32x16_bf16 v[160:175], a[116:119], v[44:47], v[160:175]
    ds_read_b64_tr_b16 a[100:101], v6 offset:8704
    ds_read_b64_tr_b16 a[102:103], v6 offset:12800
    buffer_load_dwordx4 v2, s[16:19], s50 offen offset:0 lds
    v_lshlrev_b32 v98, 16, v33
    v_and_b32 v99, 0xffff0000, v33
    s_waitcnt lgkmcnt(10)
    v_mfma_f32_32x32x16_bf16 v[176:191], a[120:123], v[40:43], v[176:191]
    ds_read_b64_tr_b16 a[104:105], v7 offset:512
    ds_read_b64_tr_b16 a[106:107], v7 offset:4608
    buffer_load_dwordx4 v3, s[16:19], s50 offen offset:1024 lds
    v_lshlrev_b32 v100, 16, v34
    v_and_b32 v101, 0xffff0000, v34
    s_waitcnt lgkmcnt(8)
    v_mfma_f32_32x32x16_bf16 v[176:191], a[124:127], v[44:47], v[176:191]
    ds_read_b64_tr_b16 a[108:109], v7 offset:8704
    ds_read_b64_tr_b16 a[110:111], v7 offset:12800
    buffer_load_dwordx4 v4, s[16:19], s50 offen offset:2048 lds
    v_lshlrev_b32 v102, 16, v35
    s_waitcnt lgkmcnt(6)
    v_mfma_f32_32x32x16_bf16 v[192:207], a[96:99], v[40:43], v[192:207]
    ds_read_b64_tr_b16 a[112:113], v6 offset:768
    ds_read_b64_tr_b16 a[114:115], v6 offset:4864
    buffer_load_dwordx4 v5, s[16:19], s50 offen offset:3072 lds
    v_and_b32 v103, 0xffff0000, v35
    s_waitcnt lgkmcnt(6)
    v_mfma_f32_32x32x16_bf16 v[192:207], a[100:103], v[44:47], v[192:207]
    ds_read_b64_tr_b16 a[116:117], v6 offset:8960
    ds_read_b64_tr_b16 a[118:119], v6 offset:13056
    s_add_u32 m0, s48, 102400
    v_pk_fma_f32 v[96:97], v[96:97], v[64:65], v[72:73]
    v_pk_fma_f32 v[98:99], v[98:99], v[66:67], v[74:75]
    s_waitcnt lgkmcnt(6)
    v_mfma_f32_32x32x16_bf16 v[208:223], a[104:107], v[40:43], v[208:223]
    ds_read_b64_tr_b16 a[120:121], v7 offset:768
    ds_read_b64_tr_b16 a[122:123], v7 offset:4864
    s_add_u32 s50, s49, 1376256
    v_pk_fma_f32 v[100:101], v[100:101], v[68:69], v[76:77]
    v_pk_fma_f32 v[102:103], v[102:103], v[70:71], v[78:79]
    s_waitcnt lgkmcnt(6)
    v_mfma_f32_32x32x16_bf16 v[208:223], a[108:111], v[44:47], v[208:223]
    ds_read_b64_tr_b16 a[124:125], v7 offset:8960
    ds_read_b64_tr_b16 a[126:127], v7 offset:13056
    buffer_load_dwordx4 v2, s[16:19], s50 offen offset:0 lds
    v_cvt_pk_bf16_f32 v32, v96, v97
    v_cvt_pk_bf16_f32 v33, v98, v99
    s_waitcnt lgkmcnt(6)
    v_mfma_f32_32x32x16_bf16 v[224:239], a[112:115], v[40:43], v[224:239]
    ds_read_b64_tr_b16 a[96:97], v6 offset:32768
    ds_read_b64_tr_b16 a[98:99], v6 offset:36864
    buffer_load_dwordx4 v3, s[16:19], s50 offen offset:1024 lds
    v_cvt_pk_bf16_f32 v34, v100, v101
    v_cvt_pk_bf16_f32 v35, v102, v103
    s_waitcnt lgkmcnt(6)
    v_mfma_f32_32x32x16_bf16 v[224:239], a[116:119], v[44:47], v[224:239]
    ds_read_b64_tr_b16 a[100:101], v6 offset:40960
    ds_read_b64_tr_b16 a[102:103], v6 offset:45056
    buffer_load_dwordx4 v4, s[16:19], s50 offen offset:2048 lds
    ds_write_b128 v15, v[32:35] offset:2048
    s_waitcnt lgkmcnt(7)
    v_mfma_f32_32x32x16_bf16 v[240:255], a[120:123], v[40:43], v[240:255]
    ds_read_b64_tr_b16 a[104:105], v7 offset:32768
    ds_read_b64_tr_b16 a[106:107], v7 offset:36864
    buffer_load_dwordx4 v5, s[16:19], s50 offen offset:3072 lds
    s_waitcnt lgkmcnt(7)
    v_mfma_f32_32x32x16_bf16 v[240:255], a[124:127], v[44:47], v[240:255]
    ds_read_b64_tr_b16 a[108:109], v7 offset:40960
    ds_read_b64_tr_b16 a[110:111], v7 offset:45056
    s_waitcnt lgkmcnt(7)
    v_mfma_f32_32x32x16_bf16 v[128:143], a[96:99], v[48:51], v[128:143]
    ds_read_b64_tr_b16 a[112:113], v6 offset:33024
    ds_read_b64_tr_b16 a[114:115], v6 offset:37120
    s_waitcnt vmcnt(9)
    s_waitcnt lgkmcnt(6)
    s_barrier
    v_mfma_f32_32x32x16_bf16 v[128:143], a[100:103], v[52:55], v[128:143]
    ds_read_b64_tr_b16 a[116:117], v6 offset:41216
    ds_read_b64_tr_b16 a[118:119], v6 offset:45312
    s_mov_b32 s50, 12288
    ds_read_b128 v[40:43], v10 offset:2048
    ds_read_b128 v[44:47], v10 offset:3072
    s_waitcnt lgkmcnt(8)
    v_mfma_f32_32x32x16_bf16 v[144:159], a[104:107], v[48:51], v[144:159]
    ds_read_b64_tr_b16 a[120:121], v7 offset:33024
    ds_read_b64_tr_b16 a[122:123], v7 offset:37120
    buffer_load_dwordx4 v[20:23], v14, s[20:23], s50 offen offset:2048
    ds_read_b128 v[80:83], v13 offset:2432
    ds_read_b128 v[84:87], v13 offset:2464
    s_waitcnt lgkmcnt(10)
    v_mfma_f32_32x32x16_bf16 v[144:159], a[108:111], v[52:55], v[144:159]
    ds_read_b64_tr_b16 a[124:125], v7 offset:41216
    ds_read_b64_tr_b16 a[126:127], v7 offset:45312
    s_add_u32 m0, s48, 0
    ds_read_b128 v[88:91], v13 offset:640
    ds_read_b128 v[92:95], v13 offset:672
    s_waitcnt lgkmcnt(12)
    v_mfma_f32_32x32x16_bf16 v[160:175], a[112:115], v[48:51], v[160:175]
    ds_read_b64_tr_b16 a[96:97], v6 offset:33280
    ds_read_b64_tr_b16 a[98:99], v6 offset:37376
    s_add_u32 s50, s49, 1572864
    v_lshlrev_b32 v104, 16, v36
    v_and_b32 v105, 0xffff0000, v36
    s_waitcnt lgkmcnt(12)
    v_mfma_f32_32x32x16_bf16 v[160:175], a[116:119], v[52:55], v[160:175]
    ds_read_b64_tr_b16 a[100:101], v6 offset:41472
    ds_read_b64_tr_b16 a[102:103], v6 offset:45568
    buffer_load_dwordx4 v2, s[16:19], s50 offen offset:0 lds
    v_lshlrev_b32 v106, 16, v37
    v_and_b32 v107, 0xffff0000, v37
    s_waitcnt lgkmcnt(10)
    v_mfma_f32_32x32x16_bf16 v[176:191], a[120:123], v[48:51], v[176:191]
    ds_read_b64_tr_b16 a[104:105], v7 offset:33280
    ds_read_b64_tr_b16 a[106:107], v7 offset:37376
    buffer_load_dwordx4 v3, s[16:19], s50 offen offset:1024 lds
    v_lshlrev_b32 v108, 16, v38
    v_and_b32 v109, 0xffff0000, v38
    s_waitcnt lgkmcnt(8)
    v_mfma_f32_32x32x16_bf16 v[176:191], a[124:127], v[52:55], v[176:191]
    ds_read_b64_tr_b16 a[108:109], v7 offset:41472
    ds_read_b64_tr_b16 a[110:111], v7 offset:45568
    buffer_load_dwordx4 v4, s[16:19], s50 offen offset:2048 lds
    v_lshlrev_b32 v110, 16, v39
    s_waitcnt lgkmcnt(6)
    v_mfma_f32_32x32x16_bf16 v[192:207], a[96:99], v[48:51], v[192:207]
    ds_read_b64_tr_b16 a[112:113], v6 offset:33536
    ds_read_b64_tr_b16 a[114:115], v6 offset:37632
    buffer_load_dwordx4 v5, s[16:19], s50 offen offset:3072 lds
    v_and_b32 v111, 0xffff0000, v39
    s_waitcnt lgkmcnt(6)
    v_mfma_f32_32x32x16_bf16 v[192:207], a[100:103], v[52:55], v[192:207]
    ds_read_b64_tr_b16 a[116:117], v6 offset:41728
    ds_read_b64_tr_b16 a[118:119], v6 offset:45824
    s_add_u32 m0, s48, 4096
    v_pk_fma_f32 v[104:105], v[104:105], v[80:81], v[88:89]
    v_pk_fma_f32 v[106:107], v[106:107], v[82:83], v[90:91]
    s_waitcnt lgkmcnt(6)
    v_mfma_f32_32x32x16_bf16 v[208:223], a[104:107], v[48:51], v[208:223]
    ds_read_b64_tr_b16 a[120:121], v7 offset:33536
    ds_read_b64_tr_b16 a[122:123], v7 offset:37632
    s_add_u32 s50, s49, 1638400
    v_pk_fma_f32 v[108:109], v[108:109], v[84:85], v[92:93]
    v_pk_fma_f32 v[110:111], v[110:111], v[86:87], v[94:95]
    s_waitcnt lgkmcnt(6)
    v_mfma_f32_32x32x16_bf16 v[208:223], a[108:111], v[52:55], v[208:223]
    ds_read_b64_tr_b16 a[124:125], v7 offset:41728
    ds_read_b64_tr_b16 a[126:127], v7 offset:45824
    buffer_load_dwordx4 v2, s[16:19], s50 offen offset:0 lds
    v_cvt_pk_bf16_f32 v36, v104, v105
    v_cvt_pk_bf16_f32 v37, v106, v107
    s_waitcnt lgkmcnt(6)
    v_mfma_f32_32x32x16_bf16 v[224:239], a[112:115], v[48:51], v[224:239]
    ds_read_b64_tr_b16 a[96:97], v8 offset:0
    ds_read_b64_tr_b16 a[98:99], v8 offset:4096
    buffer_load_dwordx4 v3, s[16:19], s50 offen offset:1024 lds
    v_cvt_pk_bf16_f32 v38, v108, v109
    v_cvt_pk_bf16_f32 v39, v110, v111
    s_waitcnt lgkmcnt(6)
    v_mfma_f32_32x32x16_bf16 v[224:239], a[116:119], v[52:55], v[224:239]
    ds_read_b64_tr_b16 a[100:101], v8 offset:8192
    ds_read_b64_tr_b16 a[102:103], v8 offset:12288
    buffer_load_dwordx4 v4, s[16:19], s50 offen offset:2048 lds
    ds_write_b128 v15, v[36:39] offset:4096
    s_waitcnt lgkmcnt(7)
    v_mfma_f32_32x32x16_bf16 v[240:255], a[120:123], v[48:51], v[240:255]
    ds_read_b64_tr_b16 a[104:105], v9 offset:0
    ds_read_b64_tr_b16 a[106:107], v9 offset:4096
    buffer_load_dwordx4 v5, s[16:19], s50 offen offset:3072 lds
    s_waitcnt lgkmcnt(7)
    v_mfma_f32_32x32x16_bf16 v[240:255], a[124:127], v[52:55], v[240:255]
    ds_read_b64_tr_b16 a[108:109], v9 offset:8192
    ds_read_b64_tr_b16 a[110:111], v9 offset:12288
    s_waitcnt lgkmcnt(7)
    v_mfma_f32_32x32x16_bf16 v[128:143], a[96:99], v[40:43], v[128:143]
    ds_read_b64_tr_b16 a[112:113], v8 offset:256
    ds_read_b64_tr_b16 a[114:115], v8 offset:4352
    s_waitcnt vmcnt(9)
    s_waitcnt lgkmcnt(6)
    s_barrier
    v_mfma_f32_32x32x16_bf16 v[128:143], a[100:103], v[44:47], v[128:143]
    ds_read_b64_tr_b16 a[116:117], v8 offset:8448
    ds_read_b64_tr_b16 a[118:119], v8 offset:12544
    s_mov_b32 s50, 16384
    ds_read_b128 v[48:51], v10 offset:4096
    ds_read_b128 v[52:55], v10 offset:5120
    s_waitcnt lgkmcnt(8)
    v_mfma_f32_32x32x16_bf16 v[144:159], a[104:107], v[40:43], v[144:159]
    ds_read_b64_tr_b16 a[120:121], v9 offset:256
    ds_read_b64_tr_b16 a[122:123], v9 offset:4352
    buffer_load_dwordx4 v[24:27], v14, s[20:23], s50 offen offset:0
    ds_read_b128 v[64:67], v13 offset:2560
    ds_read_b128 v[68:71], v13 offset:2592
    s_waitcnt lgkmcnt(10)
    v_mfma_f32_32x32x16_bf16 v[144:159], a[108:111], v[44:47], v[144:159]
    ds_read_b64_tr_b16 a[124:125], v9 offset:8448
    ds_read_b64_tr_b16 a[126:127], v9 offset:12544
    s_add_u32 m0, s48, 32768
    ds_read_b128 v[72:75], v13 offset:768
    ds_read_b128 v[76:79], v13 offset:800
    s_waitcnt lgkmcnt(12)
    v_mfma_f32_32x32x16_bf16 v[160:175], a[112:115], v[40:43], v[160:175]
    ds_read_b64_tr_b16 a[96:97], v8 offset:512
    ds_read_b64_tr_b16 a[98:99], v8 offset:4608
    s_add_u32 s50, s49, 1835008
    v_lshlrev_b32 v96, 16, v16
    v_and_b32 v97, 0xffff0000, v16
    s_waitcnt lgkmcnt(12)
    v_mfma_f32_32x32x16_bf16 v[160:175], a[116:119], v[44:47], v[160:175]
    ds_read_b64_tr_b16 a[100:101], v8 offset:8704
    ds_read_b64_tr_b16 a[102:103], v8 offset:12800
    buffer_load_dwordx4 v2, s[16:19], s50 offen offset:0 lds
    v_lshlrev_b32 v98, 16, v17
    v_and_b32 v99, 0xffff0000, v17
    s_waitcnt lgkmcnt(10)
    v_mfma_f32_32x32x16_bf16 v[176:191], a[120:123], v[40:43], v[176:191]
    ds_read_b64_tr_b16 a[104:105], v9 offset:512
    ds_read_b64_tr_b16 a[106:107], v9 offset:4608
    buffer_load_dwordx4 v3, s[16:19], s50 offen offset:1024 lds
    v_lshlrev_b32 v100, 16, v18
    v_and_b32 v101, 0xffff0000, v18
    s_waitcnt lgkmcnt(8)
    v_mfma_f32_32x32x16_bf16 v[176:191], a[124:127], v[44:47], v[176:191]
    ds_read_b64_tr_b16 a[108:109], v9 offset:8704
    ds_read_b64_tr_b16 a[110:111], v9 offset:12800
    buffer_load_dwordx4 v4, s[16:19], s50 offen offset:2048 lds
    v_lshlrev_b32 v102, 16, v19
    s_waitcnt lgkmcnt(6)
    v_mfma_f32_32x32x16_bf16 v[192:207], a[96:99], v[40:43], v[192:207]
    ds_read_b64_tr_b16 a[112:113], v8 offset:768
    ds_read_b64_tr_b16 a[114:115], v8 offset:4864
    buffer_load_dwordx4 v5, s[16:19], s50 offen offset:3072 lds
    v_and_b32 v103, 0xffff0000, v19
    s_waitcnt lgkmcnt(6)
    v_mfma_f32_32x32x16_bf16 v[192:207], a[100:103], v[44:47], v[192:207]
    ds_read_b64_tr_b16 a[116:117], v8 offset:8960
    ds_read_b64_tr_b16 a[118:119], v8 offset:13056
    s_add_u32 m0, s48, 36864
    v_pk_fma_f32 v[96:97], v[96:97], v[64:65], v[72:73]
    v_pk_fma_f32 v[98:99], v[98:99], v[66:67], v[74:75]
    s_waitcnt lgkmcnt(6)
    v_mfma_f32_32x32x16_bf16 v[208:223], a[104:107], v[40:43], v[208:223]
    ds_read_b64_tr_b16 a[120:121], v9 offset:768
    ds_read_b64_tr_b16 a[122:123], v9 offset:4864
    s_add_u32 s50, s49, 1900544
    v_pk_fma_f32 v[100:101], v[100:101], v[68:69], v[76:77]
    v_pk_fma_f32 v[102:103], v[102:103], v[70:71], v[78:79]
    s_waitcnt lgkmcnt(6)
    v_mfma_f32_32x32x16_bf16 v[208:223], a[108:111], v[44:47], v[208:223]
    ds_read_b64_tr_b16 a[124:125], v9 offset:8960
    ds_read_b64_tr_b16 a[126:127], v9 offset:13056
    buffer_load_dwordx4 v2, s[16:19], s50 offen offset:0 lds
    v_cvt_pk_bf16_f32 v16, v96, v97
    v_cvt_pk_bf16_f32 v17, v98, v99
    s_waitcnt lgkmcnt(6)
    v_mfma_f32_32x32x16_bf16 v[224:239], a[112:115], v[40:43], v[224:239]
    ds_read_b64_tr_b16 a[96:97], v8 offset:32768
    ds_read_b64_tr_b16 a[98:99], v8 offset:36864
    buffer_load_dwordx4 v3, s[16:19], s50 offen offset:1024 lds
    v_cvt_pk_bf16_f32 v18, v100, v101
    v_cvt_pk_bf16_f32 v19, v102, v103
    s_waitcnt lgkmcnt(6)
    v_mfma_f32_32x32x16_bf16 v[224:239], a[116:119], v[44:47], v[224:239]
    ds_read_b64_tr_b16 a[100:101], v8 offset:40960
    ds_read_b64_tr_b16 a[102:103], v8 offset:45056
    buffer_load_dwordx4 v4, s[16:19], s50 offen offset:2048 lds
    ds_write_b128 v15, v[16:19] offset:0
    s_waitcnt lgkmcnt(7)
    v_mfma_f32_32x32x16_bf16 v[240:255], a[120:123], v[40:43], v[240:255]
    ds_read_b64_tr_b16 a[104:105], v9 offset:32768
    ds_read_b64_tr_b16 a[106:107], v9 offset:36864
    buffer_load_dwordx4 v5, s[16:19], s50 offen offset:3072 lds
    s_waitcnt lgkmcnt(7)
    v_mfma_f32_32x32x16_bf16 v[240:255], a[124:127], v[44:47], v[240:255]
    ds_read_b64_tr_b16 a[108:109], v9 offset:40960
    ds_read_b64_tr_b16 a[110:111], v9 offset:45056
    s_waitcnt lgkmcnt(7)
    v_mfma_f32_32x32x16_bf16 v[128:143], a[96:99], v[48:51], v[128:143]
    ds_read_b64_tr_b16 a[112:113], v8 offset:33024
    ds_read_b64_tr_b16 a[114:115], v8 offset:37120
    s_waitcnt vmcnt(9)
    s_waitcnt lgkmcnt(6)
    s_barrier
    v_mfma_f32_32x32x16_bf16 v[128:143], a[100:103], v[52:55], v[128:143]
    ds_read_b64_tr_b16 a[116:117], v8 offset:41216
    ds_read_b64_tr_b16 a[118:119], v8 offset:45312
    s_mov_b32 s50, 16384
    ds_read_b128 v[40:43], v10 offset:0
    ds_read_b128 v[44:47], v10 offset:1024
    s_waitcnt lgkmcnt(8)
    v_mfma_f32_32x32x16_bf16 v[144:159], a[104:107], v[48:51], v[144:159]
    ds_read_b64_tr_b16 a[120:121], v9 offset:33024
    ds_read_b64_tr_b16 a[122:123], v9 offset:37120
    buffer_load_dwordx4 v[28:31], v14, s[20:23], s50 offen offset:2048
    ds_read_b128 v[80:83], v13 offset:2688
    ds_read_b128 v[84:87], v13 offset:2720
    s_waitcnt lgkmcnt(10)
    v_mfma_f32_32x32x16_bf16 v[144:159], a[108:111], v[52:55], v[144:159]
    ds_read_b64_tr_b16 a[124:125], v9 offset:41216
    ds_read_b64_tr_b16 a[126:127], v9 offset:45312
    s_add_u32 m0, s48, 65536
    ds_read_b128 v[88:91], v13 offset:896
    ds_read_b128 v[92:95], v13 offset:928
    s_waitcnt lgkmcnt(12)
    v_mfma_f32_32x32x16_bf16 v[160:175], a[112:115], v[48:51], v[160:175]
    ds_read_b64_tr_b16 a[96:97], v8 offset:33280
    ds_read_b64_tr_b16 a[98:99], v8 offset:37376
    s_add_u32 s50, s49, 2097152
    v_lshlrev_b32 v104, 16, v20
    v_and_b32 v105, 0xffff0000, v20
    s_waitcnt lgkmcnt(12)
    v_mfma_f32_32x32x16_bf16 v[160:175], a[116:119], v[52:55], v[160:175]
    ds_read_b64_tr_b16 a[100:101], v8 offset:41472
    ds_read_b64_tr_b16 a[102:103], v8 offset:45568
    buffer_load_dwordx4 v2, s[16:19], s50 offen offset:0 lds
    v_lshlrev_b32 v106, 16, v21
    v_and_b32 v107, 0xffff0000, v21
    s_waitcnt lgkmcnt(10)
    v_mfma_f32_32x32x16_bf16 v[176:191], a[120:123], v[48:51], v[176:191]
    ds_read_b64_tr_b16 a[104:105], v9 offset:33280
    ds_read_b64_tr_b16 a[106:107], v9 offset:37376
    buffer_load_dwordx4 v3, s[16:19], s50 offen offset:1024 lds
    v_lshlrev_b32 v108, 16, v22
    v_and_b32 v109, 0xffff0000, v22
    s_waitcnt lgkmcnt(8)
    v_mfma_f32_32x32x16_bf16 v[176:191], a[124:127], v[52:55], v[176:191]
    ds_read_b64_tr_b16 a[108:109], v9 offset:41472
    ds_read_b64_tr_b16 a[110:111], v9 offset:45568
    buffer_load_dwordx4 v4, s[16:19], s50 offen offset:2048 lds
    v_lshlrev_b32 v110, 16, v23
    s_waitcnt lgkmcnt(6)
    v_mfma_f32_32x32x16_bf16 v[192:207], a[96:99], v[48:51], v[192:207]
    ds_read_b64_tr_b16 a[112:113], v8 offset:33536
    ds_read_b64_tr_b16 a[114:115], v8 offset:37632
    buffer_load_dwordx4 v5, s[16:19], s50 offen offset:3072 lds
    v_and_b32 v111, 0xffff0000, v23
    s_waitcnt lgkmcnt(6)
    v_mfma_f32_32x32x16_bf16 v[192:207], a[100:103], v[52:55], v[192:207]
    ds_read_b64_tr_b16 a[116:117], v8 offset:41728
    ds_read_b64_tr_b16 a[118:119], v8 offset:45824
    s_add_u32 m0, s48, 69632
    v_pk_fma_f32 v[104:105], v[104:105], v[80:81], v[88:89]
    v_pk_fma_f32 v[106:107], v[106:107], v[82:83], v[90:91]
    s_waitcnt lgkmcnt(6)
    v_mfma_f32_32x32x16_bf16 v[208:223], a[104:107], v[48:51], v[208:223]
    ds_read_b64_tr_b16 a[120:121], v9 offset:33536
    ds_read_b64_tr_b16 a[122:123], v9 offset:37632
    s_add_u32 s50, s49, 2162688
    v_pk_fma_f32 v[108:109], v[108:109], v[84:85], v[92:93]
    v_pk_fma_f32 v[110:111], v[110:111], v[86:87], v[94:95]
    s_waitcnt lgkmcnt(6)
    v_mfma_f32_32x32x16_bf16 v[208:223], a[108:111], v[52:55], v[208:223]
    ds_read_b64_tr_b16 a[124:125], v9 offset:41728
    ds_read_b64_tr_b16 a[126:127], v9 offset:45824
    buffer_load_dwordx4 v2, s[16:19], s50 offen offset:0 lds
    v_cvt_pk_bf16_f32 v20, v104, v105
    v_cvt_pk_bf16_f32 v21, v106, v107
    s_waitcnt lgkmcnt(6)
    v_mfma_f32_32x32x16_bf16 v[224:239], a[112:115], v[48:51], v[224:239]
    ds_read_b64_tr_b16 a[96:97], v6 offset:0
    ds_read_b64_tr_b16 a[98:99], v6 offset:4096
    buffer_load_dwordx4 v3, s[16:19], s50 offen offset:1024 lds
    v_cvt_pk_bf16_f32 v22, v108, v109
    v_cvt_pk_bf16_f32 v23, v110, v111
    s_waitcnt lgkmcnt(6)
    v_mfma_f32_32x32x16_bf16 v[224:239], a[116:119], v[52:55], v[224:239]
    ds_read_b64_tr_b16 a[100:101], v6 offset:8192
    ds_read_b64_tr_b16 a[102:103], v6 offset:12288
    buffer_load_dwordx4 v4, s[16:19], s50 offen offset:2048 lds
    ds_write_b128 v15, v[20:23] offset:2048
    s_waitcnt lgkmcnt(7)
    v_mfma_f32_32x32x16_bf16 v[240:255], a[120:123], v[48:51], v[240:255]
    ds_read_b64_tr_b16 a[104:105], v7 offset:0
    ds_read_b64_tr_b16 a[106:107], v7 offset:4096
    buffer_load_dwordx4 v5, s[16:19], s50 offen offset:3072 lds
    s_waitcnt lgkmcnt(7)
    v_mfma_f32_32x32x16_bf16 v[240:255], a[124:127], v[52:55], v[240:255]
    ds_read_b64_tr_b16 a[108:109], v7 offset:8192
    ds_read_b64_tr_b16 a[110:111], v7 offset:12288
    s_waitcnt lgkmcnt(7)
    v_mfma_f32_32x32x16_bf16 v[128:143], a[96:99], v[40:43], v[128:143]
    ds_read_b64_tr_b16 a[112:113], v6 offset:256
    ds_read_b64_tr_b16 a[114:115], v6 offset:4352
    s_waitcnt vmcnt(9)
    s_waitcnt lgkmcnt(6)
    s_barrier
    v_mfma_f32_32x32x16_bf16 v[128:143], a[100:103], v[44:47], v[128:143]
    ds_read_b64_tr_b16 a[116:117], v6 offset:8448
    ds_read_b64_tr_b16 a[118:119], v6 offset:12544
    s_mov_b32 s50, 20480
    ds_read_b128 v[48:51], v10 offset:2048
    ds_read_b128 v[52:55], v10 offset:3072
    s_waitcnt lgkmcnt(8)
    v_mfma_f32_32x32x16_bf16 v[144:159], a[104:107], v[40:43], v[144:159]
    ds_read_b64_tr_b16 a[120:121], v7 offset:256
    ds_read_b64_tr_b16 a[122:123], v7 offset:4352
    buffer_load_dwordx4 v[32:35], v14, s[20:23], s50 offen offset:0
    ds_read_b128 v[64:67], v13 offset:2816
    ds_read_b128 v[68:71], v13 offset:2848
    s_waitcnt lgkmcnt(10)
    v_mfma_f32_32x32x16_bf16 v[144:159], a[108:111], v[44:47], v[144:159]
    ds_read_b64_tr_b16 a[124:125], v7 offset:8448
    ds_read_b64_tr_b16 a[126:127], v7 offset:12544
    s_add_u32 m0, s48, 98304
    ds_read_b128 v[72:75], v13 offset:1024
    ds_read_b128 v[76:79], v13 offset:1056
    s_waitcnt lgkmcnt(12)
    v_mfma_f32_32x32x16_bf16 v[160:175], a[112:115], v[40:43], v[160:175]
    ds_read_b64_tr_b16 a[96:97], v6 offset:512
    ds_read_b64_tr_b16 a[98:99], v6 offset:4608
    s_add_u32 s50, s49, 2359296
    v_lshlrev_b32 v96, 16, v24
    v_and_b32 v97, 0xffff0000, v24
    s_waitcnt lgkmcnt(12)
    v_mfma_f32_32x32x16_bf16 v[160:175], a[116:119], v[44:47], v[160:175]
    ds_read_b64_tr_b16 a[100:101], v6 offset:8704
    ds_read_b64_tr_b16 a[102:103], v6 offset:12800
    buffer_load_dwordx4 v2, s[16:19], s50 offen offset:0 lds
    v_lshlrev_b32 v98, 16, v25
    v_and_b32 v99, 0xffff0000, v25
    s_waitcnt lgkmcnt(10)
    v_mfma_f32_32x32x16_bf16 v[176:191], a[120:123], v[40:43], v[176:191]
    ds_read_b64_tr_b16 a[104:105], v7 offset:512
    ds_read_b64_tr_b16 a[106:107], v7 offset:4608
    buffer_load_dwordx4 v3, s[16:19], s50 offen offset:1024 lds
    v_lshlrev_b32 v100, 16, v26
    v_and_b32 v101, 0xffff0000, v26
    s_waitcnt lgkmcnt(8)
    v_mfma_f32_32x32x16_bf16 v[176:191], a[124:127], v[44:47], v[176:191]
    ds_read_b64_tr_b16 a[108:109], v7 offset:8704
    ds_read_b64_tr_b16 a[110:111], v7 offset:12800
    buffer_load_dwordx4 v4, s[16:19], s50 offen offset:2048 lds
    v_lshlrev_b32 v102, 16, v27
    s_waitcnt lgkmcnt(6)
    v_mfma_f32_32x32x16_bf16 v[192:207], a[96:99], v[40:43], v[192:207]
    ds_read_b64_tr_b16 a[112:113], v6 offset:768
    ds_read_b64_tr_b16 a[114:115], v6 offset:4864
    buffer_load_dwordx4 v5, s[16:19], s50 offen offset:3072 lds
    v_and_b32 v103, 0xffff0000, v27
    s_waitcnt lgkmcnt(6)
    v_mfma_f32_32x32x16_bf16 v[192:207], a[100:103], v[44:47], v[192:207]
    ds_read_b64_tr_b16 a[116:117], v6 offset:8960
    ds_read_b64_tr_b16 a[118:119], v6 offset:13056
    s_add_u32 m0, s48, 102400
    v_pk_fma_f32 v[96:97], v[96:97], v[64:65], v[72:73]
    v_pk_fma_f32 v[98:99], v[98:99], v[66:67], v[74:75]
    s_waitcnt lgkmcnt(6)
    v_mfma_f32_32x32x16_bf16 v[208:223], a[104:107], v[40:43], v[208:223]
    ds_read_b64_tr_b16 a[120:121], v7 offset:768
    ds_read_b64_tr_b16 a[122:123], v7 offset:4864
    s_add_u32 s50, s49, 2424832
    v_pk_fma_f32 v[100:101], v[100:101], v[68:69], v[76:77]
    v_pk_fma_f32 v[102:103], v[102:103], v[70:71], v[78:79]
    s_waitcnt lgkmcnt(6)
    v_mfma_f32_32x32x16_bf16 v[208:223], a[108:111], v[44:47], v[208:223]
    ds_read_b64_tr_b16 a[124:125], v7 offset:8960
    ds_read_b64_tr_b16 a[126:127], v7 offset:13056
    buffer_load_dwordx4 v2, s[16:19], s50 offen offset:0 lds
    v_cvt_pk_bf16_f32 v24, v96, v97
    v_cvt_pk_bf16_f32 v25, v98, v99
    s_waitcnt lgkmcnt(6)
    v_mfma_f32_32x32x16_bf16 v[224:239], a[112:115], v[40:43], v[224:239]
    ds_read_b64_tr_b16 a[96:97], v6 offset:32768
    ds_read_b64_tr_b16 a[98:99], v6 offset:36864
    buffer_load_dwordx4 v3, s[16:19], s50 offen offset:1024 lds
    v_cvt_pk_bf16_f32 v26, v100, v101
    v_cvt_pk_bf16_f32 v27, v102, v103
    s_waitcnt lgkmcnt(6)
    v_mfma_f32_32x32x16_bf16 v[224:239], a[116:119], v[44:47], v[224:239]
    ds_read_b64_tr_b16 a[100:101], v6 offset:40960
    ds_read_b64_tr_b16 a[102:103], v6 offset:45056
    buffer_load_dwordx4 v4, s[16:19], s50 offen offset:2048 lds
    ds_write_b128 v15, v[24:27] offset:4096
    s_waitcnt lgkmcnt(7)
    v_mfma_f32_32x32x16_bf16 v[240:255], a[120:123], v[40:43], v[240:255]
    ds_read_b64_tr_b16 a[104:105], v7 offset:32768
    ds_read_b64_tr_b16 a[106:107], v7 offset:36864
    buffer_load_dwordx4 v5, s[16:19], s50 offen offset:3072 lds
    s_waitcnt lgkmcnt(7)
    v_mfma_f32_32x32x16_bf16 v[240:255], a[124:127], v[44:47], v[240:255]
    ds_read_b64_tr_b16 a[108:109], v7 offset:40960
    ds_read_b64_tr_b16 a[110:111], v7 offset:45056
    s_waitcnt lgkmcnt(7)
    v_mfma_f32_32x32x16_bf16 v[128:143], a[96:99], v[48:51], v[128:143]
    ds_read_b64_tr_b16 a[112:113], v6 offset:33024
    ds_read_b64_tr_b16 a[114:115], v6 offset:37120
    s_waitcnt vmcnt(9)
    s_waitcnt lgkmcnt(6)
    s_barrier
    v_mfma_f32_32x32x16_bf16 v[128:143], a[100:103], v[52:55], v[128:143]
    ds_read_b64_tr_b16 a[116:117], v6 offset:41216
    ds_read_b64_tr_b16 a[118:119], v6 offset:45312
    s_mov_b32 s50, 20480
    ds_read_b128 v[40:43], v10 offset:4096
    ds_read_b128 v[44:47], v10 offset:5120
    s_waitcnt lgkmcnt(8)
    v_mfma_f32_32x32x16_bf16 v[144:159], a[104:107], v[48:51], v[144:159]
    ds_read_b64_tr_b16 a[120:121], v7 offset:33024
    ds_read_b64_tr_b16 a[122:123], v7 offset:37120
    buffer_load_dwordx4 v[36:39], v14, s[20:23], s50 offen offset:2048
    ds_read_b128 v[80:83], v13 offset:2944
    ds_read_b128 v[84:87], v13 offset:2976
    s_waitcnt lgkmcnt(10)
    v_mfma_f32_32x32x16_bf16 v[144:159], a[108:111], v[52:55], v[144:159]
    ds_read_b64_tr_b16 a[124:125], v7 offset:41216
    ds_read_b64_tr_b16 a[126:127], v7 offset:45312
    s_add_u32 m0, s48, 0
    ds_read_b128 v[88:91], v13 offset:1152
    ds_read_b128 v[92:95], v13 offset:1184
    s_waitcnt lgkmcnt(12)
    v_mfma_f32_32x32x16_bf16 v[160:175], a[112:115], v[48:51], v[160:175]
    ds_read_b64_tr_b16 a[96:97], v6 offset:33280
    ds_read_b64_tr_b16 a[98:99], v6 offset:37376
    s_add_u32 s50, s49, 2621440
    v_lshlrev_b32 v104, 16, v28
    v_and_b32 v105, 0xffff0000, v28
    s_waitcnt lgkmcnt(12)
    v_mfma_f32_32x32x16_bf16 v[160:175], a[116:119], v[52:55], v[160:175]
    ds_read_b64_tr_b16 a[100:101], v6 offset:41472
    ds_read_b64_tr_b16 a[102:103], v6 offset:45568
    buffer_load_dwordx4 v2, s[16:19], s50 offen offset:0 lds
    v_lshlrev_b32 v106, 16, v29
    v_and_b32 v107, 0xffff0000, v29
    s_waitcnt lgkmcnt(10)
    v_mfma_f32_32x32x16_bf16 v[176:191], a[120:123], v[48:51], v[176:191]
    ds_read_b64_tr_b16 a[104:105], v7 offset:33280
    ds_read_b64_tr_b16 a[106:107], v7 offset:37376
    buffer_load_dwordx4 v3, s[16:19], s50 offen offset:1024 lds
    v_lshlrev_b32 v108, 16, v30
    v_and_b32 v109, 0xffff0000, v30
    s_waitcnt lgkmcnt(8)
    v_mfma_f32_32x32x16_bf16 v[176:191], a[124:127], v[52:55], v[176:191]
    ds_read_b64_tr_b16 a[108:109], v7 offset:41472
    ds_read_b64_tr_b16 a[110:111], v7 offset:45568
    buffer_load_dwordx4 v4, s[16:19], s50 offen offset:2048 lds
    v_lshlrev_b32 v110, 16, v31
    s_waitcnt lgkmcnt(6)
    v_mfma_f32_32x32x16_bf16 v[192:207], a[96:99], v[48:51], v[192:207]
    ds_read_b64_tr_b16 a[112:113], v6 offset:33536
    ds_read_b64_tr_b16 a[114:115], v6 offset:37632
    buffer_load_dwordx4 v5, s[16:19], s50 offen offset:3072 lds
    v_and_b32 v111, 0xffff0000, v31
    s_waitcnt lgkmcnt(6)
    v_mfma_f32_32x32x16_bf16 v[192:207], a[100:103], v[52:55], v[192:207]
    ds_read_b64_tr_b16 a[116:117], v6 offset:41728
    ds_read_b64_tr_b16 a[118:119], v6 offset:45824
    s_add_u32 m0, s48, 4096
    v_pk_fma_f32 v[104:105], v[104:105], v[80:81], v[88:89]
    v_pk_fma_f32 v[106:107], v[106:107], v[82:83], v[90:91]
    s_waitcnt lgkmcnt(6)
    v_mfma_f32_32x32x16_bf16 v[208:223], a[104:107], v[48:51], v[208:223]
    ds_read_b64_tr_b16 a[120:121], v7 offset:33536
    ds_read_b64_tr_b16 a[122:123], v7 offset:37632
    s_add_u32 s50, s49, 2686976
    v_pk_fma_f32 v[108:109], v[108:109], v[84:85], v[92:93]
    v_pk_fma_f32 v[110:111], v[110:111], v[86:87], v[94:95]
    s_waitcnt lgkmcnt(6)
    v_mfma_f32_32x32x16_bf16 v[208:223], a[108:111], v[52:55], v[208:223]
    ds_read_b64_tr_b16 a[124:125], v7 offset:41728
    ds_read_b64_tr_b16 a[126:127], v7 offset:45824
    buffer_load_dwordx4 v2, s[16:19], s50 offen offset:0 lds
    v_cvt_pk_bf16_f32 v28, v104, v105
    v_cvt_pk_bf16_f32 v29, v106, v107
    s_waitcnt lgkmcnt(6)
    v_mfma_f32_32x32x16_bf16 v[224:239], a[112:115], v[48:51], v[224:239]
    ds_read_b64_tr_b16 a[96:97], v8 offset:0
    ds_read_b64_tr_b16 a[98:99], v8 offset:4096
    buffer_load_dwordx4 v3, s[16:19], s50 offen offset:1024 lds
    v_cvt_pk_bf16_f32 v30, v108, v109
    v_cvt_pk_bf16_f32 v31, v110, v111
    s_waitcnt lgkmcnt(6)
    v_mfma_f32_32x32x16_bf16 v[224:239], a[116:119], v[52:55], v[224:239]
    ds_read_b64_tr_b16 a[100:101], v8 offset:8192
    ds_read_b64_tr_b16 a[102:103], v8 offset:12288
    buffer_load_dwordx4 v4, s[16:19], s50 offen offset:2048 lds
    ds_write_b128 v15, v[28:31] offset:0
    s_waitcnt lgkmcnt(7)
    v_mfma_f32_32x32x16_bf16 v[240:255], a[120:123], v[48:51], v[240:255]
    ds_read_b64_tr_b16 a[104:105], v9 offset:0
    ds_read_b64_tr_b16 a[106:107], v9 offset:4096
    buffer_load_dwordx4 v5, s[16:19], s50 offen offset:3072 lds
    s_waitcnt lgkmcnt(7)
    v_mfma_f32_32x32x16_bf16 v[240:255], a[124:127], v[52:55], v[240:255]
    ds_read_b64_tr_b16 a[108:109], v9 offset:8192
    ds_read_b64_tr_b16 a[110:111], v9 offset:12288
    s_waitcnt lgkmcnt(7)
    v_mfma_f32_32x32x16_bf16 v[128:143], a[96:99], v[40:43], v[128:143]
    ds_read_b64_tr_b16 a[112:113], v8 offset:256
    ds_read_b64_tr_b16 a[114:115], v8 offset:4352
    s_waitcnt vmcnt(9)
    s_waitcnt lgkmcnt(6)
    s_barrier
    v_mfma_f32_32x32x16_bf16 v[128:143], a[100:103], v[44:47], v[128:143]
    ds_read_b64_tr_b16 a[116:117], v8 offset:8448
    ds_read_b64_tr_b16 a[118:119], v8 offset:12544
    s_mov_b32 s50, 24576
    ds_read_b128 v[48:51], v10 offset:0
    ds_read_b128 v[52:55], v10 offset:1024
    s_waitcnt lgkmcnt(8)
    v_mfma_f32_32x32x16_bf16 v[144:159], a[104:107], v[40:43], v[144:159]
    ds_read_b64_tr_b16 a[120:121], v9 offset:256
    ds_read_b64_tr_b16 a[122:123], v9 offset:4352
    buffer_load_dwordx4 v[16:19], v14, s[20:23], s50 offen offset:0
    ds_read_b128 v[64:67], v13 offset:3072
    ds_read_b128 v[68:71], v13 offset:3104
    s_waitcnt lgkmcnt(10)
    v_mfma_f32_32x32x16_bf16 v[144:159], a[108:111], v[44:47], v[144:159]
    ds_read_b64_tr_b16 a[124:125], v9 offset:8448
    ds_read_b64_tr_b16 a[126:127], v9 offset:12544
    s_add_u32 m0, s48, 32768
    ds_read_b128 v[72:75], v13 offset:1280
    ds_read_b128 v[76:79], v13 offset:1312
    s_waitcnt lgkmcnt(12)
    v_mfma_f32_32x32x16_bf16 v[160:175], a[112:115], v[40:43], v[160:175]
    ds_read_b64_tr_b16 a[96:97], v8 offset:512
    ds_read_b64_tr_b16 a[98:99], v8 offset:4608
    s_add_u32 s50, s49, 2883584
    v_lshlrev_b32 v96, 16, v32
    v_and_b32 v97, 0xffff0000, v32
    s_waitcnt lgkmcnt(12)
    v_mfma_f32_32x32x16_bf16 v[160:175], a[116:119], v[44:47], v[160:175]
    ds_read_b64_tr_b16 a[100:101], v8 offset:8704
    ds_read_b64_tr_b16 a[102:103], v8 offset:12800
    buffer_load_dwordx4 v2, s[16:19], s50 offen offset:0 lds
    v_lshlrev_b32 v98, 16, v33
    v_and_b32 v99, 0xffff0000, v33
    s_waitcnt lgkmcnt(10)
    v_mfma_f32_32x32x16_bf16 v[176:191], a[120:123], v[40:43], v[176:191]
    ds_read_b64_tr_b16 a[104:105], v9 offset:512
    ds_read_b64_tr_b16 a[106:107], v9 offset:4608
    buffer_load_dwordx4 v3, s[16:19], s50 offen offset:1024 lds
    v_lshlrev_b32 v100, 16, v34
    v_and_b32 v101, 0xffff0000, v34
    s_waitcnt lgkmcnt(8)
    v_mfma_f32_32x32x16_bf16 v[176:191], a[124:127], v[44:47], v[176:191]
    ds_read_b64_tr_b16 a[108:109], v9 offset:8704
    ds_read_b64_tr_b16 a[110:111], v9 offset:12800
    buffer_load_dwordx4 v4, s[16:19], s50 offen offset:2048 lds
    v_lshlrev_b32 v102, 16, v35
    s_waitcnt lgkmcnt(6)
    v_mfma_f32_32x32x16_bf16 v[192:207], a[96:99], v[40:43], v[192:207]
    ds_read_b64_tr_b16 a[112:113], v8 offset:768
    ds_read_b64_tr_b16 a[114:115], v8 offset:4864
    buffer_load_dwordx4 v5, s[16:19], s50 offen offset:3072 lds
    v_and_b32 v103, 0xffff0000, v35
    s_waitcnt lgkmcnt(6)
    v_mfma_f32_32x32x16_bf16 v[192:207], a[100:103], v[44:47], v[192:207]
    ds_read_b64_tr_b16 a[116:117], v8 offset:8960
    ds_read_b64_tr_b16 a[118:119], v8 offset:13056
    s_add_u32 m0, s48, 36864
    v_pk_fma_f32 v[96:97], v[96:97], v[64:65], v[72:73]
    v_pk_fma_f32 v[98:99], v[98:99], v[66:67], v[74:75]
    s_waitcnt lgkmcnt(6)
    v_mfma_f32_32x32x16_bf16 v[208:223], a[104:107], v[40:43], v[208:223]
    ds_read_b64_tr_b16 a[120:121], v9 offset:768
    ds_read_b64_tr_b16 a[122:123], v9 offset:4864
    s_add_u32 s50, s49, 2949120
    v_pk_fma_f32 v[100:101], v[100:101], v[68:69], v[76:77]
    v_pk_fma_f32 v[102:103], v[102:103], v[70:71], v[78:79]
    s_waitcnt lgkmcnt(6)
    v_mfma_f32_32x32x16_bf16 v[208:223], a[108:111], v[44:47], v[208:223]
    ds_read_b64_tr_b16 a[124:125], v9 offset:8960
    ds_read_b64_tr_b16 a[126:127], v9 offset:13056
    buffer_load_dwordx4 v2, s[16:19], s50 offen offset:0 lds
    v_cvt_pk_bf16_f32 v32, v96, v97
    v_cvt_pk_bf16_f32 v33, v98, v99
    s_waitcnt lgkmcnt(6)
    v_mfma_f32_32x32x16_bf16 v[224:239], a[112:115], v[40:43], v[224:239]
    ds_read_b64_tr_b16 a[96:97], v8 offset:32768
    ds_read_b64_tr_b16 a[98:99], v8 offset:36864
    buffer_load_dwordx4 v3, s[16:19], s50 offen offset:1024 lds
    v_cvt_pk_bf16_f32 v34, v100, v101
    v_cvt_pk_bf16_f32 v35, v102, v103
    s_waitcnt lgkmcnt(6)
    v_mfma_f32_32x32x16_bf16 v[224:239], a[116:119], v[44:47], v[224:239]
    ds_read_b64_tr_b16 a[100:101], v8 offset:40960
    ds_read_b64_tr_b16 a[102:103], v8 offset:45056
    buffer_load_dwordx4 v4, s[16:19], s50 offen offset:2048 lds
    ds_write_b128 v15, v[32:35] offset:2048
    s_waitcnt lgkmcnt(7)
    v_mfma_f32_32x32x16_bf16 v[240:255], a[120:123], v[40:43], v[240:255]
    ds_read_b64_tr_b16 a[104:105], v9 offset:32768
    ds_read_b64_tr_b16 a[106:107], v9 offset:36864
    buffer_load_dwordx4 v5, s[16:19], s50 offen offset:3072 lds
    s_waitcnt lgkmcnt(7)
    v_mfma_f32_32x32x16_bf16 v[240:255], a[124:127], v[44:47], v[240:255]
    ds_read_b64_tr_b16 a[108:109], v9 offset:40960
    ds_read_b64_tr_b16 a[110:111], v9 offset:45056
    s_waitcnt lgkmcnt(7)
    v_mfma_f32_32x32x16_bf16 v[128:143], a[96:99], v[48:51], v[128:143]
    ds_read_b64_tr_b16 a[112:113], v8 offset:33024
    ds_read_b64_tr_b16 a[114:115], v8 offset:37120
    s_waitcnt vmcnt(9)
    s_waitcnt lgkmcnt(6)
    s_barrier
    v_mfma_f32_32x32x16_bf16 v[128:143], a[100:103], v[52:55], v[128:143]
    ds_read_b64_tr_b16 a[116:117], v8 offset:41216
    ds_read_b64_tr_b16 a[118:119], v8 offset:45312
    s_mov_b32 s50, 24576
    ds_read_b128 v[40:43], v10 offset:2048
    ds_read_b128 v[44:47], v10 offset:3072
    s_waitcnt lgkmcnt(8)
    v_mfma_f32_32x32x16_bf16 v[144:159], a[104:107], v[48:51], v[144:159]
    ds_read_b64_tr_b16 a[120:121], v9 offset:33024
    ds_read_b64_tr_b16 a[122:123], v9 offset:37120
    buffer_load_dwordx4 v[20:23], v14, s[20:23], s50 offen offset:2048
    ds_read_b128 v[80:83], v13 offset:3200
    ds_read_b128 v[84:87], v13 offset:3232
    s_waitcnt lgkmcnt(10)
    v_mfma_f32_32x32x16_bf16 v[144:159], a[108:111], v[52:55], v[144:159]
    ds_read_b64_tr_b16 a[124:125], v9 offset:41216
    ds_read_b64_tr_b16 a[126:127], v9 offset:45312
    s_add_u32 m0, s48, 65536
    ds_read_b128 v[88:91], v13 offset:1408
    ds_read_b128 v[92:95], v13 offset:1440
    s_waitcnt lgkmcnt(12)
    v_mfma_f32_32x32x16_bf16 v[160:175], a[112:115], v[48:51], v[160:175]
    ds_read_b64_tr_b16 a[96:97], v8 offset:33280
    ds_read_b64_tr_b16 a[98:99], v8 offset:37376
    s_add_u32 s50, s49, 3145728
    v_lshlrev_b32 v104, 16, v36
    v_and_b32 v105, 0xffff0000, v36
    s_waitcnt lgkmcnt(12)
    v_mfma_f32_32x32x16_bf16 v[160:175], a[116:119], v[52:55], v[160:175]
    ds_read_b64_tr_b16 a[100:101], v8 offset:41472
    ds_read_b64_tr_b16 a[102:103], v8 offset:45568
    buffer_load_dwordx4 v2, s[16:19], s50 offen offset:0 lds
    v_lshlrev_b32 v106, 16, v37
    v_and_b32 v107, 0xffff0000, v37
    s_waitcnt lgkmcnt(10)
    v_mfma_f32_32x32x16_bf16 v[176:191], a[120:123], v[48:51], v[176:191]
    ds_read_b64_tr_b16 a[104:105], v9 offset:33280
    ds_read_b64_tr_b16 a[106:107], v9 offset:37376
    buffer_load_dwordx4 v3, s[16:19], s50 offen offset:1024 lds
    v_lshlrev_b32 v108, 16, v38
    v_and_b32 v109, 0xffff0000, v38
    s_waitcnt lgkmcnt(8)
    v_mfma_f32_32x32x16_bf16 v[176:191], a[124:127], v[52:55], v[176:191]
    ds_read_b64_tr_b16 a[108:109], v9 offset:41472
    ds_read_b64_tr_b16 a[110:111], v9 offset:45568
    buffer_load_dwordx4 v4, s[16:19], s50 offen offset:2048 lds
    v_lshlrev_b32 v110, 16, v39
    s_waitcnt lgkmcnt(6)
    v_mfma_f32_32x32x16_bf16 v[192:207], a[96:99], v[48:51], v[192:207]
    ds_read_b64_tr_b16 a[112:113], v8 offset:33536
    ds_read_b64_tr_b16 a[114:115], v8 offset:37632
    buffer_load_dwordx4 v5, s[16:19], s50 offen offset:3072 lds
    v_and_b32 v111, 0xffff0000, v39
    s_waitcnt lgkmcnt(6)
    v_mfma_f32_32x32x16_bf16 v[192:207], a[100:103], v[52:55], v[192:207]
    ds_read_b64_tr_b16 a[116:117], v8 offset:41728
    ds_read_b64_tr_b16 a[118:119], v8 offset:45824
    s_add_u32 m0, s48, 69632
    v_pk_fma_f32 v[104:105], v[104:105], v[80:81], v[88:89]
    v_pk_fma_f32 v[106:107], v[106:107], v[82:83], v[90:91]
    s_waitcnt lgkmcnt(6)
    v_mfma_f32_32x32x16_bf16 v[208:223], a[104:107], v[48:51], v[208:223]
    ds_read_b64_tr_b16 a[120:121], v9 offset:33536
    ds_read_b64_tr_b16 a[122:123], v9 offset:37632
    s_add_u32 s50, s49, 3211264
    v_pk_fma_f32 v[108:109], v[108:109], v[84:85], v[92:93]
    v_pk_fma_f32 v[110:111], v[110:111], v[86:87], v[94:95]
    s_waitcnt lgkmcnt(6)
    v_mfma_f32_32x32x16_bf16 v[208:223], a[108:111], v[52:55], v[208:223]
    ds_read_b64_tr_b16 a[124:125], v9 offset:41728
    ds_read_b64_tr_b16 a[126:127], v9 offset:45824
    buffer_load_dwordx4 v2, s[16:19], s50 offen offset:0 lds
    v_cvt_pk_bf16_f32 v36, v104, v105
    v_cvt_pk_bf16_f32 v37, v106, v107
    s_waitcnt lgkmcnt(6)
    v_mfma_f32_32x32x16_bf16 v[224:239], a[112:115], v[48:51], v[224:239]
    ds_read_b64_tr_b16 a[96:97], v6 offset:0
    ds_read_b64_tr_b16 a[98:99], v6 offset:4096
    buffer_load_dwordx4 v3, s[16:19], s50 offen offset:1024 lds
    v_cvt_pk_bf16_f32 v38, v108, v109
    v_cvt_pk_bf16_f32 v39, v110, v111
    s_waitcnt lgkmcnt(6)
    v_mfma_f32_32x32x16_bf16 v[224:239], a[116:119], v[52:55], v[224:239]
    ds_read_b64_tr_b16 a[100:101], v6 offset:8192
    ds_read_b64_tr_b16 a[102:103], v6 offset:12288
    buffer_load_dwordx4 v4, s[16:19], s50 offen offset:2048 lds
    ds_write_b128 v15, v[36:39] offset:4096
    s_waitcnt lgkmcnt(7)
    v_mfma_f32_32x32x16_bf16 v[240:255], a[120:123], v[48:51], v[240:255]
    ds_read_b64_tr_b16 a[104:105], v7 offset:0
    ds_read_b64_tr_b16 a[106:107], v7 offset:4096
    buffer_load_dwordx4 v5, s[16:19], s50 offen offset:3072 lds
    s_waitcnt lgkmcnt(7)
    v_mfma_f32_32x32x16_bf16 v[240:255], a[124:127], v[52:55], v[240:255]
    ds_read_b64_tr_b16 a[108:109], v7 offset:8192
    ds_read_b64_tr_b16 a[110:111], v7 offset:12288
    s_waitcnt lgkmcnt(7)
    v_mfma_f32_32x32x16_bf16 v[128:143], a[96:99], v[40:43], v[128:143]
    ds_read_b64_tr_b16 a[112:113], v6 offset:256
    ds_read_b64_tr_b16 a[114:115], v6 offset:4352
    s_waitcnt vmcnt(9)
    s_waitcnt lgkmcnt(6)
    s_barrier
    v_mfma_f32_32x32x16_bf16 v[128:143], a[100:103], v[44:47], v[128:143]
    ds_read_b64_tr_b16 a[116:117], v6 offset:8448
    ds_read_b64_tr_b16 a[118:119], v6 offset:12544
    s_add_u32 m0, s48, 98304
    ds_read_b128 v[48:51], v10 offset:4096
    ds_read_b128 v[52:55], v10 offset:5120
    s_waitcnt lgkmcnt(8)
    v_mfma_f32_32x32x16_bf16 v[144:159], a[104:107], v[40:43], v[144:159]
    ds_read_b64_tr_b16 a[120:121], v7 offset:256
    ds_read_b64_tr_b16 a[122:123], v7 offset:4352
    s_add_u32 s50, s49, 3407872
    ds_read_b128 v[64:67], v13 offset:3328
    ds_read_b128 v[68:71], v13 offset:3360
    s_waitcnt lgkmcnt(10)
    v_mfma_f32_32x32x16_bf16 v[144:159], a[108:111], v[44:47], v[144:159]
    ds_read_b64_tr_b16 a[124:125], v7 offset:8448
    ds_read_b64_tr_b16 a[126:127], v7 offset:12544
    buffer_load_dwordx4 v2, s[16:19], s50 offen offset:0 lds
    ds_read_b128 v[72:75], v13 offset:1536
    ds_read_b128 v[76:79], v13 offset:1568
    s_waitcnt lgkmcnt(12)
    v_mfma_f32_32x32x16_bf16 v[160:175], a[112:115], v[40:43], v[160:175]
    ds_read_b64_tr_b16 a[96:97], v6 offset:512
    ds_read_b64_tr_b16 a[98:99], v6 offset:4608
    buffer_load_dwordx4 v3, s[16:19], s50 offen offset:1024 lds
    v_lshlrev_b32 v96, 16, v16
    v_and_b32 v97, 0xffff0000, v16
    s_waitcnt lgkmcnt(12)
    v_mfma_f32_32x32x16_bf16 v[160:175], a[116:119], v[44:47], v[160:175]
    ds_read_b64_tr_b16 a[100:101], v6 offset:8704
    ds_read_b64_tr_b16 a[102:103], v6 offset:12800
    buffer_load_dwordx4 v4, s[16:19], s50 offen offset:2048 lds
    v_lshlrev_b32 v98, 16, v17
    v_and_b32 v99, 0xffff0000, v17
    s_waitcnt lgkmcnt(10)
    v_mfma_f32_32x32x16_bf16 v[176:191], a[120:123], v[40:43], v[176:191]
    ds_read_b64_tr_b16 a[104:105], v7 offset:512
    ds_read_b64_tr_b16 a[106:107], v7 offset:4608
    buffer_load_dwordx4 v5, s[16:19], s50 offen offset:3072 lds
    v_lshlrev_b32 v100, 16, v18
    v_and_b32 v101, 0xffff0000, v18
    s_waitcnt lgkmcnt(8)
    v_mfma_f32_32x32x16_bf16 v[176:191], a[124:127], v[44:47], v[176:191]
    ds_read_b64_tr_b16 a[108:109], v7 offset:8704
    ds_read_b64_tr_b16 a[110:111], v7 offset:12800
    v_lshlrev_b32 v102, 16, v19
    s_waitcnt lgkmcnt(6)
    v_mfma_f32_32x32x16_bf16 v[192:207], a[96:99], v[40:43], v[192:207]
    ds_read_b64_tr_b16 a[112:113], v6 offset:768
    ds_read_b64_tr_b16 a[114:115], v6 offset:4864
    s_add_u32 m0, s48, 102400
    v_and_b32 v103, 0xffff0000, v19
    s_waitcnt lgkmcnt(6)
    v_mfma_f32_32x32x16_bf16 v[192:207], a[100:103], v[44:47], v[192:207]
    ds_read_b64_tr_b16 a[116:117], v6 offset:8960
    ds_read_b64_tr_b16 a[118:119], v6 offset:13056
    s_add_u32 s50, s49, 3473408
    v_pk_fma_f32 v[96:97], v[96:97], v[64:65], v[72:73]
    v_pk_fma_f32 v[98:99], v[98:99], v[66:67], v[74:75]
    s_waitcnt lgkmcnt(6)
    v_mfma_f32_32x32x16_bf16 v[208:223], a[104:107], v[40:43], v[208:223]
    ds_read_b64_tr_b16 a[120:121], v7 offset:768
    ds_read_b64_tr_b16 a[122:123], v7 offset:4864
    buffer_load_dwordx4 v2, s[16:19], s50 offen offset:0 lds
    v_pk_fma_f32 v[100:101], v[100:101], v[68:69], v[76:77]
    v_pk_fma_f32 v[102:103], v[102:103], v[70:71], v[78:79]
    s_waitcnt lgkmcnt(6)
    v_mfma_f32_32x32x16_bf16 v[208:223], a[108:111], v[44:47], v[208:223]
    ds_read_b64_tr_b16 a[124:125], v7 offset:8960
    ds_read_b64_tr_b16 a[126:127], v7 offset:13056
    buffer_load_dwordx4 v3, s[16:19], s50 offen offset:1024 lds
    v_cvt_pk_bf16_f32 v16, v96, v97
    v_cvt_pk_bf16_f32 v17, v98, v99
    s_waitcnt lgkmcnt(6)
    v_mfma_f32_32x32x16_bf16 v[224:239], a[112:115], v[40:43], v[224:239]
    ds_read_b64_tr_b16 a[96:97], v6 offset:32768
    ds_read_b64_tr_b16 a[98:99], v6 offset:36864
    buffer_load_dwordx4 v4, s[16:19], s50 offen offset:2048 lds
    v_cvt_pk_bf16_f32 v18, v100, v101
    v_cvt_pk_bf16_f32 v19, v102, v103
    s_waitcnt lgkmcnt(6)
    v_mfma_f32_32x32x16_bf16 v[224:239], a[116:119], v[44:47], v[224:239]
    ds_read_b64_tr_b16 a[100:101], v6 offset:40960
    ds_read_b64_tr_b16 a[102:103], v6 offset:45056
    buffer_load_dwordx4 v5, s[16:19], s50 offen offset:3072 lds
    ds_write_b128 v15, v[16:19] offset:0
    s_waitcnt lgkmcnt(7)
    v_mfma_f32_32x32x16_bf16 v[240:255], a[120:123], v[40:43], v[240:255]
    ds_read_b64_tr_b16 a[104:105], v7 offset:32768
    ds_read_b64_tr_b16 a[106:107], v7 offset:36864
    s_waitcnt lgkmcnt(7)
    v_mfma_f32_32x32x16_bf16 v[240:255], a[124:127], v[44:47], v[240:255]
    ds_read_b64_tr_b16 a[108:109], v7 offset:40960
    ds_read_b64_tr_b16 a[110:111], v7 offset:45056
    s_waitcnt lgkmcnt(7)
    v_mfma_f32_32x32x16_bf16 v[128:143], a[96:99], v[48:51], v[128:143]
    ds_read_b64_tr_b16 a[112:113], v6 offset:33024
    ds_read_b64_tr_b16 a[114:115], v6 offset:37120
    s_waitcnt vmcnt(8)
    s_waitcnt lgkmcnt(6)
    s_barrier
    v_mfma_f32_32x32x16_bf16 v[128:143], a[100:103], v[52:55], v[128:143]
    ds_read_b64_tr_b16 a[116:117], v6 offset:41216
    ds_read_b64_tr_b16 a[118:119], v6 offset:45312
    ds_read_b128 v[40:43], v10 offset:0
    ds_read_b128 v[44:47], v10 offset:1024
    s_waitcnt lgkmcnt(8)
    v_mfma_f32_32x32x16_bf16 v[144:159], a[104:107], v[48:51], v[144:159]
    ds_read_b64_tr_b16 a[120:121], v7 offset:33024
    ds_read_b64_tr_b16 a[122:123], v7 offset:37120
    ds_read_b128 v[80:83], v13 offset:3456
    ds_read_b128 v[84:87], v13 offset:3488
    s_waitcnt lgkmcnt(10)
    v_mfma_f32_32x32x16_bf16 v[144:159], a[108:111], v[52:55], v[144:159]
    ds_read_b64_tr_b16 a[124:125], v7 offset:41216
    ds_read_b64_tr_b16 a[126:127], v7 offset:45312
    ds_read_b128 v[88:91], v13 offset:1664
    ds_read_b128 v[92:95], v13 offset:1696
    s_waitcnt lgkmcnt(12)
    v_mfma_f32_32x32x16_bf16 v[160:175], a[112:115], v[48:51], v[160:175]
    ds_read_b64_tr_b16 a[96:97], v6 offset:33280
    ds_read_b64_tr_b16 a[98:99], v6 offset:37376
    v_lshlrev_b32 v104, 16, v20
    v_and_b32 v105, 0xffff0000, v20
    s_waitcnt lgkmcnt(12)
    v_mfma_f32_32x32x16_bf16 v[160:175], a[116:119], v[52:55], v[160:175]
    ds_read_b64_tr_b16 a[100:101], v6 offset:41472
    ds_read_b64_tr_b16 a[102:103], v6 offset:45568
    v_lshlrev_b32 v106, 16, v21
    v_and_b32 v107, 0xffff0000, v21
    s_waitcnt lgkmcnt(10)
    v_mfma_f32_32x32x16_bf16 v[176:191], a[120:123], v[48:51], v[176:191]
    ds_read_b64_tr_b16 a[104:105], v7 offset:33280
    ds_read_b64_tr_b16 a[106:107], v7 offset:37376
    v_lshlrev_b32 v108, 16, v22
    v_and_b32 v109, 0xffff0000, v22
    s_waitcnt lgkmcnt(8)
    v_mfma_f32_32x32x16_bf16 v[176:191], a[124:127], v[52:55], v[176:191]
    ds_read_b64_tr_b16 a[108:109], v7 offset:41472
    ds_read_b64_tr_b16 a[110:111], v7 offset:45568
    v_lshlrev_b32 v110, 16, v23
    s_waitcnt lgkmcnt(6)
    v_mfma_f32_32x32x16_bf16 v[192:207], a[96:99], v[48:51], v[192:207]
    ds_read_b64_tr_b16 a[112:113], v6 offset:33536
    ds_read_b64_tr_b16 a[114:115], v6 offset:37632
    v_and_b32 v111, 0xffff0000, v23
    s_waitcnt lgkmcnt(6)
    v_mfma_f32_32x32x16_bf16 v[192:207], a[100:103], v[52:55], v[192:207]
    ds_read_b64_tr_b16 a[116:117], v6 offset:41728
    ds_read_b64_tr_b16 a[118:119], v6 offset:45824
    v_pk_fma_f32 v[104:105], v[104:105], v[80:81], v[88:89]
    v_pk_fma_f32 v[106:107], v[106:107], v[82:83], v[90:91]
    s_waitcnt lgkmcnt(6)
    v_mfma_f32_32x32x16_bf16 v[208:223], a[104:107], v[48:51], v[208:223]
    ds_read_b64_tr_b16 a[120:121], v7 offset:33536
    ds_read_b64_tr_b16 a[122:123], v7 offset:37632
    v_pk_fma_f32 v[108:109], v[108:109], v[84:85], v[92:93]
    v_pk_fma_f32 v[110:111], v[110:111], v[86:87], v[94:95]
    s_waitcnt lgkmcnt(6)
    v_mfma_f32_32x32x16_bf16 v[208:223], a[108:111], v[52:55], v[208:223]
    ds_read_b64_tr_b16 a[124:125], v7 offset:41728
    ds_read_b64_tr_b16 a[126:127], v7 offset:45824
    v_cvt_pk_bf16_f32 v20, v104, v105
    v_cvt_pk_bf16_f32 v21, v106, v107
    s_waitcnt lgkmcnt(6)
    v_mfma_f32_32x32x16_bf16 v[224:239], a[112:115], v[48:51], v[224:239]
    ds_read_b64_tr_b16 a[96:97], v8 offset:0
    ds_read_b64_tr_b16 a[98:99], v8 offset:4096
    v_cvt_pk_bf16_f32 v22, v108, v109
    v_cvt_pk_bf16_f32 v23, v110, v111
    s_waitcnt lgkmcnt(6)
    v_mfma_f32_32x32x16_bf16 v[224:239], a[116:119], v[52:55], v[224:239]
    ds_read_b64_tr_b16 a[100:101], v8 offset:8192
    ds_read_b64_tr_b16 a[102:103], v8 offset:12288
    ds_write_b128 v15, v[20:23] offset:2048
    s_waitcnt lgkmcnt(7)
    v_mfma_f32_32x32x16_bf16 v[240:255], a[120:123], v[48:51], v[240:255]
    ds_read_b64_tr_b16 a[104:105], v9 offset:0
    ds_read_b64_tr_b16 a[106:107], v9 offset:4096
    s_waitcnt lgkmcnt(7)
    v_mfma_f32_32x32x16_bf16 v[240:255], a[124:127], v[52:55], v[240:255]
    ds_read_b64_tr_b16 a[108:109], v9 offset:8192
    ds_read_b64_tr_b16 a[110:111], v9 offset:12288
    s_waitcnt lgkmcnt(7)
    v_mfma_f32_32x32x16_bf16 v[128:143], a[96:99], v[40:43], v[128:143]
    ds_read_b64_tr_b16 a[112:113], v8 offset:256
    ds_read_b64_tr_b16 a[114:115], v8 offset:4352
    s_waitcnt vmcnt(0)
    s_waitcnt lgkmcnt(6)
    s_barrier
    v_mfma_f32_32x32x16_bf16 v[128:143], a[100:103], v[44:47], v[128:143]
    ds_read_b64_tr_b16 a[116:117], v8 offset:8448
    ds_read_b64_tr_b16 a[118:119], v8 offset:12544
    s_add_u32 m0, s30, 0
    s_mov_b32 s50, 0
    ds_read_b128 v[48:51], v10 offset:2048
    s_waitcnt lgkmcnt(7)
    v_mfma_f32_32x32x16_bf16 v[144:159], a[104:107], v[40:43], v[144:159]
    ds_read_b64_tr_b16 a[120:121], v9 offset:256
    ds_read_b64_tr_b16 a[122:123], v9 offset:4352
    buffer_load_dwordx4 v112, s[8:11], s50 offen offset:0 lds
    s_waitcnt lgkmcnt(7)
    v_mfma_f32_32x32x16_bf16 v[144:159], a[108:111], v[44:47], v[144:159]
    ds_read_b64_tr_b16 a[124:125], v9 offset:8448
    ds_read_b64_tr_b16 a[126:127], v9 offset:12544
    buffer_load_dwordx4 v113, s[8:11], s50 offen offset:1056 lds
    s_waitcnt lgkmcnt(7)
    v_mfma_f32_32x32x16_bf16 v[160:175], a[112:115], v[40:43], v[160:175]
    ds_read_b64_tr_b16 a[96:97], v8 offset:512
    ds_read_b64_tr_b16 a[98:99], v8 offset:4608
    buffer_load_dwordx4 v114, s[8:11], s50 offen offset:2112 lds
    buffer_load_dwordx4 v115, s[8:11], s50 offen offset:3168 lds
    s_waitcnt lgkmcnt(7)
    v_mfma_f32_32x32x16_bf16 v[160:175], a[116:119], v[44:47], v[160:175]
    ds_read_b64_tr_b16 a[100:101], v8 offset:8704
    ds_read_b64_tr_b16 a[102:103], v8 offset:12800
    s_add_u32 m0, s30, 16896
    s_waitcnt lgkmcnt(6)
    v_mfma_f32_32x32x16_bf16 v[176:191], a[120:123], v[40:43], v[176:191]
    ds_read_b64_tr_b16 a[104:105], v9 offset:512
    ds_read_b64_tr_b16 a[106:107], v9 offset:4608
    s_mov_b32 s50, 16384
    s_waitcnt lgkmcnt(6)
    v_mfma_f32_32x32x16_bf16 v[176:191], a[124:127], v[44:47], v[176:191]
    ds_read_b64_tr_b16 a[108:109], v9 offset:8704
    ds_read_b64_tr_b16 a[110:111], v9 offset:12800
    buffer_load_dwordx4 v112, s[8:11], s50 offen offset:0 lds
    ds_read_b128 v[52:55], v10 offset:3072
    s_waitcnt lgkmcnt(7)
    v_mfma_f32_32x32x16_bf16 v[192:207], a[96:99], v[40:43], v[192:207]
    ds_read_b64_tr_b16 a[112:113], v8 offset:768
    ds_read_b64_tr_b16 a[114:115], v8 offset:4864
    buffer_load_dwordx4 v113, s[8:11], s50 offen offset:1056 lds
    buffer_load_dwordx4 v114, s[8:11], s50 offen offset:2112 lds
    s_waitcnt lgkmcnt(7)
    v_mfma_f32_32x32x16_bf16 v[192:207], a[100:103], v[44:47], v[192:207]
    ds_read_b64_tr_b16 a[116:117], v8 offset:8960
    ds_read_b64_tr_b16 a[118:119], v8 offset:13056
    buffer_load_dwordx4 v115, s[8:11], s50 offen offset:3168 lds
    s_waitcnt lgkmcnt(7)
    v_mfma_f32_32x32x16_bf16 v[208:223], a[104:107], v[40:43], v[208:223]
    ds_read_b64_tr_b16 a[120:121], v9 offset:768
    ds_read_b64_tr_b16 a[122:123], v9 offset:4864
    s_add_u32 m0, s30, 33792
    s_waitcnt lgkmcnt(7)
    v_mfma_f32_32x32x16_bf16 v[208:223], a[108:111], v[44:47], v[208:223]
    ds_read_b64_tr_b16 a[124:125], v9 offset:8960
    ds_read_b64_tr_b16 a[126:127], v9 offset:13056
    s_mov_b32 s50, 32768
    buffer_load_dwordx4 v112, s[8:11], s50 offen offset:0 lds
    s_waitcnt lgkmcnt(6)
    v_mfma_f32_32x32x16_bf16 v[224:239], a[112:115], v[40:43], v[224:239]
    ds_read_b64_tr_b16 a[96:97], v8 offset:32768
    ds_read_b64_tr_b16 a[98:99], v8 offset:36864
    buffer_load_dwordx4 v113, s[8:11], s50 offen offset:1056 lds
    s_waitcnt lgkmcnt(6)
    v_mfma_f32_32x32x16_bf16 v[224:239], a[116:119], v[44:47], v[224:239]
    ds_read_b64_tr_b16 a[100:101], v8 offset:40960
    ds_read_b64_tr_b16 a[102:103], v8 offset:45056
    buffer_load_dwordx4 v114, s[8:11], s50 offen offset:2112 lds
    s_waitcnt lgkmcnt(6)
    v_mfma_f32_32x32x16_bf16 v[240:255], a[120:123], v[40:43], v[240:255]
    ds_read_b64_tr_b16 a[104:105], v9 offset:32768
    ds_read_b64_tr_b16 a[106:107], v9 offset:36864
    buffer_load_dwordx4 v115, s[8:11], s50 offen offset:3168 lds
    s_waitcnt lgkmcnt(6)
    v_mfma_f32_32x32x16_bf16 v[240:255], a[124:127], v[44:47], v[240:255]
    ds_read_b64_tr_b16 a[108:109], v9 offset:40960
    ds_read_b64_tr_b16 a[110:111], v9 offset:45056
    s_waitcnt lgkmcnt(6)
    v_mfma_f32_32x32x16_bf16 v[128:143], a[96:99], v[48:51], v[128:143]
    ds_read_b64_tr_b16 a[112:113], v8 offset:33024
    ds_read_b64_tr_b16 a[114:115], v8 offset:37120
    s_barrier
    s_waitcnt lgkmcnt(6)
    v_mfma_f32_32x32x16_bf16 v[128:143], a[100:103], v[52:55], v[128:143]
    ds_read_b64_tr_b16 a[116:117], v8 offset:41216
    ds_read_b64_tr_b16 a[118:119], v8 offset:45312
    s_add_u32 m0, s30, 50688
    s_waitcnt lgkmcnt(6)
    v_mfma_f32_32x32x16_bf16 v[144:159], a[104:107], v[48:51], v[144:159]
    ds_read_b64_tr_b16 a[120:121], v9 offset:33024
    ds_read_b64_tr_b16 a[122:123], v9 offset:37120
    s_mov_b32 s50, 49152
    s_waitcnt lgkmcnt(6)
    v_mfma_f32_32x32x16_bf16 v[144:159], a[108:111], v[52:55], v[144:159]
    ds_read_b64_tr_b16 a[124:125], v9 offset:41216
    ds_read_b64_tr_b16 a[126:127], v9 offset:45312
    buffer_load_dwordx4 v112, s[8:11], s50 offen offset:0 lds
    s_waitcnt lgkmcnt(6)
    v_mfma_f32_32x32x16_bf16 v[160:175], a[112:115], v[48:51], v[160:175]
    ds_read_b64_tr_b16 a[96:97], v8 offset:33280
    ds_read_b64_tr_b16 a[98:99], v8 offset:37376
    buffer_load_dwordx4 v113, s[8:11], s50 offen offset:1056 lds
    s_waitcnt lgkmcnt(6)
    v_mfma_f32_32x32x16_bf16 v[160:175], a[116:119], v[52:55], v[160:175]
    ds_read_b64_tr_b16 a[100:101], v8 offset:41472
    ds_read_b64_tr_b16 a[102:103], v8 offset:45568
    buffer_load_dwordx4 v114, s[8:11], s50 offen offset:2112 lds
    s_waitcnt lgkmcnt(6)
    v_mfma_f32_32x32x16_bf16 v[176:191], a[120:123], v[48:51], v[176:191]
    ds_read_b64_tr_b16 a[104:105], v9 offset:33280
    ds_read_b64_tr_b16 a[106:107], v9 offset:37376
    buffer_load_dwordx4 v115, s[8:11], s50 offen offset:3168 lds
    s_waitcnt lgkmcnt(6)
    v_mfma_f32_32x32x16_bf16 v[176:191], a[124:127], v[52:55], v[176:191]
    ds_read_b64_tr_b16 a[108:109], v9 offset:41472
    ds_read_b64_tr_b16 a[110:111], v9 offset:45568
    s_waitcnt lgkmcnt(6)
    v_mfma_f32_32x32x16_bf16 v[192:207], a[96:99], v[48:51], v[192:207]
    ds_read_b64_tr_b16 a[112:113], v8 offset:33536
    ds_read_b64_tr_b16 a[114:115], v8 offset:37632
    s_add_u32 m0, s31, 0
    s_waitcnt lgkmcnt(6)
    v_mfma_f32_32x32x16_bf16 v[192:207], a[100:103], v[52:55], v[192:207]
    ds_read_b64_tr_b16 a[116:117], v8 offset:41728
    ds_read_b64_tr_b16 a[118:119], v8 offset:45824
    s_mov_b32 s50, 32768
    s_waitcnt lgkmcnt(6)
    v_mfma_f32_32x32x16_bf16 v[208:223], a[104:107], v[48:51], v[208:223]
    ds_read_b64_tr_b16 a[120:121], v9 offset:33536
    ds_read_b64_tr_b16 a[122:123], v9 offset:37632
    buffer_load_dwordx4 v116, s[12:15], s50 offen offset:0 lds
    s_waitcnt lgkmcnt(6)
    v_mfma_f32_32x32x16_bf16 v[208:223], a[108:111], v[52:55], v[208:223]
    ds_read_b64_tr_b16 a[124:125], v9 offset:41728
    ds_read_b64_tr_b16 a[126:127], v9 offset:45824
    buffer_load_dwordx4 v117, s[12:15], s50 offen offset:1024 lds
    s_waitcnt lgkmcnt(6)
    v_mfma_f32_32x32x16_bf16 v[224:239], a[112:115], v[48:51], v[224:239]
    buffer_load_dwordx4 v118, s[12:15], s50 offen offset:2048 lds
    s_waitcnt lgkmcnt(4)
    v_mfma_f32_32x32x16_bf16 v[224:239], a[116:119], v[52:55], v[224:239]
    buffer_load_dwordx4 v119, s[12:15], s50 offen offset:3072 lds
    s_waitcnt lgkmcnt(2)
    v_mfma_f32_32x32x16_bf16 v[240:255], a[120:123], v[48:51], v[240:255]
    s_waitcnt lgkmcnt(0)
    v_mfma_f32_32x32x16_bf16 v[240:255], a[124:127], v[52:55], v[240:255]
    s_barrier
    v_mov_b32 v8, v112
    v_mov_b32 v9, v113
    v_mov_b32 v10, v114
    v_mov_b32 v11, v115
    v_mov_b32 v12, v116
    v_mov_b32 v13, v117
    v_mov_b32 v14, v118
    v_mov_b32 v15, v119
    v_bfe_u32 v16, v1, 1, 3
    v_mul_u32_u24 v16, 1056, v16
    v_and_b32 v17, 1, v1
    v_lshl_add_u32 v16, v17, 9, v16
    v_lshrrev_b32 v18, 4, v1
    v_lshl_add_u32 v16, v18, 4, v16
    v_lshlrev_b32 v17, 7, v17
    v_add_u32 v2, v16, v17
    v_sub_u32 v3, v16, v17
    v_bfe_u32 v17, v1, 3, 1
    v_lshl_add_u32 v19, v18, 1, v17
    v_lshlrev_b32 v16, 10, v19
    v_bfe_u32 v17, v1, 2, 1
    v_lshl_add_u32 v16, v17, 7, v16
    v_and_b32 v17, 3, v1
    v_lshl_add_u32 v16, v17, 3, v16
    v_add_u32 v16, 67584, v16
    v_and_b32 v19, 3, v19
    v_xor_b32 v17, 0, v19
    v_lshl_add_u32 v4, v17, 5, v16
    v_xor_b32 v17, 1, v19
    v_lshl_add_u32 v5, v17, 5, v16
    v_xor_b32 v17, 2, v19
    v_lshl_add_u32 v6, v17, 5, v16
    v_xor_b32 v17, 3, v19
    v_lshl_add_u32 v7, v17, 5, v16
    s_add_u32 s50, s28, 1
    s_lshl_b32 s50, s50, 14
    s_add_u32 s50, s50, 67584
    s_cmp_eq_u32 s28, 3
    s_cselect_b32 s50, 137216, s50
    v_and_b32 v16, 31, v1
    v_lshlrev_b32 v17, 9, v16
    v_and_b32 v16, 15, v1
    v_lshrrev_b32 v18, 5, v1
    v_xor_b32 v18, v18, v16
    v_lshl_add_u32 v17, v18, 4, v17
    v_add_u32 v20, s50, v17
    v_lshlrev_b32 v17, 9, v16
    v_lshrrev_b32 v18, 4, v1
    v_xor_b32 v18, v18, v16
    v_lshl_add_u32 v17, v18, 4, v17
    v_add_u32 v21, s50, v17
    v_cvt_pk_bf16_f32 v24, v128, v129
    v_cvt_pk_bf16_f32 v25, v130, v131
    v_cvt_pk_bf16_f32 v26, v132, v133
    v_cvt_pk_bf16_f32 v27, v134, v135
    v_xor_b32 v40, 0, v20
    ds_write_b128 v40, v[24:27]
    v_cvt_pk_bf16_f32 v28, v136, v137
    v_cvt_pk_bf16_f32 v29, v138, v139
    v_cvt_pk_bf16_f32 v30, v140, v141
    v_cvt_pk_bf16_f32 v31, v142, v143
    v_xor_b32 v41, 32, v20
    ds_write_b128 v41, v[28:31]
    v_cvt_pk_bf16_f32 v32, v144, v145
    v_cvt_pk_bf16_f32 v33, v146, v147
    v_cvt_pk_bf16_f32 v34, v148, v149
    v_cvt_pk_bf16_f32 v35, v150, v151
    v_xor_b32 v42, 64, v20
    ds_write_b128 v42, v[32:35]
    v_cvt_pk_bf16_f32 v36, v152, v153
    v_cvt_pk_bf16_f32 v37, v154, v155
    v_cvt_pk_bf16_f32 v38, v156, v157
    v_cvt_pk_bf16_f32 v39, v158, v159
    v_xor_b32 v43, 96, v20
    ds_write_b128 v43, v[36:39]
    v_cvt_pk_bf16_f32 v24, v160, v161
    v_cvt_pk_bf16_f32 v25, v162, v163
    v_cvt_pk_bf16_f32 v26, v164, v165
    v_cvt_pk_bf16_f32 v27, v166, v167
    v_xor_b32 v40, 128, v20
    ds_write_b128 v40, v[24:27]
    v_cvt_pk_bf16_f32 v28, v168, v169
    v_cvt_pk_bf16_f32 v29, v170, v171
    v_cvt_pk_bf16_f32 v30, v172, v173
    v_cvt_pk_bf16_f32 v31, v174, v175
    v_xor_b32 v41, 160, v20
    ds_write_b128 v41, v[28:31]
    v_cvt_pk_bf16_f32 v32, v176, v177
    v_cvt_pk_bf16_f32 v33, v178, v179
    v_cvt_pk_bf16_f32 v34, v180, v181
    v_cvt_pk_bf16_f32 v35, v182, v183
    v_xor_b32 v42, 192, v20
    ds_write_b128 v42, v[32:35]
    v_cvt_pk_bf16_f32 v36, v184, v185
    v_cvt_pk_bf16_f32 v37, v186, v187
    v_cvt_pk_bf16_f32 v38, v188, v189
    v_cvt_pk_bf16_f32 v39, v190, v191
    v_xor_b32 v43, 224, v20
    ds_write_b128 v43, v[36:39]
    v_cvt_pk_bf16_f32 v24, v192, v193
    v_cvt_pk_bf16_f32 v25, v194, v195
    v_cvt_pk_bf16_f32 v26, v196, v197
    v_cvt_pk_bf16_f32 v27, v198, v199
    v_xor_b32 v40, 256, v20
    ds_write_b128 v40, v[24:27]
    v_cvt_pk_bf16_f32 v28, v200, v201
    v_cvt_pk_bf16_f32 v29, v202, v203
    v_cvt_pk_bf16_f32 v30, v204, v205
    v_cvt_pk_bf16_f32 v31, v206, v207
    v_xor_b32 v41, 288, v20
    ds_write_b128 v41, v[28:31]
    v_cvt_pk_bf16_f32 v32, v208, v209
    v_cvt_pk_bf16_f32 v33, v210, v211
    v_cvt_pk_bf16_f32 v34, v212, v213
    v_cvt_pk_bf16_f32 v35, v214, v215
    v_xor_b32 v42, 320, v20
    ds_write_b128 v42, v[32:35]
    v_cvt_pk_bf16_f32 v36, v216, v217
    v_cvt_pk_bf16_f32 v37, v218, v219
    v_cvt_pk_bf16_f32 v38, v220, v221
    v_cvt_pk_bf16_f32 v39, v222, v223
    v_xor_b32 v43, 352, v20
    ds_write_b128 v43, v[36:39]
    v_cvt_pk_bf16_f32 v24, v224, v225
    v_cvt_pk_bf16_f32 v25, v226, v227
    v_cvt_pk_bf16_f32 v26, v228, v229
    v_cvt_pk_bf16_f32 v27, v230, v231
    v_xor_b32 v40, 384, v20
    ds_write_b128 v40, v[24:27]
    v_cvt_pk_bf16_f32 v28, v232, v233
    v_cvt_pk_bf16_f32 v29, v234, v235
    v_cvt_pk_bf16_f32 v30, v236, v237
    v_cvt_pk_bf16_f32 v31, v238, v239
    v_xor_b32 v41, 416, v20
    ds_write_b128 v41, v[28:31]
    v_cvt_pk_bf16_f32 v32, v240, v241
    v_cvt_pk_bf16_f32 v33, v242, v243
    v_cvt_pk_bf16_f32 v34, v244, v245
    v_cvt_pk_bf16_f32 v35, v246, v247
    v_xor_b32 v42, 448, v20
    ds_write_b128 v42, v[32:35]
    v_cvt_pk_bf16_f32 v36, v248, v249
    v_cvt_pk_bf16_f32 v37, v250, v251
    v_cvt_pk_bf16_f32 v38, v252, v253
    v_cvt_pk_bf16_f32 v39, v254, v255
    v_xor_b32 v43, 480, v20
    ds_write_b128 v43, v[36:39]
    s_waitcnt lgkmcnt(0)
    v_xor_b32 v40, 0, v21
    ds_read_b128 a[0:3], v40 offset:0
    ds_read_b128 a[32:35], v40 offset:8192
    v_xor_b32 v41, 64, v21
    ds_read_b128 a[4:7], v41 offset:0
    ds_read_b128 a[36:39], v41 offset:8192
    v_xor_b32 v42, 128, v21
    ds_read_b128 a[8:11], v42 offset:0
    ds_read_b128 a[40:43], v42 offset:8192
    v_xor_b32 v43, 192, v21
    ds_read_b128 a[12:15], v43 offset:0
    ds_read_b128 a[44:47], v43 offset:8192
    v_xor_b32 v40, 256, v21
    ds_read_b128 a[16:19], v40 offset:0
    ds_read_b128 a[48:51], v40 offset:8192
    v_xor_b32 v41, 320, v21
    ds_read_b128 a[20:23], v41 offset:0
    ds_read_b128 a[52:55], v41 offset:8192
    v_xor_b32 v42, 384, v21
    ds_read_b128 a[24:27], v42 offset:0
    ds_read_b128 a[56:59], v42 offset:8192
    v_xor_b32 v43, 448, v21
    ds_read_b128 a[28:31], v43 offset:0
    ds_read_b128 a[60:63], v43 offset:8192
    s_waitcnt lgkmcnt(0)
    s_waitcnt vmcnt(12)
    s_barrier
    s_add_u32 m0, s31, 16384
    s_mov_b32 s50, 49152
    buffer_load_dwordx4 v12, s[12:15], s50 offen offset:0 lds
    buffer_load_dwordx4 v13, s[12:15], s50 offen offset:1024 lds
    buffer_load_dwordx4 v14, s[12:15], s50 offen offset:2048 lds
    buffer_load_dwordx4 v15, s[12:15], s50 offen offset:3072 lds
    ds_read_b128 a[64:67], v2 offset:0
    ds_read_b128 a[68:71], v2 offset:8448
    ds_read_b128 a[72:75], v2 offset:64
    ds_read_b128 a[76:79], v2 offset:8512
    s_waitcnt lgkmcnt(3)
    v_mfma_f32_16x16x32_bf16 v[96:99], a[64:67], a[0:3], 0
    v_mfma_f32_16x16x32_bf16 v[100:103], a[64:67], a[32:35], 0
    ds_read_b128 a[80:83], v3 offset:128
    s_waitcnt lgkmcnt(3)
    v_mfma_f32_16x16x32_bf16 v[104:107], a[68:71], a[0:3], 0
    v_mfma_f32_16x16x32_bf16 v[108:111], a[68:71], a[32:35], 0
    ds_read_b128 a[84:87], v3 offset:8576
    s_waitcnt lgkmcnt(3)
    v_mfma_f32_16x16x32_bf16 v[96:99], a[72:75], a[4:7], v[96:99]
    v_mfma_f32_16x16x32_bf16 v[100:103], a[72:75], a[36:39], v[100:103]
    ds_read_b128 a[88:91], v3 offset:192
    s_waitcnt lgkmcnt(3)
    v_mfma_f32_16x16x32_bf16 v[104:107], a[76:79], a[4:7], v[104:107]
    v_mfma_f32_16x16x32_bf16 v[108:111], a[76:79], a[36:39], v[108:111]
    ds_read_b128 a[92:95], v3 offset:8640
    s_waitcnt lgkmcnt(3)
    v_mfma_f32_16x16x32_bf16 v[96:99], a[80:83], a[8:11], v[96:99]
    v_mfma_f32_16x16x32_bf16 v[100:103], a[80:83], a[40:43], v[100:103]
    ds_read_b128 a[64:67], v2 offset:256
    s_waitcnt lgkmcnt(3)
    v_mfma_f32_16x16x32_bf16 v[104:107], a[84:87], a[8:11], v[104:107]
    v_mfma_f32_16x16x32_bf16 v[108:111], a[84:87], a[40:43], v[108:111]
    ds_read_b128 a[68:71], v2 offset:8704
    s_waitcnt lgkmcnt(3)
    v_mfma_f32_16x16x32_bf16 v[96:99], a[88:91], a[12:15], v[96:99]
    v_mfma_f32_16x16x32_bf16 v[100:103], a[88:91], a[44:47], v[100:103]
    ds_read_b128 a[72:75], v2 offset:320
    s_waitcnt lgkmcnt(3)
    v_mfma_f32_16x16x32_bf16 v[104:107], a[92:95], a[12:15], v[104:107]
    v_mfma_f32_16x16x32_bf16 v[108:111], a[92:95], a[44:47], v[108:111]
    ds_read_b128 a[76:79], v2 offset:8768
    s_waitcnt lgkmcnt(3)
    v_mfma_f32_16x16x32_bf16 v[96:99], a[64:67], a[16:19], v[96:99]
    v_mfma_f32_16x16x32_bf16 v[100:103], a[64:67], a[48:51], v[100:103]
    ds_read_b128 a[80:83], v3 offset:384
    s_waitcnt lgkmcnt(3)
    v_mfma_f32_16x16x32_bf16 v[104:107], a[68:71], a[16:19], v[104:107]
    v_mfma_f32_16x16x32_bf16 v[108:111], a[68:71], a[48:51], v[108:111]
    ds_read_b128 a[84:87], v3 offset:8832
    s_waitcnt lgkmcnt(3)
    v_mfma_f32_16x16x32_bf16 v[96:99], a[72:75], a[20:23], v[96:99]
    v_mfma_f32_16x16x32_bf16 v[100:103], a[72:75], a[52:55], v[100:103]
    ds_read_b128 a[88:91], v3 offset:448
    s_waitcnt lgkmcnt(3)
    v_mfma_f32_16x16x32_bf16 v[104:107], a[76:79], a[20:23], v[104:107]
    v_mfma_f32_16x16x32_bf16 v[108:111], a[76:79], a[52:55], v[108:111]
    ds_read_b128 a[92:95], v3 offset:8896
    s_waitcnt lgkmcnt(3)
    v_mfma_f32_16x16x32_bf16 v[96:99], a[80:83], a[24:27], v[96:99]
    v_mfma_f32_16x16x32_bf16 v[100:103], a[80:83], a[56:59], v[100:103]
    ds_read_b128 a[64:67], v2 offset:16896
    s_waitcnt lgkmcnt(3)
    v_mfma_f32_16x16x32_bf16 v[104:107], a[84:87], a[24:27], v[104:107]
    v_mfma_f32_16x16x32_bf16 v[108:111], a[84:87], a[56:59], v[108:111]
    ds_read_b128 a[68:71], v2 offset:25344
    s_waitcnt lgkmcnt(3)
    v_mfma_f32_16x16x32_bf16 v[96:99], a[88:91], a[28:31], v[96:99]
    v_mfma_f32_16x16x32_bf16 v[100:103], a[88:91], a[60:63], v[100:103]
    ds_read_b128 a[72:75], v2 offset:16960
    s_waitcnt lgkmcnt(3)
    v_mfma_f32_16x16x32_bf16 v[104:107], a[92:95], a[28:31], v[104:107]
    v_mfma_f32_16x16x32_bf16 v[108:111], a[92:95], a[60:63], v[108:111]
    ds_read_b128 a[76:79], v2 offset:25408
    s_waitcnt lgkmcnt(3)
    v_mfma_f32_16x16x32_bf16 v[112:115], a[64:67], a[0:3], 0
    v_mfma_f32_16x16x32_bf16 v[116:119], a[64:67], a[32:35], 0
    ds_read_b128 a[80:83], v3 offset:17024
    s_waitcnt lgkmcnt(3)
    v_mfma_f32_16x16x32_bf16 v[120:123], a[68:71], a[0:3], 0
    v_mfma_f32_16x16x32_bf16 v[124:127], a[68:71], a[32:35], 0
    ds_read_b128 a[84:87], v3 offset:25472
    s_waitcnt lgkmcnt(3)
    v_mfma_f32_16x16x32_bf16 v[112:115], a[72:75], a[4:7], v[112:115]
    v_mfma_f32_16x16x32_bf16 v[116:119], a[72:75], a[36:39], v[116:119]
    ds_read_b128 a[88:91], v3 offset:17088
    s_waitcnt lgkmcnt(3)
    v_mfma_f32_16x16x32_bf16 v[120:123], a[76:79], a[4:7], v[120:123]
    v_mfma_f32_16x16x32_bf16 v[124:127], a[76:79], a[36:39], v[124:127]
    ds_read_b128 a[92:95], v3 offset:25536
    s_waitcnt lgkmcnt(3)
    v_mfma_f32_16x16x32_bf16 v[112:115], a[80:83], a[8:11], v[112:115]
    v_mfma_f32_16x16x32_bf16 v[116:119], a[80:83], a[40:43], v[116:119]
    ds_read_b128 a[64:67], v2 offset:17152
    s_waitcnt lgkmcnt(3)
    v_mfma_f32_16x16x32_bf16 v[120:123], a[84:87], a[8:11], v[120:123]
    v_mfma_f32_16x16x32_bf16 v[124:127], a[84:87], a[40:43], v[124:127]
    ds_read_b128 a[68:71], v2 offset:25600
    s_waitcnt lgkmcnt(3)
    v_mfma_f32_16x16x32_bf16 v[112:115], a[88:91], a[12:15], v[112:115]
    v_mfma_f32_16x16x32_bf16 v[116:119], a[88:91], a[44:47], v[116:119]
    ds_read_b128 a[72:75], v2 offset:17216
    s_waitcnt lgkmcnt(3)
    v_mfma_f32_16x16x32_bf16 v[120:123], a[92:95], a[12:15], v[120:123]
    v_mfma_f32_16x16x32_bf16 v[124:127], a[92:95], a[44:47], v[124:127]
    ds_read_b128 a[76:79], v2 offset:25664
    s_waitcnt lgkmcnt(3)
    v_mfma_f32_16x16x32_bf16 v[112:115], a[64:67], a[16:19], v[112:115]
    v_mfma_f32_16x16x32_bf16 v[116:119], a[64:67], a[48:51], v[116:119]
    ds_read_b128 a[80:83], v3 offset:17280
    s_waitcnt lgkmcnt(3)
    v_mfma_f32_16x16x32_bf16 v[120:123], a[68:71], a[16:19], v[120:123]
    v_mfma_f32_16x16x32_bf16 v[124:127], a[68:71], a[48:51], v[124:127]
    ds_read_b128 a[84:87], v3 offset:25728
    s_waitcnt lgkmcnt(3)
    v_mfma_f32_16x16x32_bf16 v[112:115], a[72:75], a[20:23], v[112:115]
    v_mfma_f32_16x16x32_bf16 v[116:119], a[72:75], a[52:55], v[116:119]
    ds_read_b128 a[88:91], v3 offset:17344
    s_waitcnt lgkmcnt(3)
    v_mfma_f32_16x16x32_bf16 v[120:123], a[76:79], a[20:23], v[120:123]
    v_mfma_f32_16x16x32_bf16 v[124:127], a[76:79], a[52:55], v[124:127]
    ds_read_b128 a[92:95], v3 offset:25792
    s_waitcnt lgkmcnt(3)
    v_mfma_f32_16x16x32_bf16 v[112:115], a[80:83], a[24:27], v[112:115]
    v_mfma_f32_16x16x32_bf16 v[116:119], a[80:83], a[56:59], v[116:119]
    s_waitcnt lgkmcnt(2)
    v_mfma_f32_16x16x32_bf16 v[120:123], a[84:87], a[24:27], v[120:123]
    v_mfma_f32_16x16x32_bf16 v[124:127], a[84:87], a[56:59], v[124:127]
    s_waitcnt lgkmcnt(1)
    v_mfma_f32_16x16x32_bf16 v[112:115], a[88:91], a[28:31], v[112:115]
    v_mfma_f32_16x16x32_bf16 v[116:119], a[88:91], a[60:63], v[116:119]
    s_waitcnt lgkmcnt(0)
    v_mfma_f32_16x16x32_bf16 v[120:123], a[92:95], a[28:31], v[120:123]
    v_mfma_f32_16x16x32_bf16 v[124:127], a[92:95], a[60:63], v[124:127]
    s_barrier
    s_add_u32 m0, s31, 32768
    s_mov_b32 s50, 65536
    buffer_load_dwordx4 v12, s[12:15], s50 offen offset:0 lds
    buffer_load_dwordx4 v13, s[12:15], s50 offen offset:1024 lds
    buffer_load_dwordx4 v14, s[12:15], s50 offen offset:2048 lds
    buffer_load_dwordx4 v15, s[12:15], s50 offen offset:3072 lds
    s_add_u32 m0, s30, 0
    s_mov_b32 s50, 65536
    buffer_load_dwordx4 v8, s[8:11], s50 offen offset:0 lds
    buffer_load_dwordx4 v9, s[8:11], s50 offen offset:1056 lds
    buffer_load_dwordx4 v10, s[8:11], s50 offen offset:2112 lds
    buffer_load_dwordx4 v11, s[8:11], s50 offen offset:3168 lds
    s_mov_b32 s29, 81920
    s_mov_b32 s33, 0x5d800000
    s_nop 7
    v_max3_f32 v16, v96, v97, v98
    v_max3_f32 v16, v16, v99, v104
    v_max3_f32 v16, v16, v105, v106
    v_max3_f32 v16, v16, v107, v112
    v_max3_f32 v16, v16, v113, v114
    v_max3_f32 v16, v16, v115, v120
    v_max3_f32 v16, v16, v121, v122
    v_max_f32 v16, v16, v123
    v_mov_b32 v18, v16
    s_nop 1
    v_permlane16_swap_b32 v16, v18
    s_nop 1
    v_max_f32 v16, v16, v18
    v_mov_b32 v18, v16
    s_nop 1
    v_permlane32_swap_b32 v16, v18
    s_nop 1
    v_max_f32 v16, v16, v18
    v_add_f32 v16, 0x42b60000, v16
    v_sub_f32 v80, 0, v16
    v_sub_f32 v81, 0, v16
    v_sub_f32 v82, 0, v16
    v_sub_f32 v83, 0, v16
    v_sub_f32 v96, v96, v16
    v_sub_f32 v97, v97, v16
    v_sub_f32 v98, v98, v16
    v_sub_f32 v99, v99, v16
    v_sub_f32 v104, v104, v16
    v_sub_f32 v105, v105, v16
    v_sub_f32 v106, v106, v16
    v_sub_f32 v107, v107, v16
    v_sub_f32 v112, v112, v16
    v_sub_f32 v113, v113, v16
    v_sub_f32 v114, v114, v16
    v_sub_f32 v115, v115, v16
    v_sub_f32 v120, v120, v16
    v_sub_f32 v121, v121, v16
    v_sub_f32 v122, v122, v16
    v_sub_f32 v123, v123, v16
    v_mov_b32 v62, 0
    v_max3_f32 v17, v100, v101, v102
    v_max3_f32 v17, v17, v103, v108
    v_max3_f32 v17, v17, v109, v110
    v_max3_f32 v17, v17, v111, v116
    v_max3_f32 v17, v17, v117, v118
    v_max3_f32 v17, v17, v119, v124
    v_max3_f32 v17, v17, v125, v126
    v_max_f32 v17, v17, v127
    v_mov_b32 v18, v17
    s_nop 1
    v_permlane16_swap_b32 v17, v18
    s_nop 1
    v_max_f32 v17, v17, v18
    v_mov_b32 v18, v17
    s_nop 1
    v_permlane32_swap_b32 v17, v18
    s_nop 1
    v_max_f32 v17, v17, v18
    v_add_f32 v17, 0x42b60000, v17
    v_sub_f32 v84, 0, v17
    v_sub_f32 v85, 0, v17
    v_sub_f32 v86, 0, v17
    v_sub_f32 v87, 0, v17
    v_sub_f32 v100, v100, v17
    v_sub_f32 v101, v101, v17
    v_sub_f32 v102, v102, v17
    v_sub_f32 v103, v103, v17
    v_sub_f32 v108, v108, v17
    v_sub_f32 v109, v109, v17
    v_sub_f32 v110, v110, v17
    v_sub_f32 v111, v111, v17
    v_sub_f32 v116, v116, v17
    v_sub_f32 v117, v117, v17
    v_sub_f32 v118, v118, v17
    v_sub_f32 v119, v119, v17
    v_sub_f32 v124, v124, v17
    v_sub_f32 v125, v125, v17
    v_sub_f32 v126, v126, v17
    v_sub_f32 v127, v127, v17
    v_mov_b32 v63, 0
    v_exp_f32 v56, v96
    v_exp_f32 v57, v97
    v_exp_f32 v58, v98
    v_exp_f32 v59, v99
    v_add_f32 v60, v62, v56
    v_add_f32 v60, v60, v57
    v_cvt_pk_bf16_f32 v64, v56, v57
    v_exp_f32 v56, v100
    v_exp_f32 v57, v101
    v_add_f32 v60, v60, v58
    v_add_f32 v60, v60, v59
    v_cvt_pk_bf16_f32 v65, v58, v59
    v_exp_f32 v58, v102
    v_exp_f32 v59, v103
    v_add_f32 v61, v63, v56
    v_add_f32 v61, v61, v57
    v_cvt_pk_bf16_f32 v68, v56, v57
    v_exp_f32 v56, v104
    v_exp_f32 v57, v105
    v_add_f32 v61, v61, v58
    v_add_f32 v61, v61, v59
    v_cvt_pk_bf16_f32 v69, v58, v59
    v_exp_f32 v58, v106
    v_exp_f32 v59, v107
    v_add_f32 v60, v60, v56
    v_add_f32 v60, v60, v57
    v_cvt_pk_bf16_f32 v66, v56, v57
    v_exp_f32 v56, v108
    v_exp_f32 v57, v109
    v_add_f32 v60, v60, v58
    v_add_f32 v60, v60, v59
    v_cvt_pk_bf16_f32 v67, v58, v59
    v_exp_f32 v58, v110
    v_exp_f32 v59, v111
    v_add_f32 v61, v61, v56
    v_add_f32 v61, v61, v57
    v_cvt_pk_bf16_f32 v70, v56, v57
    v_add_f32 v61, v61, v58
    v_add_f32 v61, v61, v59
    v_cvt_pk_bf16_f32 v71, v58, v59
    s_waitcnt vmcnt(8)
    s_barrier
    ds_read_b64_tr_b16 a[96:97], v4 offset:0
    ds_read_b64_tr_b16 a[98:99], v4 offset:8192
    ds_read_b64_tr_b16 a[100:101], v5 offset:0
    ds_read_b64_tr_b16 a[102:103], v5 offset:8192
    ds_read_b64_tr_b16 a[104:105], v6 offset:0
    ds_read_b64_tr_b16 a[106:107], v6 offset:8192
    ds_read_b64_tr_b16 a[108:109], v7 offset:0
    ds_read_b64_tr_b16 a[110:111], v7 offset:8192
    ds_read_b64_tr_b16 a[112:113], v4 offset:256
    ds_read_b64_tr_b16 a[114:115], v4 offset:8448
    ds_read_b64_tr_b16 a[116:117], v5 offset:256
    ds_read_b64_tr_b16 a[118:119], v5 offset:8448
    ds_read_b64_tr_b16 a[120:121], v6 offset:256
    ds_read_b64_tr_b16 a[122:123], v6 offset:8448
    s_waitcnt lgkmcnt(6)
    v_mfma_f32_16x16x32_bf16 v[128:131], a[96:99], v[64:67], 0
    ds_read_b64_tr_b16 a[124:125], v7 offset:256
    ds_read_b64_tr_b16 a[126:127], v7 offset:8448
    v_mfma_f32_16x16x32_bf16 v[132:135], a[96:99], v[68:71], 0
    s_waitcnt vmcnt(8)
    s_barrier
    v_mfma_f32_16x16x32_bf16 v[136:139], a[100:103], v[64:67], 0
    ds_read_b64_tr_b16 a[96:97], v4 offset:512
    ds_read_b64_tr_b16 a[98:99], v4 offset:8704
    v_mfma_f32_16x16x32_bf16 v[140:143], a[100:103], v[68:71], 0
    s_add_u32 m0, s30, 16896
    v_mfma_f32_16x16x32_bf16 v[144:147], a[104:107], v[64:67], 0
    ds_read_b64_tr_b16 a[100:101], v5 offset:512
    ds_read_b64_tr_b16 a[102:103], v5 offset:8704
    v_mfma_f32_16x16x32_bf16 v[148:151], a[104:107], v[68:71], 0
    buffer_load_dwordx4 v8, s[8:11], s29 offen offset:0  lds
    v_mfma_f32_16x16x32_bf16 v[152:155], a[108:111], v[64:67], 0
    ds_read_b64_tr_b16 a[104:105], v6 offset:512
    ds_read_b64_tr_b16 a[106:107], v6 offset:8704
    v_mfma_f32_16x16x32_bf16 v[156:159], a[108:111], v[68:71], 0
    v_exp_f32 v56, v112
    s_waitcnt lgkmcnt(6)
    v_mfma_f32_16x16x32_bf16 v[160:163], a[112:115], v[64:67], 0
    ds_read_b64_tr_b16 a[108:109], v7 offset:512
    ds_read_b64_tr_b16 a[110:111], v7 offset:8704
    v_mfma_f32_16x16x32_bf16 v[164:167], a[112:115], v[68:71], 0
    v_exp_f32 v57, v113
    v_mfma_f32_16x16x32_bf16 v[168:171], a[116:119], v[64:67], 0
    ds_read_b64_tr_b16 a[112:113], v4 offset:768
    ds_read_b64_tr_b16 a[114:115], v4 offset:8960
    v_mfma_f32_16x16x32_bf16 v[172:175], a[116:119], v[68:71], 0
    v_exp_f32 v58, v114
    v_mfma_f32_16x16x32_bf16 v[176:179], a[120:123], v[64:67], 0
    ds_read_b64_tr_b16 a[116:117], v5 offset:768
    ds_read_b64_tr_b16 a[118:119], v5 offset:8960
    v_mfma_f32_16x16x32_bf16 v[180:183], a[120:123], v[68:71], 0
    buffer_load_dwordx4 v9, s[8:11], s29 offen offset:1056  lds
    v_mfma_f32_16x16x32_bf16 v[184:187], a[124:127], v[64:67], 0
    ds_read_b64_tr_b16 a[120:121], v6 offset:768
    ds_read_b64_tr_b16 a[122:123], v6 offset:8960
    v_mfma_f32_16x16x32_bf16 v[188:191], a[124:127], v[68:71], 0
    v_exp_f32 v59, v115
    s_waitcnt lgkmcnt(6)
    v_mfma_f32_16x16x32_bf16 v[192:195], a[96:99], v[64:67], 0
    ds_read_b64_tr_b16 a[124:125], v7 offset:768
    ds_read_b64_tr_b16 a[126:127], v7 offset:8960
    v_mfma_f32_16x16x32_bf16 v[196:199], a[96:99], v[68:71], 0
    v_add_f32 v62, v60, v56
    v_add_f32 v62, v62, v57
    v_mfma_f32_16x16x32_bf16 v[200:203], a[100:103], v[64:67], 0
    ds_read_b128 a[64:67], v2 offset:33792
    v_cvt_pk_bf16_f32 v72, v56, v57
    v_mfma_f32_16x16x32_bf16 v[204:207], a[100:103], v[68:71], 0
    v_exp_f32 v56, v116
    v_mfma_f32_16x16x32_bf16 v[208:211], a[104:107], v[64:67], 0
    ds_read_b128 a[68:71], v2 offset:42240
    v_mfma_f32_16x16x32_bf16 v[212:215], a[104:107], v[68:71], 0
    buffer_load_dwordx4 v10, s[8:11], s29 offen offset:2112  lds
    v_mfma_f32_16x16x32_bf16 v[216:219], a[108:111], v[64:67], 0
    ds_read_b128 a[72:75], v2 offset:33856
    v_mfma_f32_16x16x32_bf16 v[220:223], a[108:111], v[68:71], 0
    v_exp_f32 v57, v117
    v_add_f32 v62, v62, v58
    s_waitcnt lgkmcnt(3)
    v_mfma_f32_16x16x32_bf16 v[224:227], a[112:115], v[64:67], 0
    ds_read_b128 a[76:79], v2 offset:42304
    v_add_f32 v62, v62, v59
    v_cvt_pk_bf16_f32 v73, v58, v59
    v_mfma_f32_16x16x32_bf16 v[228:231], a[112:115], v[68:71], 0
    v_exp_f32 v58, v118
    v_mfma_f32_16x16x32_bf16 v[232:235], a[116:119], v[64:67], 0
    ds_read_b128 a[80:83], v3 offset:33920
    v_mfma_f32_16x16x32_bf16 v[236:239], a[116:119], v[68:71], 0
    v_exp_f32 v59, v119
    v_add_f32 v63, v61, v56
    v_mfma_f32_16x16x32_bf16 v[240:243], a[120:123], v[64:67], 0
    ds_read_b128 a[84:87], v3 offset:42368
    v_mfma_f32_16x16x32_bf16 v[244:247], a[120:123], v[68:71], 0
    buffer_load_dwordx4 v11, s[8:11], s29 offen offset:3168  lds
    v_mfma_f32_16x16x32_bf16 v[248:251], a[124:127], v[64:67], 0
    ds_read_b128 a[88:91], v3 offset:33984
    v_add_f32 v63, v63, v57
    v_mfma_f32_16x16x32_bf16 v[252:255], a[124:127], v[68:71], 0
    v_cvt_pk_bf16_f32 v76, v56, v57
    s_waitcnt lgkmcnt(3)
    v_mfma_f32_16x16x32_bf16 v[96:99], a[64:67], a[0:3], v[80:83]
    ds_read_b128 a[92:95], v3 offset:42432
    v_exp_f32 v56, v120
    v_mfma_f32_16x16x32_bf16 v[100:103], a[64:67], a[32:35], v[84:87]
    v_exp_f32 v57, v121
    v_mfma_f32_16x16x32_bf16 v[104:107], a[68:71], a[0:3], v[80:83]
    ds_read_b128 a[64:67], v2 offset:34048
    s_add_u32 m0, s31, 49152
    v_add_f32 v63, v63, v58
    v_mfma_f32_16x16x32_bf16 v[108:111], a[68:71], a[32:35], v[84:87]
    v_add_f32 v63, v63, v59
    v_cvt_pk_bf16_f32 v77, v58, v59
    v_mfma_f32_16x16x32_bf16 v[96:99], a[72:75], a[4:7], v[96:99]
    ds_read_b128 a[68:71], v2 offset:42496
    v_mfma_f32_16x16x32_bf16 v[100:103], a[72:75], a[36:39], v[100:103]
    buffer_load_dwordx4 v12, s[12:15], s29 offen offset:0  lds
    v_mfma_f32_16x16x32_bf16 v[104:107], a[76:79], a[4:7], v[104:107]
    ds_read_b128 a[72:75], v2 offset:34112
    v_mfma_f32_16x16x32_bf16 v[108:111], a[76:79], a[36:39], v[108:111]
    v_exp_f32 v58, v122
    s_waitcnt lgkmcnt(3)
    v_mfma_f32_16x16x32_bf16 v[96:99], a[80:83], a[8:11], v[96:99]
    ds_read_b128 a[76:79], v2 offset:42560
    v_exp_f32 v59, v123
    v_mfma_f32_16x16x32_bf16 v[100:103], a[80:83], a[40:43], v[100:103]
    v_add_f32 v62, v62, v56
    v_add_f32 v62, v62, v57
    v_mfma_f32_16x16x32_bf16 v[104:107], a[84:87], a[8:11], v[104:107]
    ds_read_b128 a[80:83], v3 offset:34176
    v_cvt_pk_bf16_f32 v74, v56, v57
    v_mfma_f32_16x16x32_bf16 v[108:111], a[84:87], a[40:43], v[108:111]
    v_exp_f32 v56, v124
    v_mfma_f32_16x16x32_bf16 v[96:99], a[88:91], a[12:15], v[96:99]
    ds_read_b128 a[84:87], v3 offset:42624
    v_mfma_f32_16x16x32_bf16 v[100:103], a[88:91], a[44:47], v[100:103]
    buffer_load_dwordx4 v13, s[12:15], s29 offen offset:1024  lds
    v_mfma_f32_16x16x32_bf16 v[104:107], a[92:95], a[12:15], v[104:107]
    ds_read_b128 a[88:91], v3 offset:34240
    v_mfma_f32_16x16x32_bf16 v[108:111], a[92:95], a[44:47], v[108:111]
    v_exp_f32 v57, v125
    v_add_f32 v62, v62, v58
    s_waitcnt lgkmcnt(3)
    v_mfma_f32_16x16x32_bf16 v[96:99], a[64:67], a[16:19], v[96:99]
    ds_read_b128 a[92:95], v3 offset:42688
    v_add_f32 v62, v62, v59
    v_cvt_pk_bf16_f32 v75, v58, v59
    v_mfma_f32_16x16x32_bf16 v[100:103], a[64:67], a[48:51], v[100:103]
    v_exp_f32 v58, v126
    v_mfma_f32_16x16x32_bf16 v[104:107], a[68:71], a[16:19], v[104:107]
    ds_read_b64_tr_b16 a[96:97], v4 offset:16384
    ds_read_b64_tr_b16 a[98:99], v4 offset:24576
    v_mfma_f32_16x16x32_bf16 v[108:111], a[68:71], a[48:51], v[108:111]
    v_exp_f32 v59, v127
    v_mfma_f32_16x16x32_bf16 v[96:99], a[72:75], a[20:23], v[96:99]
    ds_read_b64_tr_b16 a[100:101], v5 offset:16384
    ds_read_b64_tr_b16 a[102:103], v5 offset:24576
    v_mfma_f32_16x16x32_bf16 v[100:103], a[72:75], a[52:55], v[100:103]
    buffer_load_dwordx4 v14, s[12:15], s29 offen offset:2048  lds
    v_mfma_f32_16x16x32_bf16 v[104:107], a[76:79], a[20:23], v[104:107]
    ds_read_b64_tr_b16 a[104:105], v6 offset:16384
    ds_read_b64_tr_b16 a[106:107], v6 offset:24576
    v_mfma_f32_16x16x32_bf16 v[108:111], a[76:79], a[52:55], v[108:111]
    v_add_f32 v63, v63, v56
    s_waitcnt lgkmcnt(6)
    v_mfma_f32_16x16x32_bf16 v[96:99], a[80:83], a[24:27], v[96:99]
    ds_read_b64_tr_b16 a[108:109], v7 offset:16384
    ds_read_b64_tr_b16 a[110:111], v7 offset:24576
    v_add_f32 v63, v63, v57
    v_mfma_f32_16x16x32_bf16 v[100:103], a[80:83], a[56:59], v[100:103]
    v_cvt_pk_bf16_f32 v78, v56, v57
    v_add_f32 v63, v63, v58
    v_mfma_f32_16x16x32_bf16 v[104:107], a[84:87], a[24:27], v[104:107]
    ds_read_b64_tr_b16 a[112:113], v4 offset:16640
    ds_read_b64_tr_b16 a[114:115], v4 offset:24832
    v_mfma_f32_16x16x32_bf16 v[108:111], a[84:87], a[56:59], v[108:111]
    v_add_f32 v63, v63, v59
    v_cvt_pk_bf16_f32 v79, v58, v59
    v_mfma_f32_16x16x32_bf16 v[96:99], a[88:91], a[28:31], v[96:99]
    ds_read_b64_tr_b16 a[116:117], v5 offset:16640
    ds_read_b64_tr_b16 a[118:119], v5 offset:24832
    v_mfma_f32_16x16x32_bf16 v[100:103], a[88:91], a[60:63], v[100:103]
    buffer_load_dwordx4 v15, s[12:15], s29 offen offset:3072  lds
    v_max_f32 v56, v62, v63
    v_mfma_f32_16x16x32_bf16 v[104:107], a[92:95], a[28:31], v[104:107]
    ds_read_b64_tr_b16 a[120:121], v6 offset:16640
    ds_read_b64_tr_b16 a[122:123], v6 offset:24832
    v_mfma_f32_16x16x32_bf16 v[108:111], a[92:95], a[60:63], v[108:111]
    s_add_u32 s29, s29, 16384
    v_cmp_lt_f32 vcc, s33, v56
    s_cbranch_vccnz RARE_F0
CONT_F0:
    s_waitcnt lgkmcnt(6)
    v_mfma_f32_16x16x32_bf16 v[128:131], a[96:99], v[72:75], v[128:131]
    ds_read_b64_tr_b16 a[124:125], v7 offset:16640
    ds_read_b64_tr_b16 a[126:127], v7 offset:24832
    v_mfma_f32_16x16x32_bf16 v[132:135], a[96:99], v[76:79], v[132:135]
    s_waitcnt vmcnt(8)
    s_barrier
    v_mfma_f32_16x16x32_bf16 v[136:139], a[100:103], v[72:75], v[136:139]
    ds_read_b64_tr_b16 a[96:97], v4 offset:16896
    ds_read_b64_tr_b16 a[98:99], v4 offset:25088
    v_mfma_f32_16x16x32_bf16 v[140:143], a[100:103], v[76:79], v[140:143]
    s_add_u32 m0, s30, 33792
    v_mfma_f32_16x16x32_bf16 v[144:147], a[104:107], v[72:75], v[144:147]
    ds_read_b64_tr_b16 a[100:101], v5 offset:16896
    ds_read_b64_tr_b16 a[102:103], v5 offset:25088
    v_mfma_f32_16x16x32_bf16 v[148:151], a[104:107], v[76:79], v[148:151]
    buffer_load_dwordx4 v8, s[8:11], s29 offen offset:0  lds
    v_mfma_f32_16x16x32_bf16 v[152:155], a[108:111], v[72:75], v[152:155]
    ds_read_b64_tr_b16 a[104:105], v6 offset:16896
    ds_read_b64_tr_b16 a[106:107], v6 offset:25088
    v_mfma_f32_16x16x32_bf16 v[156:159], a[108:111], v[76:79], v[156:159]
    v_exp_f32 v56, v96
    s_waitcnt lgkmcnt(6)
    v_mfma_f32_16x16x32_bf16 v[160:163], a[112:115], v[72:75], v[160:163]
    ds_read_b64_tr_b16 a[108:109], v7 offset:16896
    ds_read_b64_tr_b16 a[110:111], v7 offset:25088
    v_mfma_f32_16x16x32_bf16 v[164:167], a[112:115], v[76:79], v[164:167]
    v_exp_f32 v57, v97
    v_mfma_f32_16x16x32_bf16 v[168:171], a[116:119], v[72:75], v[168:171]
    ds_read_b64_tr_b16 a[112:113], v4 offset:17152
    ds_read_b64_tr_b16 a[114:115], v4 offset:25344
    v_mfma_f32_16x16x32_bf16 v[172:175], a[116:119], v[76:79], v[172:175]
    v_exp_f32 v58, v98
    v_mfma_f32_16x16x32_bf16 v[176:179], a[120:123], v[72:75], v[176:179]
    ds_read_b64_tr_b16 a[116:117], v5 offset:17152
    ds_read_b64_tr_b16 a[118:119], v5 offset:25344
    v_mfma_f32_16x16x32_bf16 v[180:183], a[120:123], v[76:79], v[180:183]
    buffer_load_dwordx4 v9, s[8:11], s29 offen offset:1056  lds
    v_mfma_f32_16x16x32_bf16 v[184:187], a[124:127], v[72:75], v[184:187]
    ds_read_b64_tr_b16 a[120:121], v6 offset:17152
    ds_read_b64_tr_b16 a[122:123], v6 offset:25344
    v_mfma_f32_16x16x32_bf16 v[188:191], a[124:127], v[76:79], v[188:191]
    v_exp_f32 v59, v99
    s_waitcnt lgkmcnt(6)
    v_mfma_f32_16x16x32_bf16 v[192:195], a[96:99], v[72:75], v[192:195]
    ds_read_b64_tr_b16 a[124:125], v7 offset:17152
    ds_read_b64_tr_b16 a[126:127], v7 offset:25344
    v_mfma_f32_16x16x32_bf16 v[196:199], a[96:99], v[76:79], v[196:199]
    v_add_f32 v60, v62, v56
    v_add_f32 v60, v60, v57
    v_mfma_f32_16x16x32_bf16 v[200:203], a[100:103], v[72:75], v[200:203]
    ds_read_b128 a[64:67], v2 offset:50688
    v_cvt_pk_bf16_f32 v64, v56, v57
    v_mfma_f32_16x16x32_bf16 v[204:207], a[100:103], v[76:79], v[204:207]
    v_exp_f32 v56, v100
    v_mfma_f32_16x16x32_bf16 v[208:211], a[104:107], v[72:75], v[208:211]
    ds_read_b128 a[68:71], v2 offset:59136
    v_mfma_f32_16x16x32_bf16 v[212:215], a[104:107], v[76:79], v[212:215]
    buffer_load_dwordx4 v10, s[8:11], s29 offen offset:2112  lds
    v_mfma_f32_16x16x32_bf16 v[216:219], a[108:111], v[72:75], v[216:219]
    ds_read_b128 a[72:75], v2 offset:50752
    v_mfma_f32_16x16x32_bf16 v[220:223], a[108:111], v[76:79], v[220:223]
    v_exp_f32 v57, v101
    v_add_f32 v60, v60, v58
    s_waitcnt lgkmcnt(3)
    v_mfma_f32_16x16x32_bf16 v[224:227], a[112:115], v[72:75], v[224:227]
    ds_read_b128 a[76:79], v2 offset:59200
    v_add_f32 v60, v60, v59
    v_cvt_pk_bf16_f32 v65, v58, v59
    v_mfma_f32_16x16x32_bf16 v[228:231], a[112:115], v[76:79], v[228:231]
    v_exp_f32 v58, v102
    v_mfma_f32_16x16x32_bf16 v[232:235], a[116:119], v[72:75], v[232:235]
    ds_read_b128 a[80:83], v3 offset:50816
    v_mfma_f32_16x16x32_bf16 v[236:239], a[116:119], v[76:79], v[236:239]
    v_exp_f32 v59, v103
    v_add_f32 v61, v63, v56
    v_mfma_f32_16x16x32_bf16 v[240:243], a[120:123], v[72:75], v[240:243]
    ds_read_b128 a[84:87], v3 offset:59264
    v_mfma_f32_16x16x32_bf16 v[244:247], a[120:123], v[76:79], v[244:247]
    buffer_load_dwordx4 v11, s[8:11], s29 offen offset:3168  lds
    v_mfma_f32_16x16x32_bf16 v[248:251], a[124:127], v[72:75], v[248:251]
    ds_read_b128 a[88:91], v3 offset:50880
    v_add_f32 v61, v61, v57
    v_mfma_f32_16x16x32_bf16 v[252:255], a[124:127], v[76:79], v[252:255]
    v_cvt_pk_bf16_f32 v68, v56, v57
    s_waitcnt lgkmcnt(3)
    v_mfma_f32_16x16x32_bf16 v[112:115], a[64:67], a[0:3], v[80:83]
    ds_read_b128 a[92:95], v3 offset:59328
    v_exp_f32 v56, v104
    v_mfma_f32_16x16x32_bf16 v[116:119], a[64:67], a[32:35], v[84:87]
    v_exp_f32 v57, v105
    v_mfma_f32_16x16x32_bf16 v[120:123], a[68:71], a[0:3], v[80:83]
    ds_read_b128 a[64:67], v2 offset:50944
    s_add_u32 m0, s31, 0
    v_add_f32 v61, v61, v58
    v_mfma_f32_16x16x32_bf16 v[124:127], a[68:71], a[32:35], v[84:87]
    v_add_f32 v61, v61, v59
    v_cvt_pk_bf16_f32 v69, v58, v59
    v_mfma_f32_16x16x32_bf16 v[112:115], a[72:75], a[4:7], v[112:115]
    ds_read_b128 a[68:71], v2 offset:59392
    v_mfma_f32_16x16x32_bf16 v[116:119], a[72:75], a[36:39], v[116:119]
    buffer_load_dwordx4 v12, s[12:15], s29 offen offset:0  lds
    v_mfma_f32_16x16x32_bf16 v[120:123], a[76:79], a[4:7], v[120:123]
    ds_read_b128 a[72:75], v2 offset:51008
    v_mfma_f32_16x16x32_bf16 v[124:127], a[76:79], a[36:39], v[124:127]
    v_exp_f32 v58, v106
    s_waitcnt lgkmcnt(3)
    v_mfma_f32_16x16x32_bf16 v[112:115], a[80:83], a[8:11], v[112:115]
    ds_read_b128 a[76:79], v2 offset:59456
    v_exp_f32 v59, v107
    v_mfma_f32_16x16x32_bf16 v[116:119], a[80:83], a[40:43], v[116:119]
    v_add_f32 v60, v60, v56
    v_add_f32 v60, v60, v57
    v_mfma_f32_16x16x32_bf16 v[120:123], a[84:87], a[8:11], v[120:123]
    ds_read_b128 a[80:83], v3 offset:51072
    v_cvt_pk_bf16_f32 v66, v56, v57
    v_mfma_f32_16x16x32_bf16 v[124:127], a[84:87], a[40:43], v[124:127]
    v_exp_f32 v56, v108
    v_mfma_f32_16x16x32_bf16 v[112:115], a[88:91], a[12:15], v[112:115]
    ds_read_b128 a[84:87], v3 offset:59520
    v_mfma_f32_16x16x32_bf16 v[116:119], a[88:91], a[44:47], v[116:119]
    buffer_load_dwordx4 v13, s[12:15], s29 offen offset:1024  lds
    v_mfma_f32_16x16x32_bf16 v[120:123], a[92:95], a[12:15], v[120:123]
    ds_read_b128 a[88:91], v3 offset:51136
    v_mfma_f32_16x16x32_bf16 v[124:127], a[92:95], a[44:47], v[124:127]
    v_exp_f32 v57, v109
    v_add_f32 v60, v60, v58
    s_waitcnt lgkmcnt(3)
    v_mfma_f32_16x16x32_bf16 v[112:115], a[64:67], a[16:19], v[112:115]
    ds_read_b128 a[92:95], v3 offset:59584
    v_add_f32 v60, v60, v59
    v_cvt_pk_bf16_f32 v67, v58, v59
    v_mfma_f32_16x16x32_bf16 v[116:119], a[64:67], a[48:51], v[116:119]
    v_exp_f32 v58, v110
    v_mfma_f32_16x16x32_bf16 v[120:123], a[68:71], a[16:19], v[120:123]
    ds_read_b64_tr_b16 a[96:97], v4 offset:32768
    ds_read_b64_tr_b16 a[98:99], v4 offset:40960
    v_mfma_f32_16x16x32_bf16 v[124:127], a[68:71], a[48:51], v[124:127]
    v_exp_f32 v59, v111
    v_mfma_f32_16x16x32_bf16 v[112:115], a[72:75], a[20:23], v[112:115]
    ds_read_b64_tr_b16 a[100:101], v5 offset:32768
    ds_read_b64_tr_b16 a[102:103], v5 offset:40960
    v_mfma_f32_16x16x32_bf16 v[116:119], a[72:75], a[52:55], v[116:119]
    buffer_load_dwordx4 v14, s[12:15], s29 offen offset:2048  lds
    v_mfma_f32_16x16x32_bf16 v[120:123], a[76:79], a[20:23], v[120:123]
    ds_read_b64_tr_b16 a[104:105], v6 offset:32768
    ds_read_b64_tr_b16 a[106:107], v6 offset:40960
    v_mfma_f32_16x16x32_bf16 v[124:127], a[76:79], a[52:55], v[124:127]
    v_add_f32 v61, v61, v56
    s_waitcnt lgkmcnt(6)
    v_mfma_f32_16x16x32_bf16 v[112:115], a[80:83], a[24:27], v[112:115]
    ds_read_b64_tr_b16 a[108:109], v7 offset:32768
    ds_read_b64_tr_b16 a[110:111], v7 offset:40960
    v_add_f32 v61, v61, v57
    v_mfma_f32_16x16x32_bf16 v[116:119], a[80:83], a[56:59], v[116:119]
    v_cvt_pk_bf16_f32 v70, v56, v57
    v_add_f32 v61, v61, v58
    v_mfma_f32_16x16x32_bf16 v[120:123], a[84:87], a[24:27], v[120:123]
    ds_read_b64_tr_b16 a[112:113], v4 offset:33024
    ds_read_b64_tr_b16 a[114:115], v4 offset:41216
    v_mfma_f32_16x16x32_bf16 v[124:127], a[84:87], a[56:59], v[124:127]
    v_add_f32 v61, v61, v59
    v_cvt_pk_bf16_f32 v71, v58, v59
    v_mfma_f32_16x16x32_bf16 v[112:115], a[88:91], a[28:31], v[112:115]
    ds_read_b64_tr_b16 a[116:117], v5 offset:33024
    ds_read_b64_tr_b16 a[118:119], v5 offset:41216
    v_mfma_f32_16x16x32_bf16 v[116:119], a[88:91], a[60:63], v[116:119]
    buffer_load_dwordx4 v15, s[12:15], s29 offen offset:3072  lds
    v_max_f32 v56, v60, v61
    v_mfma_f32_16x16x32_bf16 v[120:123], a[92:95], a[28:31], v[120:123]
    ds_read_b64_tr_b16 a[120:121], v6 offset:33024
    ds_read_b64_tr_b16 a[122:123], v6 offset:41216
    v_mfma_f32_16x16x32_bf16 v[124:127], a[92:95], a[60:63], v[124:127]
    s_add_u32 s29, s29, 16384
    v_cmp_lt_f32 vcc, s33, v56
    s_cbranch_vccnz RARE_F1
CONT_F1:
    s_waitcnt lgkmcnt(6)
    v_mfma_f32_16x16x32_bf16 v[128:131], a[96:99], v[64:67], v[128:131]
    ds_read_b64_tr_b16 a[124:125], v7 offset:33024
    ds_read_b64_tr_b16 a[126:127], v7 offset:41216
    v_mfma_f32_16x16x32_bf16 v[132:135], a[96:99], v[68:71], v[132:135]
    s_waitcnt vmcnt(8)
    s_barrier
    v_mfma_f32_16x16x32_bf16 v[136:139], a[100:103], v[64:67], v[136:139]
    ds_read_b64_tr_b16 a[96:97], v4 offset:33280
    ds_read_b64_tr_b16 a[98:99], v4 offset:41472
    v_mfma_f32_16x16x32_bf16 v[140:143], a[100:103], v[68:71], v[140:143]
    s_add_u32 m0, s30, 50688
    v_mfma_f32_16x16x32_bf16 v[144:147], a[104:107], v[64:67], v[144:147]
    ds_read_b64_tr_b16 a[100:101], v5 offset:33280
    ds_read_b64_tr_b16 a[102:103], v5 offset:41472
    v_mfma_f32_16x16x32_bf16 v[148:151], a[104:107], v[68:71], v[148:151]
    buffer_load_dwordx4 v8, s[8:11], s29 offen offset:0  lds
    v_mfma_f32_16x16x32_bf16 v[152:155], a[108:111], v[64:67], v[152:155]
    ds_read_b64_tr_b16 a[104:105], v6 offset:33280
    ds_read_b64_tr_b16 a[106:107], v6 offset:41472
    v_mfma_f32_16x16x32_bf16 v[156:159], a[108:111], v[68:71], v[156:159]
    v_exp_f32 v56, v112
    s_waitcnt lgkmcnt(6)
    v_mfma_f32_16x16x32_bf16 v[160:163], a[112:115], v[64:67], v[160:163]
    ds_read_b64_tr_b16 a[108:109], v7 offset:33280
    ds_read_b64_tr_b16 a[110:111], v7 offset:41472
    v_mfma_f32_16x16x32_bf16 v[164:167], a[112:115], v[68:71], v[164:167]
    v_exp_f32 v57, v113
    v_mfma_f32_16x16x32_bf16 v[168:171], a[116:119], v[64:67], v[168:171]
    ds_read_b64_tr_b16 a[112:113], v4 offset:33536
    ds_read_b64_tr_b16 a[114:115], v4 offset:41728
    v_mfma_f32_16x16x32_bf16 v[172:175], a[116:119], v[68:71], v[172:175]
    v_exp_f32 v58, v114
    v_mfma_f32_16x16x32_bf16 v[176:179], a[120:123], v[64:67], v[176:179]
    ds_read_b64_tr_b16 a[116:117], v5 offset:33536
    ds_read_b64_tr_b16 a[118:119], v5 offset:41728
    v_mfma_f32_16x16x32_bf16 v[180:183], a[120:123], v[68:71], v[180:183]
    buffer_load_dwordx4 v9, s[8:11], s29 offen offset:1056  lds
    v_mfma_f32_16x16x32_bf16 v[184:187], a[124:127], v[64:67], v[184:187]
    ds_read_b64_tr_b16 a[120:121], v6 offset:33536
    ds_read_b64_tr_b16 a[122:123], v6 offset:41728
    v_mfma_f32_16x16x32_bf16 v[188:191], a[124:127], v[68:71], v[188:191]
    v_exp_f32 v59, v115
    s_waitcnt lgkmcnt(6)
    v_mfma_f32_16x16x32_bf16 v[192:195], a[96:99], v[64:67], v[192:195]
    ds_read_b64_tr_b16 a[124:125], v7 offset:33536
    ds_read_b64_tr_b16 a[126:127], v7 offset:41728
    v_mfma_f32_16x16x32_bf16 v[196:199], a[96:99], v[68:71], v[196:199]
    v_add_f32 v62, v60, v56
    v_add_f32 v62, v62, v57
    v_mfma_f32_16x16x32_bf16 v[200:203], a[100:103], v[64:67], v[200:203]
    ds_read_b128 a[64:67], v2 offset:0
    v_cvt_pk_bf16_f32 v72, v56, v57
    v_mfma_f32_16x16x32_bf16 v[204:207], a[100:103], v[68:71], v[204:207]
    v_exp_f32 v56, v116
    v_mfma_f32_16x16x32_bf16 v[208:211], a[104:107], v[64:67], v[208:211]
    ds_read_b128 a[68:71], v2 offset:8448
    v_mfma_f32_16x16x32_bf16 v[212:215], a[104:107], v[68:71], v[212:215]
    buffer_load_dwordx4 v10, s[8:11], s29 offen offset:2112  lds
    v_mfma_f32_16x16x32_bf16 v[216:219], a[108:111], v[64:67], v[216:219]
    ds_read_b128 a[72:75], v2 offset:64
    v_mfma_f32_16x16x32_bf16 v[220:223], a[108:111], v[68:71], v[220:223]
    v_exp_f32 v57, v117
    v_add_f32 v62, v62, v58
    s_waitcnt lgkmcnt(3)
    v_mfma_f32_16x16x32_bf16 v[224:227], a[112:115], v[64:67], v[224:227]
    ds_read_b128 a[76:79], v2 offset:8512
    v_add_f32 v62, v62, v59
    v_cvt_pk_bf16_f32 v73, v58, v59
    v_mfma_f32_16x16x32_bf16 v[228:231], a[112:115], v[68:71], v[228:231]
    v_exp_f32 v58, v118
    v_mfma_f32_16x16x32_bf16 v[232:235], a[116:119], v[64:67], v[232:235]
    ds_read_b128 a[80:83], v3 offset:128
    v_mfma_f32_16x16x32_bf16 v[236:239], a[116:119], v[68:71], v[236:239]
    v_exp_f32 v59, v119
    v_add_f32 v63, v61, v56
    v_mfma_f32_16x16x32_bf16 v[240:243], a[120:123], v[64:67], v[240:243]
    ds_read_b128 a[84:87], v3 offset:8576
    v_mfma_f32_16x16x32_bf16 v[244:247], a[120:123], v[68:71], v[244:247]
    buffer_load_dwordx4 v11, s[8:11], s29 offen offset:3168  lds
    v_mfma_f32_16x16x32_bf16 v[248:251], a[124:127], v[64:67], v[248:251]
    ds_read_b128 a[88:91], v3 offset:192
    v_add_f32 v63, v63, v57
    v_mfma_f32_16x16x32_bf16 v[252:255], a[124:127], v[68:71], v[252:255]
    v_cvt_pk_bf16_f32 v76, v56, v57
    s_waitcnt lgkmcnt(3)
    v_mfma_f32_16x16x32_bf16 v[96:99], a[64:67], a[0:3], v[80:83]
    ds_read_b128 a[92:95], v3 offset:8640
    v_exp_f32 v56, v120
    v_mfma_f32_16x16x32_bf16 v[100:103], a[64:67], a[32:35], v[84:87]
    v_exp_f32 v57, v121
    v_mfma_f32_16x16x32_bf16 v[104:107], a[68:71], a[0:3], v[80:83]
    ds_read_b128 a[64:67], v2 offset:256
    s_add_u32 m0, s31, 16384
    v_add_f32 v63, v63, v58
    v_mfma_f32_16x16x32_bf16 v[108:111], a[68:71], a[32:35], v[84:87]
    v_add_f32 v63, v63, v59
    v_cvt_pk_bf16_f32 v77, v58, v59
    v_mfma_f32_16x16x32_bf16 v[96:99], a[72:75], a[4:7], v[96:99]
    ds_read_b128 a[68:71], v2 offset:8704
    v_mfma_f32_16x16x32_bf16 v[100:103], a[72:75], a[36:39], v[100:103]
    buffer_load_dwordx4 v12, s[12:15], s29 offen offset:0  lds
    v_mfma_f32_16x16x32_bf16 v[104:107], a[76:79], a[4:7], v[104:107]
    ds_read_b128 a[72:75], v2 offset:320
    v_mfma_f32_16x16x32_bf16 v[108:111], a[76:79], a[36:39], v[108:111]
    v_exp_f32 v58, v122
    s_waitcnt lgkmcnt(3)
    v_mfma_f32_16x16x32_bf16 v[96:99], a[80:83], a[8:11], v[96:99]
    ds_read_b128 a[76:79], v2 offset:8768
    v_exp_f32 v59, v123
    v_mfma_f32_16x16x32_bf16 v[100:103], a[80:83], a[40:43], v[100:103]
    v_add_f32 v62, v62, v56
    v_add_f32 v62, v62, v57
    v_mfma_f32_16x16x32_bf16 v[104:107], a[84:87], a[8:11], v[104:107]
    ds_read_b128 a[80:83], v3 offset:384
    v_cvt_pk_bf16_f32 v74, v56, v57
    v_mfma_f32_16x16x32_bf16 v[108:111], a[84:87], a[40:43], v[108:111]
    v_exp_f32 v56, v124
    v_mfma_f32_16x16x32_bf16 v[96:99], a[88:91], a[12:15], v[96:99]
    ds_read_b128 a[84:87], v3 offset:8832
    v_mfma_f32_16x16x32_bf16 v[100:103], a[88:91], a[44:47], v[100:103]
    buffer_load_dwordx4 v13, s[12:15], s29 offen offset:1024  lds
    v_mfma_f32_16x16x32_bf16 v[104:107], a[92:95], a[12:15], v[104:107]
    ds_read_b128 a[88:91], v3 offset:448
    v_mfma_f32_16x16x32_bf16 v[108:111], a[92:95], a[44:47], v[108:111]
    v_exp_f32 v57, v125
    v_add_f32 v62, v62, v58
    s_waitcnt lgkmcnt(3)
    v_mfma_f32_16x16x32_bf16 v[96:99], a[64:67], a[16:19], v[96:99]
    ds_read_b128 a[92:95], v3 offset:8896
    v_add_f32 v62, v62, v59
    v_cvt_pk_bf16_f32 v75, v58, v59
    v_mfma_f32_16x16x32_bf16 v[100:103], a[64:67], a[48:51], v[100:103]
    v_exp_f32 v58, v126
    v_mfma_f32_16x16x32_bf16 v[104:107], a[68:71], a[16:19], v[104:107]
    ds_read_b64_tr_b16 a[96:97], v4 offset:49152
    ds_read_b64_tr_b16 a[98:99], v4 offset:57344
    v_mfma_f32_16x16x32_bf16 v[108:111], a[68:71], a[48:51], v[108:111]
    v_exp_f32 v59, v127
    v_mfma_f32_16x16x32_bf16 v[96:99], a[72:75], a[20:23], v[96:99]
    ds_read_b64_tr_b16 a[100:101], v5 offset:49152
    ds_read_b64_tr_b16 a[102:103], v5 offset:57344
    v_mfma_f32_16x16x32_bf16 v[100:103], a[72:75], a[52:55], v[100:103]
    buffer_load_dwordx4 v14, s[12:15], s29 offen offset:2048  lds
    v_mfma_f32_16x16x32_bf16 v[104:107], a[76:79], a[20:23], v[104:107]
    ds_read_b64_tr_b16 a[104:105], v6 offset:49152
    ds_read_b64_tr_b16 a[106:107], v6 offset:57344
    v_mfma_f32_16x16x32_bf16 v[108:111], a[76:79], a[52:55], v[108:111]
    v_add_f32 v63, v63, v56
    s_waitcnt lgkmcnt(6)
    v_mfma_f32_16x16x32_bf16 v[96:99], a[80:83], a[24:27], v[96:99]
    ds_read_b64_tr_b16 a[108:109], v7 offset:49152
    ds_read_b64_tr_b16 a[110:111], v7 offset:57344
    v_add_f32 v63, v63, v57
    v_mfma_f32_16x16x32_bf16 v[100:103], a[80:83], a[56:59], v[100:103]
    v_cvt_pk_bf16_f32 v78, v56, v57
    v_add_f32 v63, v63, v58
    v_mfma_f32_16x16x32_bf16 v[104:107], a[84:87], a[24:27], v[104:107]
    ds_read_b64_tr_b16 a[112:113], v4 offset:49408
    ds_read_b64_tr_b16 a[114:115], v4 offset:57600
    v_mfma_f32_16x16x32_bf16 v[108:111], a[84:87], a[56:59], v[108:111]
    v_add_f32 v63, v63, v59
    v_cvt_pk_bf16_f32 v79, v58, v59
    v_mfma_f32_16x16x32_bf16 v[96:99], a[88:91], a[28:31], v[96:99]
    ds_read_b64_tr_b16 a[116:117], v5 offset:49408
    ds_read_b64_tr_b16 a[118:119], v5 offset:57600
    v_mfma_f32_16x16x32_bf16 v[100:103], a[88:91], a[60:63], v[100:103]
    buffer_load_dwordx4 v15, s[12:15], s29 offen offset:3072  lds
    v_max_f32 v56, v62, v63
    v_mfma_f32_16x16x32_bf16 v[104:107], a[92:95], a[28:31], v[104:107]
    ds_read_b64_tr_b16 a[120:121], v6 offset:49408
    ds_read_b64_tr_b16 a[122:123], v6 offset:57600
    v_mfma_f32_16x16x32_bf16 v[108:111], a[92:95], a[60:63], v[108:111]
    s_add_u32 s29, s29, 16384
    v_cmp_lt_f32 vcc, s33, v56
    s_cbranch_vccnz RARE_F2
CONT_F2:
    s_waitcnt lgkmcnt(6)
    v_mfma_f32_16x16x32_bf16 v[128:131], a[96:99], v[72:75], v[128:131]
    ds_read_b64_tr_b16 a[124:125], v7 offset:49408
    ds_read_b64_tr_b16 a[126:127], v7 offset:57600
    v_mfma_f32_16x16x32_bf16 v[132:135], a[96:99], v[76:79], v[132:135]
    s_waitcnt vmcnt(8)
    s_barrier
    v_mfma_f32_16x16x32_bf16 v[136:139], a[100:103], v[72:75], v[136:139]
    ds_read_b64_tr_b16 a[96:97], v4 offset:49664
    ds_read_b64_tr_b16 a[98:99], v4 offset:57856
    v_mfma_f32_16x16x32_bf16 v[140:143], a[100:103], v[76:79], v[140:143]
    s_add_u32 m0, s30, 0
    v_mfma_f32_16x16x32_bf16 v[144:147], a[104:107], v[72:75], v[144:147]
    ds_read_b64_tr_b16 a[100:101], v5 offset:49664
    ds_read_b64_tr_b16 a[102:103], v5 offset:57856
    v_mfma_f32_16x16x32_bf16 v[148:151], a[104:107], v[76:79], v[148:151]
    buffer_load_dwordx4 v8, s[8:11], s29 offen offset:0  lds
    v_mfma_f32_16x16x32_bf16 v[152:155], a[108:111], v[72:75], v[152:155]
    ds_read_b64_tr_b16 a[104:105], v6 offset:49664
    ds_read_b64_tr_b16 a[106:107], v6 offset:57856
    v_mfma_f32_16x16x32_bf16 v[156:159], a[108:111], v[76:79], v[156:159]
    v_exp_f32 v56, v96
    s_waitcnt lgkmcnt(6)
    v_mfma_f32_16x16x32_bf16 v[160:163], a[112:115], v[72:75], v[160:163]
    ds_read_b64_tr_b16 a[108:109], v7 offset:49664
    ds_read_b64_tr_b16 a[110:111], v7 offset:57856
    v_mfma_f32_16x16x32_bf16 v[164:167], a[112:115], v[76:79], v[164:167]
    v_exp_f32 v57, v97
    v_mfma_f32_16x16x32_bf16 v[168:171], a[116:119], v[72:75], v[168:171]
    ds_read_b64_tr_b16 a[112:113], v4 offset:49920
    ds_read_b64_tr_b16 a[114:115], v4 offset:58112
    v_mfma_f32_16x16x32_bf16 v[172:175], a[116:119], v[76:79], v[172:175]
    v_exp_f32 v58, v98
    v_mfma_f32_16x16x32_bf16 v[176:179], a[120:123], v[72:75], v[176:179]
    ds_read_b64_tr_b16 a[116:117], v5 offset:49920
    ds_read_b64_tr_b16 a[118:119], v5 offset:58112
    v_mfma_f32_16x16x32_bf16 v[180:183], a[120:123], v[76:79], v[180:183]
    buffer_load_dwordx4 v9, s[8:11], s29 offen offset:1056  lds
    v_mfma_f32_16x16x32_bf16 v[184:187], a[124:127], v[72:75], v[184:187]
    ds_read_b64_tr_b16 a[120:121], v6 offset:49920
    ds_read_b64_tr_b16 a[122:123], v6 offset:58112
    v_mfma_f32_16x16x32_bf16 v[188:191], a[124:127], v[76:79], v[188:191]
    v_exp_f32 v59, v99
    s_waitcnt lgkmcnt(6)
    v_mfma_f32_16x16x32_bf16 v[192:195], a[96:99], v[72:75], v[192:195]
    ds_read_b64_tr_b16 a[124:125], v7 offset:49920
    ds_read_b64_tr_b16 a[126:127], v7 offset:58112
    v_mfma_f32_16x16x32_bf16 v[196:199], a[96:99], v[76:79], v[196:199]
    v_add_f32 v60, v62, v56
    v_add_f32 v60, v60, v57
    v_mfma_f32_16x16x32_bf16 v[200:203], a[100:103], v[72:75], v[200:203]
    ds_read_b128 a[64:67], v2 offset:16896
    v_cvt_pk_bf16_f32 v64, v56, v57
    v_mfma_f32_16x16x32_bf16 v[204:207], a[100:103], v[76:79], v[204:207]
    v_exp_f32 v56, v100
    v_mfma_f32_16x16x32_bf16 v[208:211], a[104:107], v[72:75], v[208:211]
    ds_read_b128 a[68:71], v2 offset:25344
    v_mfma_f32_16x16x32_bf16 v[212:215], a[104:107], v[76:79], v[212:215]
    buffer_load_dwordx4 v10, s[8:11], s29 offen offset:2112  lds
    v_mfma_f32_16x16x32_bf16 v[216:219], a[108:111], v[72:75], v[216:219]
    ds_read_b128 a[72:75], v2 offset:16960
    v_mfma_f32_16x16x32_bf16 v[220:223], a[108:111], v[76:79], v[220:223]
    v_exp_f32 v57, v101
    v_add_f32 v60, v60, v58
    s_waitcnt lgkmcnt(3)
    v_mfma_f32_16x16x32_bf16 v[224:227], a[112:115], v[72:75], v[224:227]
    ds_read_b128 a[76:79], v2 offset:25408
    v_add_f32 v60, v60, v59
    v_cvt_pk_bf16_f32 v65, v58, v59
    v_mfma_f32_16x16x32_bf16 v[228:231], a[112:115], v[76:79], v[228:231]
    v_exp_f32 v58, v102
    v_mfma_f32_16x16x32_bf16 v[232:235], a[116:119], v[72:75], v[232:235]
    ds_read_b128 a[80:83], v3 offset:17024
    v_mfma_f32_16x16x32_bf16 v[236:239], a[116:119], v[76:79], v[236:239]
    v_exp_f32 v59, v103
    v_add_f32 v61, v63, v56
    v_mfma_f32_16x16x32_bf16 v[240:243], a[120:123], v[72:75], v[240:243]
    ds_read_b128 a[84:87], v3 offset:25472
    v_mfma_f32_16x16x32_bf16 v[244:247], a[120:123], v[76:79], v[244:247]
    buffer_load_dwordx4 v11, s[8:11], s29 offen offset:3168  lds
    v_mfma_f32_16x16x32_bf16 v[248:251], a[124:127], v[72:75], v[248:251]
    ds_read_b128 a[88:91], v3 offset:17088
    v_add_f32 v61, v61, v57
    v_mfma_f32_16x16x32_bf16 v[252:255], a[124:127], v[76:79], v[252:255]
    v_cvt_pk_bf16_f32 v68, v56, v57
    s_waitcnt lgkmcnt(3)
    v_mfma_f32_16x16x32_bf16 v[112:115], a[64:67], a[0:3], v[80:83]
    ds_read_b128 a[92:95], v3 offset:25536
    v_exp_f32 v56, v104
    v_mfma_f32_16x16x32_bf16 v[116:119], a[64:67], a[32:35], v[84:87]
    v_exp_f32 v57, v105
    v_mfma_f32_16x16x32_bf16 v[120:123], a[68:71], a[0:3], v[80:83]
    ds_read_b128 a[64:67], v2 offset:17152
    s_add_u32 m0, s31, 32768
    v_add_f32 v61, v61, v58
    v_mfma_f32_16x16x32_bf16 v[124:127], a[68:71], a[32:35], v[84:87]
    v_add_f32 v61, v61, v59
    v_cvt_pk_bf16_f32 v69, v58, v59
    v_mfma_f32_16x16x32_bf16 v[112:115], a[72:75], a[4:7], v[112:115]
    ds_read_b128 a[68:71], v2 offset:25600
    v_mfma_f32_16x16x32_bf16 v[116:119], a[72:75], a[36:39], v[116:119]
    buffer_load_dwordx4 v12, s[12:15], s29 offen offset:0  lds
    v_mfma_f32_16x16x32_bf16 v[120:123], a[76:79], a[4:7], v[120:123]
    ds_read_b128 a[72:75], v2 offset:17216
    v_mfma_f32_16x16x32_bf16 v[124:127], a[76:79], a[36:39], v[124:127]
    v_exp_f32 v58, v106
    s_waitcnt lgkmcnt(3)
    v_mfma_f32_16x16x32_bf16 v[112:115], a[80:83], a[8:11], v[112:115]
    ds_read_b128 a[76:79], v2 offset:25664
    v_exp_f32 v59, v107
    v_mfma_f32_16x16x32_bf16 v[116:119], a[80:83], a[40:43], v[116:119]
    v_add_f32 v60, v60, v56
    v_add_f32 v60, v60, v57
    v_mfma_f32_16x16x32_bf16 v[120:123], a[84:87], a[8:11], v[120:123]
    ds_read_b128 a[80:83], v3 offset:17280
    v_cvt_pk_bf16_f32 v66, v56, v57
    v_mfma_f32_16x16x32_bf16 v[124:127], a[84:87], a[40:43], v[124:127]
    v_exp_f32 v56, v108
    v_mfma_f32_16x16x32_bf16 v[112:115], a[88:91], a[12:15], v[112:115]
    ds_read_b128 a[84:87], v3 offset:25728
    v_mfma_f32_16x16x32_bf16 v[116:119], a[88:91], a[44:47], v[116:119]
    buffer_load_dwordx4 v13, s[12:15], s29 offen offset:1024  lds
    v_mfma_f32_16x16x32_bf16 v[120:123], a[92:95], a[12:15], v[120:123]
    ds_read_b128 a[88:91], v3 offset:17344
    v_mfma_f32_16x16x32_bf16 v[124:127], a[92:95], a[44:47], v[124:127]
    v_exp_f32 v57, v109
    v_add_f32 v60, v60, v58
    s_waitcnt lgkmcnt(3)
    v_mfma_f32_16x16x32_bf16 v[112:115], a[64:67], a[16:19], v[112:115]
    ds_read_b128 a[92:95], v3 offset:25792
    v_add_f32 v60, v60, v59
    v_cvt_pk_bf16_f32 v67, v58, v59
    v_mfma_f32_16x16x32_bf16 v[116:119], a[64:67], a[48:51], v[116:119]
    v_exp_f32 v58, v110
    v_mfma_f32_16x16x32_bf16 v[120:123], a[68:71], a[16:19], v[120:123]
    ds_read_b64_tr_b16 a[96:97], v4 offset:0
    ds_read_b64_tr_b16 a[98:99], v4 offset:8192
    v_mfma_f32_16x16x32_bf16 v[124:127], a[68:71], a[48:51], v[124:127]
    v_exp_f32 v59, v111
    v_mfma_f32_16x16x32_bf16 v[112:115], a[72:75], a[20:23], v[112:115]
    ds_read_b64_tr_b16 a[100:101], v5 offset:0
    ds_read_b64_tr_b16 a[102:103], v5 offset:8192
    v_mfma_f32_16x16x32_bf16 v[116:119], a[72:75], a[52:55], v[116:119]
    buffer_load_dwordx4 v14, s[12:15], s29 offen offset:2048  lds
    v_mfma_f32_16x16x32_bf16 v[120:123], a[76:79], a[20:23], v[120:123]
    ds_read_b64_tr_b16 a[104:105], v6 offset:0
    ds_read_b64_tr_b16 a[106:107], v6 offset:8192
    v_mfma_f32_16x16x32_bf16 v[124:127], a[76:79], a[52:55], v[124:127]
    v_add_f32 v61, v61, v56
    s_waitcnt lgkmcnt(6)
    v_mfma_f32_16x16x32_bf16 v[112:115], a[80:83], a[24:27], v[112:115]
    ds_read_b64_tr_b16 a[108:109], v7 offset:0
    ds_read_b64_tr_b16 a[110:111], v7 offset:8192
    v_add_f32 v61, v61, v57
    v_mfma_f32_16x16x32_bf16 v[116:119], a[80:83], a[56:59], v[116:119]
    v_cvt_pk_bf16_f32 v70, v56, v57
    v_add_f32 v61, v61, v58
    v_mfma_f32_16x16x32_bf16 v[120:123], a[84:87], a[24:27], v[120:123]
    ds_read_b64_tr_b16 a[112:113], v4 offset:256
    ds_read_b64_tr_b16 a[114:115], v4 offset:8448
    v_mfma_f32_16x16x32_bf16 v[124:127], a[84:87], a[56:59], v[124:127]
    v_add_f32 v61, v61, v59
    v_cvt_pk_bf16_f32 v71, v58, v59
    v_mfma_f32_16x16x32_bf16 v[112:115], a[88:91], a[28:31], v[112:115]
    ds_read_b64_tr_b16 a[116:117], v5 offset:256
    ds_read_b64_tr_b16 a[118:119], v5 offset:8448
    v_mfma_f32_16x16x32_bf16 v[116:119], a[88:91], a[60:63], v[116:119]
    buffer_load_dwordx4 v15, s[12:15], s29 offen offset:3072  lds
    v_max_f32 v56, v60, v61
    v_mfma_f32_16x16x32_bf16 v[120:123], a[92:95], a[28:31], v[120:123]
    ds_read_b64_tr_b16 a[120:121], v6 offset:256
    ds_read_b64_tr_b16 a[122:123], v6 offset:8448
    v_mfma_f32_16x16x32_bf16 v[124:127], a[92:95], a[60:63], v[124:127]
    s_add_u32 s29, s29, 16384
    v_cmp_lt_f32 vcc, s33, v56
    s_cbranch_vccnz RARE_F3
CONT_F3:
    s_mov_b32 s32, 14
.p2align 6
K1_LOOP:
    s_cmp_lg_u32 s32, 4
    s_cbranch_scc1 K1_NOPF
    s_mul_i32 s50, s44, 458752
    s_add_u32 s56, s42, s50
    s_addc_u32 s57, s43, 0
    s_and_b32 s57, s57, 0xffff
    s_mov_b32 s58, 458752
    s_mov_b32 s59, 0x00020000
    s_lshr_b32 s50, s2, 3
    s_mul_i32 s50, s50, 14336
    v_lshlrev_b32 v26, 7, v0
    v_min_u32 v26, 14208, v26
    buffer_load_dword v27, v26, s[56:59], s50 offen
K1_NOPF:
    s_cmp_lg_u32 s32, 1
    s_cbranch_scc1 K1_NOPF1
    s_load_dwordx2 s[56:57], s[0:1], 48
    s_waitcnt lgkmcnt(0)
    s_and_b32 s57, s57, 0xffff
    s_mov_b32 s58, 1605632
    s_mov_b32 s59, 0x00020000
    s_lshr_b32 s50, s2, 3
    s_mul_i32 s50, s50, 50176
    v_lshlrev_b32 v26, 7, v0
    buffer_load_dword v27, v26, s[56:59], s50 offen
    v_add_u32 v26, 32768, v26
    v_min_u32 v26, 50048, v26
    buffer_load_dword v28, v26, s[56:59], s50 offen
K1_NOPF1:
    s_waitcnt lgkmcnt(6)
    v_mfma_f32_16x16x32_bf16 v[128:131], a[96:99], v[64:67], v[128:131]
    ds_read_b64_tr_b16 a[124:125], v7 offset:256
    ds_read_b64_tr_b16 a[126:127], v7 offset:8448
    v_mfma_f32_16x16x32_bf16 v[132:135], a[96:99], v[68:71], v[132:135]
    s_waitcnt vmcnt(8)
    s_barrier
    v_mfma_f32_16x16x32_bf16 v[136:139], a[100:103], v[64:67], v[136:139]
    ds_read_b64_tr_b16 a[96:97], v4 offset:512
    ds_read_b64_tr_b16 a[98:99], v4 offset:8704
    v_mfma_f32_16x16x32_bf16 v[140:143], a[100:103], v[68:71], v[140:143]
    s_add_u32 m0, s30, 16896
    v_mfma_f32_16x16x32_bf16 v[144:147], a[104:107], v[64:67], v[144:147]
    ds_read_b64_tr_b16 a[100:101], v5 offset:512
    ds_read_b64_tr_b16 a[102:103], v5 offset:8704
    v_mfma_f32_16x16x32_bf16 v[148:151], a[104:107], v[68:71], v[148:151]
    buffer_load_dwordx4 v8, s[8:11], s29 offen offset:0  lds
    v_mfma_f32_16x16x32_bf16 v[152:155], a[108:111], v[64:67], v[152:155]
    ds_read_b64_tr_b16 a[104:105], v6 offset:512
    ds_read_b64_tr_b16 a[106:107], v6 offset:8704
    v_mfma_f32_16x16x32_bf16 v[156:159], a[108:111], v[68:71], v[156:159]
    v_exp_f32 v56, v112
    s_waitcnt lgkmcnt(6)
    v_mfma_f32_16x16x32_bf16 v[160:163], a[112:115], v[64:67], v[160:163]
    ds_read_b64_tr_b16 a[108:109], v7 offset:512
    ds_read_b64_tr_b16 a[110:111], v7 offset:8704
    v_mfma_f32_16x16x32_bf16 v[164:167], a[112:115], v[68:71], v[164:167]
    v_exp_f32 v57, v113
    v_mfma_f32_16x16x32_bf16 v[168:171], a[116:119], v[64:67], v[168:171]
    ds_read_b64_tr_b16 a[112:113], v4 offset:768
    ds_read_b64_tr_b16 a[114:115], v4 offset:8960
    v_mfma_f32_16x16x32_bf16 v[172:175], a[116:119], v[68:71], v[172:175]
    v_exp_f32 v58, v114
    v_mfma_f32_16x16x32_bf16 v[176:179], a[120:123], v[64:67], v[176:179]
    ds_read_b64_tr_b16 a[116:117], v5 offset:768
    ds_read_b64_tr_b16 a[118:119], v5 offset:8960
    v_mfma_f32_16x16x32_bf16 v[180:183], a[120:123], v[68:71], v[180:183]
    buffer_load_dwordx4 v9, s[8:11], s29 offen offset:1056  lds
    v_mfma_f32_16x16x32_bf16 v[184:187], a[124:127], v[64:67], v[184:187]
    ds_read_b64_tr_b16 a[120:121], v6 offset:768
    ds_read_b64_tr_b16 a[122:123], v6 offset:8960
    v_mfma_f32_16x16x32_bf16 v[188:191], a[124:127], v[68:71], v[188:191]
    v_exp_f32 v59, v115
    s_waitcnt lgkmcnt(6)
    v_mfma_f32_16x16x32_bf16 v[192:195], a[96:99], v[64:67], v[192:195]
    ds_read_b64_tr_b16 a[124:125], v7 offset:768
    ds_read_b64_tr_b16 a[126:127], v7 offset:8960
    v_mfma_f32_16x16x32_bf16 v[196:199], a[96:99], v[68:71], v[196:199]
    v_add_f32 v62, v60, v56
    v_add_f32 v62, v62, v57
    v_mfma_f32_16x16x32_bf16 v[200:203], a[100:103], v[64:67], v[200:203]
    ds_read_b128 a[64:67], v2 offset:33792
    v_cvt_pk_bf16_f32 v72, v56, v57
    v_mfma_f32_16x16x32_bf16 v[204:207], a[100:103], v[68:71], v[204:207]
    v_exp_f32 v56, v116
    v_mfma_f32_16x16x32_bf16 v[208:211], a[104:107], v[64:67], v[208:211]
    ds_read_b128 a[68:71], v2 offset:42240
    v_mfma_f32_16x16x32_bf16 v[212:215], a[104:107], v[68:71], v[212:215]
    buffer_load_dwordx4 v10, s[8:11], s29 offen offset:2112  lds
    v_mfma_f32_16x16x32_bf16 v[216:219], a[108:111], v[64:67], v[216:219]
    ds_read_b128 a[72:75], v2 offset:33856
    v_mfma_f32_16x16x32_bf16 v[220:223], a[108:111], v[68:71], v[220:223]
    v_exp_f32 v57, v117
    v_add_f32 v62, v62, v58
    s_waitcnt lgkmcnt(3)
    v_mfma_f32_16x16x32_bf16 v[224:227], a[112:115], v[64:67], v[224:227]
    ds_read_b128 a[76:79], v2 offset:42304
    v_add_f32 v62, v62, v59
    v_cvt_pk_bf16_f32 v73, v58, v59
    v_mfma_f32_16x16x32_bf16 v[228:231], a[112:115], v[68:71], v[228:231]
    v_exp_f32 v58, v118
    v_mfma_f32_16x16x32_bf16 v[232:235], a[116:119], v[64:67], v[232:235]
    ds_read_b128 a[80:83], v3 offset:33920
    v_mfma_f32_16x16x32_bf16 v[236:239], a[116:119], v[68:71], v[236:239]
    v_exp_f32 v59, v119
    v_add_f32 v63, v61, v56
    v_mfma_f32_16x16x32_bf16 v[240:243], a[120:123], v[64:67], v[240:243]
    ds_read_b128 a[84:87], v3 offset:42368
    v_mfma_f32_16x16x32_bf16 v[244:247], a[120:123], v[68:71], v[244:247]
    buffer_load_dwordx4 v11, s[8:11], s29 offen offset:3168  lds
    v_mfma_f32_16x16x32_bf16 v[248:251], a[124:127], v[64:67], v[248:251]
    ds_read_b128 a[88:91], v3 offset:33984
    v_add_f32 v63, v63, v57
    v_mfma_f32_16x16x32_bf16 v[252:255], a[124:127], v[68:71], v[252:255]
    v_cvt_pk_bf16_f32 v76, v56, v57
    s_waitcnt lgkmcnt(3)
    v_mfma_f32_16x16x32_bf16 v[96:99], a[64:67], a[0:3], v[80:83]
    ds_read_b128 a[92:95], v3 offset:42432
    v_exp_f32 v56, v120
    v_mfma_f32_16x16x32_bf16 v[100:103], a[64:67], a[32:35], v[84:87]
    v_exp_f32 v57, v121
    v_mfma_f32_16x16x32_bf16 v[104:107], a[68:71], a[0:3], v[80:83]
    ds_read_b128 a[64:67], v2 offset:34048
    s_add_u32 m0, s31, 49152
    v_add_f32 v63, v63, v58
    v_mfma_f32_16x16x32_bf16 v[108:111], a[68:71], a[32:35], v[84:87]
    v_add_f32 v63, v63, v59
    v_cvt_pk_bf16_f32 v77, v58, v59
    v_mfma_f32_16x16x32_bf16 v[96:99], a[72:75], a[4:7], v[96:99]
    ds_read_b128 a[68:71], v2 offset:42496
    v_mfma_f32_16x16x32_bf16 v[100:103], a[72:75], a[36:39], v[100:103]
    buffer_load_dwordx4 v12, s[12:15], s29 offen offset:0  lds
    v_mfma_f32_16x16x32_bf16 v[104:107], a[76:79], a[4:7], v[104:107]
    ds_read_b128 a[72:75], v2 offset:34112
    v_mfma_f32_16x16x32_bf16 v[108:111], a[76:79], a[36:39], v[108:111]
    v_exp_f32 v58, v122
    s_waitcnt lgkmcnt(3)
    v_mfma_f32_16x16x32_bf16 v[96:99], a[80:83], a[8:11], v[96:99]
    ds_read_b128 a[76:79], v2 offset:42560
    v_exp_f32 v59, v123
    v_mfma_f32_16x16x32_bf16 v[100:103], a[80:83], a[40:43], v[100:103]
    v_add_f32 v62, v62, v56
    v_add_f32 v62, v62, v57
    v_mfma_f32_16x16x32_bf16 v[104:107], a[84:87], a[8:11], v[104:107]
    ds_read_b128 a[80:83], v3 offset:34176
    v_cvt_pk_bf16_f32 v74, v56, v57
    v_mfma_f32_16x16x32_bf16 v[108:111], a[84:87], a[40:43], v[108:111]
    v_exp_f32 v56, v124
    v_mfma_f32_16x16x32_bf16 v[96:99], a[88:91], a[12:15], v[96:99]
    ds_read_b128 a[84:87], v3 offset:42624
    v_mfma_f32_16x16x32_bf16 v[100:103], a[88:91], a[44:47], v[100:103]
    buffer_load_dwordx4 v13, s[12:15], s29 offen offset:1024  lds
    v_mfma_f32_16x16x32_bf16 v[104:107], a[92:95], a[12:15], v[104:107]
    ds_read_b128 a[88:91], v3 offset:34240
    v_mfma_f32_16x16x32_bf16 v[108:111], a[92:95], a[44:47], v[108:111]
    v_exp_f32 v57, v125
    v_add_f32 v62, v62, v58
    s_waitcnt lgkmcnt(3)
    v_mfma_f32_16x16x32_bf16 v[96:99], a[64:67], a[16:19], v[96:99]
    ds_read_b128 a[92:95], v3 offset:42688
    v_add_f32 v62, v62, v59
    v_cvt_pk_bf16_f32 v75, v58, v59
    v_mfma_f32_16x16x32_bf16 v[100:103], a[64:67], a[48:51], v[100:103]
    v_exp_f32 v58, v126
    v_mfma_f32_16x16x32_bf16 v[104:107], a[68:71], a[16:19], v[104:107]
    ds_read_b64_tr_b16 a[96:97], v4 offset:16384
    ds_read_b64_tr_b16 a[98:99], v4 offset:24576
    v_mfma_f32_16x16x32_bf16 v[108:111], a[68:71], a[48:51], v[108:111]
    v_exp_f32 v59, v127
    v_mfma_f32_16x16x32_bf16 v[96:99], a[72:75], a[20:23], v[96:99]
    ds_read_b64_tr_b16 a[100:101], v5 offset:16384
    ds_read_b64_tr_b16 a[102:103], v5 offset:24576
    v_mfma_f32_16x16x32_bf16 v[100:103], a[72:75], a[52:55], v[100:103]
    buffer_load_dwordx4 v14, s[12:15], s29 offen offset:2048  lds
    v_mfma_f32_16x16x32_bf16 v[104:107], a[76:79], a[20:23], v[104:107]
    ds_read_b64_tr_b16 a[104:105], v6 offset:16384
    ds_read_b64_tr_b16 a[106:107], v6 offset:24576
    v_mfma_f32_16x16x32_bf16 v[108:111], a[76:79], a[52:55], v[108:111]
    v_add_f32 v63, v63, v56
    s_waitcnt lgkmcnt(6)
    v_mfma_f32_16x16x32_bf16 v[96:99], a[80:83], a[24:27], v[96:99]
    ds_read_b64_tr_b16 a[108:109], v7 offset:16384
    ds_read_b64_tr_b16 a[110:111], v7 offset:24576
    v_add_f32 v63, v63, v57
    v_mfma_f32_16x16x32_bf16 v[100:103], a[80:83], a[56:59], v[100:103]
    v_cvt_pk_bf16_f32 v78, v56, v57
    v_add_f32 v63, v63, v58
    v_mfma_f32_16x16x32_bf16 v[104:107], a[84:87], a[24:27], v[104:107]
    ds_read_b64_tr_b16 a[112:113], v4 offset:16640
    ds_read_b64_tr_b16 a[114:115], v4 offset:24832
    v_mfma_f32_16x16x32_bf16 v[108:111], a[84:87], a[56:59], v[108:111]
    v_add_f32 v63, v63, v59
    v_cvt_pk_bf16_f32 v79, v58, v59
    v_mfma_f32_16x16x32_bf16 v[96:99], a[88:91], a[28:31], v[96:99]
    ds_read_b64_tr_b16 a[116:117], v5 offset:16640
    ds_read_b64_tr_b16 a[118:119], v5 offset:24832
    v_mfma_f32_16x16x32_bf16 v[100:103], a[88:91], a[60:63], v[100:103]
    buffer_load_dwordx4 v15, s[12:15], s29 offen offset:3072  lds
    v_max_f32 v56, v62, v63
    v_mfma_f32_16x16x32_bf16 v[104:107], a[92:95], a[28:31], v[104:107]
    ds_read_b64_tr_b16 a[120:121], v6 offset:16640
    ds_read_b64_tr_b16 a[122:123], v6 offset:24832
    v_mfma_f32_16x16x32_bf16 v[108:111], a[92:95], a[60:63], v[108:111]
    s_add_u32 s29, s29, 16384
    v_cmp_lt_f32 vcc, s33, v56
    s_cbranch_vccnz RARE_M0
CONT_M0:
    s_waitcnt lgkmcnt(6)
    v_mfma_f32_16x16x32_bf16 v[128:131], a[96:99], v[72:75], v[128:131]
    ds_read_b64_tr_b16 a[124:125], v7 offset:16640
    ds_read_b64_tr_b16 a[126:127], v7 offset:24832
    v_mfma_f32_16x16x32_bf16 v[132:135], a[96:99], v[76:79], v[132:135]
    s_waitcnt vmcnt(8)
    s_barrier
    v_mfma_f32_16x16x32_bf16 v[136:139], a[100:103], v[72:75], v[136:139]
    ds_read_b64_tr_b16 a[96:97], v4 offset:16896
    ds_read_b64_tr_b16 a[98:99], v4 offset:25088
    v_mfma_f32_16x16x32_bf16 v[140:143], a[100:103], v[76:79], v[140:143]
    s_add_u32 m0, s30, 33792
    v_mfma_f32_16x16x32_bf16 v[144:147], a[104:107], v[72:75], v[144:147]
    ds_read_b64_tr_b16 a[100:101], v5 offset:16896
    ds_read_b64_tr_b16 a[102:103], v5 offset:25088
    v_mfma_f32_16x16x32_bf16 v[148:151], a[104:107], v[76:79], v[148:151]
    buffer_load_dwordx4 v8, s[8:11], s29 offen offset:0  lds
    v_mfma_f32_16x16x32_bf16 v[152:155], a[108:111], v[72:75], v[152:155]
    ds_read_b64_tr_b16 a[104:105], v6 offset:16896
    ds_read_b64_tr_b16 a[106:107], v6 offset:25088
    v_mfma_f32_16x16x32_bf16 v[156:159], a[108:111], v[76:79], v[156:159]
    v_exp_f32 v56, v96
    s_waitcnt lgkmcnt(6)
    v_mfma_f32_16x16x32_bf16 v[160:163], a[112:115], v[72:75], v[160:163]
    ds_read_b64_tr_b16 a[108:109], v7 offset:16896
    ds_read_b64_tr_b16 a[110:111], v7 offset:25088
    v_mfma_f32_16x16x32_bf16 v[164:167], a[112:115], v[76:79], v[164:167]
    v_exp_f32 v57, v97
    v_mfma_f32_16x16x32_bf16 v[168:171], a[116:119], v[72:75], v[168:171]
    ds_read_b64_tr_b16 a[112:113], v4 offset:17152
    ds_read_b64_tr_b16 a[114:115], v4 offset:25344
    v_mfma_f32_16x16x32_bf16 v[172:175], a[116:119], v[76:79], v[172:175]
    v_exp_f32 v58, v98
    v_mfma_f32_16x16x32_bf16 v[176:179], a[120:123], v[72:75], v[176:179]
    ds_read_b64_tr_b16 a[116:117], v5 offset:17152
    ds_read_b64_tr_b16 a[118:119], v5 offset:25344
    v_mfma_f32_16x16x32_bf16 v[180:183], a[120:123], v[76:79], v[180:183]
    buffer_load_dwordx4 v9, s[8:11], s29 offen offset:1056  lds
    v_mfma_f32_16x16x32_bf16 v[184:187], a[124:127], v[72:75], v[184:187]
    ds_read_b64_tr_b16 a[120:121], v6 offset:17152
    ds_read_b64_tr_b16 a[122:123], v6 offset:25344
    v_mfma_f32_16x16x32_bf16 v[188:191], a[124:127], v[76:79], v[188:191]
    v_exp_f32 v59, v99
    s_waitcnt lgkmcnt(6)
    v_mfma_f32_16x16x32_bf16 v[192:195], a[96:99], v[72:75], v[192:195]
    ds_read_b64_tr_b16 a[124:125], v7 offset:17152
    ds_read_b64_tr_b16 a[126:127], v7 offset:25344
    v_mfma_f32_16x16x32_bf16 v[196:199], a[96:99], v[76:79], v[196:199]
    v_add_f32 v60, v62, v56
    v_add_f32 v60, v60, v57
    v_mfma_f32_16x16x32_bf16 v[200:203], a[100:103], v[72:75], v[200:203]
    ds_read_b128 a[64:67], v2 offset:50688
    v_cvt_pk_bf16_f32 v64, v56, v57
    v_mfma_f32_16x16x32_bf16 v[204:207], a[100:103], v[76:79], v[204:207]
    v_exp_f32 v56, v100
    v_mfma_f32_16x16x32_bf16 v[208:211], a[104:107], v[72:75], v[208:211]
    ds_read_b128 a[68:71], v2 offset:59136
    v_mfma_f32_16x16x32_bf16 v[212:215], a[104:107], v[76:79], v[212:215]
    buffer_load_dwordx4 v10, s[8:11], s29 offen offset:2112  lds
    v_mfma_f32_16x16x32_bf16 v[216:219], a[108:111], v[72:75], v[216:219]
    ds_read_b128 a[72:75], v2 offset:50752
    v_mfma_f32_16x16x32_bf16 v[220:223], a[108:111], v[76:79], v[220:223]
    v_exp_f32 v57, v101
    v_add_f32 v60, v60, v58
    s_waitcnt lgkmcnt(3)
    v_mfma_f32_16x16x32_bf16 v[224:227], a[112:115], v[72:75], v[224:227]
    ds_read_b128 a[76:79], v2 offset:59200
    v_add_f32 v60, v60, v59
    v_cvt_pk_bf16_f32 v65, v58, v59
    v_mfma_f32_16x16x32_bf16 v[228:231], a[112:115], v[76:79], v[228:231]
    v_exp_f32 v58, v102
    v_mfma_f32_16x16x32_bf16 v[232:235], a[116:119], v[72:75], v[232:235]
    ds_read_b128 a[80:83], v3 offset:50816
    v_mfma_f32_16x16x32_bf16 v[236:239], a[116:119], v[76:79], v[236:239]
    v_exp_f32 v59, v103
    v_add_f32 v61, v63, v56
    v_mfma_f32_16x16x32_bf16 v[240:243], a[120:123], v[72:75], v[240:243]
    ds_read_b128 a[84:87], v3 offset:59264
    v_mfma_f32_16x16x32_bf16 v[244:247], a[120:123], v[76:79], v[244:247]
    buffer_load_dwordx4 v11, s[8:11], s29 offen offset:3168  lds
    v_mfma_f32_16x16x32_bf16 v[248:251], a[124:127], v[72:75], v[248:251]
    ds_read_b128 a[88:91], v3 offset:50880
    v_add_f32 v61, v61, v57
    v_mfma_f32_16x16x32_bf16 v[252:255], a[124:127], v[76:79], v[252:255]
    v_cvt_pk_bf16_f32 v68, v56, v57
    s_waitcnt lgkmcnt(3)
    v_mfma_f32_16x16x32_bf16 v[112:115], a[64:67], a[0:3], v[80:83]
    ds_read_b128 a[92:95], v3 offset:59328
    v_exp_f32 v56, v104
    v_mfma_f32_16x16x32_bf16 v[116:119], a[64:67], a[32:35], v[84:87]
    v_exp_f32 v57, v105
    v_mfma_f32_16x16x32_bf16 v[120:123], a[68:71], a[0:3], v[80:83]
    ds_read_b128 a[64:67], v2 offset:50944
    s_add_u32 m0, s31, 0
    v_add_f32 v61, v61, v58
    v_mfma_f32_16x16x32_bf16 v[124:127], a[68:71], a[32:35], v[84:87]
    v_add_f32 v61, v61, v59
    v_cvt_pk_bf16_f32 v69, v58, v59
    v_mfma_f32_16x16x32_bf16 v[112:115], a[72:75], a[4:7], v[112:115]
    ds_read_b128 a[68:71], v2 offset:59392
    v_mfma_f32_16x16x32_bf16 v[116:119], a[72:75], a[36:39], v[116:119]
    buffer_load_dwordx4 v12, s[12:15], s29 offen offset:0  lds
    v_mfma_f32_16x16x32_bf16 v[120:123], a[76:79], a[4:7], v[120:123]
    ds_read_b128 a[72:75], v2 offset:51008
    v_mfma_f32_16x16x32_bf16 v[124:127], a[76:79], a[36:39], v[124:127]
    v_exp_f32 v58, v106
    s_waitcnt lgkmcnt(3)
    v_mfma_f32_16x16x32_bf16 v[112:115], a[80:83], a[8:11], v[112:115]
    ds_read_b128 a[76:79], v2 offset:59456
    v_exp_f32 v59, v107
    v_mfma_f32_16x16x32_bf16 v[116:119], a[80:83], a[40:43], v[116:119]
    v_add_f32 v60, v60, v56
    v_add_f32 v60, v60, v57
    v_mfma_f32_16x16x32_bf16 v[120:123], a[84:87], a[8:11], v[120:123]
    ds_read_b128 a[80:83], v3 offset:51072
    v_cvt_pk_bf16_f32 v66, v56, v57
    v_mfma_f32_16x16x32_bf16 v[124:127], a[84:87], a[40:43], v[124:127]
    v_exp_f32 v56, v108
    v_mfma_f32_16x16x32_bf16 v[112:115], a[88:91], a[12:15], v[112:115]
    ds_read_b128 a[84:87], v3 offset:59520
    v_mfma_f32_16x16x32_bf16 v[116:119], a[88:91], a[44:47], v[116:119]
    buffer_load_dwordx4 v13, s[12:15], s29 offen offset:1024  lds
    v_mfma_f32_16x16x32_bf16 v[120:123], a[92:95], a[12:15], v[120:123]
    ds_read_b128 a[88:91], v3 offset:51136
    v_mfma_f32_16x16x32_bf16 v[124:127], a[92:95], a[44:47], v[124:127]
    v_exp_f32 v57, v109
    v_add_f32 v60, v60, v58
    s_waitcnt lgkmcnt(3)
    v_mfma_f32_16x16x32_bf16 v[112:115], a[64:67], a[16:19], v[112:115]
    ds_read_b128 a[92:95], v3 offset:59584
    v_add_f32 v60, v60, v59
    v_cvt_pk_bf16_f32 v67, v58, v59
    v_mfma_f32_16x16x32_bf16 v[116:119], a[64:67], a[48:51], v[116:119]
    v_exp_f32 v58, v110
    v_mfma_f32_16x16x32_bf16 v[120:123], a[68:71], a[16:19], v[120:123]
    ds_read_b64_tr_b16 a[96:97], v4 offset:32768
    ds_read_b64_tr_b16 a[98:99], v4 offset:40960
    v_mfma_f32_16x16x32_bf16 v[124:127], a[68:71], a[48:51], v[124:127]
    v_exp_f32 v59, v111
    v_mfma_f32_16x16x32_bf16 v[112:115], a[72:75], a[20:23], v[112:115]
    ds_read_b64_tr_b16 a[100:101], v5 offset:32768
    ds_read_b64_tr_b16 a[102:103], v5 offset:40960
    v_mfma_f32_16x16x32_bf16 v[116:119], a[72:75], a[52:55], v[116:119]
    buffer_load_dwordx4 v14, s[12:15], s29 offen offset:2048  lds
    v_mfma_f32_16x16x32_bf16 v[120:123], a[76:79], a[20:23], v[120:123]
    ds_read_b64_tr_b16 a[104:105], v6 offset:32768
    ds_read_b64_tr_b16 a[106:107], v6 offset:40960
    v_mfma_f32_16x16x32_bf16 v[124:127], a[76:79], a[52:55], v[124:127]
    v_add_f32 v61, v61, v56
    s_waitcnt lgkmcnt(6)
    v_mfma_f32_16x16x32_bf16 v[112:115], a[80:83], a[24:27], v[112:115]
    ds_read_b64_tr_b16 a[108:109], v7 offset:32768
    ds_read_b64_tr_b16 a[110:111], v7 offset:40960
    v_add_f32 v61, v61, v57
    v_mfma_f32_16x16x32_bf16 v[116:119], a[80:83], a[56:59], v[116:119]
    v_cvt_pk_bf16_f32 v70, v56, v57
    v_add_f32 v61, v61, v58
    v_mfma_f32_16x16x32_bf16 v[120:123], a[84:87], a[24:27], v[120:123]
    ds_read_b64_tr_b16 a[112:113], v4 offset:33024
    ds_read_b64_tr_b16 a[114:115], v4 offset:41216
    v_mfma_f32_16x16x32_bf16 v[124:127], a[84:87], a[56:59], v[124:127]
    v_add_f32 v61, v61, v59
    v_cvt_pk_bf16_f32 v71, v58, v59
    v_mfma_f32_16x16x32_bf16 v[112:115], a[88:91], a[28:31], v[112:115]
    ds_read_b64_tr_b16 a[116:117], v5 offset:33024
    ds_read_b64_tr_b16 a[118:119], v5 offset:41216
    v_mfma_f32_16x16x32_bf16 v[116:119], a[88:91], a[60:63], v[116:119]
    buffer_load_dwordx4 v15, s[12:15], s29 offen offset:3072  lds
    v_max_f32 v56, v60, v61
    v_mfma_f32_16x16x32_bf16 v[120:123], a[92:95], a[28:31], v[120:123]
    ds_read_b64_tr_b16 a[120:121], v6 offset:33024
    ds_read_b64_tr_b16 a[122:123], v6 offset:41216
    v_mfma_f32_16x16x32_bf16 v[124:127], a[92:95], a[60:63], v[124:127]
    s_add_u32 s29, s29, 16384
    v_cmp_lt_f32 vcc, s33, v56
    s_cbranch_vccnz RARE_M1
CONT_M1:
    s_waitcnt lgkmcnt(6)
    v_mfma_f32_16x16x32_bf16 v[128:131], a[96:99], v[64:67], v[128:131]
    ds_read_b64_tr_b16 a[124:125], v7 offset:33024
    ds_read_b64_tr_b16 a[126:127], v7 offset:41216
    v_mfma_f32_16x16x32_bf16 v[132:135], a[96:99], v[68:71], v[132:135]
    s_waitcnt vmcnt(8)
    s_barrier
    v_mfma_f32_16x16x32_bf16 v[136:139], a[100:103], v[64:67], v[136:139]
    ds_read_b64_tr_b16 a[96:97], v4 offset:33280
    ds_read_b64_tr_b16 a[98:99], v4 offset:41472
    v_mfma_f32_16x16x32_bf16 v[140:143], a[100:103], v[68:71], v[140:143]
    s_add_u32 m0, s30, 50688
    v_mfma_f32_16x16x32_bf16 v[144:147], a[104:107], v[64:67], v[144:147]
    ds_read_b64_tr_b16 a[100:101], v5 offset:33280
    ds_read_b64_tr_b16 a[102:103], v5 offset:41472
    v_mfma_f32_16x16x32_bf16 v[148:151], a[104:107], v[68:71], v[148:151]
    buffer_load_dwordx4 v8, s[8:11], s29 offen offset:0  lds
    v_mfma_f32_16x16x32_bf16 v[152:155], a[108:111], v[64:67], v[152:155]
    ds_read_b64_tr_b16 a[104:105], v6 offset:33280
    ds_read_b64_tr_b16 a[106:107], v6 offset:41472
    v_mfma_f32_16x16x32_bf16 v[156:159], a[108:111], v[68:71], v[156:159]
    v_exp_f32 v56, v112
    s_waitcnt lgkmcnt(6)
    v_mfma_f32_16x16x32_bf16 v[160:163], a[112:115], v[64:67], v[160:163]
    ds_read_b64_tr_b16 a[108:109], v7 offset:33280
    ds_read_b64_tr_b16 a[110:111], v7 offset:41472
    v_mfma_f32_16x16x32_bf16 v[164:167], a[112:115], v[68:71], v[164:167]
    v_exp_f32 v57, v113
    v_mfma_f32_16x16x32_bf16 v[168:171], a[116:119], v[64:67], v[168:171]
    ds_read_b64_tr_b16 a[112:113], v4 offset:33536
    ds_read_b64_tr_b16 a[114:115], v4 offset:41728
    v_mfma_f32_16x16x32_bf16 v[172:175], a[116:119], v[68:71], v[172:175]
    v_exp_f32 v58, v114
    v_mfma_f32_16x16x32_bf16 v[176:179], a[120:123], v[64:67], v[176:179]
    ds_read_b64_tr_b16 a[116:117], v5 offset:33536
    ds_read_b64_tr_b16 a[118:119], v5 offset:41728
    v_mfma_f32_16x16x32_bf16 v[180:183], a[120:123], v[68:71], v[180:183]
    buffer_load_dwordx4 v9, s[8:11], s29 offen offset:1056  lds
    v_mfma_f32_16x16x32_bf16 v[184:187], a[124:127], v[64:67], v[184:187]
    ds_read_b64_tr_b16 a[120:121], v6 offset:33536
    ds_read_b64_tr_b16 a[122:123], v6 offset:41728
    v_mfma_f32_16x16x32_bf16 v[188:191], a[124:127], v[68:71], v[188:191]
    v_exp_f32 v59, v115
    s_waitcnt lgkmcnt(6)
    v_mfma_f32_16x16x32_bf16 v[192:195], a[96:99], v[64:67], v[192:195]
    ds_read_b64_tr_b16 a[124:125], v7 offset:33536
    ds_read_b64_tr_b16 a[126:127], v7 offset:41728
    v_mfma_f32_16x16x32_bf16 v[196:199], a[96:99], v[68:71], v[196:199]
    v_add_f32 v62, v60, v56
    v_add_f32 v62, v62, v57
    v_mfma_f32_16x16x32_bf16 v[200:203], a[100:103], v[64:67], v[200:203]
    ds_read_b128 a[64:67], v2 offset:0
    v_cvt_pk_bf16_f32 v72, v56, v57
    v_mfma_f32_16x16x32_bf16 v[204:207], a[100:103], v[68:71], v[204:207]
    v_exp_f32 v56, v116
    v_mfma_f32_16x16x32_bf16 v[208:211], a[104:107], v[64:67], v[208:211]
    ds_read_b128 a[68:71], v2 offset:8448
    v_mfma_f32_16x16x32_bf16 v[212:215], a[104:107], v[68:71], v[212:215]
    buffer_load_dwordx4 v10, s[8:11], s29 offen offset:2112  lds
    v_mfma_f32_16x16x32_bf16 v[216:219], a[108:111], v[64:67], v[216:219]
    ds_read_b128 a[72:75], v2 offset:64
    v_mfma_f32_16x16x32_bf16 v[220:223], a[108:111], v[68:71], v[220:223]
    v_exp_f32 v57, v117
    v_add_f32 v62, v62, v58
    s_waitcnt lgkmcnt(3)
    v_mfma_f32_16x16x32_bf16 v[224:227], a[112:115], v[64:67], v[224:227]
    ds_read_b128 a[76:79], v2 offset:8512
    v_add_f32 v62, v62, v59
    v_cvt_pk_bf16_f32 v73, v58, v59
    v_mfma_f32_16x16x32_bf16 v[228:231], a[112:115], v[68:71], v[228:231]
    v_exp_f32 v58, v118
    v_mfma_f32_16x16x32_bf16 v[232:235], a[116:119], v[64:67], v[232:235]
    ds_read_b128 a[80:83], v3 offset:128
    v_mfma_f32_16x16x32_bf16 v[236:239], a[116:119], v[68:71], v[236:239]
    v_exp_f32 v59, v119
    v_add_f32 v63, v61, v56
    v_mfma_f32_16x16x32_bf16 v[240:243], a[120:123], v[64:67], v[240:243]
    ds_read_b128 a[84:87], v3 offset:8576
    v_mfma_f32_16x16x32_bf16 v[244:247], a[120:123], v[68:71], v[244:247]
    buffer_load_dwordx4 v11, s[8:11], s29 offen offset:3168  lds
    v_mfma_f32_16x16x32_bf16 v[248:251], a[124:127], v[64:67], v[248:251]
    ds_read_b128 a[88:91], v3 offset:192
    v_add_f32 v63, v63, v57
    v_mfma_f32_16x16x32_bf16 v[252:255], a[124:127], v[68:71], v[252:255]
    v_cvt_pk_bf16_f32 v76, v56, v57
    s_waitcnt lgkmcnt(3)
    v_mfma_f32_16x16x32_bf16 v[96:99], a[64:67], a[0:3], v[80:83]
    ds_read_b128 a[92:95], v3 offset:8640
    v_exp_f32 v56, v120
    v_mfma_f32_16x16x32_bf16 v[100:103], a[64:67], a[32:35], v[84:87]
    v_exp_f32 v57, v121
    v_mfma_f32_16x16x32_bf16 v[104:107], a[68:71], a[0:3], v[80:83]
    ds_read_b128 a[64:67], v2 offset:256
    s_add_u32 m0, s31, 16384
    v_add_f32 v63, v63, v58
    v_mfma_f32_16x16x32_bf16 v[108:111], a[68:71], a[32:35], v[84:87]
    v_add_f32 v63, v63, v59
    v_cvt_pk_bf16_f32 v77, v58, v59
    v_mfma_f32_16x16x32_bf16 v[96:99], a[72:75], a[4:7], v[96:99]
    ds_read_b128 a[68:71], v2 offset:8704
    v_mfma_f32_16x16x32_bf16 v[100:103], a[72:75], a[36:39], v[100:103]
    buffer_load_dwordx4 v12, s[12:15], s29 offen offset:0  lds
    v_mfma_f32_16x16x32_bf16 v[104:107], a[76:79], a[4:7], v[104:107]
    ds_read_b128 a[72:75], v2 offset:320
    v_mfma_f32_16x16x32_bf16 v[108:111], a[76:79], a[36:39], v[108:111]
    v_exp_f32 v58, v122
    s_waitcnt lgkmcnt(3)
    v_mfma_f32_16x16x32_bf16 v[96:99], a[80:83], a[8:11], v[96:99]
    ds_read_b128 a[76:79], v2 offset:8768
    v_exp_f32 v59, v123
    v_mfma_f32_16x16x32_bf16 v[100:103], a[80:83], a[40:43], v[100:103]
    v_add_f32 v62, v62, v56
    v_add_f32 v62, v62, v57
    v_mfma_f32_16x16x32_bf16 v[104:107], a[84:87], a[8:11], v[104:107]
    ds_read_b128 a[80:83], v3 offset:384
    v_cvt_pk_bf16_f32 v74, v56, v57
    v_mfma_f32_16x16x32_bf16 v[108:111], a[84:87], a[40:43], v[108:111]
    v_exp_f32 v56, v124
    v_mfma_f32_16x16x32_bf16 v[96:99], a[88:91], a[12:15], v[96:99]
    ds_read_b128 a[84:87], v3 offset:8832
    v_mfma_f32_16x16x32_bf16 v[100:103], a[88:91], a[44:47], v[100:103]
    buffer_load_dwordx4 v13, s[12:15], s29 offen offset:1024  lds
    v_mfma_f32_16x16x32_bf16 v[104:107], a[92:95], a[12:15], v[104:107]
    ds_read_b128 a[88:91], v3 offset:448
    v_mfma_f32_16x16x32_bf16 v[108:111], a[92:95], a[44:47], v[108:111]
    v_exp_f32 v57, v125
    v_add_f32 v62, v62, v58
    s_waitcnt lgkmcnt(3)
    v_mfma_f32_16x16x32_bf16 v[96:99], a[64:67], a[16:19], v[96:99]
    ds_read_b128 a[92:95], v3 offset:8896
    v_add_f32 v62, v62, v59
    v_cvt_pk_bf16_f32 v75, v58, v59
    v_mfma_f32_16x16x32_bf16 v[100:103], a[64:67], a[48:51], v[100:103]
    v_exp_f32 v58, v126
    v_mfma_f32_16x16x32_bf16 v[104:107], a[68:71], a[16:19], v[104:107]
    ds_read_b64_tr_b16 a[96:97], v4 offset:49152
    ds_read_b64_tr_b16 a[98:99], v4 offset:57344
    v_mfma_f32_16x16x32_bf16 v[108:111], a[68:71], a[48:51], v[108:111]
    v_exp_f32 v59, v127
    v_mfma_f32_16x16x32_bf16 v[96:99], a[72:75], a[20:23], v[96:99]
    ds_read_b64_tr_b16 a[100:101], v5 offset:49152
    ds_read_b64_tr_b16 a[102:103], v5 offset:57344
    v_mfma_f32_16x16x32_bf16 v[100:103], a[72:75], a[52:55], v[100:103]
    buffer_load_dwordx4 v14, s[12:15], s29 offen offset:2048  lds
    v_mfma_f32_16x16x32_bf16 v[104:107], a[76:79], a[20:23], v[104:107]
    ds_read_b64_tr_b16 a[104:105], v6 offset:49152
    ds_read_b64_tr_b16 a[106:107], v6 offset:57344
    v_mfma_f32_16x16x32_bf16 v[108:111], a[76:79], a[52:55], v[108:111]
    v_add_f32 v63, v63, v56
    s_waitcnt lgkmcnt(6)
    v_mfma_f32_16x16x32_bf16 v[96:99], a[80:83], a[24:27], v[96:99]
    ds_read_b64_tr_b16 a[108:109], v7 offset:49152
    ds_read_b64_tr_b16 a[110:111], v7 offset:57344
    v_add_f32 v63, v63, v57
    v_mfma_f32_16x16x32_bf16 v[100:103], a[80:83], a[56:59], v[100:103]
    v_cvt_pk_bf16_f32 v78, v56, v57
    v_add_f32 v63, v63, v58
    v_mfma_f32_16x16x32_bf16 v[104:107], a[84:87], a[24:27], v[104:107]
    ds_read_b64_tr_b16 a[112:113], v4 offset:49408
    ds_read_b64_tr_b16 a[114:115], v4 offset:57600
    v_mfma_f32_16x16x32_bf16 v[108:111], a[84:87], a[56:59], v[108:111]
    v_add_f32 v63, v63, v59
    v_cvt_pk_bf16_f32 v79, v58, v59
    v_mfma_f32_16x16x32_bf16 v[96:99], a[88:91], a[28:31], v[96:99]
    ds_read_b64_tr_b16 a[116:117], v5 offset:49408
    ds_read_b64_tr_b16 a[118:119], v5 offset:57600
    v_mfma_f32_16x16x32_bf16 v[100:103], a[88:91], a[60:63], v[100:103]
    buffer_load_dwordx4 v15, s[12:15], s29 offen offset:3072  lds
    v_max_f32 v56, v62, v63
    v_mfma_f32_16x16x32_bf16 v[104:107], a[92:95], a[28:31], v[104:107]
    ds_read_b64_tr_b16 a[120:121], v6 offset:49408
    ds_read_b64_tr_b16 a[122:123], v6 offset:57600
    v_mfma_f32_16x16x32_bf16 v[108:111], a[92:95], a[60:63], v[108:111]
    s_add_u32 s29, s29, 16384
    v_cmp_lt_f32 vcc, s33, v56
    s_cbranch_vccnz RARE_M2
CONT_M2:
    s_waitcnt lgkmcnt(6)
    v_mfma_f32_16x16x32_bf16 v[128:131], a[96:99], v[72:75], v[128:131]
    ds_read_b64_tr_b16 a[124:125], v7 offset:49408
    ds_read_b64_tr_b16 a[126:127], v7 offset:57600
    v_mfma_f32_16x16x32_bf16 v[132:135], a[96:99], v[76:79], v[132:135]
    s_waitcnt vmcnt(8)
    s_barrier
    v_mfma_f32_16x16x32_bf16 v[136:139], a[100:103], v[72:75], v[136:139]
    ds_read_b64_tr_b16 a[96:97], v4 offset:49664
    ds_read_b64_tr_b16 a[98:99], v4 offset:57856
    v_mfma_f32_16x16x32_bf16 v[140:143], a[100:103], v[76:79], v[140:143]
    s_add_u32 m0, s30, 0
    v_mfma_f32_16x16x32_bf16 v[144:147], a[104:107], v[72:75], v[144:147]
    ds_read_b64_tr_b16 a[100:101], v5 offset:49664
    ds_read_b64_tr_b16 a[102:103], v5 offset:57856
    v_mfma_f32_16x16x32_bf16 v[148:151], a[104:107], v[76:79], v[148:151]
    buffer_load_dwordx4 v8, s[8:11], s29 offen offset:0  lds
    v_mfma_f32_16x16x32_bf16 v[152:155], a[108:111], v[72:75], v[152:155]
    ds_read_b64_tr_b16 a[104:105], v6 offset:49664
    ds_read_b64_tr_b16 a[106:107], v6 offset:57856
    v_mfma_f32_16x16x32_bf16 v[156:159], a[108:111], v[76:79], v[156:159]
    v_exp_f32 v56, v96
    s_waitcnt lgkmcnt(6)
    v_mfma_f32_16x16x32_bf16 v[160:163], a[112:115], v[72:75], v[160:163]
    ds_read_b64_tr_b16 a[108:109], v7 offset:49664
    ds_read_b64_tr_b16 a[110:111], v7 offset:57856
    v_mfma_f32_16x16x32_bf16 v[164:167], a[112:115], v[76:79], v[164:167]
    v_exp_f32 v57, v97
    v_mfma_f32_16x16x32_bf16 v[168:171], a[116:119], v[72:75], v[168:171]
    ds_read_b64_tr_b16 a[112:113], v4 offset:49920
    ds_read_b64_tr_b16 a[114:115], v4 offset:58112
    v_mfma_f32_16x16x32_bf16 v[172:175], a[116:119], v[76:79], v[172:175]
    v_exp_f32 v58, v98
    v_mfma_f32_16x16x32_bf16 v[176:179], a[120:123], v[72:75], v[176:179]
    ds_read_b64_tr_b16 a[116:117], v5 offset:49920
    ds_read_b64_tr_b16 a[118:119], v5 offset:58112
    v_mfma_f32_16x16x32_bf16 v[180:183], a[120:123], v[76:79], v[180:183]
    buffer_load_dwordx4 v9, s[8:11], s29 offen offset:1056  lds
    v_mfma_f32_16x16x32_bf16 v[184:187], a[124:127], v[72:75], v[184:187]
    ds_read_b64_tr_b16 a[120:121], v6 offset:49920
    ds_read_b64_tr_b16 a[122:123], v6 offset:58112
    v_mfma_f32_16x16x32_bf16 v[188:191], a[124:127], v[76:79], v[188:191]
    v_exp_f32 v59, v99
    s_waitcnt lgkmcnt(6)
    v_mfma_f32_16x16x32_bf16 v[192:195], a[96:99], v[72:75], v[192:195]
    ds_read_b64_tr_b16 a[124:125], v7 offset:49920
    ds_read_b64_tr_b16 a[126:127], v7 offset:58112
    v_mfma_f32_16x16x32_bf16 v[196:199], a[96:99], v[76:79], v[196:199]
    v_add_f32 v60, v62, v56
    v_add_f32 v60, v60, v57
    v_mfma_f32_16x16x32_bf16 v[200:203], a[100:103], v[72:75], v[200:203]
    ds_read_b128 a[64:67], v2 offset:16896
    v_cvt_pk_bf16_f32 v64, v56, v57
    v_mfma_f32_16x16x32_bf16 v[204:207], a[100:103], v[76:79], v[204:207]
    v_exp_f32 v56, v100
    v_mfma_f32_16x16x32_bf16 v[208:211], a[104:107], v[72:75], v[208:211]
    ds_read_b128 a[68:71], v2 offset:25344
    v_mfma_f32_16x16x32_bf16 v[212:215], a[104:107], v[76:79], v[212:215]
    buffer_load_dwordx4 v10, s[8:11], s29 offen offset:2112  lds
    v_mfma_f32_16x16x32_bf16 v[216:219], a[108:111], v[72:75], v[216:219]
    ds_read_b128 a[72:75], v2 offset:16960
    v_mfma_f32_16x16x32_bf16 v[220:223], a[108:111], v[76:79], v[220:223]
    v_exp_f32 v57, v101
    v_add_f32 v60, v60, v58
    s_waitcnt lgkmcnt(3)
    v_mfma_f32_16x16x32_bf16 v[224:227], a[112:115], v[72:75], v[224:227]
    ds_read_b128 a[76:79], v2 offset:25408
    v_add_f32 v60, v60, v59
    v_cvt_pk_bf16_f32 v65, v58, v59
    v_mfma_f32_16x16x32_bf16 v[228:231], a[112:115], v[76:79], v[228:231]
    v_exp_f32 v58, v102
    v_mfma_f32_16x16x32_bf16 v[232:235], a[116:119], v[72:75], v[232:235]
    ds_read_b128 a[80:83], v3 offset:17024
    v_mfma_f32_16x16x32_bf16 v[236:239], a[116:119], v[76:79], v[236:239]
    v_exp_f32 v59, v103
    v_add_f32 v61, v63, v56
    v_mfma_f32_16x16x32_bf16 v[240:243], a[120:123], v[72:75], v[240:243]
    ds_read_b128 a[84:87], v3 offset:25472
    v_mfma_f32_16x16x32_bf16 v[244:247], a[120:123], v[76:79], v[244:247]
    buffer_load_dwordx4 v11, s[8:11], s29 offen offset:3168  lds
    v_mfma_f32_16x16x32_bf16 v[248:251], a[124:127], v[72:75], v[248:251]
    ds_read_b128 a[88:91], v3 offset:17088
    v_add_f32 v61, v61, v57
    v_mfma_f32_16x16x32_bf16 v[252:255], a[124:127], v[76:79], v[252:255]
    v_cvt_pk_bf16_f32 v68, v56, v57
    s_waitcnt lgkmcnt(3)
    v_mfma_f32_16x16x32_bf16 v[112:115], a[64:67], a[0:3], v[80:83]
    ds_read_b128 a[92:95], v3 offset:25536
    v_exp_f32 v56, v104
    v_mfma_f32_16x16x32_bf16 v[116:119], a[64:67], a[32:35], v[84:87]
    v_exp_f32 v57, v105
    v_mfma_f32_16x16x32_bf16 v[120:123], a[68:71], a[0:3], v[80:83]
    ds_read_b128 a[64:67], v2 offset:17152
    s_add_u32 m0, s31, 32768
    v_add_f32 v61, v61, v58
    v_mfma_f32_16x16x32_bf16 v[124:127], a[68:71], a[32:35], v[84:87]
    v_add_f32 v61, v61, v59
    v_cvt_pk_bf16_f32 v69, v58, v59
    v_mfma_f32_16x16x32_bf16 v[112:115], a[72:75], a[4:7], v[112:115]
    ds_read_b128 a[68:71], v2 offset:25600
    v_mfma_f32_16x16x32_bf16 v[116:119], a[72:75], a[36:39], v[116:119]
    buffer_load_dwordx4 v12, s[12:15], s29 offen offset:0  lds
    v_mfma_f32_16x16x32_bf16 v[120:123], a[76:79], a[4:7], v[120:123]
    ds_read_b128 a[72:75], v2 offset:17216
    v_mfma_f32_16x16x32_bf16 v[124:127], a[76:79], a[36:39], v[124:127]
    v_exp_f32 v58, v106
    s_waitcnt lgkmcnt(3)
    v_mfma_f32_16x16x32_bf16 v[112:115], a[80:83], a[8:11], v[112:115]
    ds_read_b128 a[76:79], v2 offset:25664
    v_exp_f32 v59, v107
    v_mfma_f32_16x16x32_bf16 v[116:119], a[80:83], a[40:43], v[116:119]
    v_add_f32 v60, v60, v56
    v_add_f32 v60, v60, v57
    v_mfma_f32_16x16x32_bf16 v[120:123], a[84:87], a[8:11], v[120:123]
    ds_read_b128 a[80:83], v3 offset:17280
    v_cvt_pk_bf16_f32 v66, v56, v57
    v_mfma_f32_16x16x32_bf16 v[124:127], a[84:87], a[40:43], v[124:127]
    v_exp_f32 v56, v108
    v_mfma_f32_16x16x32_bf16 v[112:115], a[88:91], a[12:15], v[112:115]
    ds_read_b128 a[84:87], v3 offset:25728
    v_mfma_f32_16x16x32_bf16 v[116:119], a[88:91], a[44:47], v[116:119]
    buffer_load_dwordx4 v13, s[12:15], s29 offen offset:1024  lds
    v_mfma_f32_16x16x32_bf16 v[120:123], a[92:95], a[12:15], v[120:123]
    ds_read_b128 a[88:91], v3 offset:17344
    v_mfma_f32_16x16x32_bf16 v[124:127], a[92:95], a[44:47], v[124:127]
    v_exp_f32 v57, v109
    v_add_f32 v60, v60, v58
    s_waitcnt lgkmcnt(3)
    v_mfma_f32_16x16x32_bf16 v[112:115], a[64:67], a[16:19], v[112:115]
    ds_read_b128 a[92:95], v3 offset:25792
    v_add_f32 v60, v60, v59
    v_cvt_pk_bf16_f32 v67, v58, v59
    v_mfma_f32_16x16x32_bf16 v[116:119], a[64:67], a[48:51], v[116:119]
    v_exp_f32 v58, v110
    v_mfma_f32_16x16x32_bf16 v[120:123], a[68:71], a[16:19], v[120:123]
    ds_read_b64_tr_b16 a[96:97], v4 offset:0
    ds_read_b64_tr_b16 a[98:99], v4 offset:8192
    v_mfma_f32_16x16x32_bf16 v[124:127], a[68:71], a[48:51], v[124:127]
    v_exp_f32 v59, v111
    v_mfma_f32_16x16x32_bf16 v[112:115], a[72:75], a[20:23], v[112:115]
    ds_read_b64_tr_b16 a[100:101], v5 offset:0
    ds_read_b64_tr_b16 a[102:103], v5 offset:8192
    v_mfma_f32_16x16x32_bf16 v[116:119], a[72:75], a[52:55], v[116:119]
    buffer_load_dwordx4 v14, s[12:15], s29 offen offset:2048  lds
    v_mfma_f32_16x16x32_bf16 v[120:123], a[76:79], a[20:23], v[120:123]
    ds_read_b64_tr_b16 a[104:105], v6 offset:0
    ds_read_b64_tr_b16 a[106:107], v6 offset:8192
    v_mfma_f32_16x16x32_bf16 v[124:127], a[76:79], a[52:55], v[124:127]
    v_add_f32 v61, v61, v56
    s_waitcnt lgkmcnt(6)
    v_mfma_f32_16x16x32_bf16 v[112:115], a[80:83], a[24:27], v[112:115]
    ds_read_b64_tr_b16 a[108:109], v7 offset:0
    ds_read_b64_tr_b16 a[110:111], v7 offset:8192
    v_add_f32 v61, v61, v57
    v_mfma_f32_16x16x32_bf16 v[116:119], a[80:83], a[56:59], v[116:119]
    v_cvt_pk_bf16_f32 v70, v56, v57
    v_add_f32 v61, v61, v58
    v_mfma_f32_16x16x32_bf16 v[120:123], a[84:87], a[24:27], v[120:123]
    ds_read_b64_tr_b16 a[112:113], v4 offset:256
    ds_read_b64_tr_b16 a[114:115], v4 offset:8448
    v_mfma_f32_16x16x32_bf16 v[124:127], a[84:87], a[56:59], v[124:127]
    v_add_f32 v61, v61, v59
    v_cvt_pk_bf16_f32 v71, v58, v59
    v_mfma_f32_16x16x32_bf16 v[112:115], a[88:91], a[28:31], v[112:115]
    ds_read_b64_tr_b16 a[116:117], v5 offset:256
    ds_read_b64_tr_b16 a[118:119], v5 offset:8448
    v_mfma_f32_16x16x32_bf16 v[116:119], a[88:91], a[60:63], v[116:119]
    buffer_load_dwordx4 v15, s[12:15], s29 offen offset:3072  lds
    v_max_f32 v56, v60, v61
    v_mfma_f32_16x16x32_bf16 v[120:123], a[92:95], a[28:31], v[120:123]
    ds_read_b64_tr_b16 a[120:121], v6 offset:256
    ds_read_b64_tr_b16 a[122:123], v6 offset:8448
    v_mfma_f32_16x16x32_bf16 v[124:127], a[92:95], a[60:63], v[124:127]
    s_add_u32 s29, s29, 16384
    v_cmp_lt_f32 vcc, s33, v56
    s_cbranch_vccnz RARE_M3
CONT_M3:
    s_sub_u32 s32, s32, 1
    s_cmp_lg_u32 s32, 0
    s_cbranch_scc1 K1_LOOP
    s_mul_i32 s50, s44, 458752
    s_add_u32 s42, s42, s50
    s_addc_u32 s43, s43, 0
    s_mov_b32 s16, s42
    s_and_b32 s17, s43, 0xffff
    s_mov_b32 s18, 458752
    s_mov_b32 s19, 0x00020000
    s_mul_i32 s50, s28, 7
    s_add_u32 s50, s50, 0
    s_cmp_ge_u32 s50, 14
    s_cselect_b32 s51, 14, 0
    s_cselect_b32 s52, 14336, 0
    s_sub_u32 s50, s50, s51
    s_and_b32 s51, s50, 1
    s_mul_i32 s51, s51, 7168
    s_lshr_b32 s50, s50, 1
    s_lshl_b32 s50, s50, 7
    s_add_u32 s50, s50, s51
    s_add_u32 s34, s50, s52
    s_mul_i32 s50, s28, 7
    s_add_u32 s50, s50, 1
    s_cmp_ge_u32 s50, 14
    s_cselect_b32 s51, 14, 0
    s_cselect_b32 s52, 14336, 0
    s_sub_u32 s50, s50, s51
    s_and_b32 s51, s50, 1
    s_mul_i32 s51, s51, 7168
    s_lshr_b32 s50, s50, 1
    s_lshl_b32 s50, s50, 7
    s_add_u32 s50, s50, s51
    s_add_u32 s35, s50, s52
    s_mul_i32 s50, s28, 7
    s_add_u32 s50, s50, 2
    s_cmp_ge_u32 s50, 14
    s_cselect_b32 s51, 14, 0
    s_cselect_b32 s52, 14336, 0
    s_sub_u32 s50, s50, s51
    s_and_b32 s51, s50, 1
    s_mul_i32 s51, s51, 7168
    s_lshr_b32 s50, s50, 1
    s_lshl_b32 s50, s50, 7
    s_add_u32 s50, s50, s51
    s_add_u32 s36, s50, s52
    s_mul_i32 s50, s28, 7
    s_add_u32 s50, s50, 3
    s_cmp_ge_u32 s50, 14
    s_cselect_b32 s51, 14, 0
    s_cselect_b32 s52, 14336, 0
    s_sub_u32 s50, s50, s51
    s_and_b32 s51, s50, 1
    s_mul_i32 s51, s51, 7168
    s_lshr_b32 s50, s50, 1
    s_lshl_b32 s50, s50, 7
    s_add_u32 s50, s50, s51
    s_add_u32 s37, s50, s52
    s_mul_i32 s50, s28, 7
    s_add_u32 s50, s50, 4
    s_cmp_ge_u32 s50, 14
    s_cselect_b32 s51, 14, 0
    s_cselect_b32 s52, 14336, 0
    s_sub_u32 s50, s50, s51
    s_and_b32 s51, s50, 1
    s_mul_i32 s51, s51, 7168
    s_lshr_b32 s50, s50, 1
    s_lshl_b32 s50, s50, 7
    s_add_u32 s50, s50, s51
    s_add_u32 s38, s50, s52
    s_mul_i32 s50, s28, 7
    s_add_u32 s50, s50, 5
    s_cmp_ge_u32 s50, 14
    s_cselect_b32 s51, 14, 0
    s_cselect_b32 s52, 14336, 0
    s_sub_u32 s50, s50, s51
    s_and_b32 s51, s50, 1
    s_mul_i32 s51, s51, 7168
    s_lshr_b32 s50, s50, 1
    s_lshl_b32 s50, s50, 7
    s_add_u32 s50, s50, s51
    s_add_u32 s39, s50, s52
    s_mul_i32 s50, s28, 7
    s_add_u32 s50, s50, 6
    s_cmp_ge_u32 s50, 14
    s_cselect_b32 s51, 14, 0
    s_cselect_b32 s52, 14336, 0
    s_sub_u32 s50, s50, s51
    s_and_b32 s51, s50, 1
    s_mul_i32 s51, s51, 7168
    s_lshr_b32 s50, s50, 1
    s_lshl_b32 s50, s50, 7
    s_add_u32 s50, s50, s51
    s_add_u32 s40, s50, s52
    s_mul_i32 s41, s28, 7168
    v_lshrrev_b32 v16, 3, v1
    v_mul_u32_u24 v23, 896, v16
    v_bfe_u32 v16, v1, 4, 1
    v_bfe_u32 v17, v1, 2, 1
    v_xor_b32 v16, v16, v17
    v_lshl_add_u32 v23, v16, 6, v23
    v_and_b32 v16, 3, v1
    v_lshl_add_u32 v23, v16, 4, v23
    s_waitcnt lgkmcnt(6)
    v_mfma_f32_16x16x32_bf16 v[128:131], a[96:99], v[64:67], v[128:131]
    ds_read_b64_tr_b16 a[124:125], v7 offset:256
    ds_read_b64_tr_b16 a[126:127], v7 offset:8448
    v_mfma_f32_16x16x32_bf16 v[132:135], a[96:99], v[68:71], v[132:135]
    s_waitcnt vmcnt(8)
    s_barrier
    v_mfma_f32_16x16x32_bf16 v[136:139], a[100:103], v[64:67], v[136:139]
    ds_read_b64_tr_b16 a[96:97], v4 offset:512
    v_mfma_f32_16x16x32_bf16 v[140:143], a[100:103], v[68:71], v[140:143]
    ds_read_b64_tr_b16 a[98:99], v4 offset:8704
    v_mfma_f32_16x16x32_bf16 v[144:147], a[104:107], v[64:67], v[144:147]
    ds_read_b64_tr_b16 a[100:101], v5 offset:512
    v_mfma_f32_16x16x32_bf16 v[148:151], a[104:107], v[68:71], v[148:151]
    ds_read_b64_tr_b16 a[102:103], v5 offset:8704
    v_mfma_f32_16x16x32_bf16 v[152:155], a[108:111], v[64:67], v[152:155]
    ds_read_b64_tr_b16 a[104:105], v6 offset:512
    ds_read_b64_tr_b16 a[106:107], v6 offset:8704
    v_mfma_f32_16x16x32_bf16 v[156:159], a[108:111], v[68:71], v[156:159]
    v_exp_f32 v56, v112
    s_waitcnt lgkmcnt(6)
    v_mfma_f32_16x16x32_bf16 v[160:163], a[112:115], v[64:67], v[160:163]
    ds_read_b64_tr_b16 a[108:109], v7 offset:512
    ds_read_b64_tr_b16 a[110:111], v7 offset:8704
    v_mfma_f32_16x16x32_bf16 v[164:167], a[112:115], v[68:71], v[164:167]
    v_exp_f32 v57, v113
    v_mfma_f32_16x16x32_bf16 v[168:171], a[116:119], v[64:67], v[168:171]
    ds_read_b64_tr_b16 a[112:113], v4 offset:768
    ds_read_b64_tr_b16 a[114:115], v4 offset:8960
    v_mfma_f32_16x16x32_bf16 v[172:175], a[116:119], v[68:71], v[172:175]
    v_exp_f32 v58, v114
    v_mfma_f32_16x16x32_bf16 v[176:179], a[120:123], v[64:67], v[176:179]
    ds_read_b64_tr_b16 a[116:117], v5 offset:768
    ds_read_b64_tr_b16 a[118:119], v5 offset:8960
    v_mfma_f32_16x16x32_bf16 v[180:183], a[120:123], v[68:71], v[180:183]
    v_exp_f32 v59, v115
    v_mfma_f32_16x16x32_bf16 v[184:187], a[124:127], v[64:67], v[184:187]
    ds_read_b64_tr_b16 a[120:121], v6 offset:768
    ds_read_b64_tr_b16 a[122:123], v6 offset:8960
    v_mfma_f32_16x16x32_bf16 v[188:191], a[124:127], v[68:71], v[188:191]
    v_add_f32 v62, v60, v56
    s_waitcnt lgkmcnt(6)
    v_mfma_f32_16x16x32_bf16 v[192:195], a[96:99], v[64:67], v[192:195]
    ds_read_b64_tr_b16 a[124:125], v7 offset:768
    ds_read_b64_tr_b16 a[126:127], v7 offset:8960
    v_mfma_f32_16x16x32_bf16 v[196:199], a[96:99], v[68:71], v[196:199]
    v_add_f32 v62, v62, v57
    v_cvt_pk_bf16_f32 v72, v56, v57
    v_mfma_f32_16x16x32_bf16 v[200:203], a[100:103], v[64:67], v[200:203]
    ds_read_b128 a[64:67], v2 offset:33792
    v_mfma_f32_16x16x32_bf16 v[204:207], a[100:103], v[68:71], v[204:207]
    v_exp_f32 v56, v116
    v_mfma_f32_16x16x32_bf16 v[208:211], a[104:107], v[64:67], v[208:211]
    ds_read_b128 a[68:71], v2 offset:42240
    v_exp_f32 v57, v117
    v_mfma_f32_16x16x32_bf16 v[212:215], a[104:107], v[68:71], v[212:215]
    v_add_f32 v62, v62, v58
    v_add_f32 v62, v62, v59
    v_mfma_f32_16x16x32_bf16 v[216:219], a[108:111], v[64:67], v[216:219]
    ds_read_b128 a[72:75], v2 offset:33856
    v_mfma_f32_16x16x32_bf16 v[220:223], a[108:111], v[68:71], v[220:223]
    v_cvt_pk_bf16_f32 v73, v58, v59
    s_waitcnt lgkmcnt(3)
    v_mfma_f32_16x16x32_bf16 v[224:227], a[112:115], v[64:67], v[224:227]
    ds_read_b128 a[76:79], v2 offset:42304
    v_exp_f32 v58, v118
    v_mfma_f32_16x16x32_bf16 v[228:231], a[112:115], v[68:71], v[228:231]
    v_exp_f32 v59, v119
    v_mfma_f32_16x16x32_bf16 v[232:235], a[116:119], v[64:67], v[232:235]
    ds_read_b128 a[80:83], v3 offset:33920
    v_add_f32 v63, v61, v56
    v_mfma_f32_16x16x32_bf16 v[236:239], a[116:119], v[68:71], v[236:239]
    v_add_f32 v63, v63, v57
    v_cvt_pk_bf16_f32 v76, v56, v57
    v_mfma_f32_16x16x32_bf16 v[240:243], a[120:123], v[64:67], v[240:243]
    ds_read_b128 a[84:87], v3 offset:42368
    v_exp_f32 v56, v120
    v_mfma_f32_16x16x32_bf16 v[244:247], a[120:123], v[68:71], v[244:247]
    v_exp_f32 v57, v121
    v_mfma_f32_16x16x32_bf16 v[248:251], a[124:127], v[64:67], v[248:251]
    ds_read_b128 a[88:91], v3 offset:33984
    v_mfma_f32_16x16x32_bf16 v[252:255], a[124:127], v[68:71], v[252:255]
    v_add_f32 v63, v63, v58
    s_waitcnt lgkmcnt(3)
    v_mfma_f32_16x16x32_bf16 v[96:99], a[64:67], a[0:3], v[80:83]
    ds_read_b128 a[92:95], v3 offset:42432
    v_add_f32 v63, v63, v59
    v_cvt_pk_bf16_f32 v77, v58, v59
    v_mfma_f32_16x16x32_bf16 v[100:103], a[64:67], a[32:35], v[84:87]
    v_exp_f32 v58, v122
    v_mfma_f32_16x16x32_bf16 v[104:107], a[68:71], a[0:3], v[80:83]
    ds_read_b128 a[64:67], v2 offset:34048
    s_add_u32 m0, s31, 49152
    v_mfma_f32_16x16x32_bf16 v[108:111], a[68:71], a[32:35], v[84:87]
    v_exp_f32 v59, v123
    v_mfma_f32_16x16x32_bf16 v[96:99], a[72:75], a[4:7], v[96:99]
    ds_read_b128 a[68:71], v2 offset:42496
    v_mfma_f32_16x16x32_bf16 v[100:103], a[72:75], a[36:39], v[100:103]
    buffer_load_dwordx4 v12, s[12:15], s29 offen offset:0  lds
    v_mfma_f32_16x16x32_bf16 v[104:107], a[76:79], a[4:7], v[104:107]
    ds_read_b128 a[72:75], v2 offset:34112
    v_add_f32 v62, v62, v56
    v_mfma_f32_16x16x32_bf16 v[108:111], a[76:79], a[36:39], v[108:111]
    v_add_f32 v62, v62, v57
    s_waitcnt lgkmcnt(3)
    v_mfma_f32_16x16x32_bf16 v[96:99], a[80:83], a[8:11], v[96:99]
    ds_read_b128 a[76:79], v2 offset:42560
    v_cvt_pk_bf16_f32 v74, v56, v57
    v_mfma_f32_16x16x32_bf16 v[100:103], a[80:83], a[40:43], v[100:103]
    v_exp_f32 v56, v124
    v_mfma_f32_16x16x32_bf16 v[104:107], a[84:87], a[8:11], v[104:107]
    ds_read_b128 a[80:83], v3 offset:34176
    v_mfma_f32_16x16x32_bf16 v[108:111], a[84:87], a[40:43], v[108:111]
    v_exp_f32 v57, v125
    v_add_f32 v62, v62, v58
    v_mfma_f32_16x16x32_bf16 v[96:99], a[88:91], a[12:15], v[96:99]
    ds_read_b128 a[84:87], v3 offset:42624
    v_mfma_f32_16x16x32_bf16 v[100:103], a[88:91], a[44:47], v[100:103]
    buffer_load_dwordx4 v13, s[12:15], s29 offen offset:1024  lds
    v_mfma_f32_16x16x32_bf16 v[104:107], a[92:95], a[12:15], v[104:107]
    ds_read_b128 a[88:91], v3 offset:34240
    v_add_f32 v62, v62, v59
    v_mfma_f32_16x16x32_bf16 v[108:111], a[92:95], a[44:47], v[108:111]
    v_cvt_pk_bf16_f32 v75, v58, v59
    s_waitcnt lgkmcnt(3)
    v_mfma_f32_16x16x32_bf16 v[96:99], a[64:67], a[16:19], v[96:99]
    ds_read_b128 a[92:95], v3 offset:42688
    v_exp_f32 v58, v126
    v_mfma_f32_16x16x32_bf16 v[100:103], a[64:67], a[48:51], v[100:103]
    v_exp_f32 v59, v127
    v_mfma_f32_16x16x32_bf16 v[104:107], a[68:71], a[16:19], v[104:107]
    ds_read_b64_tr_b16 a[96:97], v4 offset:16384
    ds_read_b64_tr_b16 a[98:99], v4 offset:24576
    v_mfma_f32_16x16x32_bf16 v[108:111], a[68:71], a[48:51], v[108:111]
    v_add_f32 v63, v63, v56
    v_add_f32 v63, v63, v57
    v_mfma_f32_16x16x32_bf16 v[96:99], a[72:75], a[20:23], v[96:99]
    ds_read_b64_tr_b16 a[100:101], v5 offset:16384
    ds_read_b64_tr_b16 a[102:103], v5 offset:24576
    v_mfma_f32_16x16x32_bf16 v[100:103], a[72:75], a[52:55], v[100:103]
    buffer_load_dwordx4 v14, s[12:15], s29 offen offset:2048  lds
    v_mfma_f32_16x16x32_bf16 v[104:107], a[76:79], a[20:23], v[104:107]
    ds_read_b64_tr_b16 a[104:105], v6 offset:16384
    v_mfma_f32_16x16x32_bf16 v[108:111], a[76:79], a[52:55], v[108:111]
    ds_read_b64_tr_b16 a[106:107], v6 offset:24576
    s_waitcnt lgkmcnt(6)
    v_mfma_f32_16x16x32_bf16 v[96:99], a[80:83], a[24:27], v[96:99]
    ds_read_b64_tr_b16 a[108:109], v7 offset:16384
    ds_read_b64_tr_b16 a[110:111], v7 offset:24576
    v_mfma_f32_16x16x32_bf16 v[100:103], a[80:83], a[56:59], v[100:103]
    v_cvt_pk_bf16_f32 v78, v56, v57
    v_add_f32 v63, v63, v58
    v_mfma_f32_16x16x32_bf16 v[104:107], a[84:87], a[24:27], v[104:107]
    ds_read_b64_tr_b16 a[112:113], v4 offset:16640
    ds_read_b64_tr_b16 a[114:115], v4 offset:24832
    v_mfma_f32_16x16x32_bf16 v[108:111], a[84:87], a[56:59], v[108:111]
    v_add_f32 v63, v63, v59
    v_cvt_pk_bf16_f32 v79, v58, v59
    v_mfma_f32_16x16x32_bf16 v[96:99], a[88:91], a[28:31], v[96:99]
    ds_read_b64_tr_b16 a[116:117], v5 offset:16640
    ds_read_b64_tr_b16 a[118:119], v5 offset:24832
    v_mfma_f32_16x16x32_bf16 v[100:103], a[88:91], a[60:63], v[100:103]
    buffer_load_dwordx4 v15, s[12:15], s29 offen offset:3072  lds
    v_max_f32 v56, v62, v63
    v_mfma_f32_16x16x32_bf16 v[104:107], a[92:95], a[28:31], v[104:107]
    ds_read_b64_tr_b16 a[120:121], v6 offset:16640
    ds_read_b64_tr_b16 a[122:123], v6 offset:24832
    v_mfma_f32_16x16x32_bf16 v[108:111], a[92:95], a[60:63], v[108:111]
    s_add_u32 s29, s29, 16384
    v_cmp_lt_f32 vcc, s33, v56
    s_cbranch_vccnz RARE_T0
CONT_T0:
    s_waitcnt lgkmcnt(6)
    v_mfma_f32_16x16x32_bf16 v[128:131], a[96:99], v[72:75], v[128:131]
    ds_read_b64_tr_b16 a[124:125], v7 offset:16640
    ds_read_b64_tr_b16 a[126:127], v7 offset:24832
    v_mfma_f32_16x16x32_bf16 v[132:135], a[96:99], v[76:79], v[132:135]
    s_waitcnt vmcnt(4)
    s_barrier
    v_mfma_f32_16x16x32_bf16 v[136:139], a[100:103], v[72:75], v[136:139]
    ds_read_b64_tr_b16 a[96:97], v4 offset:16896
    v_mfma_f32_16x16x32_bf16 v[140:143], a[100:103], v[76:79], v[140:143]
    ds_read_b64_tr_b16 a[98:99], v4 offset:25088
    v_mfma_f32_16x16x32_bf16 v[144:147], a[104:107], v[72:75], v[144:147]
    ds_read_b64_tr_b16 a[100:101], v5 offset:16896
    v_mfma_f32_16x16x32_bf16 v[148:151], a[104:107], v[76:79], v[148:151]
    ds_read_b64_tr_b16 a[102:103], v5 offset:25088
    v_mfma_f32_16x16x32_bf16 v[152:155], a[108:111], v[72:75], v[152:155]
    ds_read_b64_tr_b16 a[104:105], v6 offset:16896
    v_mfma_f32_16x16x32_bf16 v[156:159], a[108:111], v[76:79], v[156:159]
    ds_read_b64_tr_b16 a[106:107], v6 offset:25088
    s_waitcnt lgkmcnt(6)
    v_mfma_f32_16x16x32_bf16 v[160:163], a[112:115], v[72:75], v[160:163]
    ds_read_b64_tr_b16 a[108:109], v7 offset:16896
    ds_read_b64_tr_b16 a[110:111], v7 offset:25088
    v_mfma_f32_16x16x32_bf16 v[164:167], a[112:115], v[76:79], v[164:167]
    v_exp_f32 v56, v96
    v_mfma_f32_16x16x32_bf16 v[168:171], a[116:119], v[72:75], v[168:171]
    ds_read_b64_tr_b16 a[112:113], v4 offset:17152
    ds_read_b64_tr_b16 a[114:115], v4 offset:25344
    v_mfma_f32_16x16x32_bf16 v[172:175], a[116:119], v[76:79], v[172:175]
    v_exp_f32 v57, v97
    v_mfma_f32_16x16x32_bf16 v[176:179], a[120:123], v[72:75], v[176:179]
    ds_read_b64_tr_b16 a[116:117], v5 offset:17152
    ds_read_b64_tr_b16 a[118:119], v5 offset:25344
    v_mfma_f32_16x16x32_bf16 v[180:183], a[120:123], v[76:79], v[180:183]
    v_exp_f32 v58, v98
    v_mfma_f32_16x16x32_bf16 v[184:187], a[124:127], v[72:75], v[184:187]
    ds_read_b64_tr_b16 a[120:121], v6 offset:17152
    v_mfma_f32_16x16x32_bf16 v[188:191], a[124:127], v[76:79], v[188:191]
    ds_read_b64_tr_b16 a[122:123], v6 offset:25344
    s_waitcnt lgkmcnt(6)
    v_mfma_f32_16x16x32_bf16 v[192:195], a[96:99], v[72:75], v[192:195]
    ds_read_b64_tr_b16 a[124:125], v7 offset:17152
    ds_read_b64_tr_b16 a[126:127], v7 offset:25344
    v_mfma_f32_16x16x32_bf16 v[196:199], a[96:99], v[76:79], v[196:199]
    v_exp_f32 v59, v99
    v_mfma_f32_16x16x32_bf16 v[200:203], a[100:103], v[72:75], v[200:203]
    ds_read_b128 a[64:67], v2 offset:50688
    v_add_f32 v60, v62, v56
    v_mfma_f32_16x16x32_bf16 v[204:207], a[100:103], v[76:79], v[204:207]
    v_add_f32 v60, v60, v57
    v_cvt_pk_bf16_f32 v64, v56, v57
    v_mfma_f32_16x16x32_bf16 v[208:211], a[104:107], v[72:75], v[208:211]
    ds_read_b128 a[68:71], v2 offset:59136
    v_mfma_f32_16x16x32_bf16 v[212:215], a[104:107], v[76:79], v[212:215]
    v_exp_f32 v56, v100
    v_mfma_f32_16x16x32_bf16 v[216:219], a[108:111], v[72:75], v[216:219]
    ds_read_b128 a[72:75], v2 offset:50752
    v_mfma_f32_16x16x32_bf16 v[220:223], a[108:111], v[76:79], v[220:223]
    v_exp_f32 v57, v101
    v_add_f32 v60, v60, v58
    s_waitcnt lgkmcnt(3)
    v_mfma_f32_16x16x32_bf16 v[224:227], a[112:115], v[72:75], v[224:227]
    ds_read_b128 a[76:79], v2 offset:59200
    v_add_f32 v60, v60, v59
    v_mfma_f32_16x16x32_bf16 v[228:231], a[112:115], v[76:79], v[228:231]
    v_cvt_pk_bf16_f32 v65, v58, v59
    v_mfma_f32_16x16x32_bf16 v[232:235], a[116:119], v[72:75], v[232:235]
    ds_read_b128 a[80:83], v3 offset:50816
    v_exp_f32 v58, v102
    v_mfma_f32_16x16x32_bf16 v[236:239], a[116:119], v[76:79], v[236:239]
    v_exp_f32 v59, v103
    v_mfma_f32_16x16x32_bf16 v[240:243], a[120:123], v[72:75], v[240:243]
    ds_read_b128 a[84:87], v3 offset:59264
    v_add_f32 v61, v63, v56
    v_mfma_f32_16x16x32_bf16 v[244:247], a[120:123], v[76:79], v[244:247]
    v_add_f32 v61, v61, v57
    v_mfma_f32_16x16x32_bf16 v[248:251], a[124:127], v[72:75], v[248:251]
    ds_read_b128 a[88:91], v3 offset:50880
    v_mfma_f32_16x16x32_bf16 v[252:255], a[124:127], v[76:79], v[252:255]
    v_cvt_pk_bf16_f32 v68, v56, v57
    s_waitcnt lgkmcnt(3)
    v_mfma_f32_16x16x32_bf16 v[112:115], a[64:67], a[0:3], v[80:83]
    ds_read_b128 a[92:95], v3 offset:59328
    v_exp_f32 v56, v104
    v_mfma_f32_16x16x32_bf16 v[116:119], a[64:67], a[32:35], v[84:87]
    v_exp_f32 v57, v105
    v_mfma_f32_16x16x32_bf16 v[120:123], a[68:71], a[0:3], v[80:83]
    ds_read_b128 a[64:67], v2 offset:50944
    v_add_f32 v61, v61, v58
    v_mfma_f32_16x16x32_bf16 v[124:127], a[68:71], a[32:35], v[84:87]
    v_add_f32 v61, v61, v59
    v_mfma_f32_16x16x32_bf16 v[112:115], a[72:75], a[4:7], v[112:115]
    ds_read_b128 a[68:71], v2 offset:59392
    v_cvt_pk_bf16_f32 v69, v58, v59
    v_mfma_f32_16x16x32_bf16 v[116:119], a[72:75], a[36:39], v[116:119]
    v_exp_f32 v58, v106
    v_mfma_f32_16x16x32_bf16 v[120:123], a[76:79], a[4:7], v[120:123]
    ds_read_b128 a[72:75], v2 offset:51008
    v_mfma_f32_16x16x32_bf16 v[124:127], a[76:79], a[36:39], v[124:127]
    v_exp_f32 v59, v107
    s_waitcnt lgkmcnt(3)
    v_mfma_f32_16x16x32_bf16 v[112:115], a[80:83], a[8:11], v[112:115]
    ds_read_b128 a[76:79], v2 offset:59456
    v_add_f32 v60, v60, v56
    v_mfma_f32_16x16x32_bf16 v[116:119], a[80:83], a[40:43], v[116:119]
    v_add_f32 v60, v60, v57
    v_mfma_f32_16x16x32_bf16 v[120:123], a[84:87], a[8:11], v[120:123]
    ds_read_b128 a[80:83], v3 offset:51072
    v_cvt_pk_bf16_f32 v66, v56, v57
    v_mfma_f32_16x16x32_bf16 v[124:127], a[84:87], a[40:43], v[124:127]
    v_exp_f32 v56, v108
    v_mfma_f32_16x16x32_bf16 v[112:115], a[88:91], a[12:15], v[112:115]
    ds_read_b128 a[84:87], v3 offset:59520
    v_mfma_f32_16x16x32_bf16 v[116:119], a[88:91], a[44:47], v[116:119]
    v_exp_f32 v57, v109
    v_add_f32 v60, v60, v58
    v_mfma_f32_16x16x32_bf16 v[120:123], a[92:95], a[12:15], v[120:123]
    ds_read_b128 a[88:91], v3 offset:51136
    v_add_f32 v60, v60, v59
    v_mfma_f32_16x16x32_bf16 v[124:127], a[92:95], a[44:47], v[124:127]
    v_cvt_pk_bf16_f32 v67, v58, v59
    s_waitcnt lgkmcnt(3)
    v_mfma_f32_16x16x32_bf16 v[112:115], a[64:67], a[16:19], v[112:115]
    ds_read_b128 a[92:95], v3 offset:59584
    v_mfma_f32_16x16x32_bf16 v[116:119], a[64:67], a[48:51], v[116:119]
    v_exp_f32 v58, v110
    v_mfma_f32_16x16x32_bf16 v[120:123], a[68:71], a[16:19], v[120:123]
    ds_read_b64_tr_b16 a[96:97], v4 offset:32768
    ds_read_b64_tr_b16 a[98:99], v4 offset:40960
    v_mfma_f32_16x16x32_bf16 v[124:127], a[68:71], a[48:51], v[124:127]
    v_exp_f32 v59, v111
    v_mfma_f32_16x16x32_bf16 v[112:115], a[72:75], a[20:23], v[112:115]
    ds_read_b64_tr_b16 a[100:101], v5 offset:32768
    ds_read_b64_tr_b16 a[102:103], v5 offset:40960
    v_mfma_f32_16x16x32_bf16 v[116:119], a[72:75], a[52:55], v[116:119]
    v_add_f32 v61, v61, v56
    v_add_f32 v61, v61, v57
    v_mfma_f32_16x16x32_bf16 v[120:123], a[76:79], a[20:23], v[120:123]
    ds_read_b64_tr_b16 a[104:105], v6 offset:32768
    ds_read_b64_tr_b16 a[106:107], v6 offset:40960
    v_mfma_f32_16x16x32_bf16 v[124:127], a[76:79], a[52:55], v[124:127]
    v_cvt_pk_bf16_f32 v70, v56, v57
    s_waitcnt lgkmcnt(6)
    v_mfma_f32_16x16x32_bf16 v[112:115], a[80:83], a[24:27], v[112:115]
    ds_read_b64_tr_b16 a[108:109], v7 offset:32768
    ds_read_b64_tr_b16 a[110:111], v7 offset:40960
    v_mfma_f32_16x16x32_bf16 v[116:119], a[80:83], a[56:59], v[116:119]
    v_add_f32 v61, v61, v58
    v_mfma_f32_16x16x32_bf16 v[120:123], a[84:87], a[24:27], v[120:123]
    ds_read_b64_tr_b16 a[112:113], v4 offset:33024
    ds_read_b64_tr_b16 a[114:115], v4 offset:41216
    v_mfma_f32_16x16x32_bf16 v[124:127], a[84:87], a[56:59], v[124:127]
    v_add_f32 v61, v61, v59
    v_cvt_pk_bf16_f32 v71, v58, v59
    v_mfma_f32_16x16x32_bf16 v[112:115], a[88:91], a[28:31], v[112:115]
    ds_read_b64_tr_b16 a[116:117], v5 offset:33024
    ds_read_b64_tr_b16 a[118:119], v5 offset:41216
    v_mfma_f32_16x16x32_bf16 v[116:119], a[88:91], a[60:63], v[116:119]
    v_max_f32 v56, v60, v61
    v_mfma_f32_16x16x32_bf16 v[120:123], a[92:95], a[28:31], v[120:123]
    ds_read_b64_tr_b16 a[120:121], v6 offset:33024
    ds_read_b64_tr_b16 a[122:123], v6 offset:41216
    v_mfma_f32_16x16x32_bf16 v[124:127], a[92:95], a[60:63], v[124:127]
    s_add_u32 s29, s29, 16384
    v_cmp_lt_f32 vcc, s33, v56
    s_cbranch_vccnz RARE_T1
CONT_T1:
    s_waitcnt lgkmcnt(6)
    v_mfma_f32_16x16x32_bf16 v[128:131], a[96:99], v[64:67], v[128:131]
    ds_read_b64_tr_b16 a[124:125], v7 offset:33024
    ds_read_b64_tr_b16 a[126:127], v7 offset:41216
    v_mfma_f32_16x16x32_bf16 v[132:135], a[96:99], v[68:71], v[132:135]
    s_waitcnt vmcnt(0)
    s_barrier
    v_mfma_f32_16x16x32_bf16 v[136:139], a[100:103], v[64:67], v[136:139]
    ds_read_b64_tr_b16 a[96:97], v4 offset:33280
    ds_read_b64_tr_b16 a[98:99], v4 offset:41472
    s_add_u32 m0, s41, 0
    v_mfma_f32_16x16x32_bf16 v[140:143], a[100:103], v[68:71], v[140:143]
    s_add_u32 s50, s34, 0
    buffer_load_dwordx4 v23, s[16:19], s50 offen lds
    v_mfma_f32_16x16x32_bf16 v[144:147], a[104:107], v[64:67], v[144:147]
    ds_read_b64_tr_b16 a[100:101], v5 offset:33280
    v_mfma_f32_16x16x32_bf16 v[148:151], a[104:107], v[68:71], v[148:151]
    ds_read_b64_tr_b16 a[102:103], v5 offset:41472
    v_mfma_f32_16x16x32_bf16 v[152:155], a[108:111], v[64:67], v[152:155]
    ds_read_b64_tr_b16 a[104:105], v6 offset:33280
    ds_read_b64_tr_b16 a[106:107], v6 offset:41472
    s_add_u32 m0, s41, 1024
    v_mfma_f32_16x16x32_bf16 v[156:159], a[108:111], v[68:71], v[156:159]
    s_add_u32 s50, s35, 0
    buffer_load_dwordx4 v23, s[16:19], s50 offen lds
    s_waitcnt lgkmcnt(6)
    v_mfma_f32_16x16x32_bf16 v[160:163], a[112:115], v[64:67], v[160:163]
    ds_read_b64_tr_b16 a[108:109], v7 offset:33280
    v_mfma_f32_16x16x32_bf16 v[164:167], a[112:115], v[68:71], v[164:167]
    ds_read_b64_tr_b16 a[110:111], v7 offset:41472
    v_mfma_f32_16x16x32_bf16 v[168:171], a[116:119], v[64:67], v[168:171]
    ds_read_b64_tr_b16 a[112:113], v4 offset:33536
    ds_read_b64_tr_b16 a[114:115], v4 offset:41728
    v_mfma_f32_16x16x32_bf16 v[172:175], a[116:119], v[68:71], v[172:175]
    v_exp_f32 v56, v112
    v_exp_f32 v57, v113
    v_mfma_f32_16x16x32_bf16 v[176:179], a[120:123], v[64:67], v[176:179]
    ds_read_b64_tr_b16 a[116:117], v5 offset:33536
    ds_read_b64_tr_b16 a[118:119], v5 offset:41728
    s_add_u32 m0, s41, 2048
    v_mfma_f32_16x16x32_bf16 v[180:183], a[120:123], v[68:71], v[180:183]
    s_add_u32 s50, s36, 0
    buffer_load_dwordx4 v23, s[16:19], s50 offen lds
    v_mfma_f32_16x16x32_bf16 v[184:187], a[124:127], v[64:67], v[184:187]
    ds_read_b64_tr_b16 a[120:121], v6 offset:33536
    v_mfma_f32_16x16x32_bf16 v[188:191], a[124:127], v[68:71], v[188:191]
    ds_read_b64_tr_b16 a[122:123], v6 offset:41728
    s_waitcnt lgkmcnt(6)
    v_mfma_f32_16x16x32_bf16 v[192:195], a[96:99], v[64:67], v[192:195]
    ds_read_b64_tr_b16 a[124:125], v7 offset:33536
    ds_read_b64_tr_b16 a[126:127], v7 offset:41728
    v_mfma_f32_16x16x32_bf16 v[196:199], a[96:99], v[68:71], v[196:199]
    v_exp_f32 v58, v114
    v_mfma_f32_16x16x32_bf16 v[200:203], a[100:103], v[64:67], v[200:203]
    s_add_u32 m0, s41, 3072
    s_add_u32 s50, s37, 0
    v_mfma_f32_16x16x32_bf16 v[204:207], a[100:103], v[68:71], v[204:207]
    buffer_load_dwordx4 v23, s[16:19], s50 offen lds
    v_mfma_f32_16x16x32_bf16 v[208:211], a[104:107], v[64:67], v[208:211]
    v_exp_f32 v59, v115
    v_add_f32 v62, v60, v56
    v_mfma_f32_16x16x32_bf16 v[212:215], a[104:107], v[68:71], v[212:215]
    v_add_f32 v62, v62, v57
    v_cvt_pk_bf16_f32 v72, v56, v57
    v_mfma_f32_16x16x32_bf16 v[216:219], a[108:111], v[64:67], v[216:219]
    s_add_u32 m0, s41, 4096
    s_add_u32 s50, s38, 0
    v_mfma_f32_16x16x32_bf16 v[220:223], a[108:111], v[68:71], v[220:223]
    buffer_load_dwordx4 v23, s[16:19], s50 offen lds
    s_waitcnt lgkmcnt(0)
    v_mfma_f32_16x16x32_bf16 v[224:227], a[112:115], v[64:67], v[224:227]
    v_exp_f32 v56, v116
    v_mfma_f32_16x16x32_bf16 v[228:231], a[112:115], v[68:71], v[228:231]
    v_exp_f32 v57, v117
    v_mfma_f32_16x16x32_bf16 v[232:235], a[116:119], v[64:67], v[232:235]
    v_add_f32 v62, v62, v58
    v_add_f32 v62, v62, v59
    v_cvt_pk_bf16_f32 v73, v58, v59
    v_mfma_f32_16x16x32_bf16 v[236:239], a[116:119], v[68:71], v[236:239]
    v_exp_f32 v58, v118
    v_mfma_f32_16x16x32_bf16 v[240:243], a[120:123], v[64:67], v[240:243]
    s_add_u32 m0, s41, 5120
    s_add_u32 s50, s39, 0
    v_mfma_f32_16x16x32_bf16 v[244:247], a[120:123], v[68:71], v[244:247]
    buffer_load_dwordx4 v23, s[16:19], s50 offen lds
    v_mfma_f32_16x16x32_bf16 v[248:251], a[124:127], v[64:67], v[248:251]
    v_exp_f32 v59, v119
    v_mfma_f32_16x16x32_bf16 v[252:255], a[124:127], v[68:71], v[252:255]
    v_add_f32 v63, v61, v56
    v_add_f32 v63, v63, v57
    v_cvt_pk_bf16_f32 v76, v56, v57
    v_exp_f32 v56, v120
    v_exp_f32 v57, v121
    s_add_u32 m0, s41, 6144
    s_add_u32 s50, s40, 0
    buffer_load_dwordx4 v23, s[16:19], s50 offen lds
    v_add_f32 v63, v63, v58
    v_add_f32 v63, v63, v59
    v_cvt_pk_bf16_f32 v77, v58, v59
    v_exp_f32 v58, v122
    v_exp_f32 v59, v123
    v_add_f32 v62, v62, v56
    v_add_f32 v62, v62, v57
    s_add_u32 m0, s41, 28672
    s_add_u32 s50, s34, 28672
    buffer_load_dwordx4 v23, s[16:19], s50 offen lds
    v_cvt_pk_bf16_f32 v74, v56, v57
    v_exp_f32 v56, v124
    v_exp_f32 v57, v125
    s_add_u32 m0, s41, 29696
    s_add_u32 s50, s35, 28672
    buffer_load_dwordx4 v23, s[16:19], s50 offen lds
    v_add_f32 v62, v62, v58
    v_add_f32 v62, v62, v59
    v_cvt_pk_bf16_f32 v75, v58, v59
    v_exp_f32 v58, v126
    v_exp_f32 v59, v127
    v_add_f32 v63, v63, v56
    v_add_f32 v63, v63, v57
    ds_read_b64_tr_b16 a[96:97], v4 offset:49152
    ds_read_b64_tr_b16 a[98:99], v4 offset:57344
    s_add_u32 m0, s41, 30720
    s_add_u32 s50, s36, 28672
    buffer_load_dwordx4 v23, s[16:19], s50 offen lds
    ds_read_b64_tr_b16 a[100:101], v5 offset:49152
    ds_read_b64_tr_b16 a[102:103], v5 offset:57344
    v_cvt_pk_bf16_f32 v78, v56, v57
    ds_read_b64_tr_b16 a[104:105], v6 offset:49152
    ds_read_b64_tr_b16 a[106:107], v6 offset:57344
    v_add_f32 v63, v63, v58
    v_add_f32 v63, v63, v59
    ds_read_b64_tr_b16 a[108:109], v7 offset:49152
    ds_read_b64_tr_b16 a[110:111], v7 offset:57344
    s_add_u32 m0, s41, 31744
    s_add_u32 s50, s37, 28672
    buffer_load_dwordx4 v23, s[16:19], s50 offen lds
    ds_read_b64_tr_b16 a[112:113], v4 offset:49408
    ds_read_b64_tr_b16 a[114:115], v4 offset:57600
    v_cvt_pk_bf16_f32 v79, v58, v59
    ds_read_b64_tr_b16 a[116:117], v5 offset:49408
    ds_read_b64_tr_b16 a[118:119], v5 offset:57600
    v_max_f32 v56, v62, v63
    ds_read_b64_tr_b16 a[120:121], v6 offset:49408
    ds_read_b64_tr_b16 a[122:123], v6 offset:57600
    s_add_u32 s29, s29, 16384
    v_cmp_lt_f32 vcc, s33, v56
    s_cbranch_vccnz RARE_T2
CONT_T2:
    s_waitcnt lgkmcnt(6)
    v_mfma_f32_16x16x32_bf16 v[128:131], a[96:99], v[72:75], v[128:131]
    ds_read_b64_tr_b16 a[124:125], v7 offset:49408
    v_mfma_f32_16x16x32_bf16 v[132:135], a[96:99], v[76:79], v[132:135]
    ds_read_b64_tr_b16 a[126:127], v7 offset:57600
    v_mfma_f32_16x16x32_bf16 v[136:139], a[100:103], v[72:75], v[136:139]
    ds_read_b64_tr_b16 a[96:97], v4 offset:49664
    ds_read_b64_tr_b16 a[98:99], v4 offset:57856
    s_add_u32 m0, s41, 32768
    v_mfma_f32_16x16x32_bf16 v[140:143], a[100:103], v[76:79], v[140:143]
    s_add_u32 s50, s38, 28672
    buffer_load_dwordx4 v23, s[16:19], s50 offen lds
    v_mfma_f32_16x16x32_bf16 v[144:147], a[104:107], v[72:75], v[144:147]
    ds_read_b64_tr_b16 a[100:101], v5 offset:49664
    v_mfma_f32_16x16x32_bf16 v[148:151], a[104:107], v[76:79], v[148:151]
    ds_read_b64_tr_b16 a[102:103], v5 offset:57856
    v_mfma_f32_16x16x32_bf16 v[152:155], a[108:111], v[72:75], v[152:155]
    ds_read_b64_tr_b16 a[104:105], v6 offset:49664
    v_mfma_f32_16x16x32_bf16 v[156:159], a[108:111], v[76:79], v[156:159]
    ds_read_b64_tr_b16 a[106:107], v6 offset:57856
    s_waitcnt lgkmcnt(6)
    v_mfma_f32_16x16x32_bf16 v[160:163], a[112:115], v[72:75], v[160:163]
    ds_read_b64_tr_b16 a[108:109], v7 offset:49664
    ds_read_b64_tr_b16 a[110:111], v7 offset:57856
    s_add_u32 m0, s41, 33792
    v_mfma_f32_16x16x32_bf16 v[164:167], a[112:115], v[76:79], v[164:167]
    s_add_u32 s50, s39, 28672
    buffer_load_dwordx4 v23, s[16:19], s50 offen lds
    v_mfma_f32_16x16x32_bf16 v[168:171], a[116:119], v[72:75], v[168:171]
    ds_read_b64_tr_b16 a[112:113], v4 offset:49920
    v_mfma_f32_16x16x32_bf16 v[172:175], a[116:119], v[76:79], v[172:175]
    ds_read_b64_tr_b16 a[114:115], v4 offset:58112
    v_mfma_f32_16x16x32_bf16 v[176:179], a[120:123], v[72:75], v[176:179]
    ds_read_b64_tr_b16 a[116:117], v5 offset:49920
    v_mfma_f32_16x16x32_bf16 v[180:183], a[120:123], v[76:79], v[180:183]
    ds_read_b64_tr_b16 a[118:119], v5 offset:58112
    v_mfma_f32_16x16x32_bf16 v[184:187], a[124:127], v[72:75], v[184:187]
    ds_read_b64_tr_b16 a[120:121], v6 offset:49920
    ds_read_b64_tr_b16 a[122:123], v6 offset:58112
    s_add_u32 m0, s41, 34816
    v_mfma_f32_16x16x32_bf16 v[188:191], a[124:127], v[76:79], v[188:191]
    s_add_u32 s50, s40, 28672
    buffer_load_dwordx4 v23, s[16:19], s50 offen lds
    s_waitcnt lgkmcnt(6)
    v_mfma_f32_16x16x32_bf16 v[192:195], a[96:99], v[72:75], v[192:195]
    ds_read_b64_tr_b16 a[124:125], v7 offset:49920
    v_mfma_f32_16x16x32_bf16 v[196:199], a[96:99], v[76:79], v[196:199]
    ds_read_b64_tr_b16 a[126:127], v7 offset:58112
    v_mfma_f32_16x16x32_bf16 v[200:203], a[100:103], v[72:75], v[200:203]
    v_mfma_f32_16x16x32_bf16 v[204:207], a[100:103], v[76:79], v[204:207]
    v_mfma_f32_16x16x32_bf16 v[208:211], a[104:107], v[72:75], v[208:211]
    s_add_u32 m0, s41, 133120
    s_add_u32 s50, s34, 57344
    v_mfma_f32_16x16x32_bf16 v[212:215], a[104:107], v[76:79], v[212:215]
    buffer_load_dwordx4 v23, s[16:19], s50 offen lds
    v_mfma_f32_16x16x32_bf16 v[216:219], a[108:111], v[72:75], v[216:219]
    v_mfma_f32_16x16x32_bf16 v[220:223], a[108:111], v[76:79], v[220:223]
    s_waitcnt lgkmcnt(0)
    v_mfma_f32_16x16x32_bf16 v[224:227], a[112:115], v[72:75], v[224:227]
    v_mfma_f32_16x16x32_bf16 v[228:231], a[112:115], v[76:79], v[228:231]
    v_mfma_f32_16x16x32_bf16 v[232:235], a[116:119], v[72:75], v[232:235]
    s_add_u32 m0, s41, 134144
    s_add_u32 s50, s35, 57344
    v_mfma_f32_16x16x32_bf16 v[236:239], a[116:119], v[76:79], v[236:239]
    buffer_load_dwordx4 v23, s[16:19], s50 offen lds
    v_mfma_f32_16x16x32_bf16 v[240:243], a[120:123], v[72:75], v[240:243]
    v_mfma_f32_16x16x32_bf16 v[244:247], a[120:123], v[76:79], v[244:247]
    v_mfma_f32_16x16x32_bf16 v[248:251], a[124:127], v[72:75], v[248:251]
    v_mfma_f32_16x16x32_bf16 v[252:255], a[124:127], v[76:79], v[252:255]
    s_add_u32 m0, s41, 135168
    s_add_u32 s50, s36, 57344
    buffer_load_dwordx4 v23, s[16:19], s50 offen lds
    s_add_u32 m0, s41, 136192
    s_add_u32 s50, s37, 57344
    buffer_load_dwordx4 v23, s[16:19], s50 offen lds
    s_add_u32 m0, s41, 137216
    s_add_u32 s50, s38, 57344
    buffer_load_dwordx4 v23, s[16:19], s50 offen lds
    s_add_u32 m0, s41, 138240
    s_add_u32 s50, s39, 57344
    buffer_load_dwordx4 v23, s[16:19], s50 offen lds
    s_add_u32 m0, s41, 139264
    s_add_u32 s50, s40, 57344
    buffer_load_dwordx4 v23, s[16:19], s50 offen lds
    s_add_u32 s29, s29, 16384
    v_mov_b32 v16, v62
    v_mov_b32 v18, v16
    s_nop 1
    v_permlane16_swap_b32 v16, v18
    s_nop 1
    v_add_f32 v16, v16, v18
    v_mov_b32 v18, v16
    s_nop 1
    v_permlane32_swap_b32 v16, v18
    s_nop 1
    v_add_f32 v16, v16, v18
    v_rcp_f32 v16, v16
    v_mov_b32 v17, v63
    v_mov_b32 v18, v17
    s_nop 1
    v_permlane16_swap_b32 v17, v18
    s_nop 1
    v_add_f32 v17, v17, v18
    v_mov_b32 v18, v17
    s_nop 1
    v_permlane32_swap_b32 v17, v18
    s_nop 1
    v_add_f32 v17, v17, v18
    v_rcp_f32 v17, v17
    s_lshl_b32 s50, s46, 1
    s_add_u32 s50, s50, s47
    s_lshl_b32 s50, s50, 14
    s_add_u32 s50, s50, 67584
    v_lshlrev_b32 v12, 4, v1
    v_and_b32 v18, 15, v1
    v_lshlrev_b32 v19, 9, v18
    v_lshrrev_b32 v20, 5, v1
    v_xor_b32 v20, v20, v18
    v_lshl_add_u32 v19, v20, 4, v19
    v_bfe_u32 v20, v1, 4, 1
    v_lshl_add_u32 v19, v20, 3, v19
    v_add_u32 v19, s50, v19
    s_barrier
    v_xor_b32 v24, 0, v19
    v_mul_f32 v128, v128, v16
    v_mul_f32 v129, v129, v16
    v_mul_f32 v130, v130, v16
    v_mul_f32 v131, v131, v16
    v_cvt_pk_bf16_f32 v32, v128, v129
    v_cvt_pk_bf16_f32 v33, v130, v131
    ds_write_b64 v24, v[32:33] offset:0
    v_mul_f32 v132, v132, v17
    v_mul_f32 v133, v133, v17
    v_mul_f32 v134, v134, v17
    v_mul_f32 v135, v135, v17
    v_cvt_pk_bf16_f32 v34, v132, v133
    v_cvt_pk_bf16_f32 v35, v134, v135
    ds_write_b64 v24, v[34:35] offset:8192
    v_xor_b32 v25, 32, v19
    v_mul_f32 v136, v136, v16
    v_mul_f32 v137, v137, v16
    v_mul_f32 v138, v138, v16
    v_mul_f32 v139, v139, v16
    v_cvt_pk_bf16_f32 v36, v136, v137
    v_cvt_pk_bf16_f32 v37, v138, v139
    ds_write_b64 v25, v[36:37] offset:0
    v_mul_f32 v140, v140, v17
    v_mul_f32 v141, v141, v17
    v_mul_f32 v142, v142, v17
    v_mul_f32 v143, v143, v17
    v_cvt_pk_bf16_f32 v38, v140, v141
    v_cvt_pk_bf16_f32 v39, v142, v143
    ds_write_b64 v25, v[38:39] offset:8192
    v_xor_b32 v26, 64, v19
    v_mul_f32 v144, v144, v16
    v_mul_f32 v145, v145, v16
    v_mul_f32 v146, v146, v16
    v_mul_f32 v147, v147, v16
    v_cvt_pk_bf16_f32 v40, v144, v145
    v_cvt_pk_bf16_f32 v41, v146, v147
    ds_write_b64 v26, v[40:41] offset:0
    v_mul_f32 v148, v148, v17
    v_mul_f32 v149, v149, v17
    v_mul_f32 v150, v150, v17
    v_mul_f32 v151, v151, v17
    v_cvt_pk_bf16_f32 v42, v148, v149
    v_cvt_pk_bf16_f32 v43, v150, v151
    ds_write_b64 v26, v[42:43] offset:8192
    v_xor_b32 v27, 96, v19
    v_mul_f32 v152, v152, v16
    v_mul_f32 v153, v153, v16
    v_mul_f32 v154, v154, v16
    v_mul_f32 v155, v155, v16
    v_cvt_pk_bf16_f32 v44, v152, v153
    v_cvt_pk_bf16_f32 v45, v154, v155
    ds_write_b64 v27, v[44:45] offset:0
    v_mul_f32 v156, v156, v17
    v_mul_f32 v157, v157, v17
    v_mul_f32 v158, v158, v17
    v_mul_f32 v159, v159, v17
    v_cvt_pk_bf16_f32 v46, v156, v157
    v_cvt_pk_bf16_f32 v47, v158, v159
    ds_write_b64 v27, v[46:47] offset:8192
    v_xor_b32 v24, 128, v19
    v_mul_f32 v160, v160, v16
    v_mul_f32 v161, v161, v16
    v_mul_f32 v162, v162, v16
    v_mul_f32 v163, v163, v16
    v_cvt_pk_bf16_f32 v32, v160, v161
    v_cvt_pk_bf16_f32 v33, v162, v163
    ds_write_b64 v24, v[32:33] offset:0
    v_mul_f32 v164, v164, v17
    v_mul_f32 v165, v165, v17
    v_mul_f32 v166, v166, v17
    v_mul_f32 v167, v167, v17
    v_cvt_pk_bf16_f32 v34, v164, v165
    v_cvt_pk_bf16_f32 v35, v166, v167
    ds_write_b64 v24, v[34:35] offset:8192
    v_xor_b32 v25, 160, v19
    v_mul_f32 v168, v168, v16
    v_mul_f32 v169, v169, v16
    v_mul_f32 v170, v170, v16
    v_mul_f32 v171, v171, v16
    v_cvt_pk_bf16_f32 v36, v168, v169
    v_cvt_pk_bf16_f32 v37, v170, v171
    ds_write_b64 v25, v[36:37] offset:0
    v_mul_f32 v172, v172, v17
    v_mul_f32 v173, v173, v17
    v_mul_f32 v174, v174, v17
    v_mul_f32 v175, v175, v17
    v_cvt_pk_bf16_f32 v38, v172, v173
    v_cvt_pk_bf16_f32 v39, v174, v175
    ds_write_b64 v25, v[38:39] offset:8192
    v_xor_b32 v26, 192, v19
    v_mul_f32 v176, v176, v16
    v_mul_f32 v177, v177, v16
    v_mul_f32 v178, v178, v16
    v_mul_f32 v179, v179, v16
    v_cvt_pk_bf16_f32 v40, v176, v177
    v_cvt_pk_bf16_f32 v41, v178, v179
    ds_write_b64 v26, v[40:41] offset:0
    v_mul_f32 v180, v180, v17
    v_mul_f32 v181, v181, v17
    v_mul_f32 v182, v182, v17
    v_mul_f32 v183, v183, v17
    v_cvt_pk_bf16_f32 v42, v180, v181
    v_cvt_pk_bf16_f32 v43, v182, v183
    ds_write_b64 v26, v[42:43] offset:8192
    v_xor_b32 v27, 224, v19
    v_mul_f32 v184, v184, v16
    v_mul_f32 v185, v185, v16
    v_mul_f32 v186, v186, v16
    v_mul_f32 v187, v187, v16
    v_cvt_pk_bf16_f32 v44, v184, v185
    v_cvt_pk_bf16_f32 v45, v186, v187
    ds_write_b64 v27, v[44:45] offset:0
    v_mul_f32 v188, v188, v17
    v_mul_f32 v189, v189, v17
    v_mul_f32 v190, v190, v17
    v_mul_f32 v191, v191, v17
    v_cvt_pk_bf16_f32 v46, v188, v189
    v_cvt_pk_bf16_f32 v47, v190, v191
    ds_write_b64 v27, v[46:47] offset:8192
    v_xor_b32 v24, 256, v19
    v_mul_f32 v192, v192, v16
    v_mul_f32 v193, v193, v16
    v_mul_f32 v194, v194, v16
    v_mul_f32 v195, v195, v16
    v_cvt_pk_bf16_f32 v32, v192, v193
    v_cvt_pk_bf16_f32 v33, v194, v195
    ds_write_b64 v24, v[32:33] offset:0
    v_mul_f32 v196, v196, v17
    v_mul_f32 v197, v197, v17
    v_mul_f32 v198, v198, v17
    v_mul_f32 v199, v199, v17
    v_cvt_pk_bf16_f32 v34, v196, v197
    v_cvt_pk_bf16_f32 v35, v198, v199
    ds_write_b64 v24, v[34:35] offset:8192
    v_xor_b32 v25, 288, v19
    v_mul_f32 v200, v200, v16
    v_mul_f32 v201, v201, v16
    v_mul_f32 v202, v202, v16
    v_mul_f32 v203, v203, v16
    v_cvt_pk_bf16_f32 v36, v200, v201
    v_cvt_pk_bf16_f32 v37, v202, v203
    ds_write_b64 v25, v[36:37] offset:0
    v_mul_f32 v204, v204, v17
    v_mul_f32 v205, v205, v17
    v_mul_f32 v206, v206, v17
    v_mul_f32 v207, v207, v17
    v_cvt_pk_bf16_f32 v38, v204, v205
    v_cvt_pk_bf16_f32 v39, v206, v207
    ds_write_b64 v25, v[38:39] offset:8192
    v_xor_b32 v26, 320, v19
    v_mul_f32 v208, v208, v16
    v_mul_f32 v209, v209, v16
    v_mul_f32 v210, v210, v16
    v_mul_f32 v211, v211, v16
    v_cvt_pk_bf16_f32 v40, v208, v209
    v_cvt_pk_bf16_f32 v41, v210, v211
    ds_write_b64 v26, v[40:41] offset:0
    v_mul_f32 v212, v212, v17
    v_mul_f32 v213, v213, v17
    v_mul_f32 v214, v214, v17
    v_mul_f32 v215, v215, v17
    v_cvt_pk_bf16_f32 v42, v212, v213
    v_cvt_pk_bf16_f32 v43, v214, v215
    ds_write_b64 v26, v[42:43] offset:8192
    v_xor_b32 v27, 352, v19
    v_mul_f32 v216, v216, v16
    v_mul_f32 v217, v217, v16
    v_mul_f32 v218, v218, v16
    v_mul_f32 v219, v219, v16
    v_cvt_pk_bf16_f32 v44, v216, v217
    v_cvt_pk_bf16_f32 v45, v218, v219
    ds_write_b64 v27, v[44:45] offset:0
    v_mul_f32 v220, v220, v17
    v_mul_f32 v221, v221, v17
    v_mul_f32 v222, v222, v17
    v_mul_f32 v223, v223, v17
    v_cvt_pk_bf16_f32 v46, v220, v221
    v_cvt_pk_bf16_f32 v47, v222, v223
    ds_write_b64 v27, v[46:47] offset:8192
    v_xor_b32 v24, 384, v19
    v_mul_f32 v224, v224, v16
    v_mul_f32 v225, v225, v16
    v_mul_f32 v226, v226, v16
    v_mul_f32 v227, v227, v16
    v_cvt_pk_bf16_f32 v32, v224, v225
    v_cvt_pk_bf16_f32 v33, v226, v227
    ds_write_b64 v24, v[32:33] offset:0
    v_mul_f32 v228, v228, v17
    v_mul_f32 v229, v229, v17
    v_mul_f32 v230, v230, v17
    v_mul_f32 v231, v231, v17
    v_cvt_pk_bf16_f32 v34, v228, v229
    v_cvt_pk_bf16_f32 v35, v230, v231
    ds_write_b64 v24, v[34:35] offset:8192
    v_xor_b32 v25, 416, v19
    v_mul_f32 v232, v232, v16
    v_mul_f32 v233, v233, v16
    v_mul_f32 v234, v234, v16
    v_mul_f32 v235, v235, v16
    v_cvt_pk_bf16_f32 v36, v232, v233
    v_cvt_pk_bf16_f32 v37, v234, v235
    ds_write_b64 v25, v[36:37] offset:0
    v_mul_f32 v236, v236, v17
    v_mul_f32 v237, v237, v17
    v_mul_f32 v238, v238, v17
    v_mul_f32 v239, v239, v17
    v_cvt_pk_bf16_f32 v38, v236, v237
    v_cvt_pk_bf16_f32 v39, v238, v239
    ds_write_b64 v25, v[38:39] offset:8192
    v_xor_b32 v26, 448, v19
    v_mul_f32 v240, v240, v16
    v_mul_f32 v241, v241, v16
    v_mul_f32 v242, v242, v16
    v_mul_f32 v243, v243, v16
    v_cvt_pk_bf16_f32 v40, v240, v241
    v_cvt_pk_bf16_f32 v41, v242, v243
    ds_write_b64 v26, v[40:41] offset:0
    v_mul_f32 v244, v244, v17
    v_mul_f32 v245, v245, v17
    v_mul_f32 v246, v246, v17
    v_mul_f32 v247, v247, v17
    v_cvt_pk_bf16_f32 v42, v244, v245
    v_cvt_pk_bf16_f32 v43, v246, v247
    ds_write_b64 v26, v[42:43] offset:8192
    v_xor_b32 v27, 480, v19
    v_mul_f32 v248, v248, v16
    v_mul_f32 v249, v249, v16
    v_mul_f32 v250, v250, v16
    v_mul_f32 v251, v251, v16
    v_cvt_pk_bf16_f32 v44, v248, v249
    v_cvt_pk_bf16_f32 v45, v250, v251
    ds_write_b64 v27, v[44:45] offset:0
    v_mul_f32 v252, v252, v17
    v_mul_f32 v253, v253, v17
    v_mul_f32 v254, v254, v17
    v_mul_f32 v255, v255, v17
    v_cvt_pk_bf16_f32 v46, v252, v253
    v_cvt_pk_bf16_f32 v47, v254, v255
    ds_write_b64 v27, v[46:47] offset:8192
    s_waitcnt lgkmcnt(0)
    s_barrier
    s_lshl_b32 s50, s46, 15
    s_add_u32 s50, s50, 67584
    v_and_b32 v18, 31, v1
    v_lshlrev_b32 v19, 9, v18
    v_and_b32 v18, 15, v1
    v_lshrrev_b32 v20, 5, v1
    v_xor_b32 v20, v20, v18
    v_lshl_add_u32 v19, v20, 4, v19
    v_add_u32 v19, s50, v19
    v_xor_b32 v24, 0, v19
    ds_read_b128 a[0:3], v24 offset:0
    ds_read_b128 a[64:67], v24 offset:16384
    v_xor_b32 v25, 32, v19
    ds_read_b128 a[4:7], v25 offset:0
    ds_read_b128 a[68:71], v25 offset:16384
    v_xor_b32 v26, 64, v19
    ds_read_b128 a[8:11], v26 offset:0
    ds_read_b128 a[72:75], v26 offset:16384
    v_xor_b32 v27, 96, v19
    ds_read_b128 a[12:15], v27 offset:0
    ds_read_b128 a[76:79], v27 offset:16384
    v_xor_b32 v24, 128, v19
    ds_read_b128 a[16:19], v24 offset:0
    ds_read_b128 a[80:83], v24 offset:16384
    v_xor_b32 v25, 160, v19
    ds_read_b128 a[20:23], v25 offset:0
    ds_read_b128 a[84:87], v25 offset:16384
    v_xor_b32 v26, 192, v19
    ds_read_b128 a[24:27], v26 offset:0
    ds_read_b128 a[88:91], v26 offset:16384
    v_xor_b32 v27, 224, v19
    ds_read_b128 a[28:31], v27 offset:0
    ds_read_b128 a[92:95], v27 offset:16384
    v_xor_b32 v24, 256, v19
    ds_read_b128 a[32:35], v24 offset:0
    ds_read_b128 a[96:99], v24 offset:16384
    v_xor_b32 v25, 288, v19
    ds_read_b128 a[36:39], v25 offset:0
    ds_read_b128 a[100:103], v25 offset:16384
    v_xor_b32 v26, 320, v19
    ds_read_b128 a[40:43], v26 offset:0
    ds_read_b128 a[104:107], v26 offset:16384
    v_xor_b32 v27, 352, v19
    ds_read_b128 a[44:47], v27 offset:0
    ds_read_b128 a[108:111], v27 offset:16384
    v_xor_b32 v24, 384, v19
    ds_read_b128 a[48:51], v24 offset:0
    ds_read_b128 a[112:115], v24 offset:16384
    v_xor_b32 v25, 416, v19
    ds_read_b128 a[52:55], v25 offset:0
    ds_read_b128 a[116:119], v25 offset:16384
    v_xor_b32 v26, 448, v19
    ds_read_b128 a[56:59], v26 offset:0
    ds_read_b128 a[120:123], v26 offset:16384
    v_xor_b32 v27, 480, v19
    ds_read_b128 a[60:63], v27 offset:0
    ds_read_b128 a[124:127], v27 offset:16384
    v_lshrrev_b32 v16, 5, v1
    v_lshlrev_b32 v17, 10, v16
    v_bfe_u32 v16, v1, 2, 2
    v_lshl_add_u32 v17, v16, 7, v17
    v_bfe_u32 v16, v1, 4, 1
    v_lshl_add_u32 v17, v16, 5, v17
    v_and_b32 v16, 3, v1
    v_lshl_add_u32 v17, v16, 3, v17
    v_bfe_u32 v16, v1, 3, 1
    v_xor_b32 v18, s47, v16
    v_lshl_add_u32 v2, v18, 6, v17
    v_xor_b32 v18, 1, v18
    v_lshl_add_u32 v3, v18, 6, v17
    s_mul_i32 s50, s47, 6144
    s_mul_i32 s51, s47, 8192
    v_add_u32 v2, s50, v2
    v_add_u32 v3, s51, v3
    v_add_u32 v4, 133120, v2
    v_add_u32 v5, 133120, v3
    v_add_u32 v6, 67584, v2
    v_add_u32 v7, 67584, v3
    s_waitcnt lgkmcnt(0)
    s_waitcnt vmcnt(14)
    s_barrier
    ds_read_b64_tr_b16 a[128:129], v2 offset:0
    ds_read_b64_tr_b16 a[130:131], v2 offset:512
    ds_read_b64_tr_b16 a[132:133], v3 offset:0
    ds_read_b64_tr_b16 a[134:135], v3 offset:512
    ds_read_b64_tr_b16 a[136:137], v2 offset:2048
    ds_read_b64_tr_b16 a[138:139], v2 offset:2560
    ds_read_b64_tr_b16 a[140:141], v3 offset:2048
    ds_read_b64_tr_b16 a[142:143], v3 offset:2560
    s_waitcnt lgkmcnt(6)
    v_mfma_f32_32x32x16_bf16 v[128:143], a[128:131], a[0:3], 0
    ds_read_b64_tr_b16 a[144:145], v2 offset:4096
    ds_read_b64_tr_b16 a[146:147], v2 offset:4608
    s_waitcnt vmcnt(7)
    s_barrier
    s_add_u32 m0, s41, 67584
    s_add_u32 s50, s34, 86016
    buffer_load_dwordx4 v23, s[16:19], s50 offen lds
    s_waitcnt lgkmcnt(6)
    v_mfma_f32_32x32x16_bf16 v[144:159], a[132:135], a[0:3], 0
    ds_read_b64_tr_b16 a[148:149], v3 offset:4096
    ds_read_b64_tr_b16 a[150:151], v3 offset:4608
    s_add_u32 m0, s41, 68608
    s_add_u32 s50, s35, 86016
    buffer_load_dwordx4 v23, s[16:19], s50 offen lds
    s_waitcnt lgkmcnt(6)
    v_mfma_f32_32x32x16_bf16 v[160:175], a[136:139], a[0:3], 0
    ds_read_b64_tr_b16 a[152:153], v2 offset:6144
    ds_read_b64_tr_b16 a[154:155], v2 offset:6656
    s_add_u32 m0, s41, 69632
    s_add_u32 s50, s36, 86016
    buffer_load_dwordx4 v23, s[16:19], s50 offen lds
    s_waitcnt lgkmcnt(6)
    v_mfma_f32_32x32x16_bf16 v[176:191], a[140:143], a[0:3], 0
    ds_read_b64_tr_b16 a[156:157], v2 offset:14336
    ds_read_b64_tr_b16 a[158:159], v2 offset:14848
    s_add_u32 m0, s41, 70656
    s_add_u32 s50, s37, 86016
    buffer_load_dwordx4 v23, s[16:19], s50 offen lds
    s_waitcnt lgkmcnt(6)
    v_mfma_f32_32x32x16_bf16 v[192:207], a[144:147], a[0:3], 0
    ds_read_b64_tr_b16 a[128:129], v3 offset:14336
    ds_read_b64_tr_b16 a[130:131], v3 offset:14848
    s_add_u32 m0, s41, 71680
    s_add_u32 s50, s38, 86016
    buffer_load_dwordx4 v23, s[16:19], s50 offen lds
    s_waitcnt lgkmcnt(6)
    v_mfma_f32_32x32x16_bf16 v[208:223], a[148:151], a[0:3], 0
    ds_read_b64_tr_b16 a[132:133], v2 offset:16384
    ds_read_b64_tr_b16 a[134:135], v2 offset:16896
    s_add_u32 m0, s41, 72704
    s_add_u32 s50, s39, 86016
    buffer_load_dwordx4 v23, s[16:19], s50 offen lds
    s_waitcnt lgkmcnt(6)
    v_mfma_f32_32x32x16_bf16 v[224:239], a[152:155], a[0:3], 0
    ds_read_b64_tr_b16 a[136:137], v3 offset:16384
    ds_read_b64_tr_b16 a[138:139], v3 offset:16896
    s_add_u32 m0, s41, 73728
    s_add_u32 s50, s40, 86016
    buffer_load_dwordx4 v23, s[16:19], s50 offen lds
    s_waitcnt lgkmcnt(6)
    v_mfma_f32_32x32x16_bf16 v[128:143], a[156:159], a[4:7], v[128:143]
    ds_read_b64_tr_b16 a[140:141], v2 offset:18432
    ds_read_b64_tr_b16 a[142:143], v2 offset:18944
    s_add_u32 m0, s41, 96256
    s_add_u32 s50, s34, 114688
    buffer_load_dwordx4 v23, s[16:19], s50 offen lds
    s_waitcnt lgkmcnt(6)
    v_mfma_f32_32x32x16_bf16 v[144:159], a[128:131], a[4:7], v[144:159]
    ds_read_b64_tr_b16 a[144:145], v3 offset:18432
    ds_read_b64_tr_b16 a[146:147], v3 offset:18944
    s_add_u32 m0, s41, 97280
    s_add_u32 s50, s35, 114688
    buffer_load_dwordx4 v23, s[16:19], s50 offen lds
    s_waitcnt lgkmcnt(6)
    v_mfma_f32_32x32x16_bf16 v[160:175], a[132:135], a[4:7], v[160:175]
    ds_read_b64_tr_b16 a[148:149], v2 offset:20480
    ds_read_b64_tr_b16 a[150:151], v2 offset:20992
    s_add_u32 m0, s41, 98304
    s_add_u32 s50, s36, 114688
    buffer_load_dwordx4 v23, s[16:19], s50 offen lds
    s_waitcnt lgkmcnt(6)
    v_mfma_f32_32x32x16_bf16 v[176:191], a[136:139], a[4:7], v[176:191]
    ds_read_b64_tr_b16 a[152:153], v2 offset:28672
    ds_read_b64_tr_b16 a[154:155], v2 offset:29184
    s_add_u32 m0, s41, 99328
    s_add_u32 s50, s37, 114688
    buffer_load_dwordx4 v23, s[16:19], s50 offen lds
    s_waitcnt lgkmcnt(6)
    v_mfma_f32_32x32x16_bf16 v[192:207], a[140:143], a[4:7], v[192:207]
    ds_read_b64_tr_b16 a[156:157], v3 offset:28672
    ds_read_b64_tr_b16 a[158:159], v3 offset:29184
    s_add_u32 m0, s41, 100352
    s_add_u32 s50, s38, 114688
    buffer_load_dwordx4 v23, s[16:19], s50 offen lds
    s_waitcnt lgkmcnt(6)
    v_mfma_f32_32x32x16_bf16 v[208:223], a[144:147], a[4:7], v[208:223]
    ds_read_b64_tr_b16 a[128:129], v2 offset:30720
    ds_read_b64_tr_b16 a[130:131], v2 offset:31232
    s_add_u32 m0, s41, 101376
    s_add_u32 s50, s39, 114688
    buffer_load_dwordx4 v23, s[16:19], s50 offen lds
    s_waitcnt lgkmcnt(6)
    v_mfma_f32_32x32x16_bf16 v[224:239], a[148:151], a[4:7], v[224:239]
    ds_read_b64_tr_b16 a[132:133], v3 offset:30720
    ds_read_b64_tr_b16 a[134:135], v3 offset:31232
    s_add_u32 m0, s41, 102400
    s_add_u32 s50, s40, 114688
    buffer_load_dwordx4 v23, s[16:19], s50 offen lds
    s_waitcnt lgkmcnt(6)
    v_mfma_f32_32x32x16_bf16 v[128:143], a[152:155], a[8:11], v[128:143]
    ds_read_b64_tr_b16 a[136:137], v2 offset:32768
    ds_read_b64_tr_b16 a[138:139], v2 offset:33280
    s_waitcnt vmcnt(14)
    s_barrier
    s_waitcnt lgkmcnt(6)
    v_mfma_f32_32x32x16_bf16 v[144:159], a[156:159], a[8:11], v[144:159]
    ds_read_b64_tr_b16 a[140:141], v3 offset:32768
    ds_read_b64_tr_b16 a[142:143], v3 offset:33280
    s_add_u32 m0, s41, 0
    s_add_u32 s50, s34, 143360
    buffer_load_dwordx4 v23, s[16:19], s50 offen lds
    s_waitcnt lgkmcnt(6)
    v_mfma_f32_32x32x16_bf16 v[160:175], a[128:131], a[8:11], v[160:175]
    ds_read_b64_tr_b16 a[144:145], v2 offset:34816
    ds_read_b64_tr_b16 a[146:147], v2 offset:35328
    s_add_u32 m0, s41, 1024
    s_add_u32 s50, s35, 143360
    buffer_load_dwordx4 v23, s[16:19], s50 offen lds
    s_waitcnt lgkmcnt(6)
    v_mfma_f32_32x32x16_bf16 v[176:191], a[132:135], a[8:11], v[176:191]
    ds_read_b64_tr_b16 a[148:149], v2 offset:43008
    ds_read_b64_tr_b16 a[150:151], v2 offset:43520
    s_waitcnt lgkmcnt(6)
    v_mfma_f32_32x32x16_bf16 v[192:207], a[136:139], a[8:11], v[192:207]
    ds_read_b64_tr_b16 a[152:153], v3 offset:43008
    ds_read_b64_tr_b16 a[154:155], v3 offset:43520
    s_add_u32 m0, s41, 2048
    s_add_u32 s50, s36, 143360
    buffer_load_dwordx4 v23, s[16:19], s50 offen lds
    s_waitcnt lgkmcnt(6)
    v_mfma_f32_32x32x16_bf16 v[208:223], a[140:143], a[8:11], v[208:223]
    ds_read_b64_tr_b16 a[156:157], v2 offset:45056
    ds_read_b64_tr_b16 a[158:159], v2 offset:45568
    s_waitcnt lgkmcnt(6)
    v_mfma_f32_32x32x16_bf16 v[224:239], a[144:147], a[8:11], v[224:239]
    ds_read_b64_tr_b16 a[128:129], v3 offset:45056
    ds_read_b64_tr_b16 a[130:131], v3 offset:45568
    s_add_u32 m0, s41, 3072
    s_add_u32 s50, s37, 143360
    buffer_load_dwordx4 v23, s[16:19], s50 offen lds
    s_waitcnt lgkmcnt(6)
    v_mfma_f32_32x32x16_bf16 v[128:143], a[148:151], a[12:15], v[128:143]
    ds_read_b64_tr_b16 a[132:133], v2 offset:47104
    ds_read_b64_tr_b16 a[134:135], v2 offset:47616
    s_add_u32 m0, s41, 4096
    s_add_u32 s50, s38, 143360
    buffer_load_dwordx4 v23, s[16:19], s50 offen lds
    s_waitcnt lgkmcnt(6)
    v_mfma_f32_32x32x16_bf16 v[144:159], a[152:155], a[12:15], v[144:159]
    ds_read_b64_tr_b16 a[136:137], v3 offset:47104
    ds_read_b64_tr_b16 a[138:139], v3 offset:47616
    s_waitcnt lgkmcnt(6)
    v_mfma_f32_32x32x16_bf16 v[160:175], a[156:159], a[12:15], v[160:175]
    ds_read_b64_tr_b16 a[140:141], v2 offset:49152
    ds_read_b64_tr_b16 a[142:143], v2 offset:49664
    s_add_u32 m0, s41, 5120
    s_add_u32 s50, s39, 143360
    buffer_load_dwordx4 v23, s[16:19], s50 offen lds
    s_waitcnt lgkmcnt(6)
    v_mfma_f32_32x32x16_bf16 v[176:191], a[128:131], a[12:15], v[176:191]
    ds_read_b64_tr_b16 a[144:145], v4 offset:0
    ds_read_b64_tr_b16 a[146:147], v4 offset:512
    s_waitcnt lgkmcnt(6)
    v_mfma_f32_32x32x16_bf16 v[192:207], a[132:135], a[12:15], v[192:207]
    ds_read_b64_tr_b16 a[148:149], v5 offset:0
    ds_read_b64_tr_b16 a[150:151], v5 offset:512
    s_add_u32 m0, s41, 6144
    s_add_u32 s50, s40, 143360
    buffer_load_dwordx4 v23, s[16:19], s50 offen lds
    s_waitcnt lgkmcnt(6)
    v_mfma_f32_32x32x16_bf16 v[208:223], a[136:139], a[12:15], v[208:223]
    ds_read_b64_tr_b16 a[152:153], v4 offset:2048
    ds_read_b64_tr_b16 a[154:155], v4 offset:2560
    s_waitcnt lgkmcnt(6)
    v_mfma_f32_32x32x16_bf16 v[224:239], a[140:143], a[12:15], v[224:239]
    ds_read_b64_tr_b16 a[156:157], v5 offset:2048
    ds_read_b64_tr_b16 a[158:159], v5 offset:2560
    s_waitcnt lgkmcnt(6)
    v_mfma_f32_32x32x16_bf16 v[128:143], a[144:147], a[16:19], v[128:143]
    ds_read_b64_tr_b16 a[128:129], v4 offset:4096
    ds_read_b64_tr_b16 a[130:131], v4 offset:4608
    s_waitcnt vmcnt(14)
    s_barrier
    s_waitcnt lgkmcnt(6)
    v_mfma_f32_32x32x16_bf16 v[144:159], a[148:151], a[16:19], v[144:159]
    ds_read_b64_tr_b16 a[132:133], v5 offset:4096
    ds_read_b64_tr_b16 a[134:135], v5 offset:4608
    s_add_u32 m0, s41, 28672
    s_add_u32 s50, s34, 172032
    buffer_load_dwordx4 v23, s[16:19], s50 offen lds
    s_waitcnt lgkmcnt(6)
    v_mfma_f32_32x32x16_bf16 v[160:175], a[152:155], a[16:19], v[160:175]
    ds_read_b64_tr_b16 a[136:137], v4 offset:6144
    ds_read_b64_tr_b16 a[138:139], v4 offset:6656
    s_add_u32 m0, s41, 29696
    s_add_u32 s50, s35, 172032
    buffer_load_dwordx4 v23, s[16:19], s50 offen lds
    s_waitcnt lgkmcnt(6)
    v_mfma_f32_32x32x16_bf16 v[176:191], a[156:159], a[16:19], v[176:191]
    ds_read_b64_tr_b16 a[140:141], v4 offset:14336
    ds_read_b64_tr_b16 a[142:143], v4 offset:14848
    s_waitcnt lgkmcnt(6)
    v_mfma_f32_32x32x16_bf16 v[192:207], a[128:131], a[16:19], v[192:207]
    ds_read_b64_tr_b16 a[144:145], v5 offset:14336
    ds_read_b64_tr_b16 a[146:147], v5 offset:14848
    s_add_u32 m0, s41, 30720
    s_add_u32 s50, s36, 172032
    buffer_load_dwordx4 v23, s[16:19], s50 offen lds
    s_waitcnt lgkmcnt(6)
    v_mfma_f32_32x32x16_bf16 v[208:223], a[132:135], a[16:19], v[208:223]
    ds_read_b64_tr_b16 a[148:149], v4 offset:16384
    ds_read_b64_tr_b16 a[150:151], v4 offset:16896
    s_waitcnt lgkmcnt(6)
    v_mfma_f32_32x32x16_bf16 v[224:239], a[136:139], a[16:19], v[224:239]
    ds_read_b64_tr_b16 a[152:153], v5 offset:16384
    ds_read_b64_tr_b16 a[154:155], v5 offset:16896
    s_add_u32 m0, s41, 31744
    s_add_u32 s50, s37, 172032
    buffer_load_dwordx4 v23, s[16:19], s50 offen lds
    s_waitcnt lgkmcnt(6)
    v_mfma_f32_32x32x16_bf16 v[128:143], a[140:143], a[20:23], v[128:143]
    ds_read_b64_tr_b16 a[156:157], v4 offset:18432
    ds_read_b64_tr_b16 a[158:159], v4 offset:18944
    s_add_u32 m0, s41, 32768
    s_add_u32 s50, s38, 172032
    buffer_load_dwordx4 v23, s[16:19], s50 offen lds
    s_waitcnt lgkmcnt(6)
    v_mfma_f32_32x32x16_bf16 v[144:159], a[144:147], a[20:23], v[144:159]
    ds_read_b64_tr_b16 a[128:129], v5 offset:18432
    ds_read_b64_tr_b16 a[130:131], v5 offset:18944
    s_waitcnt lgkmcnt(6)
    v_mfma_f32_32x32x16_bf16 v[160:175], a[148:151], a[20:23], v[160:175]
    ds_read_b64_tr_b16 a[132:133], v4 offset:20480
    ds_read_b64_tr_b16 a[134:135], v4 offset:20992
    s_add_u32 m0, s41, 33792
    s_add_u32 s50, s39, 172032
    buffer_load_dwordx4 v23, s[16:19], s50 offen lds
    s_waitcnt lgkmcnt(6)
    v_mfma_f32_32x32x16_bf16 v[176:191], a[152:155], a[20:23], v[176:191]
    ds_read_b64_tr_b16 a[136:137], v6 offset:0
    ds_read_b64_tr_b16 a[138:139], v6 offset:512
    s_waitcnt lgkmcnt(6)
    v_mfma_f32_32x32x16_bf16 v[192:207], a[156:159], a[20:23], v[192:207]
    ds_read_b64_tr_b16 a[140:141], v7 offset:0
    ds_read_b64_tr_b16 a[142:143], v7 offset:512
    s_add_u32 m0, s41, 34816
    s_add_u32 s50, s40, 172032
    buffer_load_dwordx4 v23, s[16:19], s50 offen lds
    s_waitcnt lgkmcnt(6)
    v_mfma_f32_32x32x16_bf16 v[208:223], a[128:131], a[20:23], v[208:223]
    ds_read_b64_tr_b16 a[144:145], v6 offset:2048
    ds_read_b64_tr_b16 a[146:147], v6 offset:2560
    s_waitcnt lgkmcnt(6)
    v_mfma_f32_32x32x16_bf16 v[224:239], a[132:135], a[20:23], v[224:239]
    ds_read_b64_tr_b16 a[148:149], v7 offset:2048
    ds_read_b64_tr_b16 a[150:151], v7 offset:2560
    s_waitcnt lgkmcnt(6)
    v_mfma_f32_32x32x16_bf16 v[128:143], a[136:139], a[24:27], v[128:143]
    ds_read_b64_tr_b16 a[152:153], v6 offset:4096
    ds_read_b64_tr_b16 a[154:155], v6 offset:4608
    s_waitcnt vmcnt(14)
    s_barrier
    s_waitcnt lgkmcnt(6)
    v_mfma_f32_32x32x16_bf16 v[144:159], a[140:143], a[24:27], v[144:159]
    ds_read_b64_tr_b16 a[156:157], v7 offset:4096
    ds_read_b64_tr_b16 a[158:159], v7 offset:4608
    s_add_u32 m0, s41, 133120
    s_add_u32 s50, s34, 200704
    buffer_load_dwordx4 v23, s[16:19], s50 offen lds
    s_waitcnt lgkmcnt(6)
    v_mfma_f32_32x32x16_bf16 v[160:175], a[144:147], a[24:27], v[160:175]
    ds_read_b64_tr_b16 a[128:129], v6 offset:6144
    ds_read_b64_tr_b16 a[130:131], v6 offset:6656
    s_add_u32 m0, s41, 134144
    s_add_u32 s50, s35, 200704
    buffer_load_dwordx4 v23, s[16:19], s50 offen lds
    s_waitcnt lgkmcnt(6)
    v_mfma_f32_32x32x16_bf16 v[176:191], a[148:151], a[24:27], v[176:191]
    ds_read_b64_tr_b16 a[132:133], v6 offset:14336
    ds_read_b64_tr_b16 a[134:135], v6 offset:14848
    s_waitcnt lgkmcnt(6)
    v_mfma_f32_32x32x16_bf16 v[192:207], a[152:155], a[24:27], v[192:207]
    ds_read_b64_tr_b16 a[136:137], v7 offset:14336
    ds_read_b64_tr_b16 a[138:139], v7 offset:14848
    s_add_u32 m0, s41, 135168
    s_add_u32 s50, s36, 200704
    buffer_load_dwordx4 v23, s[16:19], s50 offen lds
    s_waitcnt lgkmcnt(6)
    v_mfma_f32_32x32x16_bf16 v[208:223], a[156:159], a[24:27], v[208:223]
    ds_read_b64_tr_b16 a[140:141], v6 offset:16384
    ds_read_b64_tr_b16 a[142:143], v6 offset:16896
    s_waitcnt lgkmcnt(6)
    v_mfma_f32_32x32x16_bf16 v[224:239], a[128:131], a[24:27], v[224:239]
    ds_read_b64_tr_b16 a[144:145], v7 offset:16384
    ds_read_b64_tr_b16 a[146:147], v7 offset:16896
    s_add_u32 m0, s41, 136192
    s_add_u32 s50, s37, 200704
    buffer_load_dwordx4 v23, s[16:19], s50 offen lds
    s_waitcnt lgkmcnt(6)
    v_mfma_f32_32x32x16_bf16 v[128:143], a[132:135], a[28:31], v[128:143]
    ds_read_b64_tr_b16 a[148:149], v6 offset:18432
    ds_read_b64_tr_b16 a[150:151], v6 offset:18944
    s_add_u32 m0, s41, 137216
    s_add_u32 s50, s38, 200704
    buffer_load_dwordx4 v23, s[16:19], s50 offen lds
    s_waitcnt lgkmcnt(6)
    v_mfma_f32_32x32x16_bf16 v[144:159], a[136:139], a[28:31], v[144:159]
    ds_read_b64_tr_b16 a[152:153], v7 offset:18432
    ds_read_b64_tr_b16 a[154:155], v7 offset:18944
    s_waitcnt lgkmcnt(6)
    v_mfma_f32_32x32x16_bf16 v[160:175], a[140:143], a[28:31], v[160:175]
    ds_read_b64_tr_b16 a[156:157], v6 offset:20480
    ds_read_b64_tr_b16 a[158:159], v6 offset:20992
    s_add_u32 m0, s41, 138240
    s_add_u32 s50, s39, 200704
    buffer_load_dwordx4 v23, s[16:19], s50 offen lds
    s_waitcnt lgkmcnt(6)
    v_mfma_f32_32x32x16_bf16 v[176:191], a[144:147], a[28:31], v[176:191]
    ds_read_b64_tr_b16 a[128:129], v6 offset:28672
    ds_read_b64_tr_b16 a[130:131], v6 offset:29184
    s_waitcnt lgkmcnt(6)
    v_mfma_f32_32x32x16_bf16 v[192:207], a[148:151], a[28:31], v[192:207]
    ds_read_b64_tr_b16 a[132:133], v7 offset:28672
    ds_read_b64_tr_b16 a[134:135], v7 offset:29184
    s_add_u32 m0, s41, 139264
    s_add_u32 s50, s40, 200704
    buffer_load_dwordx4 v23, s[16:19], s50 offen lds
    s_waitcnt lgkmcnt(6)
    v_mfma_f32_32x32x16_bf16 v[208:223], a[152:155], a[28:31], v[208:223]
    ds_read_b64_tr_b16 a[136:137], v6 offset:30720
    ds_read_b64_tr_b16 a[138:139], v6 offset:31232
    s_waitcnt lgkmcnt(6)
    v_mfma_f32_32x32x16_bf16 v[224:239], a[156:159], a[28:31], v[224:239]
    ds_read_b64_tr_b16 a[140:141], v7 offset:30720
    ds_read_b64_tr_b16 a[142:143], v7 offset:31232
    s_waitcnt lgkmcnt(6)
    v_mfma_f32_32x32x16_bf16 v[128:143], a[128:131], a[32:35], v[128:143]
    ds_read_b64_tr_b16 a[144:145], v6 offset:32768
    ds_read_b64_tr_b16 a[146:147], v6 offset:33280
    s_waitcnt vmcnt(14)
    s_barrier
    s_waitcnt lgkmcnt(6)
    v_mfma_f32_32x32x16_bf16 v[144:159], a[132:135], a[32:35], v[144:159]
    ds_read_b64_tr_b16 a[148:149], v7 offset:32768
    ds_read_b64_tr_b16 a[150:151], v7 offset:33280
    s_add_u32 m0, s41, 67584
    s_add_u32 s50, s34, 229376
    buffer_load_dwordx4 v23, s[16:19], s50 offen lds
    s_waitcnt lgkmcnt(6)
    v_mfma_f32_32x32x16_bf16 v[160:175], a[136:139], a[32:35], v[160:175]
    ds_read_b64_tr_b16 a[152:153], v6 offset:34816
    ds_read_b64_tr_b16 a[154:155], v6 offset:35328
    s_add_u32 m0, s41, 68608
    s_add_u32 s50, s35, 229376
    buffer_load_dwordx4 v23, s[16:19], s50 offen lds
    s_waitcnt lgkmcnt(6)
    v_mfma_f32_32x32x16_bf16 v[176:191], a[140:143], a[32:35], v[176:191]
    ds_read_b64_tr_b16 a[156:157], v6 offset:43008
    ds_read_b64_tr_b16 a[158:159], v6 offset:43520
    s_waitcnt lgkmcnt(6)
    v_mfma_f32_32x32x16_bf16 v[192:207], a[144:147], a[32:35], v[192:207]
    ds_read_b64_tr_b16 a[128:129], v7 offset:43008
    ds_read_b64_tr_b16 a[130:131], v7 offset:43520
    s_add_u32 m0, s41, 69632
    s_add_u32 s50, s36, 229376
    buffer_load_dwordx4 v23, s[16:19], s50 offen lds
    s_waitcnt lgkmcnt(6)
    v_mfma_f32_32x32x16_bf16 v[208:223], a[148:151], a[32:35], v[208:223]
    ds_read_b64_tr_b16 a[132:133], v6 offset:45056
    ds_read_b64_tr_b16 a[134:135], v6 offset:45568
    s_waitcnt lgkmcnt(6)
    v_mfma_f32_32x32x16_bf16 v[224:239], a[152:155], a[32:35], v[224:239]
    ds_read_b64_tr_b16 a[136:137], v7 offset:45056
    ds_read_b64_tr_b16 a[138:139], v7 offset:45568
    s_add_u32 m0, s41, 70656
    s_add_u32 s50, s37, 229376
    buffer_load_dwordx4 v23, s[16:19], s50 offen lds
    s_waitcnt lgkmcnt(6)
    v_mfma_f32_32x32x16_bf16 v[128:143], a[156:159], a[36:39], v[128:143]
    ds_read_b64_tr_b16 a[140:141], v6 offset:47104
    ds_read_b64_tr_b16 a[142:143], v6 offset:47616
    s_add_u32 m0, s41, 71680
    s_add_u32 s50, s38, 229376
    buffer_load_dwordx4 v23, s[16:19], s50 offen lds
    s_waitcnt lgkmcnt(6)
    v_mfma_f32_32x32x16_bf16 v[144:159], a[128:131], a[36:39], v[144:159]
    ds_read_b64_tr_b16 a[144:145], v7 offset:47104
    ds_read_b64_tr_b16 a[146:147], v7 offset:47616
    s_waitcnt lgkmcnt(6)
    v_mfma_f32_32x32x16_bf16 v[160:175], a[132:135], a[36:39], v[160:175]
    ds_read_b64_tr_b16 a[148:149], v6 offset:49152
    ds_read_b64_tr_b16 a[150:151], v6 offset:49664
    s_add_u32 m0, s41, 72704
    s_add_u32 s50, s39, 229376
    buffer_load_dwordx4 v23, s[16:19], s50 offen lds
    s_waitcnt lgkmcnt(6)
    v_mfma_f32_32x32x16_bf16 v[176:191], a[136:139], a[36:39], v[176:191]
    ds_read_b64_tr_b16 a[152:153], v2 offset:0
    ds_read_b64_tr_b16 a[154:155], v2 offset:512
    s_waitcnt lgkmcnt(6)
    v_mfma_f32_32x32x16_bf16 v[192:207], a[140:143], a[36:39], v[192:207]
    ds_read_b64_tr_b16 a[156:157], v3 offset:0
    ds_read_b64_tr_b16 a[158:159], v3 offset:512
    s_add_u32 m0, s41, 73728
    s_add_u32 s50, s40, 229376
    buffer_load_dwordx4 v23, s[16:19], s50 offen lds
    s_waitcnt lgkmcnt(6)
    v_mfma_f32_32x32x16_bf16 v[208:223], a[144:147], a[36:39], v[208:223]
    ds_read_b64_tr_b16 a[128:129], v2 offset:2048
    ds_read_b64_tr_b16 a[130:131], v2 offset:2560
    s_waitcnt lgkmcnt(6)
    v_mfma_f32_32x32x16_bf16 v[224:239], a[148:151], a[36:39], v[224:239]
    ds_read_b64_tr_b16 a[132:133], v3 offset:2048
    ds_read_b64_tr_b16 a[134:135], v3 offset:2560
    s_waitcnt lgkmcnt(6)
    v_mfma_f32_32x32x16_bf16 v[128:143], a[152:155], a[40:43], v[128:143]
    ds_read_b64_tr_b16 a[136:137], v2 offset:4096
    ds_read_b64_tr_b16 a[138:139], v2 offset:4608
    s_waitcnt vmcnt(14)
    s_barrier
    s_waitcnt lgkmcnt(6)
    v_mfma_f32_32x32x16_bf16 v[144:159], a[156:159], a[40:43], v[144:159]
    ds_read_b64_tr_b16 a[140:141], v3 offset:4096
    ds_read_b64_tr_b16 a[142:143], v3 offset:4608
    s_add_u32 m0, s41, 96256
    s_add_u32 s50, s34, 258048
    buffer_load_dwordx4 v23, s[16:19], s50 offen lds
    s_waitcnt lgkmcnt(6)
    v_mfma_f32_32x32x16_bf16 v[160:175], a[128:131], a[40:43], v[160:175]
    ds_read_b64_tr_b16 a[144:145], v2 offset:6144
    ds_read_b64_tr_b16 a[146:147], v2 offset:6656
    s_add_u32 m0, s41, 97280
    s_add_u32 s50, s35, 258048
    buffer_load_dwordx4 v23, s[16:19], s50 offen lds
    s_waitcnt lgkmcnt(6)
    v_mfma_f32_32x32x16_bf16 v[176:191], a[132:135], a[40:43], v[176:191]
    ds_read_b64_tr_b16 a[148:149], v2 offset:14336
    ds_read_b64_tr_b16 a[150:151], v2 offset:14848
    s_waitcnt lgkmcnt(6)
    v_mfma_f32_32x32x16_bf16 v[192:207], a[136:139], a[40:43], v[192:207]
    ds_read_b64_tr_b16 a[152:153], v3 offset:14336
    ds_read_b64_tr_b16 a[154:155], v3 offset:14848
    s_add_u32 m0, s41, 98304
    s_add_u32 s50, s36, 258048
    buffer_load_dwordx4 v23, s[16:19], s50 offen lds
    s_waitcnt lgkmcnt(6)
    v_mfma_f32_32x32x16_bf16 v[208:223], a[140:143], a[40:43], v[208:223]
    ds_read_b64_tr_b16 a[156:157], v2 offset:16384
    ds_read_b64_tr_b16 a[158:159], v2 offset:16896
    s_waitcnt lgkmcnt(6)
    v_mfma_f32_32x32x16_bf16 v[224:239], a[144:147], a[40:43], v[224:239]
    ds_read_b64_tr_b16 a[128:129], v3 offset:16384
    ds_read_b64_tr_b16 a[130:131], v3 offset:16896
    s_add_u32 m0, s41, 99328
    s_add_u32 s50, s37, 258048
    buffer_load_dwordx4 v23, s[16:19], s50 offen lds
    s_waitcnt lgkmcnt(6)
    v_mfma_f32_32x32x16_bf16 v[128:143], a[148:151], a[44:47], v[128:143]
    ds_read_b64_tr_b16 a[132:133], v2 offset:18432
    ds_read_b64_tr_b16 a[134:135], v2 offset:18944
    s_add_u32 m0, s41, 100352
    s_add_u32 s50, s38, 258048
    buffer_load_dwordx4 v23, s[16:19], s50 offen lds
    s_waitcnt lgkmcnt(6)
    v_mfma_f32_32x32x16_bf16 v[144:159], a[152:155], a[44:47], v[144:159]
    ds_read_b64_tr_b16 a[136:137], v3 offset:18432
    ds_read_b64_tr_b16 a[138:139], v3 offset:18944
    s_waitcnt lgkmcnt(6)
    v_mfma_f32_32x32x16_bf16 v[160:175], a[156:159], a[44:47], v[160:175]
    ds_read_b64_tr_b16 a[140:141], v2 offset:20480
    ds_read_b64_tr_b16 a[142:143], v2 offset:20992
    s_add_u32 m0, s41, 101376
    s_add_u32 s50, s39, 258048
    buffer_load_dwordx4 v23, s[16:19], s50 offen lds
    s_waitcnt lgkmcnt(6)
    v_mfma_f32_32x32x16_bf16 v[176:191], a[128:131], a[44:47], v[176:191]
    ds_read_b64_tr_b16 a[144:145], v2 offset:28672
    ds_read_b64_tr_b16 a[146:147], v2 offset:29184
    s_waitcnt lgkmcnt(6)
    v_mfma_f32_32x32x16_bf16 v[192:207], a[132:135], a[44:47], v[192:207]
    ds_read_b64_tr_b16 a[148:149], v3 offset:28672
    ds_read_b64_tr_b16 a[150:151], v3 offset:29184
    s_add_u32 m0, s41, 102400
    s_add_u32 s50, s40, 258048
    buffer_load_dwordx4 v23, s[16:19], s50 offen lds
    s_waitcnt lgkmcnt(6)
    v_mfma_f32_32x32x16_bf16 v[208:223], a[136:139], a[44:47], v[208:223]
    ds_read_b64_tr_b16 a[152:153], v2 offset:30720
    ds_read_b64_tr_b16 a[154:155], v2 offset:31232
    s_waitcnt lgkmcnt(6)
    v_mfma_f32_32x32x16_bf16 v[224:239], a[140:143], a[44:47], v[224:239]
    ds_read_b64_tr_b16 a[156:157], v3 offset:30720
    ds_read_b64_tr_b16 a[158:159], v3 offset:31232
    s_waitcnt lgkmcnt(6)
    v_mfma_f32_32x32x16_bf16 v[128:143], a[144:147], a[48:51], v[128:143]
    ds_read_b64_tr_b16 a[128:129], v2 offset:32768
    ds_read_b64_tr_b16 a[130:131], v2 offset:33280
    s_waitcnt vmcnt(14)
    s_barrier
    s_waitcnt lgkmcnt(6)
    v_mfma_f32_32x32x16_bf16 v[144:159], a[148:151], a[48:51], v[144:159]
    ds_read_b64_tr_b16 a[132:133], v3 offset:32768
    ds_read_b64_tr_b16 a[134:135], v3 offset:33280
    s_add_u32 m0, s41, 0
    s_add_u32 s50, s34, 286720
    buffer_load_dwordx4 v23, s[16:19], s50 offen lds
    s_waitcnt lgkmcnt(6)
    v_mfma_f32_32x32x16_bf16 v[160:175], a[152:155], a[48:51], v[160:175]
    ds_read_b64_tr_b16 a[136:137], v2 offset:34816
    ds_read_b64_tr_b16 a[138:139], v2 offset:35328
    s_add_u32 m0, s41, 1024
    s_add_u32 s50, s35, 286720
    buffer_load_dwordx4 v23, s[16:19], s50 offen lds
    s_waitcnt lgkmcnt(6)
    v_mfma_f32_32x32x16_bf16 v[176:191], a[156:159], a[48:51], v[176:191]
    ds_read_b64_tr_b16 a[140:141], v2 offset:43008
    ds_read_b64_tr_b16 a[142:143], v2 offset:43520
    s_waitcnt lgkmcnt(6)
    v_mfma_f32_32x32x16_bf16 v[192:207], a[128:131], a[48:51], v[192:207]
    ds_read_b64_tr_b16 a[144:145], v3 offset:43008
    ds_read_b64_tr_b16 a[146:147], v3 offset:43520
    s_add_u32 m0, s41, 2048
    s_add_u32 s50, s36, 286720
    buffer_load_dwordx4 v23, s[16:19], s50 offen lds
    s_waitcnt lgkmcnt(6)
    v_mfma_f32_32x32x16_bf16 v[208:223], a[132:135], a[48:51], v[208:223]
    ds_read_b64_tr_b16 a[148:149], v2 offset:45056
    ds_read_b64_tr_b16 a[150:151], v2 offset:45568
    s_waitcnt lgkmcnt(6)
    v_mfma_f32_32x32x16_bf16 v[224:239], a[136:139], a[48:51], v[224:239]
    ds_read_b64_tr_b16 a[152:153], v3 offset:45056
    ds_read_b64_tr_b16 a[154:155], v3 offset:45568
    s_add_u32 m0, s41, 3072
    s_add_u32 s50, s37, 286720
    buffer_load_dwordx4 v23, s[16:19], s50 offen lds
    s_waitcnt lgkmcnt(6)
    v_mfma_f32_32x32x16_bf16 v[128:143], a[140:143], a[52:55], v[128:143]
    ds_read_b64_tr_b16 a[156:157], v2 offset:47104
    ds_read_b64_tr_b16 a[158:159], v2 offset:47616
    s_add_u32 m0, s41, 4096
    s_add_u32 s50, s38, 286720
    buffer_load_dwordx4 v23, s[16:19], s50 offen lds
    s_waitcnt lgkmcnt(6)
    v_mfma_f32_32x32x16_bf16 v[144:159], a[144:147], a[52:55], v[144:159]
    ds_read_b64_tr_b16 a[128:129], v3 offset:47104
    ds_read_b64_tr_b16 a[130:131], v3 offset:47616
    s_waitcnt lgkmcnt(6)
    v_mfma_f32_32x32x16_bf16 v[160:175], a[148:151], a[52:55], v[160:175]
    ds_read_b64_tr_b16 a[132:133], v2 offset:49152
    ds_read_b64_tr_b16 a[134:135], v2 offset:49664
    s_add_u32 m0, s41, 5120
    s_add_u32 s50, s39, 286720
    buffer_load_dwordx4 v23, s[16:19], s50 offen lds
    s_waitcnt lgkmcnt(6)
    v_mfma_f32_32x32x16_bf16 v[176:191], a[152:155], a[52:55], v[176:191]
    ds_read_b64_tr_b16 a[136:137], v4 offset:0
    ds_read_b64_tr_b16 a[138:139], v4 offset:512
    s_waitcnt lgkmcnt(6)
    v_mfma_f32_32x32x16_bf16 v[192:207], a[156:159], a[52:55], v[192:207]
    ds_read_b64_tr_b16 a[140:141], v5 offset:0
    ds_read_b64_tr_b16 a[142:143], v5 offset:512
    s_add_u32 m0, s41, 6144
    s_add_u32 s50, s40, 286720
    buffer_load_dwordx4 v23, s[16:19], s50 offen lds
    s_waitcnt lgkmcnt(6)
    v_mfma_f32_32x32x16_bf16 v[208:223], a[128:131], a[52:55], v[208:223]
    ds_read_b64_tr_b16 a[144:145], v4 offset:2048
    ds_read_b64_tr_b16 a[146:147], v4 offset:2560
    s_waitcnt lgkmcnt(6)
    v_mfma_f32_32x32x16_bf16 v[224:239], a[132:135], a[52:55], v[224:239]
    ds_read_b64_tr_b16 a[148:149], v5 offset:2048
    ds_read_b64_tr_b16 a[150:151], v5 offset:2560
    s_waitcnt lgkmcnt(6)
    v_mfma_f32_32x32x16_bf16 v[128:143], a[136:139], a[56:59], v[128:143]
    ds_read_b64_tr_b16 a[152:153], v4 offset:4096
    ds_read_b64_tr_b16 a[154:155], v4 offset:4608
    s_waitcnt vmcnt(14)
    s_barrier
    s_waitcnt lgkmcnt(6)
    v_mfma_f32_32x32x16_bf16 v[144:159], a[140:143], a[56:59], v[144:159]
    ds_read_b64_tr_b16 a[156:157], v5 offset:4096
    ds_read_b64_tr_b16 a[158:159], v5 offset:4608
    s_add_u32 m0, s41, 28672
    s_add_u32 s50, s34, 315392
    buffer_load_dwordx4 v23, s[16:19], s50 offen lds
    s_waitcnt lgkmcnt(6)
    v_mfma_f32_32x32x16_bf16 v[160:175], a[144:147], a[56:59], v[160:175]
    ds_read_b64_tr_b16 a[128:129], v4 offset:6144
    ds_read_b64_tr_b16 a[130:131], v4 offset:6656
    s_add_u32 m0, s41, 29696
    s_add_u32 s50, s35, 315392
    buffer_load_dwordx4 v23, s[16:19], s50 offen lds
    s_waitcnt lgkmcnt(6)
    v_mfma_f32_32x32x16_bf16 v[176:191], a[148:151], a[56:59], v[176:191]
    ds_read_b64_tr_b16 a[132:133], v4 offset:14336
    ds_read_b64_tr_b16 a[134:135], v4 offset:14848
    s_waitcnt lgkmcnt(6)
    v_mfma_f32_32x32x16_bf16 v[192:207], a[152:155], a[56:59], v[192:207]
    ds_read_b64_tr_b16 a[136:137], v5 offset:14336
    ds_read_b64_tr_b16 a[138:139], v5 offset:14848
    s_add_u32 m0, s41, 30720
    s_add_u32 s50, s36, 315392
    buffer_load_dwordx4 v23, s[16:19], s50 offen lds
    s_waitcnt lgkmcnt(6)
    v_mfma_f32_32x32x16_bf16 v[208:223], a[156:159], a[56:59], v[208:223]
    ds_read_b64_tr_b16 a[140:141], v4 offset:16384
    ds_read_b64_tr_b16 a[142:143], v4 offset:16896
    s_waitcnt lgkmcnt(6)
    v_mfma_f32_32x32x16_bf16 v[224:239], a[128:131], a[56:59], v[224:239]
    ds_read_b64_tr_b16 a[144:145], v5 offset:16384
    ds_read_b64_tr_b16 a[146:147], v5 offset:16896
    s_add_u32 m0, s41, 31744
    s_add_u32 s50, s37, 315392
    buffer_load_dwordx4 v23, s[16:19], s50 offen lds
    s_waitcnt lgkmcnt(6)
    v_mfma_f32_32x32x16_bf16 v[128:143], a[132:135], a[60:63], v[128:143]
    ds_read_b64_tr_b16 a[148:149], v4 offset:18432
    ds_read_b64_tr_b16 a[150:151], v4 offset:18944
    s_add_u32 m0, s41, 32768
    s_add_u32 s50, s38, 315392
    buffer_load_dwordx4 v23, s[16:19], s50 offen lds
    s_waitcnt lgkmcnt(6)
    v_mfma_f32_32x32x16_bf16 v[144:159], a[136:139], a[60:63], v[144:159]
    ds_read_b64_tr_b16 a[152:153], v5 offset:18432
    ds_read_b64_tr_b16 a[154:155], v5 offset:18944
    s_waitcnt lgkmcnt(6)
    v_mfma_f32_32x32x16_bf16 v[160:175], a[140:143], a[60:63], v[160:175]
    ds_read_b64_tr_b16 a[156:157], v4 offset:20480
    ds_read_b64_tr_b16 a[158:159], v4 offset:20992
    s_add_u32 m0, s41, 33792
    s_add_u32 s50, s39, 315392
    buffer_load_dwordx4 v23, s[16:19], s50 offen lds
    s_waitcnt lgkmcnt(6)
    v_mfma_f32_32x32x16_bf16 v[176:191], a[144:147], a[60:63], v[176:191]
    ds_read_b64_tr_b16 a[128:129], v6 offset:0
    ds_read_b64_tr_b16 a[130:131], v6 offset:512
    s_waitcnt lgkmcnt(6)
    v_mfma_f32_32x32x16_bf16 v[192:207], a[148:151], a[60:63], v[192:207]
    ds_read_b64_tr_b16 a[132:133], v7 offset:0
    ds_read_b64_tr_b16 a[134:135], v7 offset:512
    s_add_u32 m0, s41, 34816
    s_add_u32 s50, s40, 315392
    buffer_load_dwordx4 v23, s[16:19], s50 offen lds
    s_waitcnt lgkmcnt(6)
    v_mfma_f32_32x32x16_bf16 v[208:223], a[152:155], a[60:63], v[208:223]
    ds_read_b64_tr_b16 a[136:137], v6 offset:2048
    ds_read_b64_tr_b16 a[138:139], v6 offset:2560
    s_waitcnt lgkmcnt(6)
    v_mfma_f32_32x32x16_bf16 v[224:239], a[156:159], a[60:63], v[224:239]
    ds_read_b64_tr_b16 a[140:141], v7 offset:2048
    ds_read_b64_tr_b16 a[142:143], v7 offset:2560
    s_waitcnt lgkmcnt(6)
    v_mfma_f32_32x32x16_bf16 v[128:143], a[128:131], a[64:67], v[128:143]
    ds_read_b64_tr_b16 a[144:145], v6 offset:4096
    ds_read_b64_tr_b16 a[146:147], v6 offset:4608
    s_waitcnt vmcnt(14)
    s_barrier
    s_waitcnt lgkmcnt(6)
    v_mfma_f32_32x32x16_bf16 v[144:159], a[132:135], a[64:67], v[144:159]
    ds_read_b64_tr_b16 a[148:149], v7 offset:4096
    ds_read_b64_tr_b16 a[150:151], v7 offset:4608
    s_add_u32 m0, s41, 133120
    s_add_u32 s50, s34, 344064
    buffer_load_dwordx4 v23, s[16:19], s50 offen lds
    s_waitcnt lgkmcnt(6)
    v_mfma_f32_32x32x16_bf16 v[160:175], a[136:139], a[64:67], v[160:175]
    ds_read_b64_tr_b16 a[152:153], v6 offset:6144
    ds_read_b64_tr_b16 a[154:155], v6 offset:6656
    s_add_u32 m0, s41, 134144
    s_add_u32 s50, s35, 344064
    buffer_load_dwordx4 v23, s[16:19], s50 offen lds
    s_waitcnt lgkmcnt(6)
    v_mfma_f32_32x32x16_bf16 v[176:191], a[140:143], a[64:67], v[176:191]
    ds_read_b64_tr_b16 a[156:157], v6 offset:14336
    ds_read_b64_tr_b16 a[158:159], v6 offset:14848
    s_waitcnt lgkmcnt(6)
    v_mfma_f32_32x32x16_bf16 v[192:207], a[144:147], a[64:67], v[192:207]
    ds_read_b64_tr_b16 a[128:129], v7 offset:14336
    ds_read_b64_tr_b16 a[130:131], v7 offset:14848
    s_add_u32 m0, s41, 135168
    s_add_u32 s50, s36, 344064
    buffer_load_dwordx4 v23, s[16:19], s50 offen lds
    s_waitcnt lgkmcnt(6)
    v_mfma_f32_32x32x16_bf16 v[208:223], a[148:151], a[64:67], v[208:223]
    ds_read_b64_tr_b16 a[132:133], v6 offset:16384
    ds_read_b64_tr_b16 a[134:135], v6 offset:16896
    s_waitcnt lgkmcnt(6)
    v_mfma_f32_32x32x16_bf16 v[224:239], a[152:155], a[64:67], v[224:239]
    ds_read_b64_tr_b16 a[136:137], v7 offset:16384
    ds_read_b64_tr_b16 a[138:139], v7 offset:16896
    s_add_u32 m0, s41, 136192
    s_add_u32 s50, s37, 344064
    buffer_load_dwordx4 v23, s[16:19], s50 offen lds
    s_waitcnt lgkmcnt(6)
    v_mfma_f32_32x32x16_bf16 v[128:143], a[156:159], a[68:71], v[128:143]
    ds_read_b64_tr_b16 a[140:141], v6 offset:18432
    ds_read_b64_tr_b16 a[142:143], v6 offset:18944
    s_add_u32 m0, s41, 137216
    s_add_u32 s50, s38, 344064
    buffer_load_dwordx4 v23, s[16:19], s50 offen lds
    s_waitcnt lgkmcnt(6)
    v_mfma_f32_32x32x16_bf16 v[144:159], a[128:131], a[68:71], v[144:159]
    ds_read_b64_tr_b16 a[144:145], v7 offset:18432
    ds_read_b64_tr_b16 a[146:147], v7 offset:18944
    s_waitcnt lgkmcnt(6)
    v_mfma_f32_32x32x16_bf16 v[160:175], a[132:135], a[68:71], v[160:175]
    ds_read_b64_tr_b16 a[148:149], v6 offset:20480
    ds_read_b64_tr_b16 a[150:151], v6 offset:20992
    s_add_u32 m0, s41, 138240
    s_add_u32 s50, s39, 344064
    buffer_load_dwordx4 v23, s[16:19], s50 offen lds
    s_waitcnt lgkmcnt(6)
    v_mfma_f32_32x32x16_bf16 v[176:191], a[136:139], a[68:71], v[176:191]
    ds_read_b64_tr_b16 a[152:153], v6 offset:28672
    ds_read_b64_tr_b16 a[154:155], v6 offset:29184
    s_waitcnt lgkmcnt(6)
    v_mfma_f32_32x32x16_bf16 v[192:207], a[140:143], a[68:71], v[192:207]
    ds_read_b64_tr_b16 a[156:157], v7 offset:28672
    ds_read_b64_tr_b16 a[158:159], v7 offset:29184
    s_add_u32 m0, s41, 139264
    s_add_u32 s50, s40, 344064
    buffer_load_dwordx4 v23, s[16:19], s50 offen lds
    s_waitcnt lgkmcnt(6)
    v_mfma_f32_32x32x16_bf16 v[208:223], a[144:147], a[68:71], v[208:223]
    ds_read_b64_tr_b16 a[128:129], v6 offset:30720
    ds_read_b64_tr_b16 a[130:131], v6 offset:31232
    s_waitcnt lgkmcnt(6)
    v_mfma_f32_32x32x16_bf16 v[224:239], a[148:151], a[68:71], v[224:239]
    ds_read_b64_tr_b16 a[132:133], v7 offset:30720
    ds_read_b64_tr_b16 a[134:135], v7 offset:31232
    s_waitcnt lgkmcnt(6)
    v_mfma_f32_32x32x16_bf16 v[128:143], a[152:155], a[72:75], v[128:143]
    ds_read_b64_tr_b16 a[136:137], v6 offset:32768
    ds_read_b64_tr_b16 a[138:139], v6 offset:33280
    s_waitcnt vmcnt(14)
    s_barrier
    s_waitcnt lgkmcnt(6)
    v_mfma_f32_32x32x16_bf16 v[144:159], a[156:159], a[72:75], v[144:159]
    ds_read_b64_tr_b16 a[140:141], v7 offset:32768
    ds_read_b64_tr_b16 a[142:143], v7 offset:33280
    s_add_u32 m0, s41, 67584
    s_add_u32 s50, s34, 372736
    buffer_load_dwordx4 v23, s[16:19], s50 offen lds
    s_waitcnt lgkmcnt(6)
    v_mfma_f32_32x32x16_bf16 v[160:175], a[128:131], a[72:75], v[160:175]
    ds_read_b64_tr_b16 a[144:145], v6 offset:34816
    ds_read_b64_tr_b16 a[146:147], v6 offset:35328
    s_add_u32 m0, s41, 68608
    s_add_u32 s50, s35, 372736
    buffer_load_dwordx4 v23, s[16:19], s50 offen lds
    s_waitcnt lgkmcnt(6)
    v_mfma_f32_32x32x16_bf16 v[176:191], a[132:135], a[72:75], v[176:191]
    ds_read_b64_tr_b16 a[148:149], v6 offset:43008
    ds_read_b64_tr_b16 a[150:151], v6 offset:43520
    s_waitcnt lgkmcnt(6)
    v_mfma_f32_32x32x16_bf16 v[192:207], a[136:139], a[72:75], v[192:207]
    ds_read_b64_tr_b16 a[152:153], v7 offset:43008
    ds_read_b64_tr_b16 a[154:155], v7 offset:43520
    s_add_u32 m0, s41, 69632
    s_add_u32 s50, s36, 372736
    buffer_load_dwordx4 v23, s[16:19], s50 offen lds
    s_waitcnt lgkmcnt(6)
    v_mfma_f32_32x32x16_bf16 v[208:223], a[140:143], a[72:75], v[208:223]
    ds_read_b64_tr_b16 a[156:157], v6 offset:45056
    ds_read_b64_tr_b16 a[158:159], v6 offset:45568
    s_waitcnt lgkmcnt(6)
    v_mfma_f32_32x32x16_bf16 v[224:239], a[144:147], a[72:75], v[224:239]
    ds_read_b64_tr_b16 a[128:129], v7 offset:45056
    ds_read_b64_tr_b16 a[130:131], v7 offset:45568
    s_add_u32 m0, s41, 70656
    s_add_u32 s50, s37, 372736
    buffer_load_dwordx4 v23, s[16:19], s50 offen lds
    s_waitcnt lgkmcnt(6)
    v_mfma_f32_32x32x16_bf16 v[128:143], a[148:151], a[76:79], v[128:143]
    ds_read_b64_tr_b16 a[132:133], v6 offset:47104
    ds_read_b64_tr_b16 a[134:135], v6 offset:47616
    s_add_u32 m0, s41, 71680
    s_add_u32 s50, s38, 372736
    buffer_load_dwordx4 v23, s[16:19], s50 offen lds
    s_waitcnt lgkmcnt(6)
    v_mfma_f32_32x32x16_bf16 v[144:159], a[152:155], a[76:79], v[144:159]
    ds_read_b64_tr_b16 a[136:137], v7 offset:47104
    ds_read_b64_tr_b16 a[138:139], v7 offset:47616
    s_waitcnt lgkmcnt(6)
    v_mfma_f32_32x32x16_bf16 v[160:175], a[156:159], a[76:79], v[160:175]
    ds_read_b64_tr_b16 a[140:141], v6 offset:49152
    ds_read_b64_tr_b16 a[142:143], v6 offset:49664
    s_add_u32 m0, s41, 72704
    s_add_u32 s50, s39, 372736
    buffer_load_dwordx4 v23, s[16:19], s50 offen lds
    s_waitcnt lgkmcnt(6)
    v_mfma_f32_32x32x16_bf16 v[176:191], a[128:131], a[76:79], v[176:191]
    ds_read_b64_tr_b16 a[144:145], v2 offset:0
    ds_read_b64_tr_b16 a[146:147], v2 offset:512
    s_waitcnt lgkmcnt(6)
    v_mfma_f32_32x32x16_bf16 v[192:207], a[132:135], a[76:79], v[192:207]
    ds_read_b64_tr_b16 a[148:149], v3 offset:0
    ds_read_b64_tr_b16 a[150:151], v3 offset:512
    s_add_u32 m0, s41, 73728
    s_add_u32 s50, s40, 372736
    buffer_load_dwordx4 v23, s[16:19], s50 offen lds
    s_waitcnt lgkmcnt(6)
    v_mfma_f32_32x32x16_bf16 v[208:223], a[136:139], a[76:79], v[208:223]
    ds_read_b64_tr_b16 a[152:153], v2 offset:2048
    ds_read_b64_tr_b16 a[154:155], v2 offset:2560
    s_waitcnt lgkmcnt(6)
    v_mfma_f32_32x32x16_bf16 v[224:239], a[140:143], a[76:79], v[224:239]
    ds_read_b64_tr_b16 a[156:157], v3 offset:2048
    ds_read_b64_tr_b16 a[158:159], v3 offset:2560
    s_waitcnt lgkmcnt(6)
    v_mfma_f32_32x32x16_bf16 v[128:143], a[144:147], a[80:83], v[128:143]
    ds_read_b64_tr_b16 a[128:129], v2 offset:4096
    ds_read_b64_tr_b16 a[130:131], v2 offset:4608
    s_waitcnt vmcnt(14)
    s_barrier
    s_waitcnt lgkmcnt(6)
    v_mfma_f32_32x32x16_bf16 v[144:159], a[148:151], a[80:83], v[144:159]
    ds_read_b64_tr_b16 a[132:133], v3 offset:4096
    ds_read_b64_tr_b16 a[134:135], v3 offset:4608
    s_add_u32 m0, s41, 96256
    s_add_u32 s50, s34, 401408
    buffer_load_dwordx4 v23, s[16:19], s50 offen lds
    s_waitcnt lgkmcnt(6)
    v_mfma_f32_32x32x16_bf16 v[160:175], a[152:155], a[80:83], v[160:175]
    ds_read_b64_tr_b16 a[136:137], v2 offset:6144
    ds_read_b64_tr_b16 a[138:139], v2 offset:6656
    s_add_u32 m0, s41, 97280
    s_add_u32 s50, s35, 401408
    buffer_load_dwordx4 v23, s[16:19], s50 offen lds
    s_waitcnt lgkmcnt(6)
    v_mfma_f32_32x32x16_bf16 v[176:191], a[156:159], a[80:83], v[176:191]
    ds_read_b64_tr_b16 a[140:141], v2 offset:14336
    ds_read_b64_tr_b16 a[142:143], v2 offset:14848
    s_waitcnt lgkmcnt(6)
    v_mfma_f32_32x32x16_bf16 v[192:207], a[128:131], a[80:83], v[192:207]
    ds_read_b64_tr_b16 a[144:145], v3 offset:14336
    ds_read_b64_tr_b16 a[146:147], v3 offset:14848
    s_add_u32 m0, s41, 98304
    s_add_u32 s50, s36, 401408
    buffer_load_dwordx4 v23, s[16:19], s50 offen lds
    s_waitcnt lgkmcnt(6)
    v_mfma_f32_32x32x16_bf16 v[208:223], a[132:135], a[80:83], v[208:223]
    ds_read_b64_tr_b16 a[148:149], v2 offset:16384
    ds_read_b64_tr_b16 a[150:151], v2 offset:16896
    s_waitcnt lgkmcnt(6)
    v_mfma_f32_32x32x16_bf16 v[224:239], a[136:139], a[80:83], v[224:239]
    ds_read_b64_tr_b16 a[152:153], v3 offset:16384
    ds_read_b64_tr_b16 a[154:155], v3 offset:16896
    s_add_u32 m0, s41, 99328
    s_add_u32 s50, s37, 401408
    buffer_load_dwordx4 v23, s[16:19], s50 offen lds
    s_waitcnt lgkmcnt(6)
    v_mfma_f32_32x32x16_bf16 v[128:143], a[140:143], a[84:87], v[128:143]
    ds_read_b64_tr_b16 a[156:157], v2 offset:18432
    ds_read_b64_tr_b16 a[158:159], v2 offset:18944
    s_add_u32 m0, s41, 100352
    s_add_u32 s50, s38, 401408
    buffer_load_dwordx4 v23, s[16:19], s50 offen lds
    s_waitcnt lgkmcnt(6)
    v_mfma_f32_32x32x16_bf16 v[144:159], a[144:147], a[84:87], v[144:159]
    ds_read_b64_tr_b16 a[128:129], v3 offset:18432
    ds_read_b64_tr_b16 a[130:131], v3 offset:18944
    s_waitcnt lgkmcnt(6)
    v_mfma_f32_32x32x16_bf16 v[160:175], a[148:151], a[84:87], v[160:175]
    ds_read_b64_tr_b16 a[132:133], v2 offset:20480
    ds_read_b64_tr_b16 a[134:135], v2 offset:20992
    s_add_u32 m0, s41, 101376
    s_add_u32 s50, s39, 401408
    buffer_load_dwordx4 v23, s[16:19], s50 offen lds
    s_waitcnt lgkmcnt(6)
    v_mfma_f32_32x32x16_bf16 v[176:191], a[152:155], a[84:87], v[176:191]
    ds_read_b64_tr_b16 a[136:137], v2 offset:28672
    ds_read_b64_tr_b16 a[138:139], v2 offset:29184
    s_waitcnt lgkmcnt(6)
    v_mfma_f32_32x32x16_bf16 v[192:207], a[156:159], a[84:87], v[192:207]
    ds_read_b64_tr_b16 a[140:141], v3 offset:28672
    ds_read_b64_tr_b16 a[142:143], v3 offset:29184
    s_add_u32 m0, s41, 102400
    s_add_u32 s50, s40, 401408
    buffer_load_dwordx4 v23, s[16:19], s50 offen lds
    s_waitcnt lgkmcnt(6)
    v_mfma_f32_32x32x16_bf16 v[208:223], a[128:131], a[84:87], v[208:223]
    ds_read_b64_tr_b16 a[144:145], v2 offset:30720
    ds_read_b64_tr_b16 a[146:147], v2 offset:31232
    s_waitcnt lgkmcnt(6)
    v_mfma_f32_32x32x16_bf16 v[224:239], a[132:135], a[84:87], v[224:239]
    ds_read_b64_tr_b16 a[148:149], v3 offset:30720
    ds_read_b64_tr_b16 a[150:151], v3 offset:31232
    s_waitcnt lgkmcnt(6)
    v_mfma_f32_32x32x16_bf16 v[128:143], a[136:139], a[88:91], v[128:143]
    ds_read_b64_tr_b16 a[152:153], v2 offset:32768
    ds_read_b64_tr_b16 a[154:155], v2 offset:33280
    s_waitcnt vmcnt(14)
    s_barrier
    s_waitcnt lgkmcnt(6)
    v_mfma_f32_32x32x16_bf16 v[144:159], a[140:143], a[88:91], v[144:159]
    ds_read_b64_tr_b16 a[156:157], v3 offset:32768
    ds_read_b64_tr_b16 a[158:159], v3 offset:33280
    s_add_u32 m0, s41, 0
    s_add_u32 s50, s34, 430080
    buffer_load_dwordx4 v23, s[16:19], s50 offen lds
    s_waitcnt lgkmcnt(6)
    v_mfma_f32_32x32x16_bf16 v[160:175], a[144:147], a[88:91], v[160:175]
    ds_read_b64_tr_b16 a[128:129], v2 offset:34816
    ds_read_b64_tr_b16 a[130:131], v2 offset:35328
    s_add_u32 m0, s41, 1024
    s_add_u32 s50, s35, 430080
    buffer_load_dwordx4 v23, s[16:19], s50 offen lds
    s_waitcnt lgkmcnt(6)
    v_mfma_f32_32x32x16_bf16 v[176:191], a[148:151], a[88:91], v[176:191]
    ds_read_b64_tr_b16 a[132:133], v2 offset:43008
    ds_read_b64_tr_b16 a[134:135], v2 offset:43520
    s_waitcnt lgkmcnt(6)
    v_mfma_f32_32x32x16_bf16 v[192:207], a[152:155], a[88:91], v[192:207]
    ds_read_b64_tr_b16 a[136:137], v3 offset:43008
    ds_read_b64_tr_b16 a[138:139], v3 offset:43520
    s_add_u32 m0, s41, 2048
    s_add_u32 s50, s36, 430080
    buffer_load_dwordx4 v23, s[16:19], s50 offen lds
    s_waitcnt lgkmcnt(6)
    v_mfma_f32_32x32x16_bf16 v[208:223], a[156:159], a[88:91], v[208:223]
    ds_read_b64_tr_b16 a[140:141], v2 offset:45056
    ds_read_b64_tr_b16 a[142:143], v2 offset:45568
    s_waitcnt lgkmcnt(6)
    v_mfma_f32_32x32x16_bf16 v[224:239], a[128:131], a[88:91], v[224:239]
    ds_read_b64_tr_b16 a[144:145], v3 offset:45056
    ds_read_b64_tr_b16 a[146:147], v3 offset:45568
    s_add_u32 m0, s41, 3072
    s_add_u32 s50, s37, 430080
    buffer_load_dwordx4 v23, s[16:19], s50 offen lds
    s_waitcnt lgkmcnt(6)
    v_mfma_f32_32x32x16_bf16 v[128:143], a[132:135], a[92:95], v[128:143]
    ds_read_b64_tr_b16 a[148:149], v2 offset:47104
    ds_read_b64_tr_b16 a[150:151], v2 offset:47616
    s_add_u32 m0, s41, 4096
    s_add_u32 s50, s38, 430080
    buffer_load_dwordx4 v23, s[16:19], s50 offen lds
    s_waitcnt lgkmcnt(6)
    v_mfma_f32_32x32x16_bf16 v[144:159], a[136:139], a[92:95], v[144:159]
    ds_read_b64_tr_b16 a[152:153], v3 offset:47104
    ds_read_b64_tr_b16 a[154:155], v3 offset:47616
    s_waitcnt lgkmcnt(6)
    v_mfma_f32_32x32x16_bf16 v[160:175], a[140:143], a[92:95], v[160:175]
    ds_read_b64_tr_b16 a[156:157], v2 offset:49152
    ds_read_b64_tr_b16 a[158:159], v2 offset:49664
    s_add_u32 m0, s41, 5120
    s_add_u32 s50, s39, 430080
    buffer_load_dwordx4 v23, s[16:19], s50 offen lds
    s_waitcnt lgkmcnt(6)
    v_mfma_f32_32x32x16_bf16 v[176:191], a[144:147], a[92:95], v[176:191]
    ds_read_b64_tr_b16 a[128:129], v4 offset:0
    ds_read_b64_tr_b16 a[130:131], v4 offset:512
    s_waitcnt lgkmcnt(6)
    v_mfma_f32_32x32x16_bf16 v[192:207], a[148:151], a[92:95], v[192:207]
    ds_read_b64_tr_b16 a[132:133], v5 offset:0
    ds_read_b64_tr_b16 a[134:135], v5 offset:512
    s_add_u32 m0, s41, 6144
    s_add_u32 s50, s40, 430080
    buffer_load_dwordx4 v23, s[16:19], s50 offen lds
    s_waitcnt lgkmcnt(6)
    v_mfma_f32_32x32x16_bf16 v[208:223], a[152:155], a[92:95], v[208:223]
    ds_read_b64_tr_b16 a[136:137], v4 offset:2048
    ds_read_b64_tr_b16 a[138:139], v4 offset:2560
    s_waitcnt lgkmcnt(6)
    v_mfma_f32_32x32x16_bf16 v[224:239], a[156:159], a[92:95], v[224:239]
    ds_read_b64_tr_b16 a[140:141], v5 offset:2048
    ds_read_b64_tr_b16 a[142:143], v5 offset:2560
    s_waitcnt lgkmcnt(6)
    v_mfma_f32_32x32x16_bf16 v[128:143], a[128:131], a[96:99], v[128:143]
    ds_read_b64_tr_b16 a[144:145], v4 offset:4096
    ds_read_b64_tr_b16 a[146:147], v4 offset:4608
    s_waitcnt vmcnt(14)
    s_barrier
    s_waitcnt lgkmcnt(6)
    v_mfma_f32_32x32x16_bf16 v[144:159], a[132:135], a[96:99], v[144:159]
    ds_read_b64_tr_b16 a[148:149], v5 offset:4096
    ds_read_b64_tr_b16 a[150:151], v5 offset:4608
    s_waitcnt lgkmcnt(6)
    v_mfma_f32_32x32x16_bf16 v[160:175], a[136:139], a[96:99], v[160:175]
    ds_read_b64_tr_b16 a[152:153], v4 offset:6144
    ds_read_b64_tr_b16 a[154:155], v4 offset:6656
    s_waitcnt lgkmcnt(6)
    v_mfma_f32_32x32x16_bf16 v[176:191], a[140:143], a[96:99], v[176:191]
    ds_read_b64_tr_b16 a[156:157], v4 offset:14336
    ds_read_b64_tr_b16 a[158:159], v4 offset:14848
    s_waitcnt lgkmcnt(6)
    v_mfma_f32_32x32x16_bf16 v[192:207], a[144:147], a[96:99], v[192:207]
    ds_read_b64_tr_b16 a[128:129], v5 offset:14336
    ds_read_b64_tr_b16 a[130:131], v5 offset:14848
    s_waitcnt lgkmcnt(6)
    v_mfma_f32_32x32x16_bf16 v[208:223], a[148:151], a[96:99], v[208:223]
    ds_read_b64_tr_b16 a[132:133], v4 offset:16384
    ds_read_b64_tr_b16 a[134:135], v4 offset:16896
    s_waitcnt lgkmcnt(6)
    v_mfma_f32_32x32x16_bf16 v[224:239], a[152:155], a[96:99], v[224:239]
    ds_read_b64_tr_b16 a[136:137], v5 offset:16384
    ds_read_b64_tr_b16 a[138:139], v5 offset:16896
    s_waitcnt lgkmcnt(6)
    v_mfma_f32_32x32x16_bf16 v[128:143], a[156:159], a[100:103], v[128:143]
    ds_read_b64_tr_b16 a[140:141], v4 offset:18432
    ds_read_b64_tr_b16 a[142:143], v4 offset:18944
    s_waitcnt lgkmcnt(6)
    v_mfma_f32_32x32x16_bf16 v[144:159], a[128:131], a[100:103], v[144:159]
    ds_read_b64_tr_b16 a[144:145], v5 offset:18432
    ds_read_b64_tr_b16 a[146:147], v5 offset:18944
    s_waitcnt lgkmcnt(6)
    v_mfma_f32_32x32x16_bf16 v[160:175], a[132:135], a[100:103], v[160:175]
    ds_read_b64_tr_b16 a[148:149], v4 offset:20480
    ds_read_b64_tr_b16 a[150:151], v4 offset:20992
    s_waitcnt lgkmcnt(6)
    v_mfma_f32_32x32x16_bf16 v[176:191], a[136:139], a[100:103], v[176:191]
    ds_read_b64_tr_b16 a[152:153], v6 offset:0
    ds_read_b64_tr_b16 a[154:155], v6 offset:512
    s_waitcnt lgkmcnt(6)
    v_mfma_f32_32x32x16_bf16 v[192:207], a[140:143], a[100:103], v[192:207]
    ds_read_b64_tr_b16 a[156:157], v7 offset:0
    ds_read_b64_tr_b16 a[158:159], v7 offset:512
    s_waitcnt lgkmcnt(6)
    v_mfma_f32_32x32x16_bf16 v[208:223], a[144:147], a[100:103], v[208:223]
    ds_read_b64_tr_b16 a[128:129], v6 offset:2048
    ds_read_b64_tr_b16 a[130:131], v6 offset:2560
    s_waitcnt lgkmcnt(6)
    v_mfma_f32_32x32x16_bf16 v[224:239], a[148:151], a[100:103], v[224:239]
    ds_read_b64_tr_b16 a[132:133], v7 offset:2048
    ds_read_b64_tr_b16 a[134:135], v7 offset:2560
    s_waitcnt lgkmcnt(6)
    v_mfma_f32_32x32x16_bf16 v[128:143], a[152:155], a[104:107], v[128:143]
    ds_read_b64_tr_b16 a[136:137], v6 offset:4096
    ds_read_b64_tr_b16 a[138:139], v6 offset:4608
    s_waitcnt vmcnt(7)
    s_barrier
    s_waitcnt lgkmcnt(6)
    v_mfma_f32_32x32x16_bf16 v[144:159], a[156:159], a[104:107], v[144:159]
    ds_read_b64_tr_b16 a[140:141], v7 offset:4096
    ds_read_b64_tr_b16 a[142:143], v7 offset:4608
    s_waitcnt lgkmcnt(6)
    v_mfma_f32_32x32x16_bf16 v[160:175], a[128:131], a[104:107], v[160:175]
    ds_read_b64_tr_b16 a[144:145], v6 offset:6144
    ds_read_b64_tr_b16 a[146:147], v6 offset:6656
    s_waitcnt lgkmcnt(6)
    v_mfma_f32_32x32x16_bf16 v[176:191], a[132:135], a[104:107], v[176:191]
    ds_read_b64_tr_b16 a[148:149], v6 offset:14336
    ds_read_b64_tr_b16 a[150:151], v6 offset:14848
    s_waitcnt lgkmcnt(6)
    v_mfma_f32_32x32x16_bf16 v[192:207], a[136:139], a[104:107], v[192:207]
    ds_read_b64_tr_b16 a[152:153], v7 offset:14336
    ds_read_b64_tr_b16 a[154:155], v7 offset:14848
    s_waitcnt lgkmcnt(6)
    v_mfma_f32_32x32x16_bf16 v[208:223], a[140:143], a[104:107], v[208:223]
    ds_read_b64_tr_b16 a[156:157], v6 offset:16384
    ds_read_b64_tr_b16 a[158:159], v6 offset:16896
    s_waitcnt lgkmcnt(6)
    v_mfma_f32_32x32x16_bf16 v[224:239], a[144:147], a[104:107], v[224:239]
    ds_read_b64_tr_b16 a[128:129], v7 offset:16384
    ds_read_b64_tr_b16 a[130:131], v7 offset:16896
    s_waitcnt lgkmcnt(6)
    v_mfma_f32_32x32x16_bf16 v[128:143], a[148:151], a[108:111], v[128:143]
    ds_read_b64_tr_b16 a[132:133], v6 offset:18432
    ds_read_b64_tr_b16 a[134:135], v6 offset:18944
    s_waitcnt lgkmcnt(6)
    v_mfma_f32_32x32x16_bf16 v[144:159], a[152:155], a[108:111], v[144:159]
    ds_read_b64_tr_b16 a[136:137], v7 offset:18432
    ds_read_b64_tr_b16 a[138:139], v7 offset:18944
    s_waitcnt lgkmcnt(6)
    v_mfma_f32_32x32x16_bf16 v[160:175], a[156:159], a[108:111], v[160:175]
    ds_read_b64_tr_b16 a[140:141], v6 offset:20480
    ds_read_b64_tr_b16 a[142:143], v6 offset:20992
    s_waitcnt lgkmcnt(6)
    v_mfma_f32_32x32x16_bf16 v[176:191], a[128:131], a[108:111], v[176:191]
    ds_read_b64_tr_b16 a[144:145], v6 offset:28672
    ds_read_b64_tr_b16 a[146:147], v6 offset:29184
    s_waitcnt lgkmcnt(6)
    v_mfma_f32_32x32x16_bf16 v[192:207], a[132:135], a[108:111], v[192:207]
    ds_read_b64_tr_b16 a[148:149], v7 offset:28672
    ds_read_b64_tr_b16 a[150:151], v7 offset:29184
    s_waitcnt lgkmcnt(6)
    v_mfma_f32_32x32x16_bf16 v[208:223], a[136:139], a[108:111], v[208:223]
    ds_read_b64_tr_b16 a[152:153], v6 offset:30720
    ds_read_b64_tr_b16 a[154:155], v6 offset:31232
    s_waitcnt lgkmcnt(6)
    v_mfma_f32_32x32x16_bf16 v[224:239], a[140:143], a[108:111], v[224:239]
    ds_read_b64_tr_b16 a[156:157], v7 offset:30720
    ds_read_b64_tr_b16 a[158:159], v7 offset:31232
    s_waitcnt lgkmcnt(6)
    v_mfma_f32_32x32x16_bf16 v[128:143], a[144:147], a[112:115], v[128:143]
    ds_read_b64_tr_b16 a[128:129], v6 offset:32768
    ds_read_b64_tr_b16 a[130:131], v6 offset:33280
    s_waitcnt vmcnt(0)
    s_barrier
    s_waitcnt lgkmcnt(6)
    v_mfma_f32_32x32x16_bf16 v[144:159], a[148:151], a[112:115], v[144:159]
    ds_read_b64_tr_b16 a[132:133], v7 offset:32768
    ds_read_b64_tr_b16 a[134:135], v7 offset:33280
    s_waitcnt lgkmcnt(6)
    v_mfma_f32_32x32x16_bf16 v[160:175], a[152:155], a[112:115], v[160:175]
    ds_read_b64_tr_b16 a[136:137], v6 offset:34816
    ds_read_b64_tr_b16 a[138:139], v6 offset:35328
    s_waitcnt lgkmcnt(6)
    v_mfma_f32_32x32x16_bf16 v[176:191], a[156:159], a[112:115], v[176:191]
    ds_read_b64_tr_b16 a[140:141], v6 offset:43008
    ds_read_b64_tr_b16 a[142:143], v6 offset:43520
    s_waitcnt lgkmcnt(6)
    v_mfma_f32_32x32x16_bf16 v[192:207], a[128:131], a[112:115], v[192:207]
    ds_read_b64_tr_b16 a[144:145], v7 offset:43008
    ds_read_b64_tr_b16 a[146:147], v7 offset:43520
    s_waitcnt lgkmcnt(6)
    v_mfma_f32_32x32x16_bf16 v[208:223], a[132:135], a[112:115], v[208:223]
    ds_read_b64_tr_b16 a[148:149], v6 offset:45056
    ds_read_b64_tr_b16 a[150:151], v6 offset:45568
    s_waitcnt lgkmcnt(6)
    v_mfma_f32_32x32x16_bf16 v[224:239], a[136:139], a[112:115], v[224:239]
    ds_read_b64_tr_b16 a[152:153], v7 offset:45056
    ds_read_b64_tr_b16 a[154:155], v7 offset:45568
    s_waitcnt lgkmcnt(6)
    v_mfma_f32_32x32x16_bf16 v[128:143], a[140:143], a[116:119], v[128:143]
    ds_read_b64_tr_b16 a[156:157], v6 offset:47104
    ds_read_b64_tr_b16 a[158:159], v6 offset:47616
    s_waitcnt lgkmcnt(6)
    v_mfma_f32_32x32x16_bf16 v[144:159], a[144:147], a[116:119], v[144:159]
    ds_read_b64_tr_b16 a[128:129], v7 offset:47104
    ds_read_b64_tr_b16 a[130:131], v7 offset:47616
    s_waitcnt lgkmcnt(6)
    v_mfma_f32_32x32x16_bf16 v[160:175], a[148:151], a[116:119], v[160:175]
    ds_read_b64_tr_b16 a[132:133], v6 offset:49152
    ds_read_b64_tr_b16 a[134:135], v6 offset:49664
    s_waitcnt lgkmcnt(6)
    v_mfma_f32_32x32x16_bf16 v[176:191], a[152:155], a[116:119], v[176:191]
    ds_read_b64_tr_b16 a[136:137], v2 offset:0
    ds_read_b64_tr_b16 a[138:139], v2 offset:512
    s_waitcnt lgkmcnt(6)
    v_mfma_f32_32x32x16_bf16 v[192:207], a[156:159], a[116:119], v[192:207]
    ds_read_b64_tr_b16 a[140:141], v3 offset:0
    ds_read_b64_tr_b16 a[142:143], v3 offset:512
    s_waitcnt lgkmcnt(6)
    v_mfma_f32_32x32x16_bf16 v[208:223], a[128:131], a[116:119], v[208:223]
    ds_read_b64_tr_b16 a[144:145], v2 offset:2048
    ds_read_b64_tr_b16 a[146:147], v2 offset:2560
    s_waitcnt lgkmcnt(6)
    v_mfma_f32_32x32x16_bf16 v[224:239], a[132:135], a[116:119], v[224:239]
    ds_read_b64_tr_b16 a[148:149], v3 offset:2048
    ds_read_b64_tr_b16 a[150:151], v3 offset:2560
    s_waitcnt lgkmcnt(6)
    v_mfma_f32_32x32x16_bf16 v[128:143], a[136:139], a[120:123], v[128:143]
    ds_read_b64_tr_b16 a[152:153], v2 offset:4096
    ds_read_b64_tr_b16 a[154:155], v2 offset:4608
    s_waitcnt lgkmcnt(6)
    v_mfma_f32_32x32x16_bf16 v[144:159], a[140:143], a[120:123], v[144:159]
    ds_read_b64_tr_b16 a[156:157], v3 offset:4096
    ds_read_b64_tr_b16 a[158:159], v3 offset:4608
    s_waitcnt lgkmcnt(6)
    v_mfma_f32_32x32x16_bf16 v[160:175], a[144:147], a[120:123], v[160:175]
    ds_read_b64_tr_b16 a[128:129], v2 offset:6144
    ds_read_b64_tr_b16 a[130:131], v2 offset:6656
    s_waitcnt lgkmcnt(6)
    v_mfma_f32_32x32x16_bf16 v[176:191], a[148:151], a[120:123], v[176:191]
    ds_read_b64_tr_b16 a[132:133], v2 offset:14336
    ds_read_b64_tr_b16 a[134:135], v2 offset:14848
    s_waitcnt lgkmcnt(6)
    v_mfma_f32_32x32x16_bf16 v[192:207], a[152:155], a[120:123], v[192:207]
    ds_read_b64_tr_b16 a[136:137], v3 offset:14336
    ds_read_b64_tr_b16 a[138:139], v3 offset:14848
    s_waitcnt lgkmcnt(6)
    v_mfma_f32_32x32x16_bf16 v[208:223], a[156:159], a[120:123], v[208:223]
    ds_read_b64_tr_b16 a[140:141], v2 offset:16384
    ds_read_b64_tr_b16 a[142:143], v2 offset:16896
    s_waitcnt lgkmcnt(6)
    v_mfma_f32_32x32x16_bf16 v[224:239], a[128:131], a[120:123], v[224:239]
    ds_read_b64_tr_b16 a[144:145], v3 offset:16384
    ds_read_b64_tr_b16 a[146:147], v3 offset:16896
    s_waitcnt lgkmcnt(6)
    v_mfma_f32_32x32x16_bf16 v[128:143], a[132:135], a[124:127], v[128:143]
    ds_read_b64_tr_b16 a[148:149], v2 offset:18432
    ds_read_b64_tr_b16 a[150:151], v2 offset:18944
    s_waitcnt lgkmcnt(6)
    v_mfma_f32_32x32x16_bf16 v[144:159], a[136:139], a[124:127], v[144:159]
    ds_read_b64_tr_b16 a[152:153], v3 offset:18432
    ds_read_b64_tr_b16 a[154:155], v3 offset:18944
    s_waitcnt lgkmcnt(6)
    v_mfma_f32_32x32x16_bf16 v[160:175], a[140:143], a[124:127], v[160:175]
    ds_read_b64_tr_b16 a[156:157], v2 offset:20480
    ds_read_b64_tr_b16 a[158:159], v2 offset:20992
    s_waitcnt lgkmcnt(6)
    v_mfma_f32_32x32x16_bf16 v[176:191], a[144:147], a[124:127], v[176:191]
    s_waitcnt lgkmcnt(4)
    v_mfma_f32_32x32x16_bf16 v[192:207], a[148:151], a[124:127], v[192:207]
    s_waitcnt lgkmcnt(2)
    v_mfma_f32_32x32x16_bf16 v[208:223], a[152:155], a[124:127], v[208:223]
    s_waitcnt lgkmcnt(0)
    v_mfma_f32_32x32x16_bf16 v[224:239], a[156:159], a[124:127], v[224:239]
    s_lshl_b32 s50, s44, 6
    s_add_u32 s50, s50, s45
    s_mul_i32 s50, s50, 28672
    s_mul_i32 s51, s47, 14336
    s_add_u32 s50, s50, s51
    s_add_u32 s50, s50, 33554432
    s_add_u32 s52, s60, s50
    s_addc_u32 s53, s61, 0
    s_mov_b32 s20, s52
    s_and_b32 s21, s53, 0xffff
    s_mov_b32 s22, 14336
    s_mov_b32 s23, 0x00020000
    s_nop 7
    v_cvt_pk_bf16_f32 v64, v128, v129
    v_cvt_pk_bf16_f32 v65, v130, v131
    v_cvt_pk_bf16_f32 v66, v132, v133
    v_cvt_pk_bf16_f32 v67, v134, v135
    s_mov_b32 s50, 0
    buffer_store_dwordx4 v[64:67], v12, s[20:23], s50 offen offset:0 sc1
    v_cvt_pk_bf16_f32 v68, v136, v137
    v_cvt_pk_bf16_f32 v69, v138, v139
    v_cvt_pk_bf16_f32 v70, v140, v141
    v_cvt_pk_bf16_f32 v71, v142, v143
    buffer_store_dwordx4 v[68:71], v12, s[20:23], s50 offen offset:1024 sc1
    v_cvt_pk_bf16_f32 v72, v144, v145
    v_cvt_pk_bf16_f32 v73, v146, v147
    v_cvt_pk_bf16_f32 v74, v148, v149
    v_cvt_pk_bf16_f32 v75, v150, v151
    buffer_store_dwordx4 v[72:75], v12, s[20:23], s50 offen offset:2048 sc1
    v_cvt_pk_bf16_f32 v76, v152, v153
    v_cvt_pk_bf16_f32 v77, v154, v155
    v_cvt_pk_bf16_f32 v78, v156, v157
    v_cvt_pk_bf16_f32 v79, v158, v159
    buffer_store_dwordx4 v[76:79], v12, s[20:23], s50 offen offset:3072 sc1
    v_cvt_pk_bf16_f32 v80, v160, v161
    v_cvt_pk_bf16_f32 v81, v162, v163
    v_cvt_pk_bf16_f32 v82, v164, v165
    v_cvt_pk_bf16_f32 v83, v166, v167
    s_mov_b32 s50, 4096
    buffer_store_dwordx4 v[80:83], v12, s[20:23], s50 offen offset:0 sc1
    v_cvt_pk_bf16_f32 v84, v168, v169
    v_cvt_pk_bf16_f32 v85, v170, v171
    v_cvt_pk_bf16_f32 v86, v172, v173
    v_cvt_pk_bf16_f32 v87, v174, v175
    buffer_store_dwordx4 v[84:87], v12, s[20:23], s50 offen offset:1024 sc1
    v_cvt_pk_bf16_f32 v88, v176, v177
    v_cvt_pk_bf16_f32 v89, v178, v179
    v_cvt_pk_bf16_f32 v90, v180, v181
    v_cvt_pk_bf16_f32 v91, v182, v183
    buffer_store_dwordx4 v[88:91], v12, s[20:23], s50 offen offset:2048 sc1
    v_cvt_pk_bf16_f32 v92, v184, v185
    v_cvt_pk_bf16_f32 v93, v186, v187
    v_cvt_pk_bf16_f32 v94, v188, v189
    v_cvt_pk_bf16_f32 v95, v190, v191
    buffer_store_dwordx4 v[92:95], v12, s[20:23], s50 offen offset:3072 sc1
    v_cvt_pk_bf16_f32 v96, v192, v193
    v_cvt_pk_bf16_f32 v97, v194, v195
    v_cvt_pk_bf16_f32 v98, v196, v197
    v_cvt_pk_bf16_f32 v99, v198, v199
    s_mov_b32 s50, 8192
    buffer_store_dwordx4 v[96:99], v12, s[20:23], s50 offen offset:0 sc1
    v_cvt_pk_bf16_f32 v100, v200, v201
    v_cvt_pk_bf16_f32 v101, v202, v203
    v_cvt_pk_bf16_f32 v102, v204, v205
    v_cvt_pk_bf16_f32 v103, v206, v207
    buffer_store_dwordx4 v[100:103], v12, s[20:23], s50 offen offset:1024 sc1
    v_cvt_pk_bf16_f32 v104, v208, v209
    v_cvt_pk_bf16_f32 v105, v210, v211
    v_cvt_pk_bf16_f32 v106, v212, v213
    v_cvt_pk_bf16_f32 v107, v214, v215
    buffer_store_dwordx4 v[104:107], v12, s[20:23], s50 offen offset:2048 sc1
    v_cvt_pk_bf16_f32 v108, v216, v217
    v_cvt_pk_bf16_f32 v109, v218, v219
    v_cvt_pk_bf16_f32 v110, v220, v221
    v_cvt_pk_bf16_f32 v111, v222, v223
    buffer_store_dwordx4 v[108:111], v12, s[20:23], s50 offen offset:3072 sc1
    v_cvt_pk_bf16_f32 v112, v224, v225
    v_cvt_pk_bf16_f32 v113, v226, v227
    v_cvt_pk_bf16_f32 v114, v228, v229
    v_cvt_pk_bf16_f32 v115, v230, v231
    s_mov_b32 s50, 12288
    buffer_store_dwordx4 v[112:115], v12, s[20:23], s50 offen offset:0 sc1
    v_cvt_pk_bf16_f32 v116, v232, v233
    v_cvt_pk_bf16_f32 v117, v234, v235
    v_cvt_pk_bf16_f32 v118, v236, v237
    v_cvt_pk_bf16_f32 v119, v238, v239
    buffer_store_dwordx4 v[116:119], v12, s[20:23], s50 offen offset:1024 sc1
K1_END:
    s_endpgm
RARE_M0:
    s_nop 15
    s_nop 15
    v_max3_f32 v16, v112, v113, v114
    v_max3_f32 v16, v16, v115, v120
    v_max3_f32 v16, v16, v121, v122
    v_max_f32 v16, v16, v123
    v_mov_b32 v20, v16
    s_nop 1
    v_permlane16_swap_b32 v16, v20
    s_nop 1
    v_max_f32 v16, v16, v20
    v_mov_b32 v20, v16
    s_nop 1
    v_permlane32_swap_b32 v16, v20
    s_nop 1
    v_max_f32 v16, v16, v20
    v_mov_b32 v21, v60
    v_mov_b32 v20, v21
    s_nop 1
    v_permlane16_swap_b32 v21, v20
    s_nop 1
    v_add_f32 v21, v21, v20
    v_mov_b32 v20, v21
    s_nop 1
    v_permlane32_swap_b32 v21, v20
    s_nop 1
    v_add_f32 v21, v21, v20
    v_log_f32 v21, v21
    s_nop 0
    v_max_f32 v16, v16, v21
    v_add_f32 v16, 0x42b60000, v16
    v_max_f32 v16, 0, v16
    v_mul_f32 v18, -0.5, v16
    v_exp_f32 v18, v18
    s_nop 0
    v_max3_f32 v17, v116, v117, v118
    v_max3_f32 v17, v17, v119, v124
    v_max3_f32 v17, v17, v125, v126
    v_max_f32 v17, v17, v127
    v_mov_b32 v20, v17
    s_nop 1
    v_permlane16_swap_b32 v17, v20
    s_nop 1
    v_max_f32 v17, v17, v20
    v_mov_b32 v20, v17
    s_nop 1
    v_permlane32_swap_b32 v17, v20
    s_nop 1
    v_max_f32 v17, v17, v20
    v_mov_b32 v21, v61
    v_mov_b32 v20, v21
    s_nop 1
    v_permlane16_swap_b32 v21, v20
    s_nop 1
    v_add_f32 v21, v21, v20
    v_mov_b32 v20, v21
    s_nop 1
    v_permlane32_swap_b32 v21, v20
    s_nop 1
    v_add_f32 v21, v21, v20
    v_log_f32 v21, v21
    s_nop 0
    v_max_f32 v17, v17, v21
    v_add_f32 v17, 0x42b60000, v17
    v_max_f32 v17, 0, v17
    v_mul_f32 v19, -0.5, v17
    v_exp_f32 v19, v19
    s_nop 0
    v_mul_f32 v128, v128, v18
    v_mul_f32 v129, v129, v18
    v_mul_f32 v130, v130, v18
    v_mul_f32 v131, v131, v18
    v_mul_f32 v132, v132, v19
    v_mul_f32 v133, v133, v19
    v_mul_f32 v134, v134, v19
    v_mul_f32 v135, v135, v19
    v_mul_f32 v136, v136, v18
    v_mul_f32 v137, v137, v18
    v_mul_f32 v138, v138, v18
    v_mul_f32 v139, v139, v18
    v_mul_f32 v140, v140, v19
    v_mul_f32 v141, v141, v19
    v_mul_f32 v142, v142, v19
    v_mul_f32 v143, v143, v19
    v_mul_f32 v144, v144, v18
    v_mul_f32 v145, v145, v18
    v_mul_f32 v146, v146, v18
    v_mul_f32 v147, v147, v18
    v_mul_f32 v148, v148, v19
    v_mul_f32 v149, v149, v19
    v_mul_f32 v150, v150, v19
    v_mul_f32 v151, v151, v19
    v_mul_f32 v152, v152, v18
    v_mul_f32 v153, v153, v18
    v_mul_f32 v154, v154, v18
    v_mul_f32 v155, v155, v18
    v_mul_f32 v156, v156, v19
    v_mul_f32 v157, v157, v19
    v_mul_f32 v158, v158, v19
    v_mul_f32 v159, v159, v19
    v_mul_f32 v160, v160, v18
    v_mul_f32 v161, v161, v18
    v_mul_f32 v162, v162, v18
    v_mul_f32 v163, v163, v18
    v_mul_f32 v164, v164, v19
    v_mul_f32 v165, v165, v19
    v_mul_f32 v166, v166, v19
    v_mul_f32 v167, v167, v19
    v_mul_f32 v168, v168, v18
    v_mul_f32 v169, v169, v18
    v_mul_f32 v170, v170, v18
    v_mul_f32 v171, v171, v18
    v_mul_f32 v172, v172, v19
    v_mul_f32 v173, v173, v19
    v_mul_f32 v174, v174, v19
    v_mul_f32 v175, v175, v19
    v_mul_f32 v176, v176, v18
    v_mul_f32 v177, v177, v18
    v_mul_f32 v178, v178, v18
    v_mul_f32 v179, v179, v18
    v_mul_f32 v180, v180, v19
    v_mul_f32 v181, v181, v19
    v_mul_f32 v182, v182, v19
    v_mul_f32 v183, v183, v19
    v_mul_f32 v184, v184, v18
    v_mul_f32 v185, v185, v18
    v_mul_f32 v186, v186, v18
    v_mul_f32 v187, v187, v18
    v_mul_f32 v188, v188, v19
    v_mul_f32 v189, v189, v19
    v_mul_f32 v190, v190, v19
    v_mul_f32 v191, v191, v19
    v_mul_f32 v192, v192, v18
    v_mul_f32 v193, v193, v18
    v_mul_f32 v194, v194, v18
    v_mul_f32 v195, v195, v18
    v_mul_f32 v196, v196, v19
    v_mul_f32 v197, v197, v19
    v_mul_f32 v198, v198, v19
    v_mul_f32 v199, v199, v19
    v_mul_f32 v200, v200, v18
    v_mul_f32 v201, v201, v18
    v_mul_f32 v202, v202, v18
    v_mul_f32 v203, v203, v18
    v_mul_f32 v204, v204, v19
    v_mul_f32 v205, v205, v19
    v_mul_f32 v206, v206, v19
    v_mul_f32 v207, v207, v19
    v_mul_f32 v208, v208, v18
    v_mul_f32 v209, v209, v18
    v_mul_f32 v210, v210, v18
    v_mul_f32 v211, v211, v18
    v_mul_f32 v212, v212, v19
    v_mul_f32 v213, v213, v19
    v_mul_f32 v214, v214, v19
    v_mul_f32 v215, v215, v19
    v_mul_f32 v216, v216, v18
    v_mul_f32 v217, v217, v18
    v_mul_f32 v218, v218, v18
    v_mul_f32 v219, v219, v18
    v_mul_f32 v220, v220, v19
    v_mul_f32 v221, v221, v19
    v_mul_f32 v222, v222, v19
    v_mul_f32 v223, v223, v19
    v_mul_f32 v224, v224, v18
    v_mul_f32 v225, v225, v18
    v_mul_f32 v226, v226, v18
    v_mul_f32 v227, v227, v18
    v_mul_f32 v228, v228, v19
    v_mul_f32 v229, v229, v19
    v_mul_f32 v230, v230, v19
    v_mul_f32 v231, v231, v19
    v_mul_f32 v232, v232, v18
    v_mul_f32 v233, v233, v18
    v_mul_f32 v234, v234, v18
    v_mul_f32 v235, v235, v18
    v_mul_f32 v236, v236, v19
    v_mul_f32 v237, v237, v19
    v_mul_f32 v238, v238, v19
    v_mul_f32 v239, v239, v19
    v_mul_f32 v240, v240, v18
    v_mul_f32 v241, v241, v18
    v_mul_f32 v242, v242, v18
    v_mul_f32 v243, v243, v18
    v_mul_f32 v244, v244, v19
    v_mul_f32 v245, v245, v19
    v_mul_f32 v246, v246, v19
    v_mul_f32 v247, v247, v19
    v_mul_f32 v248, v248, v18
    v_mul_f32 v249, v249, v18
    v_mul_f32 v250, v250, v18
    v_mul_f32 v251, v251, v18
    v_mul_f32 v252, v252, v19
    v_mul_f32 v253, v253, v19
    v_mul_f32 v254, v254, v19
    v_mul_f32 v255, v255, v19
    v_mul_f32 v128, v128, v18
    v_mul_f32 v129, v129, v18
    v_mul_f32 v130, v130, v18
    v_mul_f32 v131, v131, v18
    v_mul_f32 v132, v132, v19
    v_mul_f32 v133, v133, v19
    v_mul_f32 v134, v134, v19
    v_mul_f32 v135, v135, v19
    v_mul_f32 v136, v136, v18
    v_mul_f32 v137, v137, v18
    v_mul_f32 v138, v138, v18
    v_mul_f32 v139, v139, v18
    v_mul_f32 v140, v140, v19
    v_mul_f32 v141, v141, v19
    v_mul_f32 v142, v142, v19
    v_mul_f32 v143, v143, v19
    v_mul_f32 v144, v144, v18
    v_mul_f32 v145, v145, v18
    v_mul_f32 v146, v146, v18
    v_mul_f32 v147, v147, v18
    v_mul_f32 v148, v148, v19
    v_mul_f32 v149, v149, v19
    v_mul_f32 v150, v150, v19
    v_mul_f32 v151, v151, v19
    v_mul_f32 v152, v152, v18
    v_mul_f32 v153, v153, v18
    v_mul_f32 v154, v154, v18
    v_mul_f32 v155, v155, v18
    v_mul_f32 v156, v156, v19
    v_mul_f32 v157, v157, v19
    v_mul_f32 v158, v158, v19
    v_mul_f32 v159, v159, v19
    v_mul_f32 v160, v160, v18
    v_mul_f32 v161, v161, v18
    v_mul_f32 v162, v162, v18
    v_mul_f32 v163, v163, v18
    v_mul_f32 v164, v164, v19
    v_mul_f32 v165, v165, v19
    v_mul_f32 v166, v166, v19
    v_mul_f32 v167, v167, v19
    v_mul_f32 v168, v168, v18
    v_mul_f32 v169, v169, v18
    v_mul_f32 v170, v170, v18
    v_mul_f32 v171, v171, v18
    v_mul_f32 v172, v172, v19
    v_mul_f32 v173, v173, v19
    v_mul_f32 v174, v174, v19
    v_mul_f32 v175, v175, v19
    v_mul_f32 v176, v176, v18
    v_mul_f32 v177, v177, v18
    v_mul_f32 v178, v178, v18
    v_mul_f32 v179, v179, v18
    v_mul_f32 v180, v180, v19
    v_mul_f32 v181, v181, v19
    v_mul_f32 v182, v182, v19
    v_mul_f32 v183, v183, v19
    v_mul_f32 v184, v184, v18
    v_mul_f32 v185, v185, v18
    v_mul_f32 v186, v186, v18
    v_mul_f32 v187, v187, v18
    v_mul_f32 v188, v188, v19
    v_mul_f32 v189, v189, v19
    v_mul_f32 v190, v190, v19
    v_mul_f32 v191, v191, v19
    v_mul_f32 v192, v192, v18
    v_mul_f32 v193, v193, v18
    v_mul_f32 v194, v194, v18
    v_mul_f32 v195, v195, v18
    v_mul_f32 v196, v196, v19
    v_mul_f32 v197, v197, v19
    v_mul_f32 v198, v198, v19
    v_mul_f32 v199, v199, v19
    v_mul_f32 v200, v200, v18
    v_mul_f32 v201, v201, v18
    v_mul_f32 v202, v202, v18
    v_mul_f32 v203, v203, v18
    v_mul_f32 v204, v204, v19
    v_mul_f32 v205, v205, v19
    v_mul_f32 v206, v206, v19
    v_mul_f32 v207, v207, v19
    v_mul_f32 v208, v208, v18
    v_mul_f32 v209, v209, v18
    v_mul_f32 v210, v210, v18
    v_mul_f32 v211, v211, v18
    v_mul_f32 v212, v212, v19
    v_mul_f32 v213, v213, v19
    v_mul_f32 v214, v214, v19
    v_mul_f32 v215, v215, v19
    v_mul_f32 v216, v216, v18
    v_mul_f32 v217, v217, v18
    v_mul_f32 v218, v218, v18
    v_mul_f32 v219, v219, v18
    v_mul_f32 v220, v220, v19
    v_mul_f32 v221, v221, v19
    v_mul_f32 v222, v222, v19
    v_mul_f32 v223, v223, v19
    v_mul_f32 v224, v224, v18
    v_mul_f32 v225, v225, v18
    v_mul_f32 v226, v226, v18
    v_mul_f32 v227, v227, v18
    v_mul_f32 v228, v228, v19
    v_mul_f32 v229, v229, v19
    v_mul_f32 v230, v230, v19
    v_mul_f32 v231, v231, v19
    v_mul_f32 v232, v232, v18
    v_mul_f32 v233, v233, v18
    v_mul_f32 v234, v234, v18
    v_mul_f32 v235, v235, v18
    v_mul_f32 v236, v236, v19
    v_mul_f32 v237, v237, v19
    v_mul_f32 v238, v238, v19
    v_mul_f32 v239, v239, v19
    v_mul_f32 v240, v240, v18
    v_mul_f32 v241, v241, v18
    v_mul_f32 v242, v242, v18
    v_mul_f32 v243, v243, v18
    v_mul_f32 v244, v244, v19
    v_mul_f32 v245, v245, v19
    v_mul_f32 v246, v246, v19
    v_mul_f32 v247, v247, v19
    v_mul_f32 v248, v248, v18
    v_mul_f32 v249, v249, v18
    v_mul_f32 v250, v250, v18
    v_mul_f32 v251, v251, v18
    v_mul_f32 v252, v252, v19
    v_mul_f32 v253, v253, v19
    v_mul_f32 v254, v254, v19
    v_mul_f32 v255, v255, v19
    v_mul_f32 v60, v60, v18
    v_mul_f32 v60, v60, v18
    v_sub_f32 v80, v80, v16
    v_sub_f32 v81, v81, v16
    v_sub_f32 v82, v82, v16
    v_sub_f32 v83, v83, v16
    v_sub_f32 v96, v96, v16
    v_sub_f32 v112, v112, v16
    v_sub_f32 v97, v97, v16
    v_sub_f32 v113, v113, v16
    v_sub_f32 v98, v98, v16
    v_sub_f32 v114, v114, v16
    v_sub_f32 v99, v99, v16
    v_sub_f32 v115, v115, v16
    v_sub_f32 v104, v104, v16
    v_sub_f32 v120, v120, v16
    v_sub_f32 v105, v105, v16
    v_sub_f32 v121, v121, v16
    v_sub_f32 v106, v106, v16
    v_sub_f32 v122, v122, v16
    v_sub_f32 v107, v107, v16
    v_sub_f32 v123, v123, v16
    v_mul_f32 v61, v61, v19
    v_mul_f32 v61, v61, v19
    v_sub_f32 v84, v84, v17
    v_sub_f32 v85, v85, v17
    v_sub_f32 v86, v86, v17
    v_sub_f32 v87, v87, v17
    v_sub_f32 v100, v100, v17
    v_sub_f32 v116, v116, v17
    v_sub_f32 v101, v101, v17
    v_sub_f32 v117, v117, v17
    v_sub_f32 v102, v102, v17
    v_sub_f32 v118, v118, v17
    v_sub_f32 v103, v103, v17
    v_sub_f32 v119, v119, v17
    v_sub_f32 v108, v108, v17
    v_sub_f32 v124, v124, v17
    v_sub_f32 v109, v109, v17
    v_sub_f32 v125, v125, v17
    v_sub_f32 v110, v110, v17
    v_sub_f32 v126, v126, v17
    v_sub_f32 v111, v111, v17
    v_sub_f32 v127, v127, v17
    v_exp_f32 v56, v112
    v_exp_f32 v57, v113
    v_exp_f32 v58, v114
    v_exp_f32 v59, v115
    v_add_f32 v62, v60, v56
    v_add_f32 v62, v62, v57
    v_cvt_pk_bf16_f32 v72, v56, v57
    v_exp_f32 v56, v116
    v_exp_f32 v57, v117
    v_add_f32 v62, v62, v58
    v_add_f32 v62, v62, v59
    v_cvt_pk_bf16_f32 v73, v58, v59
    v_exp_f32 v58, v118
    v_exp_f32 v59, v119
    v_add_f32 v63, v61, v56
    v_add_f32 v63, v63, v57
    v_cvt_pk_bf16_f32 v76, v56, v57
    v_exp_f32 v56, v120
    v_exp_f32 v57, v121
    v_add_f32 v63, v63, v58
    v_add_f32 v63, v63, v59
    v_cvt_pk_bf16_f32 v77, v58, v59
    v_exp_f32 v58, v122
    v_exp_f32 v59, v123
    v_add_f32 v62, v62, v56
    v_add_f32 v62, v62, v57
    v_cvt_pk_bf16_f32 v74, v56, v57
    v_exp_f32 v56, v124
    v_exp_f32 v57, v125
    v_add_f32 v62, v62, v58
    v_add_f32 v62, v62, v59
    v_cvt_pk_bf16_f32 v75, v58, v59
    v_exp_f32 v58, v126
    v_exp_f32 v59, v127
    v_add_f32 v63, v63, v56
    v_add_f32 v63, v63, v57
    v_cvt_pk_bf16_f32 v78, v56, v57
    v_add_f32 v63, v63, v58
    v_add_f32 v63, v63, v59
    v_cvt_pk_bf16_f32 v79, v58, v59
    s_nop 1
    s_branch CONT_M0
RARE_M1:
    s_nop 15
    s_nop 15
    v_max3_f32 v16, v96, v97, v98
    v_max3_f32 v16, v16, v99, v104
    v_max3_f32 v16, v16, v105, v106
    v_max_f32 v16, v16, v107
    v_mov_b32 v20, v16
    s_nop 1
    v_permlane16_swap_b32 v16, v20
    s_nop 1
    v_max_f32 v16, v16, v20
    v_mov_b32 v20, v16
    s_nop 1
    v_permlane32_swap_b32 v16, v20
    s_nop 1
    v_max_f32 v16, v16, v20
    v_mov_b32 v21, v62
    v_mov_b32 v20, v21
    s_nop 1
    v_permlane16_swap_b32 v21, v20
    s_nop 1
    v_add_f32 v21, v21, v20
    v_mov_b32 v20, v21
    s_nop 1
    v_permlane32_swap_b32 v21, v20
    s_nop 1
    v_add_f32 v21, v21, v20
    v_log_f32 v21, v21
    s_nop 0
    v_max_f32 v16, v16, v21
    v_add_f32 v16, 0x42b60000, v16
    v_max_f32 v16, 0, v16
    v_mul_f32 v18, -0.5, v16
    v_exp_f32 v18, v18
    s_nop 0
    v_max3_f32 v17, v100, v101, v102
    v_max3_f32 v17, v17, v103, v108
    v_max3_f32 v17, v17, v109, v110
    v_max_f32 v17, v17, v111
    v_mov_b32 v20, v17
    s_nop 1
    v_permlane16_swap_b32 v17, v20
    s_nop 1
    v_max_f32 v17, v17, v20
    v_mov_b32 v20, v17
    s_nop 1
    v_permlane32_swap_b32 v17, v20
    s_nop 1
    v_max_f32 v17, v17, v20
    v_mov_b32 v21, v63
    v_mov_b32 v20, v21
    s_nop 1
    v_permlane16_swap_b32 v21, v20
    s_nop 1
    v_add_f32 v21, v21, v20
    v_mov_b32 v20, v21
    s_nop 1
    v_permlane32_swap_b32 v21, v20
    s_nop 1
    v_add_f32 v21, v21, v20
    v_log_f32 v21, v21
    s_nop 0
    v_max_f32 v17, v17, v21
    v_add_f32 v17, 0x42b60000, v17
    v_max_f32 v17, 0, v17
    v_mul_f32 v19, -0.5, v17
    v_exp_f32 v19, v19
    s_nop 0
    v_mul_f32 v128, v128, v18
    v_mul_f32 v129, v129, v18
    v_mul_f32 v130, v130, v18
    v_mul_f32 v131, v131, v18
    v_mul_f32 v132, v132, v19
    v_mul_f32 v133, v133, v19
    v_mul_f32 v134, v134, v19
    v_mul_f32 v135, v135, v19
    v_mul_f32 v136, v136, v18
    v_mul_f32 v137, v137, v18
    v_mul_f32 v138, v138, v18
    v_mul_f32 v139, v139, v18
    v_mul_f32 v140, v140, v19
    v_mul_f32 v141, v141, v19
    v_mul_f32 v142, v142, v19
    v_mul_f32 v143, v143, v19
    v_mul_f32 v144, v144, v18
    v_mul_f32 v145, v145, v18
    v_mul_f32 v146, v146, v18
    v_mul_f32 v147, v147, v18
    v_mul_f32 v148, v148, v19
    v_mul_f32 v149, v149, v19
    v_mul_f32 v150, v150, v19
    v_mul_f32 v151, v151, v19
    v_mul_f32 v152, v152, v18
    v_mul_f32 v153, v153, v18
    v_mul_f32 v154, v154, v18
    v_mul_f32 v155, v155, v18
    v_mul_f32 v156, v156, v19
    v_mul_f32 v157, v157, v19
    v_mul_f32 v158, v158, v19
    v_mul_f32 v159, v159, v19
    v_mul_f32 v160, v160, v18
    v_mul_f32 v161, v161, v18
    v_mul_f32 v162, v162, v18
    v_mul_f32 v163, v163, v18
    v_mul_f32 v164, v164, v19
    v_mul_f32 v165, v165, v19
    v_mul_f32 v166, v166, v19
    v_mul_f32 v167, v167, v19
    v_mul_f32 v168, v168, v18
    v_mul_f32 v169, v169, v18
    v_mul_f32 v170, v170, v18
    v_mul_f32 v171, v171, v18
    v_mul_f32 v172, v172, v19
    v_mul_f32 v173, v173, v19
    v_mul_f32 v174, v174, v19
    v_mul_f32 v175, v175, v19
    v_mul_f32 v176, v176, v18
    v_mul_f32 v177, v177, v18
    v_mul_f32 v178, v178, v18
    v_mul_f32 v179, v179, v18
    v_mul_f32 v180, v180, v19
    v_mul_f32 v181, v181, v19
    v_mul_f32 v182, v182, v19
    v_mul_f32 v183, v183, v19
    v_mul_f32 v184, v184, v18
    v_mul_f32 v185, v185, v18
    v_mul_f32 v186, v186, v18
    v_mul_f32 v187, v187, v18
    v_mul_f32 v188, v188, v19
    v_mul_f32 v189, v189, v19
    v_mul_f32 v190, v190, v19
    v_mul_f32 v191, v191, v19
    v_mul_f32 v192, v192, v18
    v_mul_f32 v193, v193, v18
    v_mul_f32 v194, v194, v18
    v_mul_f32 v195, v195, v18
    v_mul_f32 v196, v196, v19
    v_mul_f32 v197, v197, v19
    v_mul_f32 v198, v198, v19
    v_mul_f32 v199, v199, v19
    v_mul_f32 v200, v200, v18
    v_mul_f32 v201, v201, v18
    v_mul_f32 v202, v202, v18
    v_mul_f32 v203, v203, v18
    v_mul_f32 v204, v204, v19
    v_mul_f32 v205, v205, v19
    v_mul_f32 v206, v206, v19
    v_mul_f32 v207, v207, v19
    v_mul_f32 v208, v208, v18
    v_mul_f32 v209, v209, v18
    v_mul_f32 v210, v210, v18
    v_mul_f32 v211, v211, v18
    v_mul_f32 v212, v212, v19
    v_mul_f32 v213, v213, v19
    v_mul_f32 v214, v214, v19
    v_mul_f32 v215, v215, v19
    v_mul_f32 v216, v216, v18
    v_mul_f32 v217, v217, v18
    v_mul_f32 v218, v218, v18
    v_mul_f32 v219, v219, v18
    v_mul_f32 v220, v220, v19
    v_mul_f32 v221, v221, v19
    v_mul_f32 v222, v222, v19
    v_mul_f32 v223, v223, v19
    v_mul_f32 v224, v224, v18
    v_mul_f32 v225, v225, v18
    v_mul_f32 v226, v226, v18
    v_mul_f32 v227, v227, v18
    v_mul_f32 v228, v228, v19
    v_mul_f32 v229, v229, v19
    v_mul_f32 v230, v230, v19
    v_mul_f32 v231, v231, v19
    v_mul_f32 v232, v232, v18
    v_mul_f32 v233, v233, v18
    v_mul_f32 v234, v234, v18
    v_mul_f32 v235, v235, v18
    v_mul_f32 v236, v236, v19
    v_mul_f32 v237, v237, v19
    v_mul_f32 v238, v238, v19
    v_mul_f32 v239, v239, v19
    v_mul_f32 v240, v240, v18
    v_mul_f32 v241, v241, v18
    v_mul_f32 v242, v242, v18
    v_mul_f32 v243, v243, v18
    v_mul_f32 v244, v244, v19
    v_mul_f32 v245, v245, v19
    v_mul_f32 v246, v246, v19
    v_mul_f32 v247, v247, v19
    v_mul_f32 v248, v248, v18
    v_mul_f32 v249, v249, v18
    v_mul_f32 v250, v250, v18
    v_mul_f32 v251, v251, v18
    v_mul_f32 v252, v252, v19
    v_mul_f32 v253, v253, v19
    v_mul_f32 v254, v254, v19
    v_mul_f32 v255, v255, v19
    v_mul_f32 v128, v128, v18
    v_mul_f32 v129, v129, v18
    v_mul_f32 v130, v130, v18
    v_mul_f32 v131, v131, v18
    v_mul_f32 v132, v132, v19
    v_mul_f32 v133, v133, v19
    v_mul_f32 v134, v134, v19
    v_mul_f32 v135, v135, v19
    v_mul_f32 v136, v136, v18
    v_mul_f32 v137, v137, v18
    v_mul_f32 v138, v138, v18
    v_mul_f32 v139, v139, v18
    v_mul_f32 v140, v140, v19
    v_mul_f32 v141, v141, v19
    v_mul_f32 v142, v142, v19
    v_mul_f32 v143, v143, v19
    v_mul_f32 v144, v144, v18
    v_mul_f32 v145, v145, v18
    v_mul_f32 v146, v146, v18
    v_mul_f32 v147, v147, v18
    v_mul_f32 v148, v148, v19
    v_mul_f32 v149, v149, v19
    v_mul_f32 v150, v150, v19
    v_mul_f32 v151, v151, v19
    v_mul_f32 v152, v152, v18
    v_mul_f32 v153, v153, v18
    v_mul_f32 v154, v154, v18
    v_mul_f32 v155, v155, v18
    v_mul_f32 v156, v156, v19
    v_mul_f32 v157, v157, v19
    v_mul_f32 v158, v158, v19
    v_mul_f32 v159, v159, v19
    v_mul_f32 v160, v160, v18
    v_mul_f32 v161, v161, v18
    v_mul_f32 v162, v162, v18
    v_mul_f32 v163, v163, v18
    v_mul_f32 v164, v164, v19
    v_mul_f32 v165, v165, v19
    v_mul_f32 v166, v166, v19
    v_mul_f32 v167, v167, v19
    v_mul_f32 v168, v168, v18
    v_mul_f32 v169, v169, v18
    v_mul_f32 v170, v170, v18
    v_mul_f32 v171, v171, v18
    v_mul_f32 v172, v172, v19
    v_mul_f32 v173, v173, v19
    v_mul_f32 v174, v174, v19
    v_mul_f32 v175, v175, v19
    v_mul_f32 v176, v176, v18
    v_mul_f32 v177, v177, v18
    v_mul_f32 v178, v178, v18
    v_mul_f32 v179, v179, v18
    v_mul_f32 v180, v180, v19
    v_mul_f32 v181, v181, v19
    v_mul_f32 v182, v182, v19
    v_mul_f32 v183, v183, v19
    v_mul_f32 v184, v184, v18
    v_mul_f32 v185, v185, v18
    v_mul_f32 v186, v186, v18
    v_mul_f32 v187, v187, v18
    v_mul_f32 v188, v188, v19
    v_mul_f32 v189, v189, v19
    v_mul_f32 v190, v190, v19
    v_mul_f32 v191, v191, v19
    v_mul_f32 v192, v192, v18
    v_mul_f32 v193, v193, v18
    v_mul_f32 v194, v194, v18
    v_mul_f32 v195, v195, v18
    v_mul_f32 v196, v196, v19
    v_mul_f32 v197, v197, v19
    v_mul_f32 v198, v198, v19
    v_mul_f32 v199, v199, v19
    v_mul_f32 v200, v200, v18
    v_mul_f32 v201, v201, v18
    v_mul_f32 v202, v202, v18
    v_mul_f32 v203, v203, v18
    v_mul_f32 v204, v204, v19
    v_mul_f32 v205, v205, v19
    v_mul_f32 v206, v206, v19
    v_mul_f32 v207, v207, v19
    v_mul_f32 v208, v208, v18
    v_mul_f32 v209, v209, v18
    v_mul_f32 v210, v210, v18
    v_mul_f32 v211, v211, v18
    v_mul_f32 v212, v212, v19
    v_mul_f32 v213, v213, v19
    v_mul_f32 v214, v214, v19
    v_mul_f32 v215, v215, v19
    v_mul_f32 v216, v216, v18
    v_mul_f32 v217, v217, v18
    v_mul_f32 v218, v218, v18
    v_mul_f32 v219, v219, v18
    v_mul_f32 v220, v220, v19
    v_mul_f32 v221, v221, v19
    v_mul_f32 v222, v222, v19
    v_mul_f32 v223, v223, v19
    v_mul_f32 v224, v224, v18
    v_mul_f32 v225, v225, v18
    v_mul_f32 v226, v226, v18
    v_mul_f32 v227, v227, v18
    v_mul_f32 v228, v228, v19
    v_mul_f32 v229, v229, v19
    v_mul_f32 v230, v230, v19
    v_mul_f32 v231, v231, v19
    v_mul_f32 v232, v232, v18
    v_mul_f32 v233, v233, v18
    v_mul_f32 v234, v234, v18
    v_mul_f32 v235, v235, v18
    v_mul_f32 v236, v236, v19
    v_mul_f32 v237, v237, v19
    v_mul_f32 v238, v238, v19
    v_mul_f32 v239, v239, v19
    v_mul_f32 v240, v240, v18
    v_mul_f32 v241, v241, v18
    v_mul_f32 v242, v242, v18
    v_mul_f32 v243, v243, v18
    v_mul_f32 v244, v244, v19
    v_mul_f32 v245, v245, v19
    v_mul_f32 v246, v246, v19
    v_mul_f32 v247, v247, v19
    v_mul_f32 v248, v248, v18
    v_mul_f32 v249, v249, v18
    v_mul_f32 v250, v250, v18
    v_mul_f32 v251, v251, v18
    v_mul_f32 v252, v252, v19
    v_mul_f32 v253, v253, v19
    v_mul_f32 v254, v254, v19
    v_mul_f32 v255, v255, v19
    v_mul_f32 v62, v62, v18
    v_mul_f32 v62, v62, v18
    v_sub_f32 v80, v80, v16
    v_sub_f32 v81, v81, v16
    v_sub_f32 v82, v82, v16
    v_sub_f32 v83, v83, v16
    v_sub_f32 v112, v112, v16
    v_sub_f32 v96, v96, v16
    v_sub_f32 v113, v113, v16
    v_sub_f32 v97, v97, v16
    v_sub_f32 v114, v114, v16
    v_sub_f32 v98, v98, v16
    v_sub_f32 v115, v115, v16
    v_sub_f32 v99, v99, v16
    v_sub_f32 v120, v120, v16
    v_sub_f32 v104, v104, v16
    v_sub_f32 v121, v121, v16
    v_sub_f32 v105, v105, v16
    v_sub_f32 v122, v122, v16
    v_sub_f32 v106, v106, v16
    v_sub_f32 v123, v123, v16
    v_sub_f32 v107, v107, v16
    v_mul_f32 v63, v63, v19
    v_mul_f32 v63, v63, v19
    v_sub_f32 v84, v84, v17
    v_sub_f32 v85, v85, v17
    v_sub_f32 v86, v86, v17
    v_sub_f32 v87, v87, v17
    v_sub_f32 v116, v116, v17
    v_sub_f32 v100, v100, v17
    v_sub_f32 v117, v117, v17
    v_sub_f32 v101, v101, v17
    v_sub_f32 v118, v118, v17
    v_sub_f32 v102, v102, v17
    v_sub_f32 v119, v119, v17
    v_sub_f32 v103, v103, v17
    v_sub_f32 v124, v124, v17
    v_sub_f32 v108, v108, v17
    v_sub_f32 v125, v125, v17
    v_sub_f32 v109, v109, v17
    v_sub_f32 v126, v126, v17
    v_sub_f32 v110, v110, v17
    v_sub_f32 v127, v127, v17
    v_sub_f32 v111, v111, v17
    v_exp_f32 v56, v96
    v_exp_f32 v57, v97
    v_exp_f32 v58, v98
    v_exp_f32 v59, v99
    v_add_f32 v60, v62, v56
    v_add_f32 v60, v60, v57
    v_cvt_pk_bf16_f32 v64, v56, v57
    v_exp_f32 v56, v100
    v_exp_f32 v57, v101
    v_add_f32 v60, v60, v58
    v_add_f32 v60, v60, v59
    v_cvt_pk_bf16_f32 v65, v58, v59
    v_exp_f32 v58, v102
    v_exp_f32 v59, v103
    v_add_f32 v61, v63, v56
    v_add_f32 v61, v61, v57
    v_cvt_pk_bf16_f32 v68, v56, v57
    v_exp_f32 v56, v104
    v_exp_f32 v57, v105
    v_add_f32 v61, v61, v58
    v_add_f32 v61, v61, v59
    v_cvt_pk_bf16_f32 v69, v58, v59
    v_exp_f32 v58, v106
    v_exp_f32 v59, v107
    v_add_f32 v60, v60, v56
    v_add_f32 v60, v60, v57
    v_cvt_pk_bf16_f32 v66, v56, v57
    v_exp_f32 v56, v108
    v_exp_f32 v57, v109
    v_add_f32 v60, v60, v58
    v_add_f32 v60, v60, v59
    v_cvt_pk_bf16_f32 v67, v58, v59
    v_exp_f32 v58, v110
    v_exp_f32 v59, v111
    v_add_f32 v61, v61, v56
    v_add_f32 v61, v61, v57
    v_cvt_pk_bf16_f32 v70, v56, v57
    v_add_f32 v61, v61, v58
    v_add_f32 v61, v61, v59
    v_cvt_pk_bf16_f32 v71, v58, v59
    s_nop 1
    s_branch CONT_M1
RARE_M2:
    s_nop 15
    s_nop 15
    v_max3_f32 v16, v112, v113, v114
    v_max3_f32 v16, v16, v115, v120
    v_max3_f32 v16, v16, v121, v122
    v_max_f32 v16, v16, v123
    v_mov_b32 v20, v16
    s_nop 1
    v_permlane16_swap_b32 v16, v20
    s_nop 1
    v_max_f32 v16, v16, v20
    v_mov_b32 v20, v16
    s_nop 1
    v_permlane32_swap_b32 v16, v20
    s_nop 1
    v_max_f32 v16, v16, v20
    v_mov_b32 v21, v60
    v_mov_b32 v20, v21
    s_nop 1
    v_permlane16_swap_b32 v21, v20
    s_nop 1
    v_add_f32 v21, v21, v20
    v_mov_b32 v20, v21
    s_nop 1
    v_permlane32_swap_b32 v21, v20
    s_nop 1
    v_add_f32 v21, v21, v20
    v_log_f32 v21, v21
    s_nop 0
    v_max_f32 v16, v16, v21
    v_add_f32 v16, 0x42b60000, v16
    v_max_f32 v16, 0, v16
    v_mul_f32 v18, -0.5, v16
    v_exp_f32 v18, v18
    s_nop 0
    v_max3_f32 v17, v116, v117, v118
    v_max3_f32 v17, v17, v119, v124
    v_max3_f32 v17, v17, v125, v126
    v_max_f32 v17, v17, v127
    v_mov_b32 v20, v17
    s_nop 1
    v_permlane16_swap_b32 v17, v20
    s_nop 1
    v_max_f32 v17, v17, v20
    v_mov_b32 v20, v17
    s_nop 1
    v_permlane32_swap_b32 v17, v20
    s_nop 1
    v_max_f32 v17, v17, v20
    v_mov_b32 v21, v61
    v_mov_b32 v20, v21
    s_nop 1
    v_permlane16_swap_b32 v21, v20
    s_nop 1
    v_add_f32 v21, v21, v20
    v_mov_b32 v20, v21
    s_nop 1
    v_permlane32_swap_b32 v21, v20
    s_nop 1
    v_add_f32 v21, v21, v20
    v_log_f32 v21, v21
    s_nop 0
    v_max_f32 v17, v17, v21
    v_add_f32 v17, 0x42b60000, v17
    v_max_f32 v17, 0, v17
    v_mul_f32 v19, -0.5, v17
    v_exp_f32 v19, v19
    s_nop 0
    v_mul_f32 v128, v128, v18
    v_mul_f32 v129, v129, v18
    v_mul_f32 v130, v130, v18
    v_mul_f32 v131, v131, v18
    v_mul_f32 v132, v132, v19
    v_mul_f32 v133, v133, v19
    v_mul_f32 v134, v134, v19
    v_mul_f32 v135, v135, v19
    v_mul_f32 v136, v136, v18
    v_mul_f32 v137, v137, v18
    v_mul_f32 v138, v138, v18
    v_mul_f32 v139, v139, v18
    v_mul_f32 v140, v140, v19
    v_mul_f32 v141, v141, v19
    v_mul_f32 v142, v142, v19
    v_mul_f32 v143, v143, v19
    v_mul_f32 v144, v144, v18
    v_mul_f32 v145, v145, v18
    v_mul_f32 v146, v146, v18
    v_mul_f32 v147, v147, v18
    v_mul_f32 v148, v148, v19
    v_mul_f32 v149, v149, v19
    v_mul_f32 v150, v150, v19
    v_mul_f32 v151, v151, v19
    v_mul_f32 v152, v152, v18
    v_mul_f32 v153, v153, v18
    v_mul_f32 v154, v154, v18
    v_mul_f32 v155, v155, v18
    v_mul_f32 v156, v156, v19
    v_mul_f32 v157, v157, v19
    v_mul_f32 v158, v158, v19
    v_mul_f32 v159, v159, v19
    v_mul_f32 v160, v160, v18
    v_mul_f32 v161, v161, v18
    v_mul_f32 v162, v162, v18
    v_mul_f32 v163, v163, v18
    v_mul_f32 v164, v164, v19
    v_mul_f32 v165, v165, v19
    v_mul_f32 v166, v166, v19
    v_mul_f32 v167, v167, v19
    v_mul_f32 v168, v168, v18
    v_mul_f32 v169, v169, v18
    v_mul_f32 v170, v170, v18
    v_mul_f32 v171, v171, v18
    v_mul_f32 v172, v172, v19
    v_mul_f32 v173, v173, v19
    v_mul_f32 v174, v174, v19
    v_mul_f32 v175, v175, v19
    v_mul_f32 v176, v176, v18
    v_mul_f32 v177, v177, v18
    v_mul_f32 v178, v178, v18
    v_mul_f32 v179, v179, v18
    v_mul_f32 v180, v180, v19
    v_mul_f32 v181, v181, v19
    v_mul_f32 v182, v182, v19
    v_mul_f32 v183, v183, v19
    v_mul_f32 v184, v184, v18
    v_mul_f32 v185, v185, v18
    v_mul_f32 v186, v186, v18
    v_mul_f32 v187, v187, v18
    v_mul_f32 v188, v188, v19
    v_mul_f32 v189, v189, v19
    v_mul_f32 v190, v190, v19
    v_mul_f32 v191, v191, v19
    v_mul_f32 v192, v192, v18
    v_mul_f32 v193, v193, v18
    v_mul_f32 v194, v194, v18
    v_mul_f32 v195, v195, v18
    v_mul_f32 v196, v196, v19
    v_mul_f32 v197, v197, v19
    v_mul_f32 v198, v198, v19
    v_mul_f32 v199, v199, v19
    v_mul_f32 v200, v200, v18
    v_mul_f32 v201, v201, v18
    v_mul_f32 v202, v202, v18
    v_mul_f32 v203, v203, v18
    v_mul_f32 v204, v204, v19
    v_mul_f32 v205, v205, v19
    v_mul_f32 v206, v206, v19
    v_mul_f32 v207, v207, v19
    v_mul_f32 v208, v208, v18
    v_mul_f32 v209, v209, v18
    v_mul_f32 v210, v210, v18
    v_mul_f32 v211, v211, v18
    v_mul_f32 v212, v212, v19
    v_mul_f32 v213, v213, v19
    v_mul_f32 v214, v214, v19
    v_mul_f32 v215, v215, v19
    v_mul_f32 v216, v216, v18
    v_mul_f32 v217, v217, v18
    v_mul_f32 v218, v218, v18
    v_mul_f32 v219, v219, v18
    v_mul_f32 v220, v220, v19
    v_mul_f32 v221, v221, v19
    v_mul_f32 v222, v222, v19
    v_mul_f32 v223, v223, v19
    v_mul_f32 v224, v224, v18
    v_mul_f32 v225, v225, v18
    v_mul_f32 v226, v226, v18
    v_mul_f32 v227, v227, v18
    v_mul_f32 v228, v228, v19
    v_mul_f32 v229, v229, v19
    v_mul_f32 v230, v230, v19
    v_mul_f32 v231, v231, v19
    v_mul_f32 v232, v232, v18
    v_mul_f32 v233, v233, v18
    v_mul_f32 v234, v234, v18
    v_mul_f32 v235, v235, v18
    v_mul_f32 v236, v236, v19
    v_mul_f32 v237, v237, v19
    v_mul_f32 v238, v238, v19
    v_mul_f32 v239, v239, v19
    v_mul_f32 v240, v240, v18
    v_mul_f32 v241, v241, v18
    v_mul_f32 v242, v242, v18
    v_mul_f32 v243, v243, v18
    v_mul_f32 v244, v244, v19
    v_mul_f32 v245, v245, v19
    v_mul_f32 v246, v246, v19
    v_mul_f32 v247, v247, v19
    v_mul_f32 v248, v248, v18
    v_mul_f32 v249, v249, v18
    v_mul_f32 v250, v250, v18
    v_mul_f32 v251, v251, v18
    v_mul_f32 v252, v252, v19
    v_mul_f32 v253, v253, v19
    v_mul_f32 v254, v254, v19
    v_mul_f32 v255, v255, v19
    v_mul_f32 v128, v128, v18
    v_mul_f32 v129, v129, v18
    v_mul_f32 v130, v130, v18
    v_mul_f32 v131, v131, v18
    v_mul_f32 v132, v132, v19
    v_mul_f32 v133, v133, v19
    v_mul_f32 v134, v134, v19
    v_mul_f32 v135, v135, v19
    v_mul_f32 v136, v136, v18
    v_mul_f32 v137, v137, v18
    v_mul_f32 v138, v138, v18
    v_mul_f32 v139, v139, v18
    v_mul_f32 v140, v140, v19
    v_mul_f32 v141, v141, v19
    v_mul_f32 v142, v142, v19
    v_mul_f32 v143, v143, v19
    v_mul_f32 v144, v144, v18
    v_mul_f32 v145, v145, v18
    v_mul_f32 v146, v146, v18
    v_mul_f32 v147, v147, v18
    v_mul_f32 v148, v148, v19
    v_mul_f32 v149, v149, v19
    v_mul_f32 v150, v150, v19
    v_mul_f32 v151, v151, v19
    v_mul_f32 v152, v152, v18
    v_mul_f32 v153, v153, v18
    v_mul_f32 v154, v154, v18
    v_mul_f32 v155, v155, v18
    v_mul_f32 v156, v156, v19
    v_mul_f32 v157, v157, v19
    v_mul_f32 v158, v158, v19
    v_mul_f32 v159, v159, v19
    v_mul_f32 v160, v160, v18
    v_mul_f32 v161, v161, v18
    v_mul_f32 v162, v162, v18
    v_mul_f32 v163, v163, v18
    v_mul_f32 v164, v164, v19
    v_mul_f32 v165, v165, v19
    v_mul_f32 v166, v166, v19
    v_mul_f32 v167, v167, v19
    v_mul_f32 v168, v168, v18
    v_mul_f32 v169, v169, v18
    v_mul_f32 v170, v170, v18
    v_mul_f32 v171, v171, v18
    v_mul_f32 v172, v172, v19
    v_mul_f32 v173, v173, v19
    v_mul_f32 v174, v174, v19
    v_mul_f32 v175, v175, v19
    v_mul_f32 v176, v176, v18
    v_mul_f32 v177, v177, v18
    v_mul_f32 v178, v178, v18
    v_mul_f32 v179, v179, v18
    v_mul_f32 v180, v180, v19
    v_mul_f32 v181, v181, v19
    v_mul_f32 v182, v182, v19
    v_mul_f32 v183, v183, v19
    v_mul_f32 v184, v184, v18
    v_mul_f32 v185, v185, v18
    v_mul_f32 v186, v186, v18
    v_mul_f32 v187, v187, v18
    v_mul_f32 v188, v188, v19
    v_mul_f32 v189, v189, v19
    v_mul_f32 v190, v190, v19
    v_mul_f32 v191, v191, v19
    v_mul_f32 v192, v192, v18
    v_mul_f32 v193, v193, v18
    v_mul_f32 v194, v194, v18
    v_mul_f32 v195, v195, v18
    v_mul_f32 v196, v196, v19
    v_mul_f32 v197, v197, v19
    v_mul_f32 v198, v198, v19
    v_mul_f32 v199, v199, v19
    v_mul_f32 v200, v200, v18
    v_mul_f32 v201, v201, v18
    v_mul_f32 v202, v202, v18
    v_mul_f32 v203, v203, v18
    v_mul_f32 v204, v204, v19
    v_mul_f32 v205, v205, v19
    v_mul_f32 v206, v206, v19
    v_mul_f32 v207, v207, v19
    v_mul_f32 v208, v208, v18
    v_mul_f32 v209, v209, v18
    v_mul_f32 v210, v210, v18
    v_mul_f32 v211, v211, v18
    v_mul_f32 v212, v212, v19
    v_mul_f32 v213, v213, v19
    v_mul_f32 v214, v214, v19
    v_mul_f32 v215, v215, v19
    v_mul_f32 v216, v216, v18
    v_mul_f32 v217, v217, v18
    v_mul_f32 v218, v218, v18
    v_mul_f32 v219, v219, v18
    v_mul_f32 v220, v220, v19
    v_mul_f32 v221, v221, v19
    v_mul_f32 v222, v222, v19
    v_mul_f32 v223, v223, v19
    v_mul_f32 v224, v224, v18
    v_mul_f32 v225, v225, v18
    v_mul_f32 v226, v226, v18
    v_mul_f32 v227, v227, v18
    v_mul_f32 v228, v228, v19
    v_mul_f32 v229, v229, v19
    v_mul_f32 v230, v230, v19
    v_mul_f32 v231, v231, v19
    v_mul_f32 v232, v232, v18
    v_mul_f32 v233, v233, v18
    v_mul_f32 v234, v234, v18
    v_mul_f32 v235, v235, v18
    v_mul_f32 v236, v236, v19
    v_mul_f32 v237, v237, v19
    v_mul_f32 v238, v238, v19
    v_mul_f32 v239, v239, v19
    v_mul_f32 v240, v240, v18
    v_mul_f32 v241, v241, v18
    v_mul_f32 v242, v242, v18
    v_mul_f32 v243, v243, v18
    v_mul_f32 v244, v244, v19
    v_mul_f32 v245, v245, v19
    v_mul_f32 v246, v246, v19
    v_mul_f32 v247, v247, v19
    v_mul_f32 v248, v248, v18
    v_mul_f32 v249, v249, v18
    v_mul_f32 v250, v250, v18
    v_mul_f32 v251, v251, v18
    v_mul_f32 v252, v252, v19
    v_mul_f32 v253, v253, v19
    v_mul_f32 v254, v254, v19
    v_mul_f32 v255, v255, v19
    v_mul_f32 v60, v60, v18
    v_mul_f32 v60, v60, v18
    v_sub_f32 v80, v80, v16
    v_sub_f32 v81, v81, v16
    v_sub_f32 v82, v82, v16
    v_sub_f32 v83, v83, v16
    v_sub_f32 v96, v96, v16
    v_sub_f32 v112, v112, v16
    v_sub_f32 v97, v97, v16
    v_sub_f32 v113, v113, v16
    v_sub_f32 v98, v98, v16
    v_sub_f32 v114, v114, v16
    v_sub_f32 v99, v99, v16
    v_sub_f32 v115, v115, v16
    v_sub_f32 v104, v104, v16
    v_sub_f32 v120, v120, v16
    v_sub_f32 v105, v105, v16
    v_sub_f32 v121, v121, v16
    v_sub_f32 v106, v106, v16
    v_sub_f32 v122, v122, v16
    v_sub_f32 v107, v107, v16
    v_sub_f32 v123, v123, v16
    v_mul_f32 v61, v61, v19
    v_mul_f32 v61, v61, v19
    v_sub_f32 v84, v84, v17
    v_sub_f32 v85, v85, v17
    v_sub_f32 v86, v86, v17
    v_sub_f32 v87, v87, v17
    v_sub_f32 v100, v100, v17
    v_sub_f32 v116, v116, v17
    v_sub_f32 v101, v101, v17
    v_sub_f32 v117, v117, v17
    v_sub_f32 v102, v102, v17
    v_sub_f32 v118, v118, v17
    v_sub_f32 v103, v103, v17
    v_sub_f32 v119, v119, v17
    v_sub_f32 v108, v108, v17
    v_sub_f32 v124, v124, v17
    v_sub_f32 v109, v109, v17
    v_sub_f32 v125, v125, v17
    v_sub_f32 v110, v110, v17
    v_sub_f32 v126, v126, v17
    v_sub_f32 v111, v111, v17
    v_sub_f32 v127, v127, v17
    v_exp_f32 v56, v112
    v_exp_f32 v57, v113
    v_exp_f32 v58, v114
    v_exp_f32 v59, v115
    v_add_f32 v62, v60, v56
    v_add_f32 v62, v62, v57
    v_cvt_pk_bf16_f32 v72, v56, v57
    v_exp_f32 v56, v116
    v_exp_f32 v57, v117
    v_add_f32 v62, v62, v58
    v_add_f32 v62, v62, v59
    v_cvt_pk_bf16_f32 v73, v58, v59
    v_exp_f32 v58, v118
    v_exp_f32 v59, v119
    v_add_f32 v63, v61, v56
    v_add_f32 v63, v63, v57
    v_cvt_pk_bf16_f32 v76, v56, v57
    v_exp_f32 v56, v120
    v_exp_f32 v57, v121
    v_add_f32 v63, v63, v58
    v_add_f32 v63, v63, v59
    v_cvt_pk_bf16_f32 v77, v58, v59
    v_exp_f32 v58, v122
    v_exp_f32 v59, v123
    v_add_f32 v62, v62, v56
    v_add_f32 v62, v62, v57
    v_cvt_pk_bf16_f32 v74, v56, v57
    v_exp_f32 v56, v124
    v_exp_f32 v57, v125
    v_add_f32 v62, v62, v58
    v_add_f32 v62, v62, v59
    v_cvt_pk_bf16_f32 v75, v58, v59
    v_exp_f32 v58, v126
    v_exp_f32 v59, v127
    v_add_f32 v63, v63, v56
    v_add_f32 v63, v63, v57
    v_cvt_pk_bf16_f32 v78, v56, v57
    v_add_f32 v63, v63, v58
    v_add_f32 v63, v63, v59
    v_cvt_pk_bf16_f32 v79, v58, v59
    s_nop 1
    s_branch CONT_M2
RARE_M3:
    s_nop 15
    s_nop 15
    v_max3_f32 v16, v96, v97, v98
    v_max3_f32 v16, v16, v99, v104
    v_max3_f32 v16, v16, v105, v106
    v_max_f32 v16, v16, v107
    v_mov_b32 v20, v16
    s_nop 1
    v_permlane16_swap_b32 v16, v20
    s_nop 1
    v_max_f32 v16, v16, v20
    v_mov_b32 v20, v16
    s_nop 1
    v_permlane32_swap_b32 v16, v20
    s_nop 1
    v_max_f32 v16, v16, v20
    v_mov_b32 v21, v62
    v_mov_b32 v20, v21
    s_nop 1
    v_permlane16_swap_b32 v21, v20
    s_nop 1
    v_add_f32 v21, v21, v20
    v_mov_b32 v20, v21
    s_nop 1
    v_permlane32_swap_b32 v21, v20
    s_nop 1
    v_add_f32 v21, v21, v20
    v_log_f32 v21, v21
    s_nop 0
    v_max_f32 v16, v16, v21
    v_add_f32 v16, 0x42b60000, v16
    v_max_f32 v16, 0, v16
    v_mul_f32 v18, -0.5, v16
    v_exp_f32 v18, v18
    s_nop 0
    v_max3_f32 v17, v100, v101, v102
    v_max3_f32 v17, v17, v103, v108
    v_max3_f32 v17, v17, v109, v110
    v_max_f32 v17, v17, v111
    v_mov_b32 v20, v17
    s_nop 1
    v_permlane16_swap_b32 v17, v20
    s_nop 1
    v_max_f32 v17, v17, v20
    v_mov_b32 v20, v17
    s_nop 1
    v_permlane32_swap_b32 v17, v20
    s_nop 1
    v_max_f32 v17, v17, v20
    v_mov_b32 v21, v63
    v_mov_b32 v20, v21
    s_nop 1
    v_permlane16_swap_b32 v21, v20
    s_nop 1
    v_add_f32 v21, v21, v20
    v_mov_b32 v20, v21
    s_nop 1
    v_permlane32_swap_b32 v21, v20
    s_nop 1
    v_add_f32 v21, v21, v20
    v_log_f32 v21, v21
    s_nop 0
    v_max_f32 v17, v17, v21
    v_add_f32 v17, 0x42b60000, v17
    v_max_f32 v17, 0, v17
    v_mul_f32 v19, -0.5, v17
    v_exp_f32 v19, v19
    s_nop 0
    v_mul_f32 v128, v128, v18
    v_mul_f32 v129, v129, v18
    v_mul_f32 v130, v130, v18
    v_mul_f32 v131, v131, v18
    v_mul_f32 v132, v132, v19
    v_mul_f32 v133, v133, v19
    v_mul_f32 v134, v134, v19
    v_mul_f32 v135, v135, v19
    v_mul_f32 v136, v136, v18
    v_mul_f32 v137, v137, v18
    v_mul_f32 v138, v138, v18
    v_mul_f32 v139, v139, v18
    v_mul_f32 v140, v140, v19
    v_mul_f32 v141, v141, v19
    v_mul_f32 v142, v142, v19
    v_mul_f32 v143, v143, v19
    v_mul_f32 v144, v144, v18
    v_mul_f32 v145, v145, v18
    v_mul_f32 v146, v146, v18
    v_mul_f32 v147, v147, v18
    v_mul_f32 v148, v148, v19
    v_mul_f32 v149, v149, v19
    v_mul_f32 v150, v150, v19
    v_mul_f32 v151, v151, v19
    v_mul_f32 v152, v152, v18
    v_mul_f32 v153, v153, v18
    v_mul_f32 v154, v154, v18
    v_mul_f32 v155, v155, v18
    v_mul_f32 v156, v156, v19
    v_mul_f32 v157, v157, v19
    v_mul_f32 v158, v158, v19
    v_mul_f32 v159, v159, v19
    v_mul_f32 v160, v160, v18
    v_mul_f32 v161, v161, v18
    v_mul_f32 v162, v162, v18
    v_mul_f32 v163, v163, v18
    v_mul_f32 v164, v164, v19
    v_mul_f32 v165, v165, v19
    v_mul_f32 v166, v166, v19
    v_mul_f32 v167, v167, v19
    v_mul_f32 v168, v168, v18
    v_mul_f32 v169, v169, v18
    v_mul_f32 v170, v170, v18
    v_mul_f32 v171, v171, v18
    v_mul_f32 v172, v172, v19
    v_mul_f32 v173, v173, v19
    v_mul_f32 v174, v174, v19
    v_mul_f32 v175, v175, v19
    v_mul_f32 v176, v176, v18
    v_mul_f32 v177, v177, v18
    v_mul_f32 v178, v178, v18
    v_mul_f32 v179, v179, v18
    v_mul_f32 v180, v180, v19
    v_mul_f32 v181, v181, v19
    v_mul_f32 v182, v182, v19
    v_mul_f32 v183, v183, v19
    v_mul_f32 v184, v184, v18
    v_mul_f32 v185, v185, v18
    v_mul_f32 v186, v186, v18
    v_mul_f32 v187, v187, v18
    v_mul_f32 v188, v188, v19
    v_mul_f32 v189, v189, v19
    v_mul_f32 v190, v190, v19
    v_mul_f32 v191, v191, v19
    v_mul_f32 v192, v192, v18
    v_mul_f32 v193, v193, v18
    v_mul_f32 v194, v194, v18
    v_mul_f32 v195, v195, v18
    v_mul_f32 v196, v196, v19
    v_mul_f32 v197, v197, v19
    v_mul_f32 v198, v198, v19
    v_mul_f32 v199, v199, v19
    v_mul_f32 v200, v200, v18
    v_mul_f32 v201, v201, v18
    v_mul_f32 v202, v202, v18
    v_mul_f32 v203, v203, v18
    v_mul_f32 v204, v204, v19
    v_mul_f32 v205, v205, v19
    v_mul_f32 v206, v206, v19
    v_mul_f32 v207, v207, v19
    v_mul_f32 v208, v208, v18
    v_mul_f32 v209, v209, v18
    v_mul_f32 v210, v210, v18
    v_mul_f32 v211, v211, v18
    v_mul_f32 v212, v212, v19
    v_mul_f32 v213, v213, v19
    v_mul_f32 v214, v214, v19
    v_mul_f32 v215, v215, v19
    v_mul_f32 v216, v216, v18
    v_mul_f32 v217, v217, v18
    v_mul_f32 v218, v218, v18
    v_mul_f32 v219, v219, v18
    v_mul_f32 v220, v220, v19
    v_mul_f32 v221, v221, v19
    v_mul_f32 v222, v222, v19
    v_mul_f32 v223, v223, v19
    v_mul_f32 v224, v224, v18
    v_mul_f32 v225, v225, v18
    v_mul_f32 v226, v226, v18
    v_mul_f32 v227, v227, v18
    v_mul_f32 v228, v228, v19
    v_mul_f32 v229, v229, v19
    v_mul_f32 v230, v230, v19
    v_mul_f32 v231, v231, v19
    v_mul_f32 v232, v232, v18
    v_mul_f32 v233, v233, v18
    v_mul_f32 v234, v234, v18
    v_mul_f32 v235, v235, v18
    v_mul_f32 v236, v236, v19
    v_mul_f32 v237, v237, v19
    v_mul_f32 v238, v238, v19
    v_mul_f32 v239, v239, v19
    v_mul_f32 v240, v240, v18
    v_mul_f32 v241, v241, v18
    v_mul_f32 v242, v242, v18
    v_mul_f32 v243, v243, v18
    v_mul_f32 v244, v244, v19
    v_mul_f32 v245, v245, v19
    v_mul_f32 v246, v246, v19
    v_mul_f32 v247, v247, v19
    v_mul_f32 v248, v248, v18
    v_mul_f32 v249, v249, v18
    v_mul_f32 v250, v250, v18
    v_mul_f32 v251, v251, v18
    v_mul_f32 v252, v252, v19
    v_mul_f32 v253, v253, v19
    v_mul_f32 v254, v254, v19
    v_mul_f32 v255, v255, v19
    v_mul_f32 v128, v128, v18
    v_mul_f32 v129, v129, v18
    v_mul_f32 v130, v130, v18
    v_mul_f32 v131, v131, v18
    v_mul_f32 v132, v132, v19
    v_mul_f32 v133, v133, v19
    v_mul_f32 v134, v134, v19
    v_mul_f32 v135, v135, v19
    v_mul_f32 v136, v136, v18
    v_mul_f32 v137, v137, v18
    v_mul_f32 v138, v138, v18
    v_mul_f32 v139, v139, v18
    v_mul_f32 v140, v140, v19
    v_mul_f32 v141, v141, v19
    v_mul_f32 v142, v142, v19
    v_mul_f32 v143, v143, v19
    v_mul_f32 v144, v144, v18
    v_mul_f32 v145, v145, v18
    v_mul_f32 v146, v146, v18
    v_mul_f32 v147, v147, v18
    v_mul_f32 v148, v148, v19
    v_mul_f32 v149, v149, v19
    v_mul_f32 v150, v150, v19
    v_mul_f32 v151, v151, v19
    v_mul_f32 v152, v152, v18
    v_mul_f32 v153, v153, v18
    v_mul_f32 v154, v154, v18
    v_mul_f32 v155, v155, v18
    v_mul_f32 v156, v156, v19
    v_mul_f32 v157, v157, v19
    v_mul_f32 v158, v158, v19
    v_mul_f32 v159, v159, v19
    v_mul_f32 v160, v160, v18
    v_mul_f32 v161, v161, v18
    v_mul_f32 v162, v162, v18
    v_mul_f32 v163, v163, v18
    v_mul_f32 v164, v164, v19
    v_mul_f32 v165, v165, v19
    v_mul_f32 v166, v166, v19
    v_mul_f32 v167, v167, v19
    v_mul_f32 v168, v168, v18
    v_mul_f32 v169, v169, v18
    v_mul_f32 v170, v170, v18
    v_mul_f32 v171, v171, v18
    v_mul_f32 v172, v172, v19
    v_mul_f32 v173, v173, v19
    v_mul_f32 v174, v174, v19
    v_mul_f32 v175, v175, v19
    v_mul_f32 v176, v176, v18
    v_mul_f32 v177, v177, v18
    v_mul_f32 v178, v178, v18
    v_mul_f32 v179, v179, v18
    v_mul_f32 v180, v180, v19
    v_mul_f32 v181, v181, v19
    v_mul_f32 v182, v182, v19
    v_mul_f32 v183, v183, v19
    v_mul_f32 v184, v184, v18
    v_mul_f32 v185, v185, v18
    v_mul_f32 v186, v186, v18
    v_mul_f32 v187, v187, v18
    v_mul_f32 v188, v188, v19
    v_mul_f32 v189, v189, v19
    v_mul_f32 v190, v190, v19
    v_mul_f32 v191, v191, v19
    v_mul_f32 v192, v192, v18
    v_mul_f32 v193, v193, v18
    v_mul_f32 v194, v194, v18
    v_mul_f32 v195, v195, v18
    v_mul_f32 v196, v196, v19
    v_mul_f32 v197, v197, v19
    v_mul_f32 v198, v198, v19
    v_mul_f32 v199, v199, v19
    v_mul_f32 v200, v200, v18
    v_mul_f32 v201, v201, v18
    v_mul_f32 v202, v202, v18
    v_mul_f32 v203, v203, v18
    v_mul_f32 v204, v204, v19
    v_mul_f32 v205, v205, v19
    v_mul_f32 v206, v206, v19
    v_mul_f32 v207, v207, v19
    v_mul_f32 v208, v208, v18
    v_mul_f32 v209, v209, v18
    v_mul_f32 v210, v210, v18
    v_mul_f32 v211, v211, v18
    v_mul_f32 v212, v212, v19
    v_mul_f32 v213, v213, v19
    v_mul_f32 v214, v214, v19
    v_mul_f32 v215, v215, v19
    v_mul_f32 v216, v216, v18
    v_mul_f32 v217, v217, v18
    v_mul_f32 v218, v218, v18
    v_mul_f32 v219, v219, v18
    v_mul_f32 v220, v220, v19
    v_mul_f32 v221, v221, v19
    v_mul_f32 v222, v222, v19
    v_mul_f32 v223, v223, v19
    v_mul_f32 v224, v224, v18
    v_mul_f32 v225, v225, v18
    v_mul_f32 v226, v226, v18
    v_mul_f32 v227, v227, v18
    v_mul_f32 v228, v228, v19
    v_mul_f32 v229, v229, v19
    v_mul_f32 v230, v230, v19
    v_mul_f32 v231, v231, v19
    v_mul_f32 v232, v232, v18
    v_mul_f32 v233, v233, v18
    v_mul_f32 v234, v234, v18
    v_mul_f32 v235, v235, v18
    v_mul_f32 v236, v236, v19
    v_mul_f32 v237, v237, v19
    v_mul_f32 v238, v238, v19
    v_mul_f32 v239, v239, v19
    v_mul_f32 v240, v240, v18
    v_mul_f32 v241, v241, v18
    v_mul_f32 v242, v242, v18
    v_mul_f32 v243, v243, v18
    v_mul_f32 v244, v244, v19
    v_mul_f32 v245, v245, v19
    v_mul_f32 v246, v246, v19
    v_mul_f32 v247, v247, v19
    v_mul_f32 v248, v248, v18
    v_mul_f32 v249, v249, v18
    v_mul_f32 v250, v250, v18
    v_mul_f32 v251, v251, v18
    v_mul_f32 v252, v252, v19
    v_mul_f32 v253, v253, v19
    v_mul_f32 v254, v254, v19
    v_mul_f32 v255, v255, v19
    v_mul_f32 v62, v62, v18
    v_mul_f32 v62, v62, v18
    v_sub_f32 v80, v80, v16
    v_sub_f32 v81, v81, v16
    v_sub_f32 v82, v82, v16
    v_sub_f32 v83, v83, v16
    v_sub_f32 v112, v112, v16
    v_sub_f32 v96, v96, v16
    v_sub_f32 v113, v113, v16
    v_sub_f32 v97, v97, v16
    v_sub_f32 v114, v114, v16
    v_sub_f32 v98, v98, v16
    v_sub_f32 v115, v115, v16
    v_sub_f32 v99, v99, v16
    v_sub_f32 v120, v120, v16
    v_sub_f32 v104, v104, v16
    v_sub_f32 v121, v121, v16
    v_sub_f32 v105, v105, v16
    v_sub_f32 v122, v122, v16
    v_sub_f32 v106, v106, v16
    v_sub_f32 v123, v123, v16
    v_sub_f32 v107, v107, v16
    v_mul_f32 v63, v63, v19
    v_mul_f32 v63, v63, v19
    v_sub_f32 v84, v84, v17
    v_sub_f32 v85, v85, v17
    v_sub_f32 v86, v86, v17
    v_sub_f32 v87, v87, v17
    v_sub_f32 v116, v116, v17
    v_sub_f32 v100, v100, v17
    v_sub_f32 v117, v117, v17
    v_sub_f32 v101, v101, v17
    v_sub_f32 v118, v118, v17
    v_sub_f32 v102, v102, v17
    v_sub_f32 v119, v119, v17
    v_sub_f32 v103, v103, v17
    v_sub_f32 v124, v124, v17
    v_sub_f32 v108, v108, v17
    v_sub_f32 v125, v125, v17
    v_sub_f32 v109, v109, v17
    v_sub_f32 v126, v126, v17
    v_sub_f32 v110, v110, v17
    v_sub_f32 v127, v127, v17
    v_sub_f32 v111, v111, v17
    v_exp_f32 v56, v96
    v_exp_f32 v57, v97
    v_exp_f32 v58, v98
    v_exp_f32 v59, v99
    v_add_f32 v60, v62, v56
    v_add_f32 v60, v60, v57
    v_cvt_pk_bf16_f32 v64, v56, v57
    v_exp_f32 v56, v100
    v_exp_f32 v57, v101
    v_add_f32 v60, v60, v58
    v_add_f32 v60, v60, v59
    v_cvt_pk_bf16_f32 v65, v58, v59
    v_exp_f32 v58, v102
    v_exp_f32 v59, v103
    v_add_f32 v61, v63, v56
    v_add_f32 v61, v61, v57
    v_cvt_pk_bf16_f32 v68, v56, v57
    v_exp_f32 v56, v104
    v_exp_f32 v57, v105
    v_add_f32 v61, v61, v58
    v_add_f32 v61, v61, v59
    v_cvt_pk_bf16_f32 v69, v58, v59
    v_exp_f32 v58, v106
    v_exp_f32 v59, v107
    v_add_f32 v60, v60, v56
    v_add_f32 v60, v60, v57
    v_cvt_pk_bf16_f32 v66, v56, v57
    v_exp_f32 v56, v108
    v_exp_f32 v57, v109
    v_add_f32 v60, v60, v58
    v_add_f32 v60, v60, v59
    v_cvt_pk_bf16_f32 v67, v58, v59
    v_exp_f32 v58, v110
    v_exp_f32 v59, v111
    v_add_f32 v61, v61, v56
    v_add_f32 v61, v61, v57
    v_cvt_pk_bf16_f32 v70, v56, v57
    v_add_f32 v61, v61, v58
    v_add_f32 v61, v61, v59
    v_cvt_pk_bf16_f32 v71, v58, v59
    s_nop 1
    s_branch CONT_M3
RARE_F0:
    s_nop 15
    s_nop 15
    v_max3_f32 v16, v112, v113, v114
    v_max3_f32 v16, v16, v115, v120
    v_max3_f32 v16, v16, v121, v122
    v_max_f32 v16, v16, v123
    v_mov_b32 v20, v16
    s_nop 1
    v_permlane16_swap_b32 v16, v20
    s_nop 1
    v_max_f32 v16, v16, v20
    v_mov_b32 v20, v16
    s_nop 1
    v_permlane32_swap_b32 v16, v20
    s_nop 1
    v_max_f32 v16, v16, v20
    v_mov_b32 v21, v60
    v_mov_b32 v20, v21
    s_nop 1
    v_permlane16_swap_b32 v21, v20
    s_nop 1
    v_add_f32 v21, v21, v20
    v_mov_b32 v20, v21
    s_nop 1
    v_permlane32_swap_b32 v21, v20
    s_nop 1
    v_add_f32 v21, v21, v20
    v_log_f32 v21, v21
    s_nop 0
    v_max_f32 v16, v16, v21
    v_add_f32 v16, 0x42b60000, v16
    v_max_f32 v16, 0, v16
    v_mul_f32 v18, -0.5, v16
    v_exp_f32 v18, v18
    s_nop 0
    v_max3_f32 v17, v116, v117, v118
    v_max3_f32 v17, v17, v119, v124
    v_max3_f32 v17, v17, v125, v126
    v_max_f32 v17, v17, v127
    v_mov_b32 v20, v17
    s_nop 1
    v_permlane16_swap_b32 v17, v20
    s_nop 1
    v_max_f32 v17, v17, v20
    v_mov_b32 v20, v17
    s_nop 1
    v_permlane32_swap_b32 v17, v20
    s_nop 1
    v_max_f32 v17, v17, v20
    v_mov_b32 v21, v61
    v_mov_b32 v20, v21
    s_nop 1
    v_permlane16_swap_b32 v21, v20
    s_nop 1
    v_add_f32 v21, v21, v20
    v_mov_b32 v20, v21
    s_nop 1
    v_permlane32_swap_b32 v21, v20
    s_nop 1
    v_add_f32 v21, v21, v20
    v_log_f32 v21, v21
    s_nop 0
    v_max_f32 v17, v17, v21
    v_add_f32 v17, 0x42b60000, v17
    v_max_f32 v17, 0, v17
    v_mul_f32 v19, -0.5, v17
    v_exp_f32 v19, v19
    s_nop 0
    v_mul_f32 v128, v128, v18
    v_mul_f32 v129, v129, v18
    v_mul_f32 v130, v130, v18
    v_mul_f32 v131, v131, v18
    v_mul_f32 v132, v132, v19
    v_mul_f32 v133, v133, v19
    v_mul_f32 v134, v134, v19
    v_mul_f32 v135, v135, v19
    v_mul_f32 v136, v136, v18
    v_mul_f32 v137, v137, v18
    v_mul_f32 v138, v138, v18
    v_mul_f32 v139, v139, v18
    v_mul_f32 v140, v140, v19
    v_mul_f32 v141, v141, v19
    v_mul_f32 v142, v142, v19
    v_mul_f32 v143, v143, v19
    v_mul_f32 v144, v144, v18
    v_mul_f32 v145, v145, v18
    v_mul_f32 v146, v146, v18
    v_mul_f32 v147, v147, v18
    v_mul_f32 v148, v148, v19
    v_mul_f32 v149, v149, v19
    v_mul_f32 v150, v150, v19
    v_mul_f32 v151, v151, v19
    v_mul_f32 v152, v152, v18
    v_mul_f32 v153, v153, v18
    v_mul_f32 v154, v154, v18
    v_mul_f32 v155, v155, v18
    v_mul_f32 v156, v156, v19
    v_mul_f32 v157, v157, v19
    v_mul_f32 v158, v158, v19
    v_mul_f32 v159, v159, v19
    v_mul_f32 v160, v160, v18
    v_mul_f32 v161, v161, v18
    v_mul_f32 v162, v162, v18
    v_mul_f32 v163, v163, v18
    v_mul_f32 v164, v164, v19
    v_mul_f32 v165, v165, v19
    v_mul_f32 v166, v166, v19
    v_mul_f32 v167, v167, v19
    v_mul_f32 v168, v168, v18
    v_mul_f32 v169, v169, v18
    v_mul_f32 v170, v170, v18
    v_mul_f32 v171, v171, v18
    v_mul_f32 v172, v172, v19
    v_mul_f32 v173, v173, v19
    v_mul_f32 v174, v174, v19
    v_mul_f32 v175, v175, v19
    v_mul_f32 v176, v176, v18
    v_mul_f32 v177, v177, v18
    v_mul_f32 v178, v178, v18
    v_mul_f32 v179, v179, v18
    v_mul_f32 v180, v180, v19
    v_mul_f32 v181, v181, v19
    v_mul_f32 v182, v182, v19
    v_mul_f32 v183, v183, v19
    v_mul_f32 v184, v184, v18
    v_mul_f32 v185, v185, v18
    v_mul_f32 v186, v186, v18
    v_mul_f32 v187, v187, v18
    v_mul_f32 v188, v188, v19
    v_mul_f32 v189, v189, v19
    v_mul_f32 v190, v190, v19
    v_mul_f32 v191, v191, v19
    v_mul_f32 v192, v192, v18
    v_mul_f32 v193, v193, v18
    v_mul_f32 v194, v194, v18
    v_mul_f32 v195, v195, v18
    v_mul_f32 v196, v196, v19
    v_mul_f32 v197, v197, v19
    v_mul_f32 v198, v198, v19
    v_mul_f32 v199, v199, v19
    v_mul_f32 v200, v200, v18
    v_mul_f32 v201, v201, v18
    v_mul_f32 v202, v202, v18
    v_mul_f32 v203, v203, v18
    v_mul_f32 v204, v204, v19
    v_mul_f32 v205, v205, v19
    v_mul_f32 v206, v206, v19
    v_mul_f32 v207, v207, v19
    v_mul_f32 v208, v208, v18
    v_mul_f32 v209, v209, v18
    v_mul_f32 v210, v210, v18
    v_mul_f32 v211, v211, v18
    v_mul_f32 v212, v212, v19
    v_mul_f32 v213, v213, v19
    v_mul_f32 v214, v214, v19
    v_mul_f32 v215, v215, v19
    v_mul_f32 v216, v216, v18
    v_mul_f32 v217, v217, v18
    v_mul_f32 v218, v218, v18
    v_mul_f32 v219, v219, v18
    v_mul_f32 v220, v220, v19
    v_mul_f32 v221, v221, v19
    v_mul_f32 v222, v222, v19
    v_mul_f32 v223, v223, v19
    v_mul_f32 v224, v224, v18
    v_mul_f32 v225, v225, v18
    v_mul_f32 v226, v226, v18
    v_mul_f32 v227, v227, v18
    v_mul_f32 v228, v228, v19
    v_mul_f32 v229, v229, v19
    v_mul_f32 v230, v230, v19
    v_mul_f32 v231, v231, v19
    v_mul_f32 v232, v232, v18
    v_mul_f32 v233, v233, v18
    v_mul_f32 v234, v234, v18
    v_mul_f32 v235, v235, v18
    v_mul_f32 v236, v236, v19
    v_mul_f32 v237, v237, v19
    v_mul_f32 v238, v238, v19
    v_mul_f32 v239, v239, v19
    v_mul_f32 v240, v240, v18
    v_mul_f32 v241, v241, v18
    v_mul_f32 v242, v242, v18
    v_mul_f32 v243, v243, v18
    v_mul_f32 v244, v244, v19
    v_mul_f32 v245, v245, v19
    v_mul_f32 v246, v246, v19
    v_mul_f32 v247, v247, v19
    v_mul_f32 v248, v248, v18
    v_mul_f32 v249, v249, v18
    v_mul_f32 v250, v250, v18
    v_mul_f32 v251, v251, v18
    v_mul_f32 v252, v252, v19
    v_mul_f32 v253, v253, v19
    v_mul_f32 v254, v254, v19
    v_mul_f32 v255, v255, v19
    v_mul_f32 v128, v128, v18
    v_mul_f32 v129, v129, v18
    v_mul_f32 v130, v130, v18
    v_mul_f32 v131, v131, v18
    v_mul_f32 v132, v132, v19
    v_mul_f32 v133, v133, v19
    v_mul_f32 v134, v134, v19
    v_mul_f32 v135, v135, v19
    v_mul_f32 v136, v136, v18
    v_mul_f32 v137, v137, v18
    v_mul_f32 v138, v138, v18
    v_mul_f32 v139, v139, v18
    v_mul_f32 v140, v140, v19
    v_mul_f32 v141, v141, v19
    v_mul_f32 v142, v142, v19
    v_mul_f32 v143, v143, v19
    v_mul_f32 v144, v144, v18
    v_mul_f32 v145, v145, v18
    v_mul_f32 v146, v146, v18
    v_mul_f32 v147, v147, v18
    v_mul_f32 v148, v148, v19
    v_mul_f32 v149, v149, v19
    v_mul_f32 v150, v150, v19
    v_mul_f32 v151, v151, v19
    v_mul_f32 v152, v152, v18
    v_mul_f32 v153, v153, v18
    v_mul_f32 v154, v154, v18
    v_mul_f32 v155, v155, v18
    v_mul_f32 v156, v156, v19
    v_mul_f32 v157, v157, v19
    v_mul_f32 v158, v158, v19
    v_mul_f32 v159, v159, v19
    v_mul_f32 v160, v160, v18
    v_mul_f32 v161, v161, v18
    v_mul_f32 v162, v162, v18
    v_mul_f32 v163, v163, v18
    v_mul_f32 v164, v164, v19
    v_mul_f32 v165, v165, v19
    v_mul_f32 v166, v166, v19
    v_mul_f32 v167, v167, v19
    v_mul_f32 v168, v168, v18
    v_mul_f32 v169, v169, v18
    v_mul_f32 v170, v170, v18
    v_mul_f32 v171, v171, v18
    v_mul_f32 v172, v172, v19
    v_mul_f32 v173, v173, v19
    v_mul_f32 v174, v174, v19
    v_mul_f32 v175, v175, v19
    v_mul_f32 v176, v176, v18
    v_mul_f32 v177, v177, v18
    v_mul_f32 v178, v178, v18
    v_mul_f32 v179, v179, v18
    v_mul_f32 v180, v180, v19
    v_mul_f32 v181, v181, v19
    v_mul_f32 v182, v182, v19
    v_mul_f32 v183, v183, v19
    v_mul_f32 v184, v184, v18
    v_mul_f32 v185, v185, v18
    v_mul_f32 v186, v186, v18
    v_mul_f32 v187, v187, v18
    v_mul_f32 v188, v188, v19
    v_mul_f32 v189, v189, v19
    v_mul_f32 v190, v190, v19
    v_mul_f32 v191, v191, v19
    v_mul_f32 v192, v192, v18
    v_mul_f32 v193, v193, v18
    v_mul_f32 v194, v194, v18
    v_mul_f32 v195, v195, v18
    v_mul_f32 v196, v196, v19
    v_mul_f32 v197, v197, v19
    v_mul_f32 v198, v198, v19
    v_mul_f32 v199, v199, v19
    v_mul_f32 v200, v200, v18
    v_mul_f32 v201, v201, v18
    v_mul_f32 v202, v202, v18
    v_mul_f32 v203, v203, v18
    v_mul_f32 v204, v204, v19
    v_mul_f32 v205, v205, v19
    v_mul_f32 v206, v206, v19
    v_mul_f32 v207, v207, v19
    v_mul_f32 v208, v208, v18
    v_mul_f32 v209, v209, v18
    v_mul_f32 v210, v210, v18
    v_mul_f32 v211, v211, v18
    v_mul_f32 v212, v212, v19
    v_mul_f32 v213, v213, v19
    v_mul_f32 v214, v214, v19
    v_mul_f32 v215, v215, v19
    v_mul_f32 v216, v216, v18
    v_mul_f32 v217, v217, v18
    v_mul_f32 v218, v218, v18
    v_mul_f32 v219, v219, v18
    v_mul_f32 v220, v220, v19
    v_mul_f32 v221, v221, v19
    v_mul_f32 v222, v222, v19
    v_mul_f32 v223, v223, v19
    v_mul_f32 v224, v224, v18
    v_mul_f32 v225, v225, v18
    v_mul_f32 v226, v226, v18
    v_mul_f32 v227, v227, v18
    v_mul_f32 v228, v228, v19
    v_mul_f32 v229, v229, v19
    v_mul_f32 v230, v230, v19
    v_mul_f32 v231, v231, v19
    v_mul_f32 v232, v232, v18
    v_mul_f32 v233, v233, v18
    v_mul_f32 v234, v234, v18
    v_mul_f32 v235, v235, v18
    v_mul_f32 v236, v236, v19
    v_mul_f32 v237, v237, v19
    v_mul_f32 v238, v238, v19
    v_mul_f32 v239, v239, v19
    v_mul_f32 v240, v240, v18
    v_mul_f32 v241, v241, v18
    v_mul_f32 v242, v242, v18
    v_mul_f32 v243, v243, v18
    v_mul_f32 v244, v244, v19
    v_mul_f32 v245, v245, v19
    v_mul_f32 v246, v246, v19
    v_mul_f32 v247, v247, v19
    v_mul_f32 v248, v248, v18
    v_mul_f32 v249, v249, v18
    v_mul_f32 v250, v250, v18
    v_mul_f32 v251, v251, v18
    v_mul_f32 v252, v252, v19
    v_mul_f32 v253, v253, v19
    v_mul_f32 v254, v254, v19
    v_mul_f32 v255, v255, v19
    v_mul_f32 v60, v60, v18
    v_mul_f32 v60, v60, v18
    v_sub_f32 v80, v80, v16
    v_sub_f32 v81, v81, v16
    v_sub_f32 v82, v82, v16
    v_sub_f32 v83, v83, v16
    v_sub_f32 v96, v96, v16
    v_sub_f32 v112, v112, v16
    v_sub_f32 v97, v97, v16
    v_sub_f32 v113, v113, v16
    v_sub_f32 v98, v98, v16
    v_sub_f32 v114, v114, v16
    v_sub_f32 v99, v99, v16
    v_sub_f32 v115, v115, v16
    v_sub_f32 v104, v104, v16
    v_sub_f32 v120, v120, v16
    v_sub_f32 v105, v105, v16
    v_sub_f32 v121, v121, v16
    v_sub_f32 v106, v106, v16
    v_sub_f32 v122, v122, v16
    v_sub_f32 v107, v107, v16
    v_sub_f32 v123, v123, v16
    v_mul_f32 v61, v61, v19
    v_mul_f32 v61, v61, v19
    v_sub_f32 v84, v84, v17
    v_sub_f32 v85, v85, v17
    v_sub_f32 v86, v86, v17
    v_sub_f32 v87, v87, v17
    v_sub_f32 v100, v100, v17
    v_sub_f32 v116, v116, v17
    v_sub_f32 v101, v101, v17
    v_sub_f32 v117, v117, v17
    v_sub_f32 v102, v102, v17
    v_sub_f32 v118, v118, v17
    v_sub_f32 v103, v103, v17
    v_sub_f32 v119, v119, v17
    v_sub_f32 v108, v108, v17
    v_sub_f32 v124, v124, v17
    v_sub_f32 v109, v109, v17
    v_sub_f32 v125, v125, v17
    v_sub_f32 v110, v110, v17
    v_sub_f32 v126, v126, v17
    v_sub_f32 v111, v111, v17
    v_sub_f32 v127, v127, v17
    v_exp_f32 v56, v112
    v_exp_f32 v57, v113
    v_exp_f32 v58, v114
    v_exp_f32 v59, v115
    v_add_f32 v62, v60, v56
    v_add_f32 v62, v62, v57
    v_cvt_pk_bf16_f32 v72, v56, v57
    v_exp_f32 v56, v116
    v_exp_f32 v57, v117
    v_add_f32 v62, v62, v58
    v_add_f32 v62, v62, v59
    v_cvt_pk_bf16_f32 v73, v58, v59
    v_exp_f32 v58, v118
    v_exp_f32 v59, v119
    v_add_f32 v63, v61, v56
    v_add_f32 v63, v63, v57
    v_cvt_pk_bf16_f32 v76, v56, v57
    v_exp_f32 v56, v120
    v_exp_f32 v57, v121
    v_add_f32 v63, v63, v58
    v_add_f32 v63, v63, v59
    v_cvt_pk_bf16_f32 v77, v58, v59
    v_exp_f32 v58, v122
    v_exp_f32 v59, v123
    v_add_f32 v62, v62, v56
    v_add_f32 v62, v62, v57
    v_cvt_pk_bf16_f32 v74, v56, v57
    v_exp_f32 v56, v124
    v_exp_f32 v57, v125
    v_add_f32 v62, v62, v58
    v_add_f32 v62, v62, v59
    v_cvt_pk_bf16_f32 v75, v58, v59
    v_exp_f32 v58, v126
    v_exp_f32 v59, v127
    v_add_f32 v63, v63, v56
    v_add_f32 v63, v63, v57
    v_cvt_pk_bf16_f32 v78, v56, v57
    v_add_f32 v63, v63, v58
    v_add_f32 v63, v63, v59
    v_cvt_pk_bf16_f32 v79, v58, v59
    s_nop 1
    s_branch CONT_F0
RARE_F1:
    s_nop 15
    s_nop 15
    v_max3_f32 v16, v96, v97, v98
    v_max3_f32 v16, v16, v99, v104
    v_max3_f32 v16, v16, v105, v106
    v_max_f32 v16, v16, v107
    v_mov_b32 v20, v16
    s_nop 1
    v_permlane16_swap_b32 v16, v20
    s_nop 1
    v_max_f32 v16, v16, v20
    v_mov_b32 v20, v16
    s_nop 1
    v_permlane32_swap_b32 v16, v20
    s_nop 1
    v_max_f32 v16, v16, v20
    v_mov_b32 v21, v62
    v_mov_b32 v20, v21
    s_nop 1
    v_permlane16_swap_b32 v21, v20
    s_nop 1
    v_add_f32 v21, v21, v20
    v_mov_b32 v20, v21
    s_nop 1
    v_permlane32_swap_b32 v21, v20
    s_nop 1
    v_add_f32 v21, v21, v20
    v_log_f32 v21, v21
    s_nop 0
    v_max_f32 v16, v16, v21
    v_add_f32 v16, 0x42b60000, v16
    v_max_f32 v16, 0, v16
    v_mul_f32 v18, -0.5, v16
    v_exp_f32 v18, v18
    s_nop 0
    v_max3_f32 v17, v100, v101, v102
    v_max3_f32 v17, v17, v103, v108
    v_max3_f32 v17, v17, v109, v110
    v_max_f32 v17, v17, v111
    v_mov_b32 v20, v17
    s_nop 1
    v_permlane16_swap_b32 v17, v20
    s_nop 1
    v_max_f32 v17, v17, v20
    v_mov_b32 v20, v17
    s_nop 1
    v_permlane32_swap_b32 v17, v20
    s_nop 1
    v_max_f32 v17, v17, v20
    v_mov_b32 v21, v63
    v_mov_b32 v20, v21
    s_nop 1
    v_permlane16_swap_b32 v21, v20
    s_nop 1
    v_add_f32 v21, v21, v20
    v_mov_b32 v20, v21
    s_nop 1
    v_permlane32_swap_b32 v21, v20
    s_nop 1
    v_add_f32 v21, v21, v20
    v_log_f32 v21, v21
    s_nop 0
    v_max_f32 v17, v17, v21
    v_add_f32 v17, 0x42b60000, v17
    v_max_f32 v17, 0, v17
    v_mul_f32 v19, -0.5, v17
    v_exp_f32 v19, v19
    s_nop 0
    v_mul_f32 v128, v128, v18
    v_mul_f32 v129, v129, v18
    v_mul_f32 v130, v130, v18
    v_mul_f32 v131, v131, v18
    v_mul_f32 v132, v132, v19
    v_mul_f32 v133, v133, v19
    v_mul_f32 v134, v134, v19
    v_mul_f32 v135, v135, v19
    v_mul_f32 v136, v136, v18
    v_mul_f32 v137, v137, v18
    v_mul_f32 v138, v138, v18
    v_mul_f32 v139, v139, v18
    v_mul_f32 v140, v140, v19
    v_mul_f32 v141, v141, v19
    v_mul_f32 v142, v142, v19
    v_mul_f32 v143, v143, v19
    v_mul_f32 v144, v144, v18
    v_mul_f32 v145, v145, v18
    v_mul_f32 v146, v146, v18
    v_mul_f32 v147, v147, v18
    v_mul_f32 v148, v148, v19
    v_mul_f32 v149, v149, v19
    v_mul_f32 v150, v150, v19
    v_mul_f32 v151, v151, v19
    v_mul_f32 v152, v152, v18
    v_mul_f32 v153, v153, v18
    v_mul_f32 v154, v154, v18
    v_mul_f32 v155, v155, v18
    v_mul_f32 v156, v156, v19
    v_mul_f32 v157, v157, v19
    v_mul_f32 v158, v158, v19
    v_mul_f32 v159, v159, v19
    v_mul_f32 v160, v160, v18
    v_mul_f32 v161, v161, v18
    v_mul_f32 v162, v162, v18
    v_mul_f32 v163, v163, v18
    v_mul_f32 v164, v164, v19
    v_mul_f32 v165, v165, v19
    v_mul_f32 v166, v166, v19
    v_mul_f32 v167, v167, v19
    v_mul_f32 v168, v168, v18
    v_mul_f32 v169, v169, v18
    v_mul_f32 v170, v170, v18
    v_mul_f32 v171, v171, v18
    v_mul_f32 v172, v172, v19
    v_mul_f32 v173, v173, v19
    v_mul_f32 v174, v174, v19
    v_mul_f32 v175, v175, v19
    v_mul_f32 v176, v176, v18
    v_mul_f32 v177, v177, v18
    v_mul_f32 v178, v178, v18
    v_mul_f32 v179, v179, v18
    v_mul_f32 v180, v180, v19
    v_mul_f32 v181, v181, v19
    v_mul_f32 v182, v182, v19
    v_mul_f32 v183, v183, v19
    v_mul_f32 v184, v184, v18
    v_mul_f32 v185, v185, v18
    v_mul_f32 v186, v186, v18
    v_mul_f32 v187, v187, v18
    v_mul_f32 v188, v188, v19
    v_mul_f32 v189, v189, v19
    v_mul_f32 v190, v190, v19
    v_mul_f32 v191, v191, v19
    v_mul_f32 v192, v192, v18
    v_mul_f32 v193, v193, v18
    v_mul_f32 v194, v194, v18
    v_mul_f32 v195, v195, v18
    v_mul_f32 v196, v196, v19
    v_mul_f32 v197, v197, v19
    v_mul_f32 v198, v198, v19
    v_mul_f32 v199, v199, v19
    v_mul_f32 v200, v200, v18
    v_mul_f32 v201, v201, v18
    v_mul_f32 v202, v202, v18
    v_mul_f32 v203, v203, v18
    v_mul_f32 v204, v204, v19
    v_mul_f32 v205, v205, v19
    v_mul_f32 v206, v206, v19
    v_mul_f32 v207, v207, v19
    v_mul_f32 v208, v208, v18
    v_mul_f32 v209, v209, v18
    v_mul_f32 v210, v210, v18
    v_mul_f32 v211, v211, v18
    v_mul_f32 v212, v212, v19
    v_mul_f32 v213, v213, v19
    v_mul_f32 v214, v214, v19
    v_mul_f32 v215, v215, v19
    v_mul_f32 v216, v216, v18
    v_mul_f32 v217, v217, v18
    v_mul_f32 v218, v218, v18
    v_mul_f32 v219, v219, v18
    v_mul_f32 v220, v220, v19
    v_mul_f32 v221, v221, v19
    v_mul_f32 v222, v222, v19
    v_mul_f32 v223, v223, v19
    v_mul_f32 v224, v224, v18
    v_mul_f32 v225, v225, v18
    v_mul_f32 v226, v226, v18
    v_mul_f32 v227, v227, v18
    v_mul_f32 v228, v228, v19
    v_mul_f32 v229, v229, v19
    v_mul_f32 v230, v230, v19
    v_mul_f32 v231, v231, v19
    v_mul_f32 v232, v232, v18
    v_mul_f32 v233, v233, v18
    v_mul_f32 v234, v234, v18
    v_mul_f32 v235, v235, v18
    v_mul_f32 v236, v236, v19
    v_mul_f32 v237, v237, v19
    v_mul_f32 v238, v238, v19
    v_mul_f32 v239, v239, v19
    v_mul_f32 v240, v240, v18
    v_mul_f32 v241, v241, v18
    v_mul_f32 v242, v242, v18
    v_mul_f32 v243, v243, v18
    v_mul_f32 v244, v244, v19
    v_mul_f32 v245, v245, v19
    v_mul_f32 v246, v246, v19
    v_mul_f32 v247, v247, v19
    v_mul_f32 v248, v248, v18
    v_mul_f32 v249, v249, v18
    v_mul_f32 v250, v250, v18
    v_mul_f32 v251, v251, v18
    v_mul_f32 v252, v252, v19
    v_mul_f32 v253, v253, v19
    v_mul_f32 v254, v254, v19
    v_mul_f32 v255, v255, v19
    v_mul_f32 v128, v128, v18
    v_mul_f32 v129, v129, v18
    v_mul_f32 v130, v130, v18
    v_mul_f32 v131, v131, v18
    v_mul_f32 v132, v132, v19
    v_mul_f32 v133, v133, v19
    v_mul_f32 v134, v134, v19
    v_mul_f32 v135, v135, v19
    v_mul_f32 v136, v136, v18
    v_mul_f32 v137, v137, v18
    v_mul_f32 v138, v138, v18
    v_mul_f32 v139, v139, v18
    v_mul_f32 v140, v140, v19
    v_mul_f32 v141, v141, v19
    v_mul_f32 v142, v142, v19
    v_mul_f32 v143, v143, v19
    v_mul_f32 v144, v144, v18
    v_mul_f32 v145, v145, v18
    v_mul_f32 v146, v146, v18
    v_mul_f32 v147, v147, v18
    v_mul_f32 v148, v148, v19
    v_mul_f32 v149, v149, v19
    v_mul_f32 v150, v150, v19
    v_mul_f32 v151, v151, v19
    v_mul_f32 v152, v152, v18
    v_mul_f32 v153, v153, v18
    v_mul_f32 v154, v154, v18
    v_mul_f32 v155, v155, v18
    v_mul_f32 v156, v156, v19
    v_mul_f32 v157, v157, v19
    v_mul_f32 v158, v158, v19
    v_mul_f32 v159, v159, v19
    v_mul_f32 v160, v160, v18
    v_mul_f32 v161, v161, v18
    v_mul_f32 v162, v162, v18
    v_mul_f32 v163, v163, v18
    v_mul_f32 v164, v164, v19
    v_mul_f32 v165, v165, v19
    v_mul_f32 v166, v166, v19
    v_mul_f32 v167, v167, v19
    v_mul_f32 v168, v168, v18
    v_mul_f32 v169, v169, v18
    v_mul_f32 v170, v170, v18
    v_mul_f32 v171, v171, v18
    v_mul_f32 v172, v172, v19
    v_mul_f32 v173, v173, v19
    v_mul_f32 v174, v174, v19
    v_mul_f32 v175, v175, v19
    v_mul_f32 v176, v176, v18
    v_mul_f32 v177, v177, v18
    v_mul_f32 v178, v178, v18
    v_mul_f32 v179, v179, v18
    v_mul_f32 v180, v180, v19
    v_mul_f32 v181, v181, v19
    v_mul_f32 v182, v182, v19
    v_mul_f32 v183, v183, v19
    v_mul_f32 v184, v184, v18
    v_mul_f32 v185, v185, v18
    v_mul_f32 v186, v186, v18
    v_mul_f32 v187, v187, v18
    v_mul_f32 v188, v188, v19
    v_mul_f32 v189, v189, v19
    v_mul_f32 v190, v190, v19
    v_mul_f32 v191, v191, v19
    v_mul_f32 v192, v192, v18
    v_mul_f32 v193, v193, v18
    v_mul_f32 v194, v194, v18
    v_mul_f32 v195, v195, v18
    v_mul_f32 v196, v196, v19
    v_mul_f32 v197, v197, v19
    v_mul_f32 v198, v198, v19
    v_mul_f32 v199, v199, v19
    v_mul_f32 v200, v200, v18
    v_mul_f32 v201, v201, v18
    v_mul_f32 v202, v202, v18
    v_mul_f32 v203, v203, v18
    v_mul_f32 v204, v204, v19
    v_mul_f32 v205, v205, v19
    v_mul_f32 v206, v206, v19
    v_mul_f32 v207, v207, v19
    v_mul_f32 v208, v208, v18
    v_mul_f32 v209, v209, v18
    v_mul_f32 v210, v210, v18
    v_mul_f32 v211, v211, v18
    v_mul_f32 v212, v212, v19
    v_mul_f32 v213, v213, v19
    v_mul_f32 v214, v214, v19
    v_mul_f32 v215, v215, v19
    v_mul_f32 v216, v216, v18
    v_mul_f32 v217, v217, v18
    v_mul_f32 v218, v218, v18
    v_mul_f32 v219, v219, v18
    v_mul_f32 v220, v220, v19
    v_mul_f32 v221, v221, v19
    v_mul_f32 v222, v222, v19
    v_mul_f32 v223, v223, v19
    v_mul_f32 v224, v224, v18
    v_mul_f32 v225, v225, v18
    v_mul_f32 v226, v226, v18
    v_mul_f32 v227, v227, v18
    v_mul_f32 v228, v228, v19
    v_mul_f32 v229, v229, v19
    v_mul_f32 v230, v230, v19
    v_mul_f32 v231, v231, v19
    v_mul_f32 v232, v232, v18
    v_mul_f32 v233, v233, v18
    v_mul_f32 v234, v234, v18
    v_mul_f32 v235, v235, v18
    v_mul_f32 v236, v236, v19
    v_mul_f32 v237, v237, v19
    v_mul_f32 v238, v238, v19
    v_mul_f32 v239, v239, v19
    v_mul_f32 v240, v240, v18
    v_mul_f32 v241, v241, v18
    v_mul_f32 v242, v242, v18
    v_mul_f32 v243, v243, v18
    v_mul_f32 v244, v244, v19
    v_mul_f32 v245, v245, v19
    v_mul_f32 v246, v246, v19
    v_mul_f32 v247, v247, v19
    v_mul_f32 v248, v248, v18
    v_mul_f32 v249, v249, v18
    v_mul_f32 v250, v250, v18
    v_mul_f32 v251, v251, v18
    v_mul_f32 v252, v252, v19
    v_mul_f32 v253, v253, v19
    v_mul_f32 v254, v254, v19
    v_mul_f32 v255, v255, v19
    v_mul_f32 v62, v62, v18
    v_mul_f32 v62, v62, v18
    v_sub_f32 v80, v80, v16
    v_sub_f32 v81, v81, v16
    v_sub_f32 v82, v82, v16
    v_sub_f32 v83, v83, v16
    v_sub_f32 v112, v112, v16
    v_sub_f32 v96, v96, v16
    v_sub_f32 v113, v113, v16
    v_sub_f32 v97, v97, v16
    v_sub_f32 v114, v114, v16
    v_sub_f32 v98, v98, v16
    v_sub_f32 v115, v115, v16
    v_sub_f32 v99, v99, v16
    v_sub_f32 v120, v120, v16
    v_sub_f32 v104, v104, v16
    v_sub_f32 v121, v121, v16
    v_sub_f32 v105, v105, v16
    v_sub_f32 v122, v122, v16
    v_sub_f32 v106, v106, v16
    v_sub_f32 v123, v123, v16
    v_sub_f32 v107, v107, v16
    v_mul_f32 v63, v63, v19
    v_mul_f32 v63, v63, v19
    v_sub_f32 v84, v84, v17
    v_sub_f32 v85, v85, v17
    v_sub_f32 v86, v86, v17
    v_sub_f32 v87, v87, v17
    v_sub_f32 v116, v116, v17
    v_sub_f32 v100, v100, v17
    v_sub_f32 v117, v117, v17
    v_sub_f32 v101, v101, v17
    v_sub_f32 v118, v118, v17
    v_sub_f32 v102, v102, v17
    v_sub_f32 v119, v119, v17
    v_sub_f32 v103, v103, v17
    v_sub_f32 v124, v124, v17
    v_sub_f32 v108, v108, v17
    v_sub_f32 v125, v125, v17
    v_sub_f32 v109, v109, v17
    v_sub_f32 v126, v126, v17
    v_sub_f32 v110, v110, v17
    v_sub_f32 v127, v127, v17
    v_sub_f32 v111, v111, v17
    v_exp_f32 v56, v96
    v_exp_f32 v57, v97
    v_exp_f32 v58, v98
    v_exp_f32 v59, v99
    v_add_f32 v60, v62, v56
    v_add_f32 v60, v60, v57
    v_cvt_pk_bf16_f32 v64, v56, v57
    v_exp_f32 v56, v100
    v_exp_f32 v57, v101
    v_add_f32 v60, v60, v58
    v_add_f32 v60, v60, v59
    v_cvt_pk_bf16_f32 v65, v58, v59
    v_exp_f32 v58, v102
    v_exp_f32 v59, v103
    v_add_f32 v61, v63, v56
    v_add_f32 v61, v61, v57
    v_cvt_pk_bf16_f32 v68, v56, v57
    v_exp_f32 v56, v104
    v_exp_f32 v57, v105
    v_add_f32 v61, v61, v58
    v_add_f32 v61, v61, v59
    v_cvt_pk_bf16_f32 v69, v58, v59
    v_exp_f32 v58, v106
    v_exp_f32 v59, v107
    v_add_f32 v60, v60, v56
    v_add_f32 v60, v60, v57
    v_cvt_pk_bf16_f32 v66, v56, v57
    v_exp_f32 v56, v108
    v_exp_f32 v57, v109
    v_add_f32 v60, v60, v58
    v_add_f32 v60, v60, v59
    v_cvt_pk_bf16_f32 v67, v58, v59
    v_exp_f32 v58, v110
    v_exp_f32 v59, v111
    v_add_f32 v61, v61, v56
    v_add_f32 v61, v61, v57
    v_cvt_pk_bf16_f32 v70, v56, v57
    v_add_f32 v61, v61, v58
    v_add_f32 v61, v61, v59
    v_cvt_pk_bf16_f32 v71, v58, v59
    s_nop 1
    s_branch CONT_F1
RARE_F2:
    s_nop 15
    s_nop 15
    v_max3_f32 v16, v112, v113, v114
    v_max3_f32 v16, v16, v115, v120
    v_max3_f32 v16, v16, v121, v122
    v_max_f32 v16, v16, v123
    v_mov_b32 v20, v16
    s_nop 1
    v_permlane16_swap_b32 v16, v20
    s_nop 1
    v_max_f32 v16, v16, v20
    v_mov_b32 v20, v16
    s_nop 1
    v_permlane32_swap_b32 v16, v20
    s_nop 1
    v_max_f32 v16, v16, v20
    v_mov_b32 v21, v60
    v_mov_b32 v20, v21
    s_nop 1
    v_permlane16_swap_b32 v21, v20
    s_nop 1
    v_add_f32 v21, v21, v20
    v_mov_b32 v20, v21
    s_nop 1
    v_permlane32_swap_b32 v21, v20
    s_nop 1
    v_add_f32 v21, v21, v20
    v_log_f32 v21, v21
    s_nop 0
    v_max_f32 v16, v16, v21
    v_add_f32 v16, 0x42b60000, v16
    v_max_f32 v16, 0, v16
    v_mul_f32 v18, -0.5, v16
    v_exp_f32 v18, v18
    s_nop 0
    v_max3_f32 v17, v116, v117, v118
    v_max3_f32 v17, v17, v119, v124
    v_max3_f32 v17, v17, v125, v126
    v_max_f32 v17, v17, v127
    v_mov_b32 v20, v17
    s_nop 1
    v_permlane16_swap_b32 v17, v20
    s_nop 1
    v_max_f32 v17, v17, v20
    v_mov_b32 v20, v17
    s_nop 1
    v_permlane32_swap_b32 v17, v20
    s_nop 1
    v_max_f32 v17, v17, v20
    v_mov_b32 v21, v61
    v_mov_b32 v20, v21
    s_nop 1
    v_permlane16_swap_b32 v21, v20
    s_nop 1
    v_add_f32 v21, v21, v20
    v_mov_b32 v20, v21
    s_nop 1
    v_permlane32_swap_b32 v21, v20
    s_nop 1
    v_add_f32 v21, v21, v20
    v_log_f32 v21, v21
    s_nop 0
    v_max_f32 v17, v17, v21
    v_add_f32 v17, 0x42b60000, v17
    v_max_f32 v17, 0, v17
    v_mul_f32 v19, -0.5, v17
    v_exp_f32 v19, v19
    s_nop 0
    v_mul_f32 v128, v128, v18
    v_mul_f32 v129, v129, v18
    v_mul_f32 v130, v130, v18
    v_mul_f32 v131, v131, v18
    v_mul_f32 v132, v132, v19
    v_mul_f32 v133, v133, v19
    v_mul_f32 v134, v134, v19
    v_mul_f32 v135, v135, v19
    v_mul_f32 v136, v136, v18
    v_mul_f32 v137, v137, v18
    v_mul_f32 v138, v138, v18
    v_mul_f32 v139, v139, v18
    v_mul_f32 v140, v140, v19
    v_mul_f32 v141, v141, v19
    v_mul_f32 v142, v142, v19
    v_mul_f32 v143, v143, v19
    v_mul_f32 v144, v144, v18
    v_mul_f32 v145, v145, v18
    v_mul_f32 v146, v146, v18
    v_mul_f32 v147, v147, v18
    v_mul_f32 v148, v148, v19
    v_mul_f32 v149, v149, v19
    v_mul_f32 v150, v150, v19
    v_mul_f32 v151, v151, v19
    v_mul_f32 v152, v152, v18
    v_mul_f32 v153, v153, v18
    v_mul_f32 v154, v154, v18
    v_mul_f32 v155, v155, v18
    v_mul_f32 v156, v156, v19
    v_mul_f32 v157, v157, v19
    v_mul_f32 v158, v158, v19
    v_mul_f32 v159, v159, v19
    v_mul_f32 v160, v160, v18
    v_mul_f32 v161, v161, v18
    v_mul_f32 v162, v162, v18
    v_mul_f32 v163, v163, v18
    v_mul_f32 v164, v164, v19
    v_mul_f32 v165, v165, v19
    v_mul_f32 v166, v166, v19
    v_mul_f32 v167, v167, v19
    v_mul_f32 v168, v168, v18
    v_mul_f32 v169, v169, v18
    v_mul_f32 v170, v170, v18
    v_mul_f32 v171, v171, v18
    v_mul_f32 v172, v172, v19
    v_mul_f32 v173, v173, v19
    v_mul_f32 v174, v174, v19
    v_mul_f32 v175, v175, v19
    v_mul_f32 v176, v176, v18
    v_mul_f32 v177, v177, v18
    v_mul_f32 v178, v178, v18
    v_mul_f32 v179, v179, v18
    v_mul_f32 v180, v180, v19
    v_mul_f32 v181, v181, v19
    v_mul_f32 v182, v182, v19
    v_mul_f32 v183, v183, v19
    v_mul_f32 v184, v184, v18
    v_mul_f32 v185, v185, v18
    v_mul_f32 v186, v186, v18
    v_mul_f32 v187, v187, v18
    v_mul_f32 v188, v188, v19
    v_mul_f32 v189, v189, v19
    v_mul_f32 v190, v190, v19
    v_mul_f32 v191, v191, v19
    v_mul_f32 v192, v192, v18
    v_mul_f32 v193, v193, v18
    v_mul_f32 v194, v194, v18
    v_mul_f32 v195, v195, v18
    v_mul_f32 v196, v196, v19
    v_mul_f32 v197, v197, v19
    v_mul_f32 v198, v198, v19
    v_mul_f32 v199, v199, v19
    v_mul_f32 v200, v200, v18
    v_mul_f32 v201, v201, v18
    v_mul_f32 v202, v202, v18
    v_mul_f32 v203, v203, v18
    v_mul_f32 v204, v204, v19
    v_mul_f32 v205, v205, v19
    v_mul_f32 v206, v206, v19
    v_mul_f32 v207, v207, v19
    v_mul_f32 v208, v208, v18
    v_mul_f32 v209, v209, v18
    v_mul_f32 v210, v210, v18
    v_mul_f32 v211, v211, v18
    v_mul_f32 v212, v212, v19
    v_mul_f32 v213, v213, v19
    v_mul_f32 v214, v214, v19
    v_mul_f32 v215, v215, v19
    v_mul_f32 v216, v216, v18
    v_mul_f32 v217, v217, v18
    v_mul_f32 v218, v218, v18
    v_mul_f32 v219, v219, v18
    v_mul_f32 v220, v220, v19
    v_mul_f32 v221, v221, v19
    v_mul_f32 v222, v222, v19
    v_mul_f32 v223, v223, v19
    v_mul_f32 v224, v224, v18
    v_mul_f32 v225, v225, v18
    v_mul_f32 v226, v226, v18
    v_mul_f32 v227, v227, v18
    v_mul_f32 v228, v228, v19
    v_mul_f32 v229, v229, v19
    v_mul_f32 v230, v230, v19
    v_mul_f32 v231, v231, v19
    v_mul_f32 v232, v232, v18
    v_mul_f32 v233, v233, v18
    v_mul_f32 v234, v234, v18
    v_mul_f32 v235, v235, v18
    v_mul_f32 v236, v236, v19
    v_mul_f32 v237, v237, v19
    v_mul_f32 v238, v238, v19
    v_mul_f32 v239, v239, v19
    v_mul_f32 v240, v240, v18
    v_mul_f32 v241, v241, v18
    v_mul_f32 v242, v242, v18
    v_mul_f32 v243, v243, v18
    v_mul_f32 v244, v244, v19
    v_mul_f32 v245, v245, v19
    v_mul_f32 v246, v246, v19
    v_mul_f32 v247, v247, v19
    v_mul_f32 v248, v248, v18
    v_mul_f32 v249, v249, v18
    v_mul_f32 v250, v250, v18
    v_mul_f32 v251, v251, v18
    v_mul_f32 v252, v252, v19
    v_mul_f32 v253, v253, v19
    v_mul_f32 v254, v254, v19
    v_mul_f32 v255, v255, v19
    v_mul_f32 v128, v128, v18
    v_mul_f32 v129, v129, v18
    v_mul_f32 v130, v130, v18
    v_mul_f32 v131, v131, v18
    v_mul_f32 v132, v132, v19
    v_mul_f32 v133, v133, v19
    v_mul_f32 v134, v134, v19
    v_mul_f32 v135, v135, v19
    v_mul_f32 v136, v136, v18
    v_mul_f32 v137, v137, v18
    v_mul_f32 v138, v138, v18
    v_mul_f32 v139, v139, v18
    v_mul_f32 v140, v140, v19
    v_mul_f32 v141, v141, v19
    v_mul_f32 v142, v142, v19
    v_mul_f32 v143, v143, v19
    v_mul_f32 v144, v144, v18
    v_mul_f32 v145, v145, v18
    v_mul_f32 v146, v146, v18
    v_mul_f32 v147, v147, v18
    v_mul_f32 v148, v148, v19
    v_mul_f32 v149, v149, v19
    v_mul_f32 v150, v150, v19
    v_mul_f32 v151, v151, v19
    v_mul_f32 v152, v152, v18
    v_mul_f32 v153, v153, v18
    v_mul_f32 v154, v154, v18
    v_mul_f32 v155, v155, v18
    v_mul_f32 v156, v156, v19
    v_mul_f32 v157, v157, v19
    v_mul_f32 v158, v158, v19
    v_mul_f32 v159, v159, v19
    v_mul_f32 v160, v160, v18
    v_mul_f32 v161, v161, v18
    v_mul_f32 v162, v162, v18
    v_mul_f32 v163, v163, v18
    v_mul_f32 v164, v164, v19
    v_mul_f32 v165, v165, v19
    v_mul_f32 v166, v166, v19
    v_mul_f32 v167, v167, v19
    v_mul_f32 v168, v168, v18
    v_mul_f32 v169, v169, v18
    v_mul_f32 v170, v170, v18
    v_mul_f32 v171, v171, v18
    v_mul_f32 v172, v172, v19
    v_mul_f32 v173, v173, v19
    v_mul_f32 v174, v174, v19
    v_mul_f32 v175, v175, v19
    v_mul_f32 v176, v176, v18
    v_mul_f32 v177, v177, v18
    v_mul_f32 v178, v178, v18
    v_mul_f32 v179, v179, v18
    v_mul_f32 v180, v180, v19
    v_mul_f32 v181, v181, v19
    v_mul_f32 v182, v182, v19
    v_mul_f32 v183, v183, v19
    v_mul_f32 v184, v184, v18
    v_mul_f32 v185, v185, v18
    v_mul_f32 v186, v186, v18
    v_mul_f32 v187, v187, v18
    v_mul_f32 v188, v188, v19
    v_mul_f32 v189, v189, v19
    v_mul_f32 v190, v190, v19
    v_mul_f32 v191, v191, v19
    v_mul_f32 v192, v192, v18
    v_mul_f32 v193, v193, v18
    v_mul_f32 v194, v194, v18
    v_mul_f32 v195, v195, v18
    v_mul_f32 v196, v196, v19
    v_mul_f32 v197, v197, v19
    v_mul_f32 v198, v198, v19
    v_mul_f32 v199, v199, v19
    v_mul_f32 v200, v200, v18
    v_mul_f32 v201, v201, v18
    v_mul_f32 v202, v202, v18
    v_mul_f32 v203, v203, v18
    v_mul_f32 v204, v204, v19
    v_mul_f32 v205, v205, v19
    v_mul_f32 v206, v206, v19
    v_mul_f32 v207, v207, v19
    v_mul_f32 v208, v208, v18
    v_mul_f32 v209, v209, v18
    v_mul_f32 v210, v210, v18
    v_mul_f32 v211, v211, v18
    v_mul_f32 v212, v212, v19
    v_mul_f32 v213, v213, v19
    v_mul_f32 v214, v214, v19
    v_mul_f32 v215, v215, v19
    v_mul_f32 v216, v216, v18
    v_mul_f32 v217, v217, v18
    v_mul_f32 v218, v218, v18
    v_mul_f32 v219, v219, v18
    v_mul_f32 v220, v220, v19
    v_mul_f32 v221, v221, v19
    v_mul_f32 v222, v222, v19
    v_mul_f32 v223, v223, v19
    v_mul_f32 v224, v224, v18
    v_mul_f32 v225, v225, v18
    v_mul_f32 v226, v226, v18
    v_mul_f32 v227, v227, v18
    v_mul_f32 v228, v228, v19
    v_mul_f32 v229, v229, v19
    v_mul_f32 v230, v230, v19
    v_mul_f32 v231, v231, v19
    v_mul_f32 v232, v232, v18
    v_mul_f32 v233, v233, v18
    v_mul_f32 v234, v234, v18
    v_mul_f32 v235, v235, v18
    v_mul_f32 v236, v236, v19
    v_mul_f32 v237, v237, v19
    v_mul_f32 v238, v238, v19
    v_mul_f32 v239, v239, v19
    v_mul_f32 v240, v240, v18
    v_mul_f32 v241, v241, v18
    v_mul_f32 v242, v242, v18
    v_mul_f32 v243, v243, v18
    v_mul_f32 v244, v244, v19
    v_mul_f32 v245, v245, v19
    v_mul_f32 v246, v246, v19
    v_mul_f32 v247, v247, v19
    v_mul_f32 v248, v248, v18
    v_mul_f32 v249, v249, v18
    v_mul_f32 v250, v250, v18
    v_mul_f32 v251, v251, v18
    v_mul_f32 v252, v252, v19
    v_mul_f32 v253, v253, v19
    v_mul_f32 v254, v254, v19
    v_mul_f32 v255, v255, v19
    v_mul_f32 v60, v60, v18
    v_mul_f32 v60, v60, v18
    v_sub_f32 v80, v80, v16
    v_sub_f32 v81, v81, v16
    v_sub_f32 v82, v82, v16
    v_sub_f32 v83, v83, v16
    v_sub_f32 v96, v96, v16
    v_sub_f32 v112, v112, v16
    v_sub_f32 v97, v97, v16
    v_sub_f32 v113, v113, v16
    v_sub_f32 v98, v98, v16
    v_sub_f32 v114, v114, v16
    v_sub_f32 v99, v99, v16
    v_sub_f32 v115, v115, v16
    v_sub_f32 v104, v104, v16
    v_sub_f32 v120, v120, v16
    v_sub_f32 v105, v105, v16
    v_sub_f32 v121, v121, v16
    v_sub_f32 v106, v106, v16
    v_sub_f32 v122, v122, v16
    v_sub_f32 v107, v107, v16
    v_sub_f32 v123, v123, v16
    v_mul_f32 v61, v61, v19
    v_mul_f32 v61, v61, v19
    v_sub_f32 v84, v84, v17
    v_sub_f32 v85, v85, v17
    v_sub_f32 v86, v86, v17
    v_sub_f32 v87, v87, v17
    v_sub_f32 v100, v100, v17
    v_sub_f32 v116, v116, v17
    v_sub_f32 v101, v101, v17
    v_sub_f32 v117, v117, v17
    v_sub_f32 v102, v102, v17
    v_sub_f32 v118, v118, v17
    v_sub_f32 v103, v103, v17
    v_sub_f32 v119, v119, v17
    v_sub_f32 v108, v108, v17
    v_sub_f32 v124, v124, v17
    v_sub_f32 v109, v109, v17
    v_sub_f32 v125, v125, v17
    v_sub_f32 v110, v110, v17
    v_sub_f32 v126, v126, v17
    v_sub_f32 v111, v111, v17
    v_sub_f32 v127, v127, v17
    v_exp_f32 v56, v112
    v_exp_f32 v57, v113
    v_exp_f32 v58, v114
    v_exp_f32 v59, v115
    v_add_f32 v62, v60, v56
    v_add_f32 v62, v62, v57
    v_cvt_pk_bf16_f32 v72, v56, v57
    v_exp_f32 v56, v116
    v_exp_f32 v57, v117
    v_add_f32 v62, v62, v58
    v_add_f32 v62, v62, v59
    v_cvt_pk_bf16_f32 v73, v58, v59
    v_exp_f32 v58, v118
    v_exp_f32 v59, v119
    v_add_f32 v63, v61, v56
    v_add_f32 v63, v63, v57
    v_cvt_pk_bf16_f32 v76, v56, v57
    v_exp_f32 v56, v120
    v_exp_f32 v57, v121
    v_add_f32 v63, v63, v58
    v_add_f32 v63, v63, v59
    v_cvt_pk_bf16_f32 v77, v58, v59
    v_exp_f32 v58, v122
    v_exp_f32 v59, v123
    v_add_f32 v62, v62, v56
    v_add_f32 v62, v62, v57
    v_cvt_pk_bf16_f32 v74, v56, v57
    v_exp_f32 v56, v124
    v_exp_f32 v57, v125
    v_add_f32 v62, v62, v58
    v_add_f32 v62, v62, v59
    v_cvt_pk_bf16_f32 v75, v58, v59
    v_exp_f32 v58, v126
    v_exp_f32 v59, v127
    v_add_f32 v63, v63, v56
    v_add_f32 v63, v63, v57
    v_cvt_pk_bf16_f32 v78, v56, v57
    v_add_f32 v63, v63, v58
    v_add_f32 v63, v63, v59
    v_cvt_pk_bf16_f32 v79, v58, v59
    s_nop 1
    s_branch CONT_F2
RARE_F3:
    s_nop 15
    s_nop 15
    v_max3_f32 v16, v96, v97, v98
    v_max3_f32 v16, v16, v99, v104
    v_max3_f32 v16, v16, v105, v106
    v_max_f32 v16, v16, v107
    v_mov_b32 v20, v16
    s_nop 1
    v_permlane16_swap_b32 v16, v20
    s_nop 1
    v_max_f32 v16, v16, v20
    v_mov_b32 v20, v16
    s_nop 1
    v_permlane32_swap_b32 v16, v20
    s_nop 1
    v_max_f32 v16, v16, v20
    v_mov_b32 v21, v62
    v_mov_b32 v20, v21
    s_nop 1
    v_permlane16_swap_b32 v21, v20
    s_nop 1
    v_add_f32 v21, v21, v20
    v_mov_b32 v20, v21
    s_nop 1
    v_permlane32_swap_b32 v21, v20
    s_nop 1
    v_add_f32 v21, v21, v20
    v_log_f32 v21, v21
    s_nop 0
    v_max_f32 v16, v16, v21
    v_add_f32 v16, 0x42b60000, v16
    v_max_f32 v16, 0, v16
    v_mul_f32 v18, -0.5, v16
    v_exp_f32 v18, v18
    s_nop 0
    v_max3_f32 v17, v100, v101, v102
    v_max3_f32 v17, v17, v103, v108
    v_max3_f32 v17, v17, v109, v110
    v_max_f32 v17, v17, v111
    v_mov_b32 v20, v17
    s_nop 1
    v_permlane16_swap_b32 v17, v20
    s_nop 1
    v_max_f32 v17, v17, v20
    v_mov_b32 v20, v17
    s_nop 1
    v_permlane32_swap_b32 v17, v20
    s_nop 1
    v_max_f32 v17, v17, v20
    v_mov_b32 v21, v63
    v_mov_b32 v20, v21
    s_nop 1
    v_permlane16_swap_b32 v21, v20
    s_nop 1
    v_add_f32 v21, v21, v20
    v_mov_b32 v20, v21
    s_nop 1
    v_permlane32_swap_b32 v21, v20
    s_nop 1
    v_add_f32 v21, v21, v20
    v_log_f32 v21, v21
    s_nop 0
    v_max_f32 v17, v17, v21
    v_add_f32 v17, 0x42b60000, v17
    v_max_f32 v17, 0, v17
    v_mul_f32 v19, -0.5, v17
    v_exp_f32 v19, v19
    s_nop 0
    v_mul_f32 v128, v128, v18
    v_mul_f32 v129, v129, v18
    v_mul_f32 v130, v130, v18
    v_mul_f32 v131, v131, v18
    v_mul_f32 v132, v132, v19
    v_mul_f32 v133, v133, v19
    v_mul_f32 v134, v134, v19
    v_mul_f32 v135, v135, v19
    v_mul_f32 v136, v136, v18
    v_mul_f32 v137, v137, v18
    v_mul_f32 v138, v138, v18
    v_mul_f32 v139, v139, v18
    v_mul_f32 v140, v140, v19
    v_mul_f32 v141, v141, v19
    v_mul_f32 v142, v142, v19
    v_mul_f32 v143, v143, v19
    v_mul_f32 v144, v144, v18
    v_mul_f32 v145, v145, v18
    v_mul_f32 v146, v146, v18
    v_mul_f32 v147, v147, v18
    v_mul_f32 v148, v148, v19
    v_mul_f32 v149, v149, v19
    v_mul_f32 v150, v150, v19
    v_mul_f32 v151, v151, v19
    v_mul_f32 v152, v152, v18
    v_mul_f32 v153, v153, v18
    v_mul_f32 v154, v154, v18
    v_mul_f32 v155, v155, v18
    v_mul_f32 v156, v156, v19
    v_mul_f32 v157, v157, v19
    v_mul_f32 v158, v158, v19
    v_mul_f32 v159, v159, v19
    v_mul_f32 v160, v160, v18
    v_mul_f32 v161, v161, v18
    v_mul_f32 v162, v162, v18
    v_mul_f32 v163, v163, v18
    v_mul_f32 v164, v164, v19
    v_mul_f32 v165, v165, v19
    v_mul_f32 v166, v166, v19
    v_mul_f32 v167, v167, v19
    v_mul_f32 v168, v168, v18
    v_mul_f32 v169, v169, v18
    v_mul_f32 v170, v170, v18
    v_mul_f32 v171, v171, v18
    v_mul_f32 v172, v172, v19
    v_mul_f32 v173, v173, v19
    v_mul_f32 v174, v174, v19
    v_mul_f32 v175, v175, v19
    v_mul_f32 v176, v176, v18
    v_mul_f32 v177, v177, v18
    v_mul_f32 v178, v178, v18
    v_mul_f32 v179, v179, v18
    v_mul_f32 v180, v180, v19
    v_mul_f32 v181, v181, v19
    v_mul_f32 v182, v182, v19
    v_mul_f32 v183, v183, v19
    v_mul_f32 v184, v184, v18
    v_mul_f32 v185, v185, v18
    v_mul_f32 v186, v186, v18
    v_mul_f32 v187, v187, v18
    v_mul_f32 v188, v188, v19
    v_mul_f32 v189, v189, v19
    v_mul_f32 v190, v190, v19
    v_mul_f32 v191, v191, v19
    v_mul_f32 v192, v192, v18
    v_mul_f32 v193, v193, v18
    v_mul_f32 v194, v194, v18
    v_mul_f32 v195, v195, v18
    v_mul_f32 v196, v196, v19
    v_mul_f32 v197, v197, v19
    v_mul_f32 v198, v198, v19
    v_mul_f32 v199, v199, v19
    v_mul_f32 v200, v200, v18
    v_mul_f32 v201, v201, v18
    v_mul_f32 v202, v202, v18
    v_mul_f32 v203, v203, v18
    v_mul_f32 v204, v204, v19
    v_mul_f32 v205, v205, v19
    v_mul_f32 v206, v206, v19
    v_mul_f32 v207, v207, v19
    v_mul_f32 v208, v208, v18
    v_mul_f32 v209, v209, v18
    v_mul_f32 v210, v210, v18
    v_mul_f32 v211, v211, v18
    v_mul_f32 v212, v212, v19
    v_mul_f32 v213, v213, v19
    v_mul_f32 v214, v214, v19
    v_mul_f32 v215, v215, v19
    v_mul_f32 v216, v216, v18
    v_mul_f32 v217, v217, v18
    v_mul_f32 v218, v218, v18
    v_mul_f32 v219, v219, v18
    v_mul_f32 v220, v220, v19
    v_mul_f32 v221, v221, v19
    v_mul_f32 v222, v222, v19
    v_mul_f32 v223, v223, v19
    v_mul_f32 v224, v224, v18
    v_mul_f32 v225, v225, v18
    v_mul_f32 v226, v226, v18
    v_mul_f32 v227, v227, v18
    v_mul_f32 v228, v228, v19
    v_mul_f32 v229, v229, v19
    v_mul_f32 v230, v230, v19
    v_mul_f32 v231, v231, v19
    v_mul_f32 v232, v232, v18
    v_mul_f32 v233, v233, v18
    v_mul_f32 v234, v234, v18
    v_mul_f32 v235, v235, v18
    v_mul_f32 v236, v236, v19
    v_mul_f32 v237, v237, v19
    v_mul_f32 v238, v238, v19
    v_mul_f32 v239, v239, v19
    v_mul_f32 v240, v240, v18
    v_mul_f32 v241, v241, v18
    v_mul_f32 v242, v242, v18
    v_mul_f32 v243, v243, v18
    v_mul_f32 v244, v244, v19
    v_mul_f32 v245, v245, v19
    v_mul_f32 v246, v246, v19
    v_mul_f32 v247, v247, v19
    v_mul_f32 v248, v248, v18
    v_mul_f32 v249, v249, v18
    v_mul_f32 v250, v250, v18
    v_mul_f32 v251, v251, v18
    v_mul_f32 v252, v252, v19
    v_mul_f32 v253, v253, v19
    v_mul_f32 v254, v254, v19
    v_mul_f32 v255, v255, v19
    v_mul_f32 v128, v128, v18
    v_mul_f32 v129, v129, v18
    v_mul_f32 v130, v130, v18
    v_mul_f32 v131, v131, v18
    v_mul_f32 v132, v132, v19
    v_mul_f32 v133, v133, v19
    v_mul_f32 v134, v134, v19
    v_mul_f32 v135, v135, v19
    v_mul_f32 v136, v136, v18
    v_mul_f32 v137, v137, v18
    v_mul_f32 v138, v138, v18
    v_mul_f32 v139, v139, v18
    v_mul_f32 v140, v140, v19
    v_mul_f32 v141, v141, v19
    v_mul_f32 v142, v142, v19
    v_mul_f32 v143, v143, v19
    v_mul_f32 v144, v144, v18
    v_mul_f32 v145, v145, v18
    v_mul_f32 v146, v146, v18
    v_mul_f32 v147, v147, v18
    v_mul_f32 v148, v148, v19
    v_mul_f32 v149, v149, v19
    v_mul_f32 v150, v150, v19
    v_mul_f32 v151, v151, v19
    v_mul_f32 v152, v152, v18
    v_mul_f32 v153, v153, v18
    v_mul_f32 v154, v154, v18
    v_mul_f32 v155, v155, v18
    v_mul_f32 v156, v156, v19
    v_mul_f32 v157, v157, v19
    v_mul_f32 v158, v158, v19
    v_mul_f32 v159, v159, v19
    v_mul_f32 v160, v160, v18
    v_mul_f32 v161, v161, v18
    v_mul_f32 v162, v162, v18
    v_mul_f32 v163, v163, v18
    v_mul_f32 v164, v164, v19
    v_mul_f32 v165, v165, v19
    v_mul_f32 v166, v166, v19
    v_mul_f32 v167, v167, v19
    v_mul_f32 v168, v168, v18
    v_mul_f32 v169, v169, v18
    v_mul_f32 v170, v170, v18
    v_mul_f32 v171, v171, v18
    v_mul_f32 v172, v172, v19
    v_mul_f32 v173, v173, v19
    v_mul_f32 v174, v174, v19
    v_mul_f32 v175, v175, v19
    v_mul_f32 v176, v176, v18
    v_mul_f32 v177, v177, v18
    v_mul_f32 v178, v178, v18
    v_mul_f32 v179, v179, v18
    v_mul_f32 v180, v180, v19
    v_mul_f32 v181, v181, v19
    v_mul_f32 v182, v182, v19
    v_mul_f32 v183, v183, v19
    v_mul_f32 v184, v184, v18
    v_mul_f32 v185, v185, v18
    v_mul_f32 v186, v186, v18
    v_mul_f32 v187, v187, v18
    v_mul_f32 v188, v188, v19
    v_mul_f32 v189, v189, v19
    v_mul_f32 v190, v190, v19
    v_mul_f32 v191, v191, v19
    v_mul_f32 v192, v192, v18
    v_mul_f32 v193, v193, v18
    v_mul_f32 v194, v194, v18
    v_mul_f32 v195, v195, v18
    v_mul_f32 v196, v196, v19
    v_mul_f32 v197, v197, v19
    v_mul_f32 v198, v198, v19
    v_mul_f32 v199, v199, v19
    v_mul_f32 v200, v200, v18
    v_mul_f32 v201, v201, v18
    v_mul_f32 v202, v202, v18
    v_mul_f32 v203, v203, v18
    v_mul_f32 v204, v204, v19
    v_mul_f32 v205, v205, v19
    v_mul_f32 v206, v206, v19
    v_mul_f32 v207, v207, v19
    v_mul_f32 v208, v208, v18
    v_mul_f32 v209, v209, v18
    v_mul_f32 v210, v210, v18
    v_mul_f32 v211, v211, v18
    v_mul_f32 v212, v212, v19
    v_mul_f32 v213, v213, v19
    v_mul_f32 v214, v214, v19
    v_mul_f32 v215, v215, v19
    v_mul_f32 v216, v216, v18
    v_mul_f32 v217, v217, v18
    v_mul_f32 v218, v218, v18
    v_mul_f32 v219, v219, v18
    v_mul_f32 v220, v220, v19
    v_mul_f32 v221, v221, v19
    v_mul_f32 v222, v222, v19
    v_mul_f32 v223, v223, v19
    v_mul_f32 v224, v224, v18
    v_mul_f32 v225, v225, v18
    v_mul_f32 v226, v226, v18
    v_mul_f32 v227, v227, v18
    v_mul_f32 v228, v228, v19
    v_mul_f32 v229, v229, v19
    v_mul_f32 v230, v230, v19
    v_mul_f32 v231, v231, v19
    v_mul_f32 v232, v232, v18
    v_mul_f32 v233, v233, v18
    v_mul_f32 v234, v234, v18
    v_mul_f32 v235, v235, v18
    v_mul_f32 v236, v236, v19
    v_mul_f32 v237, v237, v19
    v_mul_f32 v238, v238, v19
    v_mul_f32 v239, v239, v19
    v_mul_f32 v240, v240, v18
    v_mul_f32 v241, v241, v18
    v_mul_f32 v242, v242, v18
    v_mul_f32 v243, v243, v18
    v_mul_f32 v244, v244, v19
    v_mul_f32 v245, v245, v19
    v_mul_f32 v246, v246, v19
    v_mul_f32 v247, v247, v19
    v_mul_f32 v248, v248, v18
    v_mul_f32 v249, v249, v18
    v_mul_f32 v250, v250, v18
    v_mul_f32 v251, v251, v18
    v_mul_f32 v252, v252, v19
    v_mul_f32 v253, v253, v19
    v_mul_f32 v254, v254, v19
    v_mul_f32 v255, v255, v19
    v_mul_f32 v62, v62, v18
    v_mul_f32 v62, v62, v18
    v_sub_f32 v80, v80, v16
    v_sub_f32 v81, v81, v16
    v_sub_f32 v82, v82, v16
    v_sub_f32 v83, v83, v16
    v_sub_f32 v112, v112, v16
    v_sub_f32 v96, v96, v16
    v_sub_f32 v113, v113, v16
    v_sub_f32 v97, v97, v16
    v_sub_f32 v114, v114, v16
    v_sub_f32 v98, v98, v16
    v_sub_f32 v115, v115, v16
    v_sub_f32 v99, v99, v16
    v_sub_f32 v120, v120, v16
    v_sub_f32 v104, v104, v16
    v_sub_f32 v121, v121, v16
    v_sub_f32 v105, v105, v16
    v_sub_f32 v122, v122, v16
    v_sub_f32 v106, v106, v16
    v_sub_f32 v123, v123, v16
    v_sub_f32 v107, v107, v16
    v_mul_f32 v63, v63, v19
    v_mul_f32 v63, v63, v19
    v_sub_f32 v84, v84, v17
    v_sub_f32 v85, v85, v17
    v_sub_f32 v86, v86, v17
    v_sub_f32 v87, v87, v17
    v_sub_f32 v116, v116, v17
    v_sub_f32 v100, v100, v17
    v_sub_f32 v117, v117, v17
    v_sub_f32 v101, v101, v17
    v_sub_f32 v118, v118, v17
    v_sub_f32 v102, v102, v17
    v_sub_f32 v119, v119, v17
    v_sub_f32 v103, v103, v17
    v_sub_f32 v124, v124, v17
    v_sub_f32 v108, v108, v17
    v_sub_f32 v125, v125, v17
    v_sub_f32 v109, v109, v17
    v_sub_f32 v126, v126, v17
    v_sub_f32 v110, v110, v17
    v_sub_f32 v127, v127, v17
    v_sub_f32 v111, v111, v17
    v_exp_f32 v56, v96
    v_exp_f32 v57, v97
    v_exp_f32 v58, v98
    v_exp_f32 v59, v99
    v_add_f32 v60, v62, v56
    v_add_f32 v60, v60, v57
    v_cvt_pk_bf16_f32 v64, v56, v57
    v_exp_f32 v56, v100
    v_exp_f32 v57, v101
    v_add_f32 v60, v60, v58
    v_add_f32 v60, v60, v59
    v_cvt_pk_bf16_f32 v65, v58, v59
    v_exp_f32 v58, v102
    v_exp_f32 v59, v103
    v_add_f32 v61, v63, v56
    v_add_f32 v61, v61, v57
    v_cvt_pk_bf16_f32 v68, v56, v57
    v_exp_f32 v56, v104
    v_exp_f32 v57, v105
    v_add_f32 v61, v61, v58
    v_add_f32 v61, v61, v59
    v_cvt_pk_bf16_f32 v69, v58, v59
    v_exp_f32 v58, v106
    v_exp_f32 v59, v107
    v_add_f32 v60, v60, v56
    v_add_f32 v60, v60, v57
    v_cvt_pk_bf16_f32 v66, v56, v57
    v_exp_f32 v56, v108
    v_exp_f32 v57, v109
    v_add_f32 v60, v60, v58
    v_add_f32 v60, v60, v59
    v_cvt_pk_bf16_f32 v67, v58, v59
    v_exp_f32 v58, v110
    v_exp_f32 v59, v111
    v_add_f32 v61, v61, v56
    v_add_f32 v61, v61, v57
    v_cvt_pk_bf16_f32 v70, v56, v57
    v_add_f32 v61, v61, v58
    v_add_f32 v61, v61, v59
    v_cvt_pk_bf16_f32 v71, v58, v59
    s_nop 1
    s_branch CONT_F3
RARE_T0:
    s_nop 15
    s_nop 15
    v_max3_f32 v16, v112, v113, v114
    v_max3_f32 v16, v16, v115, v120
    v_max3_f32 v16, v16, v121, v122
    v_max_f32 v16, v16, v123
    v_mov_b32 v20, v16
    s_nop 1
    v_permlane16_swap_b32 v16, v20
    s_nop 1
    v_max_f32 v16, v16, v20
    v_mov_b32 v20, v16
    s_nop 1
    v_permlane32_swap_b32 v16, v20
    s_nop 1
    v_max_f32 v16, v16, v20
    v_mov_b32 v21, v60
    v_mov_b32 v20, v21
    s_nop 1
    v_permlane16_swap_b32 v21, v20
    s_nop 1
    v_add_f32 v21, v21, v20
    v_mov_b32 v20, v21
    s_nop 1
    v_permlane32_swap_b32 v21, v20
    s_nop 1
    v_add_f32 v21, v21, v20
    v_log_f32 v21, v21
    s_nop 0
    v_max_f32 v16, v16, v21
    v_add_f32 v16, 0x42b60000, v16
    v_max_f32 v16, 0, v16
    v_mul_f32 v18, -0.5, v16
    v_exp_f32 v18, v18
    s_nop 0
    v_max3_f32 v17, v116, v117, v118
    v_max3_f32 v17, v17, v119, v124
    v_max3_f32 v17, v17, v125, v126
    v_max_f32 v17, v17, v127
    v_mov_b32 v20, v17
    s_nop 1
    v_permlane16_swap_b32 v17, v20
    s_nop 1
    v_max_f32 v17, v17, v20
    v_mov_b32 v20, v17
    s_nop 1
    v_permlane32_swap_b32 v17, v20
    s_nop 1
    v_max_f32 v17, v17, v20
    v_mov_b32 v21, v61
    v_mov_b32 v20, v21
    s_nop 1
    v_permlane16_swap_b32 v21, v20
    s_nop 1
    v_add_f32 v21, v21, v20
    v_mov_b32 v20, v21
    s_nop 1
    v_permlane32_swap_b32 v21, v20
    s_nop 1
    v_add_f32 v21, v21, v20
    v_log_f32 v21, v21
    s_nop 0
    v_max_f32 v17, v17, v21
    v_add_f32 v17, 0x42b60000, v17
    v_max_f32 v17, 0, v17
    v_mul_f32 v19, -0.5, v17
    v_exp_f32 v19, v19
    s_nop 0
    v_mul_f32 v128, v128, v18
    v_mul_f32 v129, v129, v18
    v_mul_f32 v130, v130, v18
    v_mul_f32 v131, v131, v18
    v_mul_f32 v132, v132, v19
    v_mul_f32 v133, v133, v19
    v_mul_f32 v134, v134, v19
    v_mul_f32 v135, v135, v19
    v_mul_f32 v136, v136, v18
    v_mul_f32 v137, v137, v18
    v_mul_f32 v138, v138, v18
    v_mul_f32 v139, v139, v18
    v_mul_f32 v140, v140, v19
    v_mul_f32 v141, v141, v19
    v_mul_f32 v142, v142, v19
    v_mul_f32 v143, v143, v19
    v_mul_f32 v144, v144, v18
    v_mul_f32 v145, v145, v18
    v_mul_f32 v146, v146, v18
    v_mul_f32 v147, v147, v18
    v_mul_f32 v148, v148, v19
    v_mul_f32 v149, v149, v19
    v_mul_f32 v150, v150, v19
    v_mul_f32 v151, v151, v19
    v_mul_f32 v152, v152, v18
    v_mul_f32 v153, v153, v18
    v_mul_f32 v154, v154, v18
    v_mul_f32 v155, v155, v18
    v_mul_f32 v156, v156, v19
    v_mul_f32 v157, v157, v19
    v_mul_f32 v158, v158, v19
    v_mul_f32 v159, v159, v19
    v_mul_f32 v160, v160, v18
    v_mul_f32 v161, v161, v18
    v_mul_f32 v162, v162, v18
    v_mul_f32 v163, v163, v18
    v_mul_f32 v164, v164, v19
    v_mul_f32 v165, v165, v19
    v_mul_f32 v166, v166, v19
    v_mul_f32 v167, v167, v19
    v_mul_f32 v168, v168, v18
    v_mul_f32 v169, v169, v18
    v_mul_f32 v170, v170, v18
    v_mul_f32 v171, v171, v18
    v_mul_f32 v172, v172, v19
    v_mul_f32 v173, v173, v19
    v_mul_f32 v174, v174, v19
    v_mul_f32 v175, v175, v19
    v_mul_f32 v176, v176, v18
    v_mul_f32 v177, v177, v18
    v_mul_f32 v178, v178, v18
    v_mul_f32 v179, v179, v18
    v_mul_f32 v180, v180, v19
    v_mul_f32 v181, v181, v19
    v_mul_f32 v182, v182, v19
    v_mul_f32 v183, v183, v19
    v_mul_f32 v184, v184, v18
    v_mul_f32 v185, v185, v18
    v_mul_f32 v186, v186, v18
    v_mul_f32 v187, v187, v18
    v_mul_f32 v188, v188, v19
    v_mul_f32 v189, v189, v19
    v_mul_f32 v190, v190, v19
    v_mul_f32 v191, v191, v19
    v_mul_f32 v192, v192, v18
    v_mul_f32 v193, v193, v18
    v_mul_f32 v194, v194, v18
    v_mul_f32 v195, v195, v18
    v_mul_f32 v196, v196, v19
    v_mul_f32 v197, v197, v19
    v_mul_f32 v198, v198, v19
    v_mul_f32 v199, v199, v19
    v_mul_f32 v200, v200, v18
    v_mul_f32 v201, v201, v18
    v_mul_f32 v202, v202, v18
    v_mul_f32 v203, v203, v18
    v_mul_f32 v204, v204, v19
    v_mul_f32 v205, v205, v19
    v_mul_f32 v206, v206, v19
    v_mul_f32 v207, v207, v19
    v_mul_f32 v208, v208, v18
    v_mul_f32 v209, v209, v18
    v_mul_f32 v210, v210, v18
    v_mul_f32 v211, v211, v18
    v_mul_f32 v212, v212, v19
    v_mul_f32 v213, v213, v19
    v_mul_f32 v214, v214, v19
    v_mul_f32 v215, v215, v19
    v_mul_f32 v216, v216, v18
    v_mul_f32 v217, v217, v18
    v_mul_f32 v218, v218, v18
    v_mul_f32 v219, v219, v18
    v_mul_f32 v220, v220, v19
    v_mul_f32 v221, v221, v19
    v_mul_f32 v222, v222, v19
    v_mul_f32 v223, v223, v19
    v_mul_f32 v224, v224, v18
    v_mul_f32 v225, v225, v18
    v_mul_f32 v226, v226, v18
    v_mul_f32 v227, v227, v18
    v_mul_f32 v228, v228, v19
    v_mul_f32 v229, v229, v19
    v_mul_f32 v230, v230, v19
    v_mul_f32 v231, v231, v19
    v_mul_f32 v232, v232, v18
    v_mul_f32 v233, v233, v18
    v_mul_f32 v234, v234, v18
    v_mul_f32 v235, v235, v18
    v_mul_f32 v236, v236, v19
    v_mul_f32 v237, v237, v19
    v_mul_f32 v238, v238, v19
    v_mul_f32 v239, v239, v19
    v_mul_f32 v240, v240, v18
    v_mul_f32 v241, v241, v18
    v_mul_f32 v242, v242, v18
    v_mul_f32 v243, v243, v18
    v_mul_f32 v244, v244, v19
    v_mul_f32 v245, v245, v19
    v_mul_f32 v246, v246, v19
    v_mul_f32 v247, v247, v19
    v_mul_f32 v248, v248, v18
    v_mul_f32 v249, v249, v18
    v_mul_f32 v250, v250, v18
    v_mul_f32 v251, v251, v18
    v_mul_f32 v252, v252, v19
    v_mul_f32 v253, v253, v19
    v_mul_f32 v254, v254, v19
    v_mul_f32 v255, v255, v19
    v_mul_f32 v128, v128, v18
    v_mul_f32 v129, v129, v18
    v_mul_f32 v130, v130, v18
    v_mul_f32 v131, v131, v18
    v_mul_f32 v132, v132, v19
    v_mul_f32 v133, v133, v19
    v_mul_f32 v134, v134, v19
    v_mul_f32 v135, v135, v19
    v_mul_f32 v136, v136, v18
    v_mul_f32 v137, v137, v18
    v_mul_f32 v138, v138, v18
    v_mul_f32 v139, v139, v18
    v_mul_f32 v140, v140, v19
    v_mul_f32 v141, v141, v19
    v_mul_f32 v142, v142, v19
    v_mul_f32 v143, v143, v19
    v_mul_f32 v144, v144, v18
    v_mul_f32 v145, v145, v18
    v_mul_f32 v146, v146, v18
    v_mul_f32 v147, v147, v18
    v_mul_f32 v148, v148, v19
    v_mul_f32 v149, v149, v19
    v_mul_f32 v150, v150, v19
    v_mul_f32 v151, v151, v19
    v_mul_f32 v152, v152, v18
    v_mul_f32 v153, v153, v18
    v_mul_f32 v154, v154, v18
    v_mul_f32 v155, v155, v18
    v_mul_f32 v156, v156, v19
    v_mul_f32 v157, v157, v19
    v_mul_f32 v158, v158, v19
    v_mul_f32 v159, v159, v19
    v_mul_f32 v160, v160, v18
    v_mul_f32 v161, v161, v18
    v_mul_f32 v162, v162, v18
    v_mul_f32 v163, v163, v18
    v_mul_f32 v164, v164, v19
    v_mul_f32 v165, v165, v19
    v_mul_f32 v166, v166, v19
    v_mul_f32 v167, v167, v19
    v_mul_f32 v168, v168, v18
    v_mul_f32 v169, v169, v18
    v_mul_f32 v170, v170, v18
    v_mul_f32 v171, v171, v18
    v_mul_f32 v172, v172, v19
    v_mul_f32 v173, v173, v19
    v_mul_f32 v174, v174, v19
    v_mul_f32 v175, v175, v19
    v_mul_f32 v176, v176, v18
    v_mul_f32 v177, v177, v18
    v_mul_f32 v178, v178, v18
    v_mul_f32 v179, v179, v18
    v_mul_f32 v180, v180, v19
    v_mul_f32 v181, v181, v19
    v_mul_f32 v182, v182, v19
    v_mul_f32 v183, v183, v19
    v_mul_f32 v184, v184, v18
    v_mul_f32 v185, v185, v18
    v_mul_f32 v186, v186, v18
    v_mul_f32 v187, v187, v18
    v_mul_f32 v188, v188, v19
    v_mul_f32 v189, v189, v19
    v_mul_f32 v190, v190, v19
    v_mul_f32 v191, v191, v19
    v_mul_f32 v192, v192, v18
    v_mul_f32 v193, v193, v18
    v_mul_f32 v194, v194, v18
    v_mul_f32 v195, v195, v18
    v_mul_f32 v196, v196, v19
    v_mul_f32 v197, v197, v19
    v_mul_f32 v198, v198, v19
    v_mul_f32 v199, v199, v19
    v_mul_f32 v200, v200, v18
    v_mul_f32 v201, v201, v18
    v_mul_f32 v202, v202, v18
    v_mul_f32 v203, v203, v18
    v_mul_f32 v204, v204, v19
    v_mul_f32 v205, v205, v19
    v_mul_f32 v206, v206, v19
    v_mul_f32 v207, v207, v19
    v_mul_f32 v208, v208, v18
    v_mul_f32 v209, v209, v18
    v_mul_f32 v210, v210, v18
    v_mul_f32 v211, v211, v18
    v_mul_f32 v212, v212, v19
    v_mul_f32 v213, v213, v19
    v_mul_f32 v214, v214, v19
    v_mul_f32 v215, v215, v19
    v_mul_f32 v216, v216, v18
    v_mul_f32 v217, v217, v18
    v_mul_f32 v218, v218, v18
    v_mul_f32 v219, v219, v18
    v_mul_f32 v220, v220, v19
    v_mul_f32 v221, v221, v19
    v_mul_f32 v222, v222, v19
    v_mul_f32 v223, v223, v19
    v_mul_f32 v224, v224, v18
    v_mul_f32 v225, v225, v18
    v_mul_f32 v226, v226, v18
    v_mul_f32 v227, v227, v18
    v_mul_f32 v228, v228, v19
    v_mul_f32 v229, v229, v19
    v_mul_f32 v230, v230, v19
    v_mul_f32 v231, v231, v19
    v_mul_f32 v232, v232, v18
    v_mul_f32 v233, v233, v18
    v_mul_f32 v234, v234, v18
    v_mul_f32 v235, v235, v18
    v_mul_f32 v236, v236, v19
    v_mul_f32 v237, v237, v19
    v_mul_f32 v238, v238, v19
    v_mul_f32 v239, v239, v19
    v_mul_f32 v240, v240, v18
    v_mul_f32 v241, v241, v18
    v_mul_f32 v242, v242, v18
    v_mul_f32 v243, v243, v18
    v_mul_f32 v244, v244, v19
    v_mul_f32 v245, v245, v19
    v_mul_f32 v246, v246, v19
    v_mul_f32 v247, v247, v19
    v_mul_f32 v248, v248, v18
    v_mul_f32 v249, v249, v18
    v_mul_f32 v250, v250, v18
    v_mul_f32 v251, v251, v18
    v_mul_f32 v252, v252, v19
    v_mul_f32 v253, v253, v19
    v_mul_f32 v254, v254, v19
    v_mul_f32 v255, v255, v19
    v_mul_f32 v60, v60, v18
    v_mul_f32 v60, v60, v18
    v_sub_f32 v80, v80, v16
    v_sub_f32 v81, v81, v16
    v_sub_f32 v82, v82, v16
    v_sub_f32 v83, v83, v16
    v_sub_f32 v96, v96, v16
    v_sub_f32 v112, v112, v16
    v_sub_f32 v97, v97, v16
    v_sub_f32 v113, v113, v16
    v_sub_f32 v98, v98, v16
    v_sub_f32 v114, v114, v16
    v_sub_f32 v99, v99, v16
    v_sub_f32 v115, v115, v16
    v_sub_f32 v104, v104, v16
    v_sub_f32 v120, v120, v16
    v_sub_f32 v105, v105, v16
    v_sub_f32 v121, v121, v16
    v_sub_f32 v106, v106, v16
    v_sub_f32 v122, v122, v16
    v_sub_f32 v107, v107, v16
    v_sub_f32 v123, v123, v16
    v_mul_f32 v61, v61, v19
    v_mul_f32 v61, v61, v19
    v_sub_f32 v84, v84, v17
    v_sub_f32 v85, v85, v17
    v_sub_f32 v86, v86, v17
    v_sub_f32 v87, v87, v17
    v_sub_f32 v100, v100, v17
    v_sub_f32 v116, v116, v17
    v_sub_f32 v101, v101, v17
    v_sub_f32 v117, v117, v17
    v_sub_f32 v102, v102, v17
    v_sub_f32 v118, v118, v17
    v_sub_f32 v103, v103, v17
    v_sub_f32 v119, v119, v17
    v_sub_f32 v108, v108, v17
    v_sub_f32 v124, v124, v17
    v_sub_f32 v109, v109, v17
    v_sub_f32 v125, v125, v17
    v_sub_f32 v110, v110, v17
    v_sub_f32 v126, v126, v17
    v_sub_f32 v111, v111, v17
    v_sub_f32 v127, v127, v17
    v_exp_f32 v56, v112
    v_exp_f32 v57, v113
    v_exp_f32 v58, v114
    v_exp_f32 v59, v115
    v_add_f32 v62, v60, v56
    v_add_f32 v62, v62, v57
    v_cvt_pk_bf16_f32 v72, v56, v57
    v_exp_f32 v56, v116
    v_exp_f32 v57, v117
    v_add_f32 v62, v62, v58
    v_add_f32 v62, v62, v59
    v_cvt_pk_bf16_f32 v73, v58, v59
    v_exp_f32 v58, v118
    v_exp_f32 v59, v119
    v_add_f32 v63, v61, v56
    v_add_f32 v63, v63, v57
    v_cvt_pk_bf16_f32 v76, v56, v57
    v_exp_f32 v56, v120
    v_exp_f32 v57, v121
    v_add_f32 v63, v63, v58
    v_add_f32 v63, v63, v59
    v_cvt_pk_bf16_f32 v77, v58, v59
    v_exp_f32 v58, v122
    v_exp_f32 v59, v123
    v_add_f32 v62, v62, v56
    v_add_f32 v62, v62, v57
    v_cvt_pk_bf16_f32 v74, v56, v57
    v_exp_f32 v56, v124
    v_exp_f32 v57, v125
    v_add_f32 v62, v62, v58
    v_add_f32 v62, v62, v59
    v_cvt_pk_bf16_f32 v75, v58, v59
    v_exp_f32 v58, v126
    v_exp_f32 v59, v127
    v_add_f32 v63, v63, v56
    v_add_f32 v63, v63, v57
    v_cvt_pk_bf16_f32 v78, v56, v57
    v_add_f32 v63, v63, v58
    v_add_f32 v63, v63, v59
    v_cvt_pk_bf16_f32 v79, v58, v59
    s_nop 1
    s_branch CONT_T0
RARE_T1:
    s_nop 15
    s_nop 15
    v_max3_f32 v16, v96, v97, v98
    v_max3_f32 v16, v16, v99, v104
    v_max3_f32 v16, v16, v105, v106
    v_max_f32 v16, v16, v107
    v_mov_b32 v20, v16
    s_nop 1
    v_permlane16_swap_b32 v16, v20
    s_nop 1
    v_max_f32 v16, v16, v20
    v_mov_b32 v20, v16
    s_nop 1
    v_permlane32_swap_b32 v16, v20
    s_nop 1
    v_max_f32 v16, v16, v20
    v_mov_b32 v21, v62
    v_mov_b32 v20, v21
    s_nop 1
    v_permlane16_swap_b32 v21, v20
    s_nop 1
    v_add_f32 v21, v21, v20
    v_mov_b32 v20, v21
    s_nop 1
    v_permlane32_swap_b32 v21, v20
    s_nop 1
    v_add_f32 v21, v21, v20
    v_log_f32 v21, v21
    s_nop 0
    v_max_f32 v16, v16, v21
    v_add_f32 v16, 0x42b60000, v16
    v_max_f32 v16, 0, v16
    v_mul_f32 v18, -0.5, v16
    v_exp_f32 v18, v18
    s_nop 0
    v_max3_f32 v17, v100, v101, v102
    v_max3_f32 v17, v17, v103, v108
    v_max3_f32 v17, v17, v109, v110
    v_max_f32 v17, v17, v111
    v_mov_b32 v20, v17
    s_nop 1
    v_permlane16_swap_b32 v17, v20
    s_nop 1
    v_max_f32 v17, v17, v20
    v_mov_b32 v20, v17
    s_nop 1
    v_permlane32_swap_b32 v17, v20
    s_nop 1
    v_max_f32 v17, v17, v20
    v_mov_b32 v21, v63
    v_mov_b32 v20, v21
    s_nop 1
    v_permlane16_swap_b32 v21, v20
    s_nop 1
    v_add_f32 v21, v21, v20
    v_mov_b32 v20, v21
    s_nop 1
    v_permlane32_swap_b32 v21, v20
    s_nop 1
    v_add_f32 v21, v21, v20
    v_log_f32 v21, v21
    s_nop 0
    v_max_f32 v17, v17, v21
    v_add_f32 v17, 0x42b60000, v17
    v_max_f32 v17, 0, v17
    v_mul_f32 v19, -0.5, v17
    v_exp_f32 v19, v19
    s_nop 0
    v_mul_f32 v128, v128, v18
    v_mul_f32 v129, v129, v18
    v_mul_f32 v130, v130, v18
    v_mul_f32 v131, v131, v18
    v_mul_f32 v132, v132, v19
    v_mul_f32 v133, v133, v19
    v_mul_f32 v134, v134, v19
    v_mul_f32 v135, v135, v19
    v_mul_f32 v136, v136, v18
    v_mul_f32 v137, v137, v18
    v_mul_f32 v138, v138, v18
    v_mul_f32 v139, v139, v18
    v_mul_f32 v140, v140, v19
    v_mul_f32 v141, v141, v19
    v_mul_f32 v142, v142, v19
    v_mul_f32 v143, v143, v19
    v_mul_f32 v144, v144, v18
    v_mul_f32 v145, v145, v18
    v_mul_f32 v146, v146, v18
    v_mul_f32 v147, v147, v18
    v_mul_f32 v148, v148, v19
    v_mul_f32 v149, v149, v19
    v_mul_f32 v150, v150, v19
    v_mul_f32 v151, v151, v19
    v_mul_f32 v152, v152, v18
    v_mul_f32 v153, v153, v18
    v_mul_f32 v154, v154, v18
    v_mul_f32 v155, v155, v18
    v_mul_f32 v156, v156, v19
    v_mul_f32 v157, v157, v19
    v_mul_f32 v158, v158, v19
    v_mul_f32 v159, v159, v19
    v_mul_f32 v160, v160, v18
    v_mul_f32 v161, v161, v18
    v_mul_f32 v162, v162, v18
    v_mul_f32 v163, v163, v18
    v_mul_f32 v164, v164, v19
    v_mul_f32 v165, v165, v19
    v_mul_f32 v166, v166, v19
    v_mul_f32 v167, v167, v19
    v_mul_f32 v168, v168, v18
    v_mul_f32 v169, v169, v18
    v_mul_f32 v170, v170, v18
    v_mul_f32 v171, v171, v18
    v_mul_f32 v172, v172, v19
    v_mul_f32 v173, v173, v19
    v_mul_f32 v174, v174, v19
    v_mul_f32 v175, v175, v19
    v_mul_f32 v176, v176, v18
    v_mul_f32 v177, v177, v18
    v_mul_f32 v178, v178, v18
    v_mul_f32 v179, v179, v18
    v_mul_f32 v180, v180, v19
    v_mul_f32 v181, v181, v19
    v_mul_f32 v182, v182, v19
    v_mul_f32 v183, v183, v19
    v_mul_f32 v184, v184, v18
    v_mul_f32 v185, v185, v18
    v_mul_f32 v186, v186, v18
    v_mul_f32 v187, v187, v18
    v_mul_f32 v188, v188, v19
    v_mul_f32 v189, v189, v19
    v_mul_f32 v190, v190, v19
    v_mul_f32 v191, v191, v19
    v_mul_f32 v192, v192, v18
    v_mul_f32 v193, v193, v18
    v_mul_f32 v194, v194, v18
    v_mul_f32 v195, v195, v18
    v_mul_f32 v196, v196, v19
    v_mul_f32 v197, v197, v19
    v_mul_f32 v198, v198, v19
    v_mul_f32 v199, v199, v19
    v_mul_f32 v200, v200, v18
    v_mul_f32 v201, v201, v18
    v_mul_f32 v202, v202, v18
    v_mul_f32 v203, v203, v18
    v_mul_f32 v204, v204, v19
    v_mul_f32 v205, v205, v19
    v_mul_f32 v206, v206, v19
    v_mul_f32 v207, v207, v19
    v_mul_f32 v208, v208, v18
    v_mul_f32 v209, v209, v18
    v_mul_f32 v210, v210, v18
    v_mul_f32 v211, v211, v18
    v_mul_f32 v212, v212, v19
    v_mul_f32 v213, v213, v19
    v_mul_f32 v214, v214, v19
    v_mul_f32 v215, v215, v19
    v_mul_f32 v216, v216, v18
    v_mul_f32 v217, v217, v18
    v_mul_f32 v218, v218, v18
    v_mul_f32 v219, v219, v18
    v_mul_f32 v220, v220, v19
    v_mul_f32 v221, v221, v19
    v_mul_f32 v222, v222, v19
    v_mul_f32 v223, v223, v19
    v_mul_f32 v224, v224, v18
    v_mul_f32 v225, v225, v18
    v_mul_f32 v226, v226, v18
    v_mul_f32 v227, v227, v18
    v_mul_f32 v228, v228, v19
    v_mul_f32 v229, v229, v19
    v_mul_f32 v230, v230, v19
    v_mul_f32 v231, v231, v19
    v_mul_f32 v232, v232, v18
    v_mul_f32 v233, v233, v18
    v_mul_f32 v234, v234, v18
    v_mul_f32 v235, v235, v18
    v_mul_f32 v236, v236, v19
    v_mul_f32 v237, v237, v19
    v_mul_f32 v238, v238, v19
    v_mul_f32 v239, v239, v19
    v_mul_f32 v240, v240, v18
    v_mul_f32 v241, v241, v18
    v_mul_f32 v242, v242, v18
    v_mul_f32 v243, v243, v18
    v_mul_f32 v244, v244, v19
    v_mul_f32 v245, v245, v19
    v_mul_f32 v246, v246, v19
    v_mul_f32 v247, v247, v19
    v_mul_f32 v248, v248, v18
    v_mul_f32 v249, v249, v18
    v_mul_f32 v250, v250, v18
    v_mul_f32 v251, v251, v18
    v_mul_f32 v252, v252, v19
    v_mul_f32 v253, v253, v19
    v_mul_f32 v254, v254, v19
    v_mul_f32 v255, v255, v19
    v_mul_f32 v128, v128, v18
    v_mul_f32 v129, v129, v18
    v_mul_f32 v130, v130, v18
    v_mul_f32 v131, v131, v18
    v_mul_f32 v132, v132, v19
    v_mul_f32 v133, v133, v19
    v_mul_f32 v134, v134, v19
    v_mul_f32 v135, v135, v19
    v_mul_f32 v136, v136, v18
    v_mul_f32 v137, v137, v18
    v_mul_f32 v138, v138, v18
    v_mul_f32 v139, v139, v18
    v_mul_f32 v140, v140, v19
    v_mul_f32 v141, v141, v19
    v_mul_f32 v142, v142, v19
    v_mul_f32 v143, v143, v19
    v_mul_f32 v144, v144, v18
    v_mul_f32 v145, v145, v18
    v_mul_f32 v146, v146, v18
    v_mul_f32 v147, v147, v18
    v_mul_f32 v148, v148, v19
    v_mul_f32 v149, v149, v19
    v_mul_f32 v150, v150, v19
    v_mul_f32 v151, v151, v19
    v_mul_f32 v152, v152, v18
    v_mul_f32 v153, v153, v18
    v_mul_f32 v154, v154, v18
    v_mul_f32 v155, v155, v18
    v_mul_f32 v156, v156, v19
    v_mul_f32 v157, v157, v19
    v_mul_f32 v158, v158, v19
    v_mul_f32 v159, v159, v19
    v_mul_f32 v160, v160, v18
    v_mul_f32 v161, v161, v18
    v_mul_f32 v162, v162, v18
    v_mul_f32 v163, v163, v18
    v_mul_f32 v164, v164, v19
    v_mul_f32 v165, v165, v19
    v_mul_f32 v166, v166, v19
    v_mul_f32 v167, v167, v19
    v_mul_f32 v168, v168, v18
    v_mul_f32 v169, v169, v18
    v_mul_f32 v170, v170, v18
    v_mul_f32 v171, v171, v18
    v_mul_f32 v172, v172, v19
    v_mul_f32 v173, v173, v19
    v_mul_f32 v174, v174, v19
    v_mul_f32 v175, v175, v19
    v_mul_f32 v176, v176, v18
    v_mul_f32 v177, v177, v18
    v_mul_f32 v178, v178, v18
    v_mul_f32 v179, v179, v18
    v_mul_f32 v180, v180, v19
    v_mul_f32 v181, v181, v19
    v_mul_f32 v182, v182, v19
    v_mul_f32 v183, v183, v19
    v_mul_f32 v184, v184, v18
    v_mul_f32 v185, v185, v18
    v_mul_f32 v186, v186, v18
    v_mul_f32 v187, v187, v18
    v_mul_f32 v188, v188, v19
    v_mul_f32 v189, v189, v19
    v_mul_f32 v190, v190, v19
    v_mul_f32 v191, v191, v19
    v_mul_f32 v192, v192, v18
    v_mul_f32 v193, v193, v18
    v_mul_f32 v194, v194, v18
    v_mul_f32 v195, v195, v18
    v_mul_f32 v196, v196, v19
    v_mul_f32 v197, v197, v19
    v_mul_f32 v198, v198, v19
    v_mul_f32 v199, v199, v19
    v_mul_f32 v200, v200, v18
    v_mul_f32 v201, v201, v18
    v_mul_f32 v202, v202, v18
    v_mul_f32 v203, v203, v18
    v_mul_f32 v204, v204, v19
    v_mul_f32 v205, v205, v19
    v_mul_f32 v206, v206, v19
    v_mul_f32 v207, v207, v19
    v_mul_f32 v208, v208, v18
    v_mul_f32 v209, v209, v18
    v_mul_f32 v210, v210, v18
    v_mul_f32 v211, v211, v18
    v_mul_f32 v212, v212, v19
    v_mul_f32 v213, v213, v19
    v_mul_f32 v214, v214, v19
    v_mul_f32 v215, v215, v19
    v_mul_f32 v216, v216, v18
    v_mul_f32 v217, v217, v18
    v_mul_f32 v218, v218, v18
    v_mul_f32 v219, v219, v18
    v_mul_f32 v220, v220, v19
    v_mul_f32 v221, v221, v19
    v_mul_f32 v222, v222, v19
    v_mul_f32 v223, v223, v19
    v_mul_f32 v224, v224, v18
    v_mul_f32 v225, v225, v18
    v_mul_f32 v226, v226, v18
    v_mul_f32 v227, v227, v18
    v_mul_f32 v228, v228, v19
    v_mul_f32 v229, v229, v19
    v_mul_f32 v230, v230, v19
    v_mul_f32 v231, v231, v19
    v_mul_f32 v232, v232, v18
    v_mul_f32 v233, v233, v18
    v_mul_f32 v234, v234, v18
    v_mul_f32 v235, v235, v18
    v_mul_f32 v236, v236, v19
    v_mul_f32 v237, v237, v19
    v_mul_f32 v238, v238, v19
    v_mul_f32 v239, v239, v19
    v_mul_f32 v240, v240, v18
    v_mul_f32 v241, v241, v18
    v_mul_f32 v242, v242, v18
    v_mul_f32 v243, v243, v18
    v_mul_f32 v244, v244, v19
    v_mul_f32 v245, v245, v19
    v_mul_f32 v246, v246, v19
    v_mul_f32 v247, v247, v19
    v_mul_f32 v248, v248, v18
    v_mul_f32 v249, v249, v18
    v_mul_f32 v250, v250, v18
    v_mul_f32 v251, v251, v18
    v_mul_f32 v252, v252, v19
    v_mul_f32 v253, v253, v19
    v_mul_f32 v254, v254, v19
    v_mul_f32 v255, v255, v19
    v_mul_f32 v62, v62, v18
    v_mul_f32 v62, v62, v18
    v_sub_f32 v80, v80, v16
    v_sub_f32 v81, v81, v16
    v_sub_f32 v82, v82, v16
    v_sub_f32 v83, v83, v16
    v_sub_f32 v112, v112, v16
    v_sub_f32 v96, v96, v16
    v_sub_f32 v113, v113, v16
    v_sub_f32 v97, v97, v16
    v_sub_f32 v114, v114, v16
    v_sub_f32 v98, v98, v16
    v_sub_f32 v115, v115, v16
    v_sub_f32 v99, v99, v16
    v_sub_f32 v120, v120, v16
    v_sub_f32 v104, v104, v16
    v_sub_f32 v121, v121, v16
    v_sub_f32 v105, v105, v16
    v_sub_f32 v122, v122, v16
    v_sub_f32 v106, v106, v16
    v_sub_f32 v123, v123, v16
    v_sub_f32 v107, v107, v16
    v_mul_f32 v63, v63, v19
    v_mul_f32 v63, v63, v19
    v_sub_f32 v84, v84, v17
    v_sub_f32 v85, v85, v17
    v_sub_f32 v86, v86, v17
    v_sub_f32 v87, v87, v17
    v_sub_f32 v116, v116, v17
    v_sub_f32 v100, v100, v17
    v_sub_f32 v117, v117, v17
    v_sub_f32 v101, v101, v17
    v_sub_f32 v118, v118, v17
    v_sub_f32 v102, v102, v17
    v_sub_f32 v119, v119, v17
    v_sub_f32 v103, v103, v17
    v_sub_f32 v124, v124, v17
    v_sub_f32 v108, v108, v17
    v_sub_f32 v125, v125, v17
    v_sub_f32 v109, v109, v17
    v_sub_f32 v126, v126, v17
    v_sub_f32 v110, v110, v17
    v_sub_f32 v127, v127, v17
    v_sub_f32 v111, v111, v17
    v_exp_f32 v56, v96
    v_exp_f32 v57, v97
    v_exp_f32 v58, v98
    v_exp_f32 v59, v99
    v_add_f32 v60, v62, v56
    v_add_f32 v60, v60, v57
    v_cvt_pk_bf16_f32 v64, v56, v57
    v_exp_f32 v56, v100
    v_exp_f32 v57, v101
    v_add_f32 v60, v60, v58
    v_add_f32 v60, v60, v59
    v_cvt_pk_bf16_f32 v65, v58, v59
    v_exp_f32 v58, v102
    v_exp_f32 v59, v103
    v_add_f32 v61, v63, v56
    v_add_f32 v61, v61, v57
    v_cvt_pk_bf16_f32 v68, v56, v57
    v_exp_f32 v56, v104
    v_exp_f32 v57, v105
    v_add_f32 v61, v61, v58
    v_add_f32 v61, v61, v59
    v_cvt_pk_bf16_f32 v69, v58, v59
    v_exp_f32 v58, v106
    v_exp_f32 v59, v107
    v_add_f32 v60, v60, v56
    v_add_f32 v60, v60, v57
    v_cvt_pk_bf16_f32 v66, v56, v57
    v_exp_f32 v56, v108
    v_exp_f32 v57, v109
    v_add_f32 v60, v60, v58
    v_add_f32 v60, v60, v59
    v_cvt_pk_bf16_f32 v67, v58, v59
    v_exp_f32 v58, v110
    v_exp_f32 v59, v111
    v_add_f32 v61, v61, v56
    v_add_f32 v61, v61, v57
    v_cvt_pk_bf16_f32 v70, v56, v57
    v_add_f32 v61, v61, v58
    v_add_f32 v61, v61, v59
    v_cvt_pk_bf16_f32 v71, v58, v59
    s_nop 1
    s_branch CONT_T1
RARE_T2:
    s_nop 15
    s_nop 15
    v_max3_f32 v16, v112, v113, v114
    v_max3_f32 v16, v16, v115, v120
    v_max3_f32 v16, v16, v121, v122
    v_max_f32 v16, v16, v123
    v_mov_b32 v20, v16
    s_nop 1
    v_permlane16_swap_b32 v16, v20
    s_nop 1
    v_max_f32 v16, v16, v20
    v_mov_b32 v20, v16
    s_nop 1
    v_permlane32_swap_b32 v16, v20
    s_nop 1
    v_max_f32 v16, v16, v20
    v_mov_b32 v21, v60
    v_mov_b32 v20, v21
    s_nop 1
    v_permlane16_swap_b32 v21, v20
    s_nop 1
    v_add_f32 v21, v21, v20
    v_mov_b32 v20, v21
    s_nop 1
    v_permlane32_swap_b32 v21, v20
    s_nop 1
    v_add_f32 v21, v21, v20
    v_log_f32 v21, v21
    s_nop 0
    v_max_f32 v16, v16, v21
    v_add_f32 v16, 0x42b60000, v16
    v_max_f32 v16, 0, v16
    v_mul_f32 v18, -0.5, v16
    v_exp_f32 v18, v18
    s_nop 0
    v_max3_f32 v17, v116, v117, v118
    v_max3_f32 v17, v17, v119, v124
    v_max3_f32 v17, v17, v125, v126
    v_max_f32 v17, v17, v127
    v_mov_b32 v20, v17
    s_nop 1
    v_permlane16_swap_b32 v17, v20
    s_nop 1
    v_max_f32 v17, v17, v20
    v_mov_b32 v20, v17
    s_nop 1
    v_permlane32_swap_b32 v17, v20
    s_nop 1
    v_max_f32 v17, v17, v20
    v_mov_b32 v21, v61
    v_mov_b32 v20, v21
    s_nop 1
    v_permlane16_swap_b32 v21, v20
    s_nop 1
    v_add_f32 v21, v21, v20
    v_mov_b32 v20, v21
    s_nop 1
    v_permlane32_swap_b32 v21, v20
    s_nop 1
    v_add_f32 v21, v21, v20
    v_log_f32 v21, v21
    s_nop 0
    v_max_f32 v17, v17, v21
    v_add_f32 v17, 0x42b60000, v17
    v_max_f32 v17, 0, v17
    v_mul_f32 v19, -0.5, v17
    v_exp_f32 v19, v19
    s_nop 0
    v_mul_f32 v128, v128, v18
    v_mul_f32 v129, v129, v18
    v_mul_f32 v130, v130, v18
    v_mul_f32 v131, v131, v18
    v_mul_f32 v132, v132, v19
    v_mul_f32 v133, v133, v19
    v_mul_f32 v134, v134, v19
    v_mul_f32 v135, v135, v19
    v_mul_f32 v136, v136, v18
    v_mul_f32 v137, v137, v18
    v_mul_f32 v138, v138, v18
    v_mul_f32 v139, v139, v18
    v_mul_f32 v140, v140, v19
    v_mul_f32 v141, v141, v19
    v_mul_f32 v142, v142, v19
    v_mul_f32 v143, v143, v19
    v_mul_f32 v144, v144, v18
    v_mul_f32 v145, v145, v18
    v_mul_f32 v146, v146, v18
    v_mul_f32 v147, v147, v18
    v_mul_f32 v148, v148, v19
    v_mul_f32 v149, v149, v19
    v_mul_f32 v150, v150, v19
    v_mul_f32 v151, v151, v19
    v_mul_f32 v152, v152, v18
    v_mul_f32 v153, v153, v18
    v_mul_f32 v154, v154, v18
    v_mul_f32 v155, v155, v18
    v_mul_f32 v156, v156, v19
    v_mul_f32 v157, v157, v19
    v_mul_f32 v158, v158, v19
    v_mul_f32 v159, v159, v19
    v_mul_f32 v160, v160, v18
    v_mul_f32 v161, v161, v18
    v_mul_f32 v162, v162, v18
    v_mul_f32 v163, v163, v18
    v_mul_f32 v164, v164, v19
    v_mul_f32 v165, v165, v19
    v_mul_f32 v166, v166, v19
    v_mul_f32 v167, v167, v19
    v_mul_f32 v168, v168, v18
    v_mul_f32 v169, v169, v18
    v_mul_f32 v170, v170, v18
    v_mul_f32 v171, v171, v18
    v_mul_f32 v172, v172, v19
    v_mul_f32 v173, v173, v19
    v_mul_f32 v174, v174, v19
    v_mul_f32 v175, v175, v19
    v_mul_f32 v176, v176, v18
    v_mul_f32 v177, v177, v18
    v_mul_f32 v178, v178, v18
    v_mul_f32 v179, v179, v18
    v_mul_f32 v180, v180, v19
    v_mul_f32 v181, v181, v19
    v_mul_f32 v182, v182, v19
    v_mul_f32 v183, v183, v19
    v_mul_f32 v184, v184, v18
    v_mul_f32 v185, v185, v18
    v_mul_f32 v186, v186, v18
    v_mul_f32 v187, v187, v18
    v_mul_f32 v188, v188, v19
    v_mul_f32 v189, v189, v19
    v_mul_f32 v190, v190, v19
    v_mul_f32 v191, v191, v19
    v_mul_f32 v192, v192, v18
    v_mul_f32 v193, v193, v18
    v_mul_f32 v194, v194, v18
    v_mul_f32 v195, v195, v18
    v_mul_f32 v196, v196, v19
    v_mul_f32 v197, v197, v19
    v_mul_f32 v198, v198, v19
    v_mul_f32 v199, v199, v19
    v_mul_f32 v200, v200, v18
    v_mul_f32 v201, v201, v18
    v_mul_f32 v202, v202, v18
    v_mul_f32 v203, v203, v18
    v_mul_f32 v204, v204, v19
    v_mul_f32 v205, v205, v19
    v_mul_f32 v206, v206, v19
    v_mul_f32 v207, v207, v19
    v_mul_f32 v208, v208, v18
    v_mul_f32 v209, v209, v18
    v_mul_f32 v210, v210, v18
    v_mul_f32 v211, v211, v18
    v_mul_f32 v212, v212, v19
    v_mul_f32 v213, v213, v19
    v_mul_f32 v214, v214, v19
    v_mul_f32 v215, v215, v19
    v_mul_f32 v216, v216, v18
    v_mul_f32 v217, v217, v18
    v_mul_f32 v218, v218, v18
    v_mul_f32 v219, v219, v18
    v_mul_f32 v220, v220, v19
    v_mul_f32 v221, v221, v19
    v_mul_f32 v222, v222, v19
    v_mul_f32 v223, v223, v19
    v_mul_f32 v224, v224, v18
    v_mul_f32 v225, v225, v18
    v_mul_f32 v226, v226, v18
    v_mul_f32 v227, v227, v18
    v_mul_f32 v228, v228, v19
    v_mul_f32 v229, v229, v19
    v_mul_f32 v230, v230, v19
    v_mul_f32 v231, v231, v19
    v_mul_f32 v232, v232, v18
    v_mul_f32 v233, v233, v18
    v_mul_f32 v234, v234, v18
    v_mul_f32 v235, v235, v18
    v_mul_f32 v236, v236, v19
    v_mul_f32 v237, v237, v19
    v_mul_f32 v238, v238, v19
    v_mul_f32 v239, v239, v19
    v_mul_f32 v240, v240, v18
    v_mul_f32 v241, v241, v18
    v_mul_f32 v242, v242, v18
    v_mul_f32 v243, v243, v18
    v_mul_f32 v244, v244, v19
    v_mul_f32 v245, v245, v19
    v_mul_f32 v246, v246, v19
    v_mul_f32 v247, v247, v19
    v_mul_f32 v248, v248, v18
    v_mul_f32 v249, v249, v18
    v_mul_f32 v250, v250, v18
    v_mul_f32 v251, v251, v18
    v_mul_f32 v252, v252, v19
    v_mul_f32 v253, v253, v19
    v_mul_f32 v254, v254, v19
    v_mul_f32 v255, v255, v19
    v_mul_f32 v128, v128, v18
    v_mul_f32 v129, v129, v18
    v_mul_f32 v130, v130, v18
    v_mul_f32 v131, v131, v18
    v_mul_f32 v132, v132, v19
    v_mul_f32 v133, v133, v19
    v_mul_f32 v134, v134, v19
    v_mul_f32 v135, v135, v19
    v_mul_f32 v136, v136, v18
    v_mul_f32 v137, v137, v18
    v_mul_f32 v138, v138, v18
    v_mul_f32 v139, v139, v18
    v_mul_f32 v140, v140, v19
    v_mul_f32 v141, v141, v19
    v_mul_f32 v142, v142, v19
    v_mul_f32 v143, v143, v19
    v_mul_f32 v144, v144, v18
    v_mul_f32 v145, v145, v18
    v_mul_f32 v146, v146, v18
    v_mul_f32 v147, v147, v18
    v_mul_f32 v148, v148, v19
    v_mul_f32 v149, v149, v19
    v_mul_f32 v150, v150, v19
    v_mul_f32 v151, v151, v19
    v_mul_f32 v152, v152, v18
    v_mul_f32 v153, v153, v18
    v_mul_f32 v154, v154, v18
    v_mul_f32 v155, v155, v18
    v_mul_f32 v156, v156, v19
    v_mul_f32 v157, v157, v19
    v_mul_f32 v158, v158, v19
    v_mul_f32 v159, v159, v19
    v_mul_f32 v160, v160, v18
    v_mul_f32 v161, v161, v18
    v_mul_f32 v162, v162, v18
    v_mul_f32 v163, v163, v18
    v_mul_f32 v164, v164, v19
    v_mul_f32 v165, v165, v19
    v_mul_f32 v166, v166, v19
    v_mul_f32 v167, v167, v19
    v_mul_f32 v168, v168, v18
    v_mul_f32 v169, v169, v18
    v_mul_f32 v170, v170, v18
    v_mul_f32 v171, v171, v18
    v_mul_f32 v172, v172, v19
    v_mul_f32 v173, v173, v19
    v_mul_f32 v174, v174, v19
    v_mul_f32 v175, v175, v19
    v_mul_f32 v176, v176, v18
    v_mul_f32 v177, v177, v18
    v_mul_f32 v178, v178, v18
    v_mul_f32 v179, v179, v18
    v_mul_f32 v180, v180, v19
    v_mul_f32 v181, v181, v19
    v_mul_f32 v182, v182, v19
    v_mul_f32 v183, v183, v19
    v_mul_f32 v184, v184, v18
    v_mul_f32 v185, v185, v18
    v_mul_f32 v186, v186, v18
    v_mul_f32 v187, v187, v18
    v_mul_f32 v188, v188, v19
    v_mul_f32 v189, v189, v19
    v_mul_f32 v190, v190, v19
    v_mul_f32 v191, v191, v19
    v_mul_f32 v192, v192, v18
    v_mul_f32 v193, v193, v18
    v_mul_f32 v194, v194, v18
    v_mul_f32 v195, v195, v18
    v_mul_f32 v196, v196, v19
    v_mul_f32 v197, v197, v19
    v_mul_f32 v198, v198, v19
    v_mul_f32 v199, v199, v19
    v_mul_f32 v200, v200, v18
    v_mul_f32 v201, v201, v18
    v_mul_f32 v202, v202, v18
    v_mul_f32 v203, v203, v18
    v_mul_f32 v204, v204, v19
    v_mul_f32 v205, v205, v19
    v_mul_f32 v206, v206, v19
    v_mul_f32 v207, v207, v19
    v_mul_f32 v208, v208, v18
    v_mul_f32 v209, v209, v18
    v_mul_f32 v210, v210, v18
    v_mul_f32 v211, v211, v18
    v_mul_f32 v212, v212, v19
    v_mul_f32 v213, v213, v19
    v_mul_f32 v214, v214, v19
    v_mul_f32 v215, v215, v19
    v_mul_f32 v216, v216, v18
    v_mul_f32 v217, v217, v18
    v_mul_f32 v218, v218, v18
    v_mul_f32 v219, v219, v18
    v_mul_f32 v220, v220, v19
    v_mul_f32 v221, v221, v19
    v_mul_f32 v222, v222, v19
    v_mul_f32 v223, v223, v19
    v_mul_f32 v224, v224, v18
    v_mul_f32 v225, v225, v18
    v_mul_f32 v226, v226, v18
    v_mul_f32 v227, v227, v18
    v_mul_f32 v228, v228, v19
    v_mul_f32 v229, v229, v19
    v_mul_f32 v230, v230, v19
    v_mul_f32 v231, v231, v19
    v_mul_f32 v232, v232, v18
    v_mul_f32 v233, v233, v18
    v_mul_f32 v234, v234, v18
    v_mul_f32 v235, v235, v18
    v_mul_f32 v236, v236, v19
    v_mul_f32 v237, v237, v19
    v_mul_f32 v238, v238, v19
    v_mul_f32 v239, v239, v19
    v_mul_f32 v240, v240, v18
    v_mul_f32 v241, v241, v18
    v_mul_f32 v242, v242, v18
    v_mul_f32 v243, v243, v18
    v_mul_f32 v244, v244, v19
    v_mul_f32 v245, v245, v19
    v_mul_f32 v246, v246, v19
    v_mul_f32 v247, v247, v19
    v_mul_f32 v248, v248, v18
    v_mul_f32 v249, v249, v18
    v_mul_f32 v250, v250, v18
    v_mul_f32 v251, v251, v18
    v_mul_f32 v252, v252, v19
    v_mul_f32 v253, v253, v19
    v_mul_f32 v254, v254, v19
    v_mul_f32 v255, v255, v19
    v_mul_f32 v60, v60, v18
    v_mul_f32 v60, v60, v18
    v_sub_f32 v80, v80, v16
    v_sub_f32 v81, v81, v16
    v_sub_f32 v82, v82, v16
    v_sub_f32 v83, v83, v16
    v_sub_f32 v112, v112, v16
    v_sub_f32 v113, v113, v16
    v_sub_f32 v114, v114, v16
    v_sub_f32 v115, v115, v16
    v_sub_f32 v120, v120, v16
    v_sub_f32 v121, v121, v16
    v_sub_f32 v122, v122, v16
    v_sub_f32 v123, v123, v16
    v_mul_f32 v61, v61, v19
    v_mul_f32 v61, v61, v19
    v_sub_f32 v84, v84, v17
    v_sub_f32 v85, v85, v17
    v_sub_f32 v86, v86, v17
    v_sub_f32 v87, v87, v17
    v_sub_f32 v116, v116, v17
    v_sub_f32 v117, v117, v17
    v_sub_f32 v118, v118, v17
    v_sub_f32 v119, v119, v17
    v_sub_f32 v124, v124, v17
    v_sub_f32 v125, v125, v17
    v_sub_f32 v126, v126, v17
    v_sub_f32 v127, v127, v17
    v_exp_f32 v56, v112
    v_exp_f32 v57, v113
    v_exp_f32 v58, v114
    v_exp_f32 v59, v115
    v_add_f32 v62, v60, v56
    v_add_f32 v62, v62, v57
    v_cvt_pk_bf16_f32 v72, v56, v57
    v_exp_f32 v56, v116
    v_exp_f32 v57, v117
    v_add_f32 v62, v62, v58
    v_add_f32 v62, v62, v59
    v_cvt_pk_bf16_f32 v73, v58, v59
    v_exp_f32 v58, v118
    v_exp_f32 v59, v119
    v_add_f32 v63, v61, v56
    v_add_f32 v63, v63, v57
    v_cvt_pk_bf16_f32 v76, v56, v57
    v_exp_f32 v56, v120
    v_exp_f32 v57, v121
    v_add_f32 v63, v63, v58
    v_add_f32 v63, v63, v59
    v_cvt_pk_bf16_f32 v77, v58, v59
    v_exp_f32 v58, v122
    v_exp_f32 v59, v123
    v_add_f32 v62, v62, v56
    v_add_f32 v62, v62, v57
    v_cvt_pk_bf16_f32 v74, v56, v57
    v_exp_f32 v56, v124
    v_exp_f32 v57, v125
    v_add_f32 v62, v62, v58
    v_add_f32 v62, v62, v59
    v_cvt_pk_bf16_f32 v75, v58, v59
    v_exp_f32 v58, v126
    v_exp_f32 v59, v127
    v_add_f32 v63, v63, v56
    v_add_f32 v63, v63, v57
    v_cvt_pk_bf16_f32 v78, v56, v57
    v_add_f32 v63, v63, v58
    v_add_f32 v63, v63, v59
    v_cvt_pk_bf16_f32 v79, v58, v59
    s_nop 1
    s_branch CONT_T2
.globl k2_reduce_kernel
.p2align 8
.type k2_reduce_kernel,@function
k2_reduce_kernel:
    s_cmp_ge_u32 s2, 256
    s_cbranch_scc1 K2R_END
    s_load_dwordx2 s[38:39], s[0:1], 96
    s_load_dwordx2 s[40:41], s[0:1], 48
    s_load_dwordx2 s[46:47], s[0:1], 0
    s_and_b32 s29, s2, 7
    s_lshr_b32 s30, s2, 3
    s_lshl_b32 s29, s29, 3
    s_lshr_b32 s31, s30, 2
    s_add_u32 s29, s29, s31
    s_and_b32 s30, s30, 3
    v_and_b32 v2, 7, v0
    v_bfe_u32 v3, v0, 3, 1
    v_lshrrev_b32 v4, 4, v0
    v_lshlrev_b32 v5, 10, v4
    v_lshl_add_u32 v5, v3, 9, v5
    v_lshl_add_u32 v5, v2, 4, v5
    s_lshl_b32 s31, s30, 7
    v_add_u32 v5, s31, v5
    v_lshlrev_b32 v6, 6, v4
    v_lshl_add_u32 v6, v3, 4, v6
    s_waitcnt lgkmcnt(0)
    s_add_u32 s42, s38, 33554432
    s_addc_u32 s43, s39, 0
    s_mov_b32 s8, s42
    s_and_b32 s9, s43, 0xffff
    s_mov_b32 s10, 14680064
    s_mov_b32 s11, 0x00020000
    s_add_u32 s42, s38, 31457280
    s_addc_u32 s43, s39, 0
    s_mov_b32 s12, s42
    s_and_b32 s13, s43, 0xffff
    s_mov_b32 s14, 1835008
    s_mov_b32 s15, 0x00020000
    s_mov_b32 s16, s38
    s_and_b32 s17, s39, 0xffff
    s_mov_b32 s18, 10752
    s_mov_b32 s19, 0x00020000
    s_mul_i32 s32, s29, 28672
    s_add_u32 s33, s32, 0
    buffer_load_dwordx4 v[16:19], v5, s[8:11], s33 offen nt
    s_add_u32 s33, s32, 1835008
    buffer_load_dwordx4 v[20:23], v5, s[8:11], s33 offen nt
    s_add_u32 s33, s32, 3670016
    buffer_load_dwordx4 v[24:27], v5, s[8:11], s33 offen nt
    s_add_u32 s33, s32, 5505024
    buffer_load_dwordx4 v[28:31], v5, s[8:11], s33 offen nt
    s_add_u32 s33, s32, 7340032
    buffer_load_dwordx4 v[32:35], v5, s[8:11], s33 offen nt
    s_add_u32 s33, s32, 9175040
    buffer_load_dwordx4 v[36:39], v5, s[8:11], s33 offen nt
    s_add_u32 s33, s32, 11010048
    buffer_load_dwordx4 v[40:43], v5, s[8:11], s33 offen nt
    s_add_u32 s33, s32, 12845056
    buffer_load_dwordx4 v[44:47], v5, s[8:11], s33 offen nt
    buffer_load_dwordx4 v[48:51], v5, s[12:15], s32 offen
    s_mov_b32 s33, 3584
    buffer_load_dwordx4 v[52:55], v6, s[16:19], s33 offen
    buffer_load_dwordx4 v[56:59], v6, s[16:19], s33 offen offset:32
    s_mov_b32 s33, 7168
    buffer_load_dwordx4 v[60:63], v6, s[16:19], s33 offen
    buffer_load_dwordx4 v[64:67], v6, s[16:19], s33 offen offset:32
    s_mov_b32 s33, 5376
    buffer_load_dwordx4 v[68:71], v6, s[16:19], s33 offen
    buffer_load_dwordx4 v[72:75], v6, s[16:19], s33 offen offset:32
    s_add_u32 s42, s38, 18874368
    s_addc_u32 s43, s39, 0
    s_mov_b32 s20, s42
    s_and_b32 s21, s43, 0xffff
    s_mov_b32 s22, 1835008
    s_mov_b32 s23, 0x00020000
    s_add_u32 s42, s38, 50331648
    s_addc_u32 s43, s39, 0
    s_mov_b32 s24, s42
    s_and_b32 s25, s43, 0xffff
    s_mov_b32 s26, 1835008
    s_mov_b32 s27, 0x00020000
    s_waitcnt vmcnt(14)
    v_lshlrev_b32 v80, 16, v16
    v_and_b32 v81, 0xffff0000, v16
    v_lshlrev_b32 v82, 16, v17
    v_and_b32 v83, 0xffff0000, v17
    v_lshlrev_b32 v84, 16, v18
    v_and_b32 v85, 0xffff0000, v18
    v_lshlrev_b32 v86, 16, v19
    v_and_b32 v87, 0xffff0000, v19
    s_waitcnt vmcnt(13)
    v_lshlrev_b32 v88, 16, v20
    v_and_b32 v89, 0xffff0000, v20
    v_lshlrev_b32 v90, 16, v21
    v_and_b32 v91, 0xffff0000, v21
    v_lshlrev_b32 v92, 16, v22
    v_and_b32 v93, 0xffff0000, v22
    v_lshlrev_b32 v94, 16, v23
    v_and_b32 v95, 0xffff0000, v23
    v_pk_add_f32 v[80:81], v[80:81], v[88:89]
    v_pk_add_f32 v[82:83], v[82:83], v[90:91]
    v_pk_add_f32 v[84:85], v[84:85], v[92:93]
    v_pk_add_f32 v[86:87], v[86:87], v[94:95]
    s_waitcnt vmcnt(12)
    v_lshlrev_b32 v88, 16, v24
    v_and_b32 v89, 0xffff0000, v24
    v_lshlrev_b32 v90, 16, v25
    v_and_b32 v91, 0xffff0000, v25
    v_lshlrev_b32 v92, 16, v26
    v_and_b32 v93, 0xffff0000, v26
    v_lshlrev_b32 v94, 16, v27
    v_and_b32 v95, 0xffff0000, v27
    v_pk_add_f32 v[80:81], v[80:81], v[88:89]
    v_pk_add_f32 v[82:83], v[82:83], v[90:91]
    v_pk_add_f32 v[84:85], v[84:85], v[92:93]
    v_pk_add_f32 v[86:87], v[86:87], v[94:95]
    s_waitcnt vmcnt(11)
    v_lshlrev_b32 v88, 16, v28
    v_and_b32 v89, 0xffff0000, v28
    v_lshlrev_b32 v90, 16, v29
    v_and_b32 v91, 0xffff0000, v29
    v_lshlrev_b32 v92, 16, v30
    v_and_b32 v93, 0xffff0000, v30
    v_lshlrev_b32 v94, 16, v31
    v_and_b32 v95, 0xffff0000, v31
    v_pk_add_f32 v[80:81], v[80:81], v[88:89]
    v_pk_add_f32 v[82:83], v[82:83], v[90:91]
    v_pk_add_f32 v[84:85], v[84:85], v[92:93]
    v_pk_add_f32 v[86:87], v[86:87], v[94:95]
    s_waitcnt vmcnt(10)
    v_lshlrev_b32 v88, 16, v32
    v_and_b32 v89, 0xffff0000, v32
    v_lshlrev_b32 v90, 16, v33
    v_and_b32 v91, 0xffff0000, v33
    v_lshlrev_b32 v92, 16, v34
    v_and_b32 v93, 0xffff0000, v34
    v_lshlrev_b32 v94, 16, v35
    v_and_b32 v95, 0xffff0000, v35
    v_pk_add_f32 v[80:81], v[80:81], v[88:89]
    v_pk_add_f32 v[82:83], v[82:83], v[90:91]
    v_pk_add_f32 v[84:85], v[84:85], v[92:93]
    v_pk_add_f32 v[86:87], v[86:87], v[94:95]
    s_waitcnt vmcnt(9)
    v_lshlrev_b32 v88, 16, v36
    v_and_b32 v89, 0xffff0000, v36
    v_lshlrev_b32 v90, 16, v37
    v_and_b32 v91, 0xffff0000, v37
    v_lshlrev_b32 v92, 16, v38
    v_and_b32 v93, 0xffff0000, v38
    v_lshlrev_b32 v94, 16, v39
    v_and_b32 v95, 0xffff0000, v39
    v_pk_add_f32 v[80:81], v[80:81], v[88:89]
    v_pk_add_f32 v[82:83], v[82:83], v[90:91]
    v_pk_add_f32 v[84:85], v[84:85], v[92:93]
    v_pk_add_f32 v[86:87], v[86:87], v[94:95]
    s_waitcnt vmcnt(8)
    v_lshlrev_b32 v88, 16, v40
    v_and_b32 v89, 0xffff0000, v40
    v_lshlrev_b32 v90, 16, v41
    v_and_b32 v91, 0xffff0000, v41
    v_lshlrev_b32 v92, 16, v42
    v_and_b32 v93, 0xffff0000, v42
    v_lshlrev_b32 v94, 16, v43
    v_and_b32 v95, 0xffff0000, v43
    v_pk_add_f32 v[80:81], v[80:81], v[88:89]
    v_pk_add_f32 v[82:83], v[82:83], v[90:91]
    v_pk_add_f32 v[84:85], v[84:85], v[92:93]
    v_pk_add_f32 v[86:87], v[86:87], v[94:95]
    s_waitcnt vmcnt(7)
    v_lshlrev_b32 v88, 16, v44
    v_and_b32 v89, 0xffff0000, v44
    v_lshlrev_b32 v90, 16, v45
    v_and_b32 v91, 0xffff0000, v45
    v_lshlrev_b32 v92, 16, v46
    v_and_b32 v93, 0xffff0000, v46
    v_lshlrev_b32 v94, 16, v47
    v_and_b32 v95, 0xffff0000, v47
    v_pk_add_f32 v[80:81], v[80:81], v[88:89]
    v_pk_add_f32 v[82:83], v[82:83], v[90:91]
    v_pk_add_f32 v[84:85], v[84:85], v[92:93]
    v_pk_add_f32 v[86:87], v[86:87], v[94:95]
    s_waitcnt vmcnt(4)
    v_lshlrev_b32 v88, 16, v48
    v_and_b32 v89, 0xffff0000, v48
    v_lshlrev_b32 v90, 16, v49
    v_and_b32 v91, 0xffff0000, v49
    v_lshlrev_b32 v92, 16, v50
    v_and_b32 v93, 0xffff0000, v50
    v_lshlrev_b32 v94, 16, v51
    v_and_b32 v95, 0xffff0000, v51
    v_pk_fma_f32 v[80:81], v[80:81], v[52:53], v[88:89]
    v_pk_fma_f32 v[82:83], v[82:83], v[54:55], v[90:91]
    v_pk_fma_f32 v[84:85], v[84:85], v[56:57], v[92:93]
    v_pk_fma_f32 v[86:87], v[86:87], v[58:59], v[94:95]
    v_cvt_pk_bf16_f32 v16, v80, v81
    v_cvt_pk_bf16_f32 v17, v82, v83
    v_cvt_pk_bf16_f32 v18, v84, v85
    v_cvt_pk_bf16_f32 v19, v86, v87
    buffer_store_dwordx4 v[16:19], v5, s[20:23], s32 offen
    v_lshlrev_b32 v80, 16, v16
    v_and_b32 v81, 0xffff0000, v16
    v_lshlrev_b32 v82, 16, v17
    v_and_b32 v83, 0xffff0000, v17
    v_lshlrev_b32 v84, 16, v18
    v_and_b32 v85, 0xffff0000, v18
    v_lshlrev_b32 v86, 16, v19
    v_and_b32 v87, 0xffff0000, v19
    v_lshrrev_b32 v9, 6, v0
    v_lshlrev_b32 v7, 5, v2
    v_lshl_add_u32 v8, v9, 2, v7
    v_and_b32 v10, 63, v0
    v_add_f32 v20, v80, v81
    v_add_f32 v20, v20, v82
    v_add_f32 v20, v20, v83
    v_add_f32 v20, v20, v84
    v_add_f32 v20, v20, v85
    v_add_f32 v20, v20, v86
    v_add_f32 v20, v20, v87
    s_nop 1
    v_add_f32_dpp v20, v20, v20 row_ror:8 row_mask:0xf bank_mask:0xf
    s_nop 0
    ds_swizzle_b32 v21, v20 offset:0x401F
    s_waitcnt lgkmcnt(0)
    v_add_f32 v20, v20, v21
    v_mov_b32 v21, v20
    s_nop 1
    v_permlane32_swap_b32 v20, v21
    s_nop 1
    v_add_f32 v20, v20, v21
    v_cmp_gt_u32 vcc, 8, v10
    s_and_saveexec_b64 s[44:45], vcc
    ds_write_b32 v8, v20 offset:0
    s_mov_b64 exec, s[44:45]
    s_waitcnt lgkmcnt(0)
    s_barrier
    ds_read_b128 v[24:27], v7 offset:0
    ds_read_b128 v[28:31], v7 offset:16
    s_waitcnt lgkmcnt(0)
    v_add_f32 v24, v24, v25
    v_add_f32 v26, v26, v27
    v_add_f32 v28, v28, v29
    v_add_f32 v24, v24, v26
    v_add_f32 v28, v28, v30
    v_add_f32 v20, v24, v28
    v_mul_f32 v22, 0x3b124925, v20
    v_sub_f32 v80, v80, v22
    v_sub_f32 v81, v81, v22
    v_sub_f32 v82, v82, v22
    v_sub_f32 v83, v83, v22
    v_sub_f32 v84, v84, v22
    v_sub_f32 v85, v85, v22
    v_sub_f32 v86, v86, v22
    v_sub_f32 v87, v87, v22
    v_mul_f32 v20, v80, v80
    v_fmac_f32 v20, v81, v81
    v_fmac_f32 v20, v82, v82
    v_fmac_f32 v20, v83, v83
    v_fmac_f32 v20, v84, v84
    v_fmac_f32 v20, v85, v85
    v_fmac_f32 v20, v86, v86
    v_fmac_f32 v20, v87, v87
    s_nop 1
    v_add_f32_dpp v20, v20, v20 row_ror:8 row_mask:0xf bank_mask:0xf
    s_nop 0
    ds_swizzle_b32 v21, v20 offset:0x401F
    s_waitcnt lgkmcnt(0)
    v_add_f32 v20, v20, v21
    v_mov_b32 v21, v20
    s_nop 1
    v_permlane32_swap_b32 v20, v21
    s_nop 1
    v_add_f32 v20, v20, v21
    v_cmp_gt_u32 vcc, 8, v10
    s_and_saveexec_b64 s[44:45], vcc
    ds_write_b32 v8, v20 offset:256
    s_mov_b64 exec, s[44:45]
    s_waitcnt lgkmcnt(0)
    s_barrier
    ds_read_b128 v[24:27], v7 offset:256
    ds_read_b128 v[28:31], v7 offset:272
    s_waitcnt lgkmcnt(0)
    v_add_f32 v24, v24, v25
    v_add_f32 v26, v26, v27
    v_add_f32 v28, v28, v29
    v_add_f32 v24, v24, v26
    v_add_f32 v28, v28, v30
    v_add_f32 v20, v24, v28
    v_mul_f32 v20, 0x3b124925, v20
    v_add_f32 v20, 0x3727c5ac, v20
    v_rsq_f32 v20, v20
    s_waitcnt vmcnt(1)
    v_mov_b32 v21, v20
    v_pk_mul_f32 v[80:81], v[80:81], v[20:21]
    v_pk_mul_f32 v[82:83], v[82:83], v[20:21]
    v_pk_mul_f32 v[84:85], v[84:85], v[20:21]
    v_pk_mul_f32 v[86:87], v[86:87], v[20:21]
    v_pk_fma_f32 v[80:81], v[80:81], v[60:61], v[68:69]
    v_pk_fma_f32 v[82:83], v[82:83], v[62:63], v[70:71]
    v_pk_fma_f32 v[84:85], v[84:85], v[64:65], v[72:73]
    v_pk_fma_f32 v[86:87], v[86:87], v[66:67], v[74:75]
    v_cvt_pk_bf16_f32 v16, v80, v81
    v_cvt_pk_bf16_f32 v17, v82, v83
    v_cvt_pk_bf16_f32 v18, v84, v85
    v_cvt_pk_bf16_f32 v19, v86, v87
    buffer_store_dwordx4 v[16:19], v5, s[24:27], s32 offen
K2R_END:
    s_endpgm
.globl k3_mlp1_kernel
.p2align 8
.type k3_mlp1_kernel,@function
k3_mlp1_kernel:
    s_cmp_ge_u32 s2, 224
    s_cbranch_scc1 K3_END
    s_load_dwordx2 s[40:41], s[0:1], 56
    s_load_dwordx2 s[36:37], s[0:1], 48
    s_load_dwordx2 s[38:39], s[0:1], 96
    v_and_b32 v1, 63, v0
    v_lshrrev_b32 v2, 6, v0
    s_nop 0
    v_readfirstlane_b32 s28, v2
    s_and_b32 s29, s2, 7
    s_lshr_b32 s30, s2, 3
    s_lshl_b32 s29, s29, 1
    s_and_b32 s31, s30, 1
    s_add_u32 s29, s29, s31
    s_lshr_b32 s30, s30, 1
    s_lshl_b32 s47, s29, 2
    s_add_u32 s47, s47, s28
    v_bfe_u32 v3, v1, 3, 2
    v_mul_u32_u24 v4, 3584, v3
    v_lshrrev_b32 v3, 5, v1
    v_lshl_add_u32 v4, v3, 7, v4
    v_bfe_u32 v3, v1, 4, 1
    v_bfe_u32 v2, v1, 2, 1
    v_xor_b32 v3, v3, v2
    v_lshl_add_u32 v4, v3, 6, v4
    v_and_b32 v3, 3, v1
    v_lshl_add_u32 v4, v3, 4, v4
    v_lshlrev_b32 v6, 4, v1
    v_lshrrev_b32 v2, 5, v1
    v_lshlrev_b32 v8, 10, v2
    v_bfe_u32 v3, v1, 2, 2
    v_lshl_add_u32 v8, v3, 7, v8
    v_bfe_u32 v3, v1, 4, 1
    v_lshl_add_u32 v8, v3, 5, v8
    v_and_b32 v3, 3, v1
    v_lshl_add_u32 v8, v3, 3, v8
    v_bfe_u32 v3, v1, 3, 1
    v_xor_b32 v5, 1, v3
    v_lshl_add_u32 v7, v5, 6, v8
    v_lshl_add_u32 v8, v3, 6, v8
    v_add_u32 v9, 0x10000, v8
    v_add_u32 v5, 0x10000, v7
    s_waitcnt lgkmcnt(0)
    s_lshl_b32 s33, s30, 8
    s_add_u32 s36, s36, s33
    s_addc_u32 s37, s37, 0
    s_sub_u32 s34, 1605632, s33
    s_mov_b32 s8, s36
    s_and_b32 s9, s37, 0xffff
    s_mov_b32 s10, s34
    s_mov_b32 s11, 0x00020000
    s_mul_i32 s33, s47, 28672
    s_add_u32 s33, s33, 50331648
    s_add_u32 s42, s38, s33
    s_addc_u32 s43, s39, 0
    s_mov_b32 s12, s42
    s_and_b32 s13, s43, 0xffff
    s_mov_b32 s14, 28672
    s_mov_b32 s15, 0x00020000
    s_lshl_b32 s51, s28, 10
    s_mul_i32 s52, s28, 14336
    s_add_u32 m0, s51, 0
    s_add_u32 s50, s52, 0
    buffer_load_dwordx4 v4, s[8:11], s50 offen lds
    s_add_u32 m0, s51, 4096
    s_add_u32 s50, s52, 57344
    buffer_load_dwordx4 v4, s[8:11], s50 offen lds
    s_add_u32 m0, s51, 8192
    s_add_u32 s50, s52, 114688
    buffer_load_dwordx4 v4, s[8:11], s50 offen lds
    s_add_u32 m0, s51, 12288
    s_add_u32 s50, s52, 172032
    buffer_load_dwordx4 v4, s[8:11], s50 offen lds
    s_mov_b32 s50, 0
    buffer_load_dwordx4 v[16:19], v6, s[12:15], s50 offen offset:0
    s_mov_b32 s50, 0
    buffer_load_dwordx4 v[20:23], v6, s[12:15], s50 offen offset:1024
    s_mov_b32 s50, 0
    buffer_load_dwordx4 v[24:27], v6, s[12:15], s50 offen offset:2048
    s_mov_b32 s50, 0
    buffer_load_dwordx4 v[28:31], v6, s[12:15], s50 offen offset:3072
    s_add_u32 m0, s51, 16384
    s_add_u32 s50, s52, 229376
    buffer_load_dwordx4 v4, s[8:11], s50 offen lds
    s_add_u32 m0, s51, 20480
    s_add_u32 s50, s52, 286720
    buffer_load_dwordx4 v4, s[8:11], s50 offen lds
    s_add_u32 m0, s51, 24576
    s_add_u32 s50, s52, 344064
    buffer_load_dwordx4 v4, s[8:11], s50 offen lds
    s_add_u32 m0, s51, 28672
    s_add_u32 s50, s52, 401408
    buffer_load_dwordx4 v4, s[8:11], s50 offen lds
    s_mov_b32 s50, 4096
    buffer_load_dwordx4 v[32:35], v6, s[12:15], s50 offen offset:0
    s_mov_b32 s50, 4096
    buffer_load_dwordx4 v[36:39], v6, s[12:15], s50 offen offset:1024
    s_mov_b32 s50, 4096
    buffer_load_dwordx4 v[40:43], v6, s[12:15], s50 offen offset:2048
    s_mov_b32 s50, 4096
    buffer_load_dwordx4 v[44:47], v6, s[12:15], s50 offen offset:3072
    s_add_u32 m0, s51, 32768
    s_add_u32 s50, s52, 458752
    buffer_load_dwordx4 v4, s[8:11], s50 offen lds
    s_add_u32 m0, s51, 36864
    s_add_u32 s50, s52, 516096
    buffer_load_dwordx4 v4, s[8:11], s50 offen lds
    s_add_u32 m0, s51, 40960
    s_add_u32 s50, s52, 573440
    buffer_load_dwordx4 v4, s[8:11], s50 offen lds
    s_add_u32 m0, s51, 45056
    s_add_u32 s50, s52, 630784
    buffer_load_dwordx4 v4, s[8:11], s50 offen lds
    s_mov_b32 s50, 8192
    buffer_load_dwordx4 v[48:51], v6, s[12:15], s50 offen offset:0
    s_mov_b32 s50, 8192
    buffer_load_dwordx4 v[52:55], v6, s[12:15], s50 offen offset:1024
    s_mov_b32 s50, 8192
    buffer_load_dwordx4 v[56:59], v6, s[12:15], s50 offen offset:2048
    s_mov_b32 s50, 8192
    buffer_load_dwordx4 v[60:63], v6, s[12:15], s50 offen offset:3072
    s_add_u32 m0, s51, 49152
    s_add_u32 s50, s52, 688128
    buffer_load_dwordx4 v4, s[8:11], s50 offen lds
    s_add_u32 m0, s51, 53248
    s_add_u32 s50, s52, 745472
    buffer_load_dwordx4 v4, s[8:11], s50 offen lds
    s_add_u32 m0, s51, 57344
    s_add_u32 s50, s52, 802816
    buffer_load_dwordx4 v4, s[8:11], s50 offen lds
    s_add_u32 m0, s51, 61440
    s_add_u32 s50, s52, 860160
    buffer_load_dwordx4 v4, s[8:11], s50 offen lds
    s_mov_b32 s50, 12288
    buffer_load_dwordx4 v[64:67], v6, s[12:15], s50 offen offset:0
    s_mov_b32 s50, 12288
    buffer_load_dwordx4 v[68:71], v6, s[12:15], s50 offen offset:1024
    s_mov_b32 s50, 12288
    buffer_load_dwordx4 v[72:75], v6, s[12:15], s50 offen offset:2048
    s_mov_b32 s50, 12288
    buffer_load_dwordx4 v[76:79], v6, s[12:15], s50 offen offset:3072
    s_waitcnt vmcnt(24)
    s_barrier
    ds_read_b64_tr_b16 v[192:193], v8 offset:0
    ds_read_b64_tr_b16 v[194:195], v8 offset:2048
    ds_read_b64_tr_b16 v[196:197], v7 offset:0
    ds_read_b64_tr_b16 v[198:199], v7 offset:2048
    ds_read_b64_tr_b16 v[200:201], v8 offset:512
    ds_read_b64_tr_b16 v[202:203], v8 offset:2560
    ds_read_b64_tr_b16 v[204:205], v7 offset:512
    ds_read_b64_tr_b16 v[206:207], v7 offset:2560
    ds_read_b64_tr_b16 v[208:209], v8 offset:4096
    ds_read_b64_tr_b16 v[210:211], v8 offset:6144
    s_waitcnt lgkmcnt(8)
    v_mfma_f32_32x32x16_bf16 v[128:143], v[192:195], v[16:19], 0
    ds_read_b64_tr_b16 v[212:213], v7 offset:4096
    ds_read_b64_tr_b16 v[214:215], v7 offset:6144
    s_add_u32 m0, s51, 65536
    s_add_u32 s50, s52, 917504
    buffer_load_dwordx4 v4, s[8:11], s50 offen lds
    s_waitcnt lgkmcnt(8)
    v_mfma_f32_32x32x16_bf16 v[144:159], v[196:199], v[16:19], 0
    ds_read_b64_tr_b16 v[216:217], v8 offset:4608
    ds_read_b64_tr_b16 v[218:219], v8 offset:6656
    s_waitcnt lgkmcnt(8)
    v_mfma_f32_32x32x16_bf16 v[160:175], v[200:203], v[16:19], 0
    ds_read_b64_tr_b16 v[220:221], v7 offset:4608
    ds_read_b64_tr_b16 v[222:223], v7 offset:6656
    s_add_u32 m0, s51, 69632
    s_add_u32 s50, s52, 974848
    buffer_load_dwordx4 v4, s[8:11], s50 offen lds
    s_waitcnt lgkmcnt(8)
    v_mfma_f32_32x32x16_bf16 v[176:191], v[204:207], v[16:19], 0
    ds_read_b64_tr_b16 v[192:193], v8 offset:8192
    ds_read_b64_tr_b16 v[194:195], v8 offset:10240
    s_waitcnt lgkmcnt(8)
    v_mfma_f32_32x32x16_bf16 v[128:143], v[208:211], v[20:23], v[128:143]
    ds_read_b64_tr_b16 v[196:197], v7 offset:8192
    ds_read_b64_tr_b16 v[198:199], v7 offset:10240
    s_add_u32 m0, s51, 73728
    s_add_u32 s50, s52, 1032192
    buffer_load_dwordx4 v4, s[8:11], s50 offen lds
    s_waitcnt lgkmcnt(8)
    v_mfma_f32_32x32x16_bf16 v[144:159], v[212:215], v[20:23], v[144:159]
    ds_read_b64_tr_b16 v[200:201], v8 offset:8704
    ds_read_b64_tr_b16 v[202:203], v8 offset:10752
    s_waitcnt lgkmcnt(8)
    v_mfma_f32_32x32x16_bf16 v[160:175], v[216:219], v[20:23], v[160:175]
    ds_read_b64_tr_b16 v[204:205], v7 offset:8704
    ds_read_b64_tr_b16 v[206:207], v7 offset:10752
    s_add_u32 m0, s51, 77824
    s_add_u32 s50, s52, 1089536
    buffer_load_dwordx4 v4, s[8:11], s50 offen lds
    s_waitcnt lgkmcnt(8)
    v_mfma_f32_32x32x16_bf16 v[176:191], v[220:223], v[20:23], v[176:191]
    ds_read_b64_tr_b16 v[208:209], v8 offset:12288
    ds_read_b64_tr_b16 v[210:211], v8 offset:14336
    s_waitcnt lgkmcnt(8)
    v_mfma_f32_32x32x16_bf16 v[128:143], v[192:195], v[24:27], v[128:143]
    ds_read_b64_tr_b16 v[212:213], v7 offset:12288
    ds_read_b64_tr_b16 v[214:215], v7 offset:14336
    s_mov_b32 s50, 16384
    buffer_load_dwordx4 v[80:83], v6, s[12:15], s50 offen offset:0
    s_waitcnt lgkmcnt(8)
    v_mfma_f32_32x32x16_bf16 v[144:159], v[196:199], v[24:27], v[144:159]
    ds_read_b64_tr_b16 v[216:217], v8 offset:12800
    ds_read_b64_tr_b16 v[218:219], v8 offset:14848
    s_waitcnt lgkmcnt(8)
    v_mfma_f32_32x32x16_bf16 v[160:175], v[200:203], v[24:27], v[160:175]
    s_waitcnt vmcnt(21)
    s_barrier
    ds_read_b64_tr_b16 v[220:221], v7 offset:12800
    ds_read_b64_tr_b16 v[222:223], v7 offset:14848
    s_mov_b32 s50, 16384
    buffer_load_dwordx4 v[84:87], v6, s[12:15], s50 offen offset:1024
    s_waitcnt lgkmcnt(8)
    v_mfma_f32_32x32x16_bf16 v[176:191], v[204:207], v[24:27], v[176:191]
    ds_read_b64_tr_b16 v[192:193], v8 offset:16384
    ds_read_b64_tr_b16 v[194:195], v8 offset:18432
    s_waitcnt lgkmcnt(8)
    v_mfma_f32_32x32x16_bf16 v[128:143], v[208:211], v[28:31], v[128:143]
    ds_read_b64_tr_b16 v[196:197], v7 offset:16384
    ds_read_b64_tr_b16 v[198:199], v7 offset:18432
    s_mov_b32 s50, 16384
    buffer_load_dwordx4 v[88:91], v6, s[12:15], s50 offen offset:2048
    s_waitcnt lgkmcnt(8)
    v_mfma_f32_32x32x16_bf16 v[144:159], v[212:215], v[28:31], v[144:159]
    ds_read_b64_tr_b16 v[200:201], v8 offset:16896
    ds_read_b64_tr_b16 v[202:203], v8 offset:18944
    s_waitcnt lgkmcnt(8)
    v_mfma_f32_32x32x16_bf16 v[160:175], v[216:219], v[28:31], v[160:175]
    ds_read_b64_tr_b16 v[204:205], v7 offset:16896
    ds_read_b64_tr_b16 v[206:207], v7 offset:18944
    s_mov_b32 s50, 16384
    buffer_load_dwordx4 v[92:95], v6, s[12:15], s50 offen offset:3072
    s_waitcnt lgkmcnt(8)
    v_mfma_f32_32x32x16_bf16 v[176:191], v[220:223], v[28:31], v[176:191]
    ds_read_b64_tr_b16 v[208:209], v8 offset:20480
    ds_read_b64_tr_b16 v[210:211], v8 offset:22528
    s_waitcnt lgkmcnt(8)
    v_mfma_f32_32x32x16_bf16 v[128:143], v[192:195], v[32:35], v[128:143]
    ds_read_b64_tr_b16 v[212:213], v7 offset:20480
    ds_read_b64_tr_b16 v[214:215], v7 offset:22528
    s_add_u32 m0, s51, 81920
    s_add_u32 s50, s52, 1146880
    buffer_load_dwordx4 v4, s[8:11], s50 offen lds
    s_waitcnt lgkmcnt(8)
    v_mfma_f32_32x32x16_bf16 v[144:159], v[196:199], v[32:35], v[144:159]
    ds_read_b64_tr_b16 v[216:217], v8 offset:20992
    ds_read_b64_tr_b16 v[218:219], v8 offset:23040
    s_waitcnt lgkmcnt(8)
    v_mfma_f32_32x32x16_bf16 v[160:175], v[200:203], v[32:35], v[160:175]
    ds_read_b64_tr_b16 v[220:221], v7 offset:20992
    ds_read_b64_tr_b16 v[222:223], v7 offset:23040
    s_add_u32 m0, s51, 86016
    s_add_u32 s50, s52, 1204224
    buffer_load_dwordx4 v4, s[8:11], s50 offen lds
    s_waitcnt lgkmcnt(8)
    v_mfma_f32_32x32x16_bf16 v[176:191], v[204:207], v[32:35], v[176:191]
    ds_read_b64_tr_b16 v[192:193], v8 offset:24576
    ds_read_b64_tr_b16 v[194:195], v8 offset:26624
    s_waitcnt lgkmcnt(8)
    v_mfma_f32_32x32x16_bf16 v[128:143], v[208:211], v[36:39], v[128:143]
    ds_read_b64_tr_b16 v[196:197], v7 offset:24576
    ds_read_b64_tr_b16 v[198:199], v7 offset:26624
    s_add_u32 m0, s51, 90112
    s_add_u32 s50, s52, 1261568
    buffer_load_dwordx4 v4, s[8:11], s50 offen lds
    s_waitcnt lgkmcnt(8)
    v_mfma_f32_32x32x16_bf16 v[144:159], v[212:215], v[36:39], v[144:159]
    ds_read_b64_tr_b16 v[200:201], v8 offset:25088
    ds_read_b64_tr_b16 v[202:203], v8 offset:27136
    s_waitcnt lgkmcnt(8)
    v_mfma_f32_32x32x16_bf16 v[160:175], v[216:219], v[36:39], v[160:175]
    ds_read_b64_tr_b16 v[204:205], v7 offset:25088
    ds_read_b64_tr_b16 v[206:207], v7 offset:27136
    s_add_u32 m0, s51, 94208
    s_add_u32 s50, s52, 1318912
    buffer_load_dwordx4 v4, s[8:11], s50 offen lds
    s_waitcnt lgkmcnt(8)
    v_mfma_f32_32x32x16_bf16 v[176:191], v[220:223], v[36:39], v[176:191]
    ds_read_b64_tr_b16 v[208:209], v8 offset:28672
    ds_read_b64_tr_b16 v[210:211], v8 offset:30720
    s_waitcnt lgkmcnt(8)
    v_mfma_f32_32x32x16_bf16 v[128:143], v[192:195], v[40:43], v[128:143]
    ds_read_b64_tr_b16 v[212:213], v7 offset:28672
    ds_read_b64_tr_b16 v[214:215], v7 offset:30720
    s_mov_b32 s50, 20480
    buffer_load_dwordx4 v[96:99], v6, s[12:15], s50 offen offset:0
    s_waitcnt lgkmcnt(8)
    v_mfma_f32_32x32x16_bf16 v[144:159], v[196:199], v[40:43], v[144:159]
    ds_read_b64_tr_b16 v[216:217], v8 offset:29184
    ds_read_b64_tr_b16 v[218:219], v8 offset:31232
    s_waitcnt lgkmcnt(8)
    v_mfma_f32_32x32x16_bf16 v[160:175], v[200:203], v[40:43], v[160:175]
    s_waitcnt vmcnt(21)
    s_barrier
    ds_read_b64_tr_b16 v[220:221], v7 offset:29184
    ds_read_b64_tr_b16 v[222:223], v7 offset:31232
    s_mov_b32 s50, 20480
    buffer_load_dwordx4 v[100:103], v6, s[12:15], s50 offen offset:1024
    s_waitcnt lgkmcnt(8)
    v_mfma_f32_32x32x16_bf16 v[176:191], v[204:207], v[40:43], v[176:191]
    ds_read_b64_tr_b16 v[192:193], v8 offset:32768
    ds_read_b64_tr_b16 v[194:195], v8 offset:34816
    s_waitcnt lgkmcnt(8)
    v_mfma_f32_32x32x16_bf16 v[128:143], v[208:211], v[44:47], v[128:143]
    ds_read_b64_tr_b16 v[196:197], v7 offset:32768
    ds_read_b64_tr_b16 v[198:199], v7 offset:34816
    s_mov_b32 s50, 20480
    buffer_load_dwordx4 v[104:107], v6, s[12:15], s50 offen offset:2048
    s_waitcnt lgkmcnt(8)
    v_mfma_f32_32x32x16_bf16 v[144:159], v[212:215], v[44:47], v[144:159]
    ds_read_b64_tr_b16 v[200:201], v8 offset:33280
    ds_read_b64_tr_b16 v[202:203], v8 offset:35328
    s_waitcnt lgkmcnt(8)
    v_mfma_f32_32x32x16_bf16 v[160:175], v[216:219], v[44:47], v[160:175]
    ds_read_b64_tr_b16 v[204:205], v7 offset:33280
    ds_read_b64_tr_b16 v[206:207], v7 offset:35328
    s_mov_b32 s50, 20480
    buffer_load_dwordx4 v[108:111], v6, s[12:15], s50 offen offset:3072
    s_waitcnt lgkmcnt(8)
    v_mfma_f32_32x32x16_bf16 v[176:191], v[220:223], v[44:47], v[176:191]
    ds_read_b64_tr_b16 v[208:209], v8 offset:36864
    ds_read_b64_tr_b16 v[210:211], v8 offset:38912
    s_waitcnt lgkmcnt(8)
    v_mfma_f32_32x32x16_bf16 v[128:143], v[192:195], v[48:51], v[128:143]
    ds_read_b64_tr_b16 v[212:213], v7 offset:36864
    ds_read_b64_tr_b16 v[214:215], v7 offset:38912
    s_add_u32 m0, s51, 98304
    s_add_u32 s50, s52, 1376256
    buffer_load_dwordx4 v4, s[8:11], s50 offen lds
    s_waitcnt lgkmcnt(8)
    v_mfma_f32_32x32x16_bf16 v[144:159], v[196:199], v[48:51], v[144:159]
    ds_read_b64_tr_b16 v[216:217], v8 offset:37376
    ds_read_b64_tr_b16 v[218:219], v8 offset:39424
    s_waitcnt lgkmcnt(8)
    v_mfma_f32_32x32x16_bf16 v[160:175], v[200:203], v[48:51], v[160:175]
    ds_read_b64_tr_b16 v[220:221], v7 offset:37376
    ds_read_b64_tr_b16 v[222:223], v7 offset:39424
    s_add_u32 m0, s51, 102400
    s_add_u32 s50, s52, 1433600
    buffer_load_dwordx4 v4, s[8:11], s50 offen lds
    s_waitcnt lgkmcnt(8)
    v_mfma_f32_32x32x16_bf16 v[176:191], v[204:207], v[48:51], v[176:191]
    ds_read_b64_tr_b16 v[192:193], v8 offset:40960
    ds_read_b64_tr_b16 v[194:195], v8 offset:43008
    s_waitcnt lgkmcnt(8)
    v_mfma_f32_32x32x16_bf16 v[128:143], v[208:211], v[52:55], v[128:143]
    ds_read_b64_tr_b16 v[196:197], v7 offset:40960
    ds_read_b64_tr_b16 v[198:199], v7 offset:43008
    s_add_u32 m0, s51, 106496
    s_add_u32 s50, s52, 1490944
    buffer_load_dwordx4 v4, s[8:11], s50 offen lds
    s_waitcnt lgkmcnt(8)
    v_mfma_f32_32x32x16_bf16 v[144:159], v[212:215], v[52:55], v[144:159]
    ds_read_b64_tr_b16 v[200:201], v8 offset:41472
    ds_read_b64_tr_b16 v[202:203], v8 offset:43520
    s_waitcnt lgkmcnt(8)
    v_mfma_f32_32x32x16_bf16 v[160:175], v[216:219], v[52:55], v[160:175]
    ds_read_b64_tr_b16 v[204:205], v7 offset:41472
    ds_read_b64_tr_b16 v[206:207], v7 offset:43520
    s_add_u32 m0, s51, 110592
    s_add_u32 s50, s52, 1548288
    buffer_load_dwordx4 v4, s[8:11], s50 offen lds
    s_waitcnt lgkmcnt(8)
    v_mfma_f32_32x32x16_bf16 v[176:191], v[220:223], v[52:55], v[176:191]
    ds_read_b64_tr_b16 v[208:209], v8 offset:45056
    ds_read_b64_tr_b16 v[210:211], v8 offset:47104
    s_waitcnt lgkmcnt(8)
    v_mfma_f32_32x32x16_bf16 v[128:143], v[192:195], v[56:59], v[128:143]
    ds_read_b64_tr_b16 v[212:213], v7 offset:45056
    ds_read_b64_tr_b16 v[214:215], v7 offset:47104
    s_mov_b32 s50, 24576
    buffer_load_dwordx4 v[112:115], v6, s[12:15], s50 offen offset:0
    s_waitcnt lgkmcnt(8)
    v_mfma_f32_32x32x16_bf16 v[144:159], v[196:199], v[56:59], v[144:159]
    ds_read_b64_tr_b16 v[216:217], v8 offset:45568
    ds_read_b64_tr_b16 v[218:219], v8 offset:47616
    s_waitcnt lgkmcnt(8)
    v_mfma_f32_32x32x16_bf16 v[160:175], v[200:203], v[56:59], v[160:175]
    s_waitcnt vmcnt(21)
    s_barrier
    ds_read_b64_tr_b16 v[220:221], v7 offset:45568
    ds_read_b64_tr_b16 v[222:223], v7 offset:47616
    s_mov_b32 s50, 24576
    buffer_load_dwordx4 v[116:119], v6, s[12:15], s50 offen offset:1024
    s_waitcnt lgkmcnt(8)
    v_mfma_f32_32x32x16_bf16 v[176:191], v[204:207], v[56:59], v[176:191]
    ds_read_b64_tr_b16 v[192:193], v8 offset:49152
    ds_read_b64_tr_b16 v[194:195], v8 offset:51200
    s_waitcnt lgkmcnt(8)
    v_mfma_f32_32x32x16_bf16 v[128:143], v[208:211], v[60:63], v[128:143]
    ds_read_b64_tr_b16 v[196:197], v7 offset:49152
    ds_read_b64_tr_b16 v[198:199], v7 offset:51200
    s_mov_b32 s50, 24576
    buffer_load_dwordx4 v[120:123], v6, s[12:15], s50 offen offset:2048
    s_waitcnt lgkmcnt(8)
    v_mfma_f32_32x32x16_bf16 v[144:159], v[212:215], v[60:63], v[144:159]
    ds_read_b64_tr_b16 v[200:201], v8 offset:49664
    ds_read_b64_tr_b16 v[202:203], v8 offset:51712
    s_waitcnt lgkmcnt(8)
    v_mfma_f32_32x32x16_bf16 v[160:175], v[216:219], v[60:63], v[160:175]
    ds_read_b64_tr_b16 v[204:205], v7 offset:49664
    ds_read_b64_tr_b16 v[206:207], v7 offset:51712
    s_mov_b32 s50, 24576
    buffer_load_dwordx4 v[124:127], v6, s[12:15], s50 offen offset:3072
    s_waitcnt lgkmcnt(8)
    v_mfma_f32_32x32x16_bf16 v[176:191], v[220:223], v[60:63], v[176:191]
    ds_read_b64_tr_b16 v[208:209], v8 offset:53248
    ds_read_b64_tr_b16 v[210:211], v8 offset:55296
    s_waitcnt lgkmcnt(8)
    v_mfma_f32_32x32x16_bf16 v[128:143], v[192:195], v[64:67], v[128:143]
    ds_read_b64_tr_b16 v[212:213], v7 offset:53248
    ds_read_b64_tr_b16 v[214:215], v7 offset:55296
    s_waitcnt lgkmcnt(8)
    v_mfma_f32_32x32x16_bf16 v[144:159], v[196:199], v[64:67], v[144:159]
    ds_read_b64_tr_b16 v[216:217], v8 offset:53760
    ds_read_b64_tr_b16 v[218:219], v8 offset:55808
    s_waitcnt lgkmcnt(8)
    v_mfma_f32_32x32x16_bf16 v[160:175], v[200:203], v[64:67], v[160:175]
    ds_read_b64_tr_b16 v[220:221], v7 offset:53760
    ds_read_b64_tr_b16 v[222:223], v7 offset:55808
    s_waitcnt lgkmcnt(8)
    v_mfma_f32_32x32x16_bf16 v[176:191], v[204:207], v[64:67], v[176:191]
    ds_read_b64_tr_b16 v[192:193], v8 offset:57344
    ds_read_b64_tr_b16 v[194:195], v8 offset:59392
    s_waitcnt lgkmcnt(8)
    v_mfma_f32_32x32x16_bf16 v[128:143], v[208:211], v[68:71], v[128:143]
    ds_read_b64_tr_b16 v[196:197], v7 offset:57344
    ds_read_b64_tr_b16 v[198:199], v7 offset:59392
    s_waitcnt lgkmcnt(8)
    v_mfma_f32_32x32x16_bf16 v[144:159], v[212:215], v[68:71], v[144:159]
    ds_read_b64_tr_b16 v[200:201], v8 offset:57856
    ds_read_b64_tr_b16 v[202:203], v8 offset:59904
    s_waitcnt lgkmcnt(8)
    v_mfma_f32_32x32x16_bf16 v[160:175], v[216:219], v[68:71], v[160:175]
    ds_read_b64_tr_b16 v[204:205], v7 offset:57856
    ds_read_b64_tr_b16 v[206:207], v7 offset:59904
    s_waitcnt lgkmcnt(8)
    v_mfma_f32_32x32x16_bf16 v[176:191], v[220:223], v[68:71], v[176:191]
    ds_read_b64_tr_b16 v[208:209], v8 offset:61440
    ds_read_b64_tr_b16 v[210:211], v8 offset:63488
    s_waitcnt lgkmcnt(8)
    v_mfma_f32_32x32x16_bf16 v[128:143], v[192:195], v[72:75], v[128:143]
    ds_read_b64_tr_b16 v[212:213], v7 offset:61440
    ds_read_b64_tr_b16 v[214:215], v7 offset:63488
    s_waitcnt lgkmcnt(8)
    v_mfma_f32_32x32x16_bf16 v[144:159], v[196:199], v[72:75], v[144:159]
    ds_read_b64_tr_b16 v[216:217], v8 offset:61952
    ds_read_b64_tr_b16 v[218:219], v8 offset:64000
    s_waitcnt lgkmcnt(8)
    v_mfma_f32_32x32x16_bf16 v[160:175], v[200:203], v[72:75], v[160:175]
    s_waitcnt vmcnt(16)
    s_barrier
    ds_read_b64_tr_b16 v[220:221], v7 offset:61952
    ds_read_b64_tr_b16 v[222:223], v7 offset:64000
    s_waitcnt lgkmcnt(8)
    v_mfma_f32_32x32x16_bf16 v[176:191], v[204:207], v[72:75], v[176:191]
    ds_read_b64_tr_b16 v[192:193], v9 offset:0
    ds_read_b64_tr_b16 v[194:195], v9 offset:2048
    s_waitcnt lgkmcnt(8)
    v_mfma_f32_32x32x16_bf16 v[128:143], v[208:211], v[76:79], v[128:143]
    ds_read_b64_tr_b16 v[196:197], v5 offset:0
    ds_read_b64_tr_b16 v[198:199], v5 offset:2048
    s_mov_b32 s16, s40
    s_and_b32 s17, s41, 0xffff
    s_mov_b32 s18, 1605632
    s_mov_b32 s19, 0x00020000
    s_lshr_b32 s33, s2, 3
    s_mul_i32 s33, s33, 57344
    v_lshlrev_b32 v10, 7, v0
    buffer_load_dword v11, v10, s[16:19], s33 offen
    v_add_u32 v10, 32768, v10
    v_min_u32 v10, 57216, v10
    buffer_load_dword v12, v10, s[16:19], s33 offen
    s_waitcnt lgkmcnt(8)
    v_mfma_f32_32x32x16_bf16 v[144:159], v[212:215], v[76:79], v[144:159]
    ds_read_b64_tr_b16 v[200:201], v9 offset:512
    ds_read_b64_tr_b16 v[202:203], v9 offset:2560
    s_waitcnt lgkmcnt(8)
    v_mfma_f32_32x32x16_bf16 v[160:175], v[216:219], v[76:79], v[160:175]
    ds_read_b64_tr_b16 v[204:205], v5 offset:512
    ds_read_b64_tr_b16 v[206:207], v5 offset:2560
    s_waitcnt lgkmcnt(8)
    v_mfma_f32_32x32x16_bf16 v[176:191], v[220:223], v[76:79], v[176:191]
    ds_read_b64_tr_b16 v[208:209], v9 offset:4096
    ds_read_b64_tr_b16 v[210:211], v9 offset:6144
    s_waitcnt lgkmcnt(8)
    v_mfma_f32_32x32x16_bf16 v[128:143], v[192:195], v[80:83], v[128:143]
    ds_read_b64_tr_b16 v[212:213], v5 offset:4096
    ds_read_b64_tr_b16 v[214:215], v5 offset:6144
    s_waitcnt lgkmcnt(8)
    v_mfma_f32_32x32x16_bf16 v[144:159], v[196:199], v[80:83], v[144:159]
    ds_read_b64_tr_b16 v[216:217], v9 offset:4608
    ds_read_b64_tr_b16 v[218:219], v9 offset:6656
    s_waitcnt lgkmcnt(8)
    v_mfma_f32_32x32x16_bf16 v[160:175], v[200:203], v[80:83], v[160:175]
    ds_read_b64_tr_b16 v[220:221], v5 offset:4608
    ds_read_b64_tr_b16 v[222:223], v5 offset:6656
    s_waitcnt lgkmcnt(8)
    v_mfma_f32_32x32x16_bf16 v[176:191], v[204:207], v[80:83], v[176:191]
    ds_read_b64_tr_b16 v[192:193], v9 offset:8192
    ds_read_b64_tr_b16 v[194:195], v9 offset:10240
    s_waitcnt lgkmcnt(8)
    v_mfma_f32_32x32x16_bf16 v[128:143], v[208:211], v[84:87], v[128:143]
    ds_read_b64_tr_b16 v[196:197], v5 offset:8192
    ds_read_b64_tr_b16 v[198:199], v5 offset:10240
    s_waitcnt lgkmcnt(8)
    v_mfma_f32_32x32x16_bf16 v[144:159], v[212:215], v[84:87], v[144:159]
    ds_read_b64_tr_b16 v[200:201], v9 offset:8704
    ds_read_b64_tr_b16 v[202:203], v9 offset:10752
    s_waitcnt lgkmcnt(8)
    v_mfma_f32_32x32x16_bf16 v[160:175], v[216:219], v[84:87], v[160:175]
    ds_read_b64_tr_b16 v[204:205], v5 offset:8704
    ds_read_b64_tr_b16 v[206:207], v5 offset:10752
    s_waitcnt lgkmcnt(8)
    v_mfma_f32_32x32x16_bf16 v[176:191], v[220:223], v[84:87], v[176:191]
    ds_read_b64_tr_b16 v[208:209], v9 offset:12288
    ds_read_b64_tr_b16 v[210:211], v9 offset:14336
    s_waitcnt lgkmcnt(8)
    v_mfma_f32_32x32x16_bf16 v[128:143], v[192:195], v[88:91], v[128:143]
    ds_read_b64_tr_b16 v[212:213], v5 offset:12288
    ds_read_b64_tr_b16 v[214:215], v5 offset:14336
    s_waitcnt lgkmcnt(8)
    v_mfma_f32_32x32x16_bf16 v[144:159], v[196:199], v[88:91], v[144:159]
    ds_read_b64_tr_b16 v[216:217], v9 offset:12800
    ds_read_b64_tr_b16 v[218:219], v9 offset:14848
    s_waitcnt lgkmcnt(8)
    v_mfma_f32_32x32x16_bf16 v[160:175], v[200:203], v[88:91], v[160:175]
    s_waitcnt vmcnt(10)
    s_barrier
    ds_read_b64_tr_b16 v[220:221], v5 offset:12800
    ds_read_b64_tr_b16 v[222:223], v5 offset:14848
    s_waitcnt lgkmcnt(8)
    v_mfma_f32_32x32x16_bf16 v[176:191], v[204:207], v[88:91], v[176:191]
    ds_read_b64_tr_b16 v[192:193], v9 offset:16384
    ds_read_b64_tr_b16 v[194:195], v9 offset:18432
    s_waitcnt lgkmcnt(8)
    v_mfma_f32_32x32x16_bf16 v[128:143], v[208:211], v[92:95], v[128:143]
    ds_read_b64_tr_b16 v[196:197], v5 offset:16384
    ds_read_b64_tr_b16 v[198:199], v5 offset:18432
    s_waitcnt lgkmcnt(8)
    v_mfma_f32_32x32x16_bf16 v[144:159], v[212:215], v[92:95], v[144:159]
    ds_read_b64_tr_b16 v[200:201], v9 offset:16896
    ds_read_b64_tr_b16 v[202:203], v9 offset:18944
    s_waitcnt lgkmcnt(8)
    v_mfma_f32_32x32x16_bf16 v[160:175], v[216:219], v[92:95], v[160:175]
    ds_read_b64_tr_b16 v[204:205], v5 offset:16896
    ds_read_b64_tr_b16 v[206:207], v5 offset:18944
    s_waitcnt lgkmcnt(8)
    v_mfma_f32_32x32x16_bf16 v[176:191], v[220:223], v[92:95], v[176:191]
    ds_read_b64_tr_b16 v[208:209], v9 offset:20480
    ds_read_b64_tr_b16 v[210:211], v9 offset:22528
    s_waitcnt lgkmcnt(8)
    v_mfma_f32_32x32x16_bf16 v[128:143], v[192:195], v[96:99], v[128:143]
    ds_read_b64_tr_b16 v[212:213], v5 offset:20480
    ds_read_b64_tr_b16 v[214:215], v5 offset:22528
    s_waitcnt lgkmcnt(8)
    v_mfma_f32_32x32x16_bf16 v[144:159], v[196:199], v[96:99], v[144:159]
    ds_read_b64_tr_b16 v[216:217], v9 offset:20992
    ds_read_b64_tr_b16 v[218:219], v9 offset:23040
    s_waitcnt lgkmcnt(8)
    v_mfma_f32_32x32x16_bf16 v[160:175], v[200:203], v[96:99], v[160:175]
    ds_read_b64_tr_b16 v[220:221], v5 offset:20992
    ds_read_b64_tr_b16 v[222:223], v5 offset:23040
    s_waitcnt lgkmcnt(8)
    v_mfma_f32_32x32x16_bf16 v[176:191], v[204:207], v[96:99], v[176:191]
    ds_read_b64_tr_b16 v[192:193], v9 offset:24576
    ds_read_b64_tr_b16 v[194:195], v9 offset:26624
    s_waitcnt lgkmcnt(8)
    v_mfma_f32_32x32x16_bf16 v[128:143], v[208:211], v[100:103], v[128:143]
    ds_read_b64_tr_b16 v[196:197], v5 offset:24576
    ds_read_b64_tr_b16 v[198:199], v5 offset:26624
    s_waitcnt lgkmcnt(8)
    v_mfma_f32_32x32x16_bf16 v[144:159], v[212:215], v[100:103], v[144:159]
    ds_read_b64_tr_b16 v[200:201], v9 offset:25088
    ds_read_b64_tr_b16 v[202:203], v9 offset:27136
    s_waitcnt lgkmcnt(8)
    v_mfma_f32_32x32x16_bf16 v[160:175], v[216:219], v[100:103], v[160:175]
    ds_read_b64_tr_b16 v[204:205], v5 offset:25088
    ds_read_b64_tr_b16 v[206:207], v5 offset:27136
    s_waitcnt lgkmcnt(8)
    v_mfma_f32_32x32x16_bf16 v[176:191], v[220:223], v[100:103], v[176:191]
    ds_read_b64_tr_b16 v[208:209], v9 offset:28672
    ds_read_b64_tr_b16 v[210:211], v9 offset:30720
    s_waitcnt lgkmcnt(8)
    v_mfma_f32_32x32x16_bf16 v[128:143], v[192:195], v[104:107], v[128:143]
    ds_read_b64_tr_b16 v[212:213], v5 offset:28672
    ds_read_b64_tr_b16 v[214:215], v5 offset:30720
    s_waitcnt lgkmcnt(8)
    v_mfma_f32_32x32x16_bf16 v[144:159], v[196:199], v[104:107], v[144:159]
    ds_read_b64_tr_b16 v[216:217], v9 offset:29184
    ds_read_b64_tr_b16 v[218:219], v9 offset:31232
    s_waitcnt lgkmcnt(8)
    v_mfma_f32_32x32x16_bf16 v[160:175], v[200:203], v[104:107], v[160:175]
    s_waitcnt vmcnt(2)
    s_barrier
    ds_read_b64_tr_b16 v[220:221], v5 offset:29184
    ds_read_b64_tr_b16 v[222:223], v5 offset:31232
    s_waitcnt lgkmcnt(8)
    v_mfma_f32_32x32x16_bf16 v[176:191], v[204:207], v[104:107], v[176:191]
    ds_read_b64_tr_b16 v[192:193], v9 offset:32768
    ds_read_b64_tr_b16 v[194:195], v9 offset:34816
    s_waitcnt lgkmcnt(8)
    v_mfma_f32_32x32x16_bf16 v[128:143], v[208:211], v[108:111], v[128:143]
    ds_read_b64_tr_b16 v[196:197], v5 offset:32768
    ds_read_b64_tr_b16 v[198:199], v5 offset:34816
    s_waitcnt lgkmcnt(8)
    v_mfma_f32_32x32x16_bf16 v[144:159], v[212:215], v[108:111], v[144:159]
    ds_read_b64_tr_b16 v[200:201], v9 offset:33280
    ds_read_b64_tr_b16 v[202:203], v9 offset:35328
    s_waitcnt lgkmcnt(8)
    v_mfma_f32_32x32x16_bf16 v[160:175], v[216:219], v[108:111], v[160:175]
    ds_read_b64_tr_b16 v[204:205], v5 offset:33280
    ds_read_b64_tr_b16 v[206:207], v5 offset:35328
    s_waitcnt lgkmcnt(8)
    v_mfma_f32_32x32x16_bf16 v[176:191], v[220:223], v[108:111], v[176:191]
    ds_read_b64_tr_b16 v[208:209], v9 offset:36864
    ds_read_b64_tr_b16 v[210:211], v9 offset:38912
    s_waitcnt lgkmcnt(8)
    v_mfma_f32_32x32x16_bf16 v[128:143], v[192:195], v[112:115], v[128:143]
    ds_read_b64_tr_b16 v[212:213], v5 offset:36864
    ds_read_b64_tr_b16 v[214:215], v5 offset:38912
    s_waitcnt lgkmcnt(8)
    v_mfma_f32_32x32x16_bf16 v[144:159], v[196:199], v[112:115], v[144:159]
    ds_read_b64_tr_b16 v[216:217], v9 offset:37376
    ds_read_b64_tr_b16 v[218:219], v9 offset:39424
    s_waitcnt lgkmcnt(8)
    v_mfma_f32_32x32x16_bf16 v[160:175], v[200:203], v[112:115], v[160:175]
    ds_read_b64_tr_b16 v[220:221], v5 offset:37376
    ds_read_b64_tr_b16 v[222:223], v5 offset:39424
    s_waitcnt lgkmcnt(8)
    v_mfma_f32_32x32x16_bf16 v[176:191], v[204:207], v[112:115], v[176:191]
    ds_read_b64_tr_b16 v[192:193], v9 offset:40960
    ds_read_b64_tr_b16 v[194:195], v9 offset:43008
    s_waitcnt lgkmcnt(8)
    v_mfma_f32_32x32x16_bf16 v[128:143], v[208:211], v[116:119], v[128:143]
    ds_read_b64_tr_b16 v[196:197], v5 offset:40960
    ds_read_b64_tr_b16 v[198:199], v5 offset:43008
    s_waitcnt lgkmcnt(8)
    v_mfma_f32_32x32x16_bf16 v[144:159], v[212:215], v[116:119], v[144:159]
    ds_read_b64_tr_b16 v[200:201], v9 offset:41472
    ds_read_b64_tr_b16 v[202:203], v9 offset:43520
    s_waitcnt lgkmcnt(8)
    v_mfma_f32_32x32x16_bf16 v[160:175], v[216:219], v[116:119], v[160:175]
    ds_read_b64_tr_b16 v[204:205], v5 offset:41472
    ds_read_b64_tr_b16 v[206:207], v5 offset:43520
    s_waitcnt lgkmcnt(8)
    v_mfma_f32_32x32x16_bf16 v[176:191], v[220:223], v[116:119], v[176:191]
    ds_read_b64_tr_b16 v[208:209], v9 offset:45056
    ds_read_b64_tr_b16 v[210:211], v9 offset:47104
    s_waitcnt lgkmcnt(8)
    v_mfma_f32_32x32x16_bf16 v[128:143], v[192:195], v[120:123], v[128:143]
    ds_read_b64_tr_b16 v[212:213], v5 offset:45056
    ds_read_b64_tr_b16 v[214:215], v5 offset:47104
    s_waitcnt lgkmcnt(8)
    v_mfma_f32_32x32x16_bf16 v[144:159], v[196:199], v[120:123], v[144:159]
    ds_read_b64_tr_b16 v[216:217], v9 offset:45568
    ds_read_b64_tr_b16 v[218:219], v9 offset:47616
    s_waitcnt lgkmcnt(8)
    v_mfma_f32_32x32x16_bf16 v[160:175], v[200:203], v[120:123], v[160:175]
    ds_read_b64_tr_b16 v[220:221], v5 offset:45568
    ds_read_b64_tr_b16 v[222:223], v5 offset:47616
    s_waitcnt lgkmcnt(8)
    v_mfma_f32_32x32x16_bf16 v[176:191], v[204:207], v[120:123], v[176:191]
    s_waitcnt lgkmcnt(6)
    v_mfma_f32_32x32x16_bf16 v[128:143], v[208:211], v[124:127], v[128:143]
    s_waitcnt lgkmcnt(4)
    v_mfma_f32_32x32x16_bf16 v[144:159], v[212:215], v[124:127], v[144:159]
    s_waitcnt lgkmcnt(2)
    v_mfma_f32_32x32x16_bf16 v[160:175], v[216:219], v[124:127], v[160:175]
    s_waitcnt lgkmcnt(0)
    v_mfma_f32_32x32x16_bf16 v[176:191], v[220:223], v[124:127], v[176:191]
    s_nop 15
    s_mul_i32 s33, s47, 114688
    s_lshl_b32 s34, s30, 13
    s_add_u32 s33, s33, s34
    s_add_u32 s33, s33, 22020096
    s_add_u32 s42, s38, s33
    s_addc_u32 s43, s39, 0
    s_mov_b32 s12, s42
    s_and_b32 s13, s43, 0xffff
    s_mov_b32 s14, 8192
    s_mov_b32 s15, 0x00020000
    v_cvt_pk_bf16_f32 v16, v128, v129
    v_cvt_pk_bf16_f32 v17, v130, v131
    v_cvt_pk_bf16_f32 v18, v132, v133
    v_cvt_pk_bf16_f32 v19, v134, v135
    v_pk_max_i16 v16, v16, 0
    v_pk_max_i16 v17, v17, 0
    v_pk_max_i16 v18, v18, 0
    v_pk_max_i16 v19, v19, 0
    s_mov_b32 s50, 0
    buffer_store_dwordx4 v[16:19], v6, s[12:15], s50 offen offset:0
    v_cvt_pk_bf16_f32 v20, v136, v137
    v_cvt_pk_bf16_f32 v21, v138, v139
    v_cvt_pk_bf16_f32 v22, v140, v141
    v_cvt_pk_bf16_f32 v23, v142, v143
    v_pk_max_i16 v20, v20, 0
    v_pk_max_i16 v21, v21, 0
    v_pk_max_i16 v22, v22, 0
    v_pk_max_i16 v23, v23, 0
    buffer_store_dwordx4 v[20:23], v6, s[12:15], s50 offen offset:1024
    v_cvt_pk_bf16_f32 v24, v144, v145
    v_cvt_pk_bf16_f32 v25, v146, v147
    v_cvt_pk_bf16_f32 v26, v148, v149
    v_cvt_pk_bf16_f32 v27, v150, v151
    v_pk_max_i16 v24, v24, 0
    v_pk_max_i16 v25, v25, 0
    v_pk_max_i16 v26, v26, 0
    v_pk_max_i16 v27, v27, 0
    buffer_store_dwordx4 v[24:27], v6, s[12:15], s50 offen offset:2048
    v_cvt_pk_bf16_f32 v28, v152, v153
    v_cvt_pk_bf16_f32 v29, v154, v155
    v_cvt_pk_bf16_f32 v30, v156, v157
    v_cvt_pk_bf16_f32 v31, v158, v159
    v_pk_max_i16 v28, v28, 0
    v_pk_max_i16 v29, v29, 0
    v_pk_max_i16 v30, v30, 0
    v_pk_max_i16 v31, v31, 0
    buffer_store_dwordx4 v[28:31], v6, s[12:15], s50 offen offset:3072
    v_cvt_pk_bf16_f32 v32, v160, v161
    v_cvt_pk_bf16_f32 v33, v162, v163
    v_cvt_pk_bf16_f32 v34, v164, v165
    v_cvt_pk_bf16_f32 v35, v166, v167
    v_pk_max_i16 v32, v32, 0
    v_pk_max_i16 v33, v33, 0
    v_pk_max_i16 v34, v34, 0
    v_pk_max_i16 v35, v35, 0
    s_mov_b32 s50, 4096
    buffer_store_dwordx4 v[32:35], v6, s[12:15], s50 offen offset:0
    v_cvt_pk_bf16_f32 v36, v168, v169
    v_cvt_pk_bf16_f32 v37, v170, v171
    v_cvt_pk_bf16_f32 v38, v172, v173
    v_cvt_pk_bf16_f32 v39, v174, v175
    v_pk_max_i16 v36, v36, 0
    v_pk_max_i16 v37, v37, 0
    v_pk_max_i16 v38, v38, 0
    v_pk_max_i16 v39, v39, 0
    buffer_store_dwordx4 v[36:39], v6, s[12:15], s50 offen offset:1024
    v_cvt_pk_bf16_f32 v40, v176, v177
    v_cvt_pk_bf16_f32 v41, v178, v179
    v_cvt_pk_bf16_f32 v42, v180, v181
    v_cvt_pk_bf16_f32 v43, v182, v183
    v_pk_max_i16 v40, v40, 0
    v_pk_max_i16 v41, v41, 0
    v_pk_max_i16 v42, v42, 0
    v_pk_max_i16 v43, v43, 0
    buffer_store_dwordx4 v[40:43], v6, s[12:15], s50 offen offset:2048
    v_cvt_pk_bf16_f32 v44, v184, v185
    v_cvt_pk_bf16_f32 v45, v186, v187
    v_cvt_pk_bf16_f32 v46, v188, v189
    v_cvt_pk_bf16_f32 v47, v190, v191
    v_pk_max_i16 v44, v44, 0
    v_pk_max_i16 v45, v45, 0
    v_pk_max_i16 v46, v46, 0
    v_pk_max_i16 v47, v47, 0
    buffer_store_dwordx4 v[44:47], v6, s[12:15], s50 offen offset:3072
K3_END:
    s_endpgm
.globl k4_mlp2_kernel
.p2align 8
.type k4_mlp2_kernel,@function
k4_mlp2_kernel:
    s_cmp_ge_u32 s2, 224
    s_cbranch_scc1 K4_END
    s_load_dwordx2 s[36:37], s[0:1], 56
    s_load_dwordx2 s[38:39], s[0:1], 96
    s_load_dwordx2 s[40:41], s[0:1], 80
    v_and_b32 v1, 63, v0
    v_lshrrev_b32 v2, 6, v0
    s_nop 0
    v_readfirstlane_b32 s28, v2
    s_and_b32 s29, s2, 7
    s_lshr_b32 s30, s2, 3
    s_lshl_b32 s29, s29, 2
    s_and_b32 s31, s30, 3
    s_add_u32 s29, s29, s31
    s_lshr_b32 s30, s30, 2
    v_lshrrev_b32 v2, 3, v1
    v_mul_u32_u24 v4, 896, v2
    v_bfe_u32 v3, v1, 4, 1
    v_bfe_u32 v2, v1, 2, 1
    v_xor_b32 v3, v3, v2
    v_lshl_add_u32 v4, v3, 6, v4
    v_and_b32 v3, 3, v1
    v_lshl_add_u32 v4, v3, 4, v4
    v_add_u32 v5, 6144, v4
    v_lshlrev_b32 v6, 4, v1
    v_add_u32 v7, 114688, v6
    v_lshrrev_b32 v2, 5, v1
    v_lshlrev_b32 v8, 9, v2
    v_bfe_u32 v3, v1, 2, 2
    v_lshl_add_u32 v8, v3, 7, v8
    v_bfe_u32 v3, v1, 4, 1
    v_lshl_add_u32 v8, v3, 5, v8
    v_and_b32 v3, 3, v1
    v_lshl_add_u32 v8, v3, 3, v8
    s_mul_i32 s31, s28, 32768
    v_add_u32 v8, s31, v8
    v_bfe_u32 v3, v1, 3, 1
    v_xor_b32 v2, 1, v3
    v_lshl_add_u32 v15, v2, 6, v8
    v_lshl_add_u32 v8, v3, 6, v8
    s_waitcnt lgkmcnt(0)
    s_lshl_b32 s33, s30, 7
    s_add_u32 s36, s36, s33
    s_addc_u32 s37, s37, 0
    s_sub_u32 s34, 1605632, s33
    s_mov_b32 s8, s36
    s_and_b32 s9, s37, 0xffff
    s_mov_b32 s10, s34
    s_mov_b32 s11, 0x00020000
    s_mul_i32 s33, s29, 229376
    s_mul_i32 s34, s28, 28672
    s_add_u32 s33, s33, s34
    s_add_u32 s33, s33, 22020096
    s_add_u32 s42, s38, s33
    s_addc_u32 s43, s39, 0
    s_mov_b32 s12, s42
    s_and_b32 s13, s43, 0xffff
    s_mov_b32 s14, 143360
    s_mov_b32 s15, 0x00020000
    s_mul_i32 s32, s28, 401408
    s_and_b32 s45, s28, 1
    s_lshr_b32 s46, s28, 1
    s_lshl_b32 s47, s29, 1
    s_add_u32 s47, s47, s46
    s_lshl_b32 s48, s30, 1
    s_add_u32 s48, s48, s45
    s_mov_b32 s16, s38
    s_and_b32 s17, s39, 0xffff
    s_mov_b32 s18, 10752
    s_mov_b32 s19, 0x00020000
    v_lshrrev_b32 v2, 5, v1
    v_lshlrev_b32 v9, 4, v2
    s_lshl_b32 s49, s48, 7
    s_add_u32 s49, s49, 8960
    buffer_load_dwordx4 v[104:107], v9, s[16:19], s49 offen offset:0
    buffer_load_dwordx4 v[108:111], v9, s[16:19], s49 offen offset:32
    buffer_load_dwordx4 v[112:115], v9, s[16:19], s49 offen offset:64
    buffer_load_dwordx4 v[116:119], v9, s[16:19], s49 offen offset:96
    s_add_u32 s42, s38, 18874368
    s_addc_u32 s43, s39, 0
    s_mov_b32 s20, s42
    s_and_b32 s21, s43, 0xffff
    s_mov_b32 s22, 1835008
    s_mov_b32 s23, 0x00020000
    s_mul_i32 s50, s47, 28672
    s_lshl_b32 s51, s48, 11
    s_add_u32 s50, s50, s51
    buffer_load_dwordx4 v[96:99], v6, s[20:23], s50 offen offset:0
    buffer_load_dwordx4 v[100:103], v6, s[20:23], s50 offen offset:1024
    s_add_u32 m0, s31, 0
    s_add_u32 s35, s32, 0
    buffer_load_dwordx4 v4, s[8:11], s35 offen lds
    buffer_load_dwordx4 v5, s[8:11], s35 offen offset:1024 lds
    s_mov_b32 s44, 0
    buffer_load_dwordx4 v[128:131], v6, s[12:15], s44 offen offset:0
    buffer_load_dwordx4 v[132:135], v7, s[12:15], s44 offen offset:0
    s_add_u32 m0, s31, 2048
    s_add_u32 s35, s32, 14336
    buffer_load_dwordx4 v4, s[8:11], s35 offen lds
    buffer_load_dwordx4 v5, s[8:11], s35 offen offset:1024 lds
    s_mov_b32 s44, 0
    buffer_load_dwordx4 v[136:139], v6, s[12:15], s44 offen offset:1024
    buffer_load_dwordx4 v[140:143], v7, s[12:15], s44 offen offset:1024
    s_add_u32 m0, s31, 4096
    s_add_u32 s35, s32, 28672
    buffer_load_dwordx4 v4, s[8:11], s35 offen lds
    buffer_load_dwordx4 v5, s[8:11], s35 offen offset:1024 lds
    s_mov_b32 s44, 0
    buffer_load_dwordx4 v[144:147], v6, s[12:15], s44 offen offset:2048
    buffer_load_dwordx4 v[148:151], v7, s[12:15], s44 offen offset:2048
    s_add_u32 m0, s31, 6144
    s_add_u32 s35, s32, 43008
    buffer_load_dwordx4 v4, s[8:11], s35 offen lds
    buffer_load_dwordx4 v5, s[8:11], s35 offen offset:1024 lds
    s_mov_b32 s44, 0
    buffer_load_dwordx4 v[152:155], v6, s[12:15], s44 offen offset:3072
    buffer_load_dwordx4 v[156:159], v7, s[12:15], s44 offen offset:3072
    s_add_u32 m0, s31, 8192
    s_add_u32 s35, s32, 57344
    buffer_load_dwordx4 v4, s[8:11], s35 offen lds
    buffer_load_dwordx4 v5, s[8:11], s35 offen offset:1024 lds
    s_mov_b32 s44, 4096
    buffer_load_dwordx4 v[160:163], v6, s[12:15], s44 offen offset:0
    buffer_load_dwordx4 v[164:167], v7, s[12:15], s44 offen offset:0
    s_add_u32 m0, s31, 10240
    s_add_u32 s35, s32, 71680
    buffer_load_dwordx4 v4, s[8:11], s35 offen lds
    buffer_load_dwordx4 v5, s[8:11], s35 offen offset:1024 lds
    s_mov_b32 s44, 4096
    buffer_load_dwordx4 v[168:171], v6, s[12:15], s44 offen offset:1024
    buffer_load_dwordx4 v[172:175], v7, s[12:15], s44 offen offset:1024
    s_add_u32 m0, s31, 12288
    s_add_u32 s35, s32, 86016
    buffer_load_dwordx4 v4, s[8:11], s35 offen lds
    buffer_load_dwordx4 v5, s[8:11], s35 offen offset:1024 lds
    s_mov_b32 s44, 4096
    buffer_load_dwordx4 v[176:179], v6, s[12:15], s44 offen offset:2048
    buffer_load_dwordx4 v[180:183], v7, s[12:15], s44 offen offset:2048
    s_add_u32 m0, s31, 14336
    s_add_u32 s35, s32, 100352
    buffer_load_dwordx4 v4, s[8:11], s35 offen lds
    buffer_load_dwordx4 v5, s[8:11], s35 offen offset:1024 lds
    s_mov_b32 s44, 4096
    buffer_load_dwordx4 v[184:187], v6, s[12:15], s44 offen offset:3072
    buffer_load_dwordx4 v[188:191], v7, s[12:15], s44 offen offset:3072
    s_waitcnt vmcnt(28)
    ds_read_b64_tr_b16 v[80:81], v8 offset:0
    ds_read_b64_tr_b16 v[82:83], v8 offset:1024
    ds_read_b64_tr_b16 v[84:85], v15 offset:0
    ds_read_b64_tr_b16 v[86:87], v15 offset:1024
    s_waitcnt vmcnt(24)
    ds_read_b64_tr_b16 v[88:89], v8 offset:2048
    ds_read_b64_tr_b16 v[90:91], v8 offset:3072
    ds_read_b64_tr_b16 v[92:93], v15 offset:2048
    ds_read_b64_tr_b16 v[94:95], v15 offset:3072
    s_waitcnt lgkmcnt(4)
    v_mfma_f32_32x32x16_bf16 v[16:31], v[80:83], v[128:131], 0
    s_add_u32 m0, s31, 16384
    s_add_u32 s35, s32, 114688
    v_mfma_f32_32x32x16_bf16 v[32:47], v[80:83], v[132:135], 0
    buffer_load_dwordx4 v4, s[8:11], s35 offen lds
    buffer_load_dwordx4 v5, s[8:11], s35 offen offset:1024 lds
    v_mfma_f32_32x32x16_bf16 v[48:63], v[84:87], v[128:131], 0
    s_mov_b32 s44, 8192
    buffer_load_dwordx4 v[192:195], v6, s[12:15], s44 offen offset:0
    v_mfma_f32_32x32x16_bf16 v[64:79], v[84:87], v[132:135], 0
    buffer_load_dwordx4 v[196:199], v7, s[12:15], s44 offen offset:0
    s_waitcnt vmcnt(24)
    ds_read_b64_tr_b16 v[80:81], v8 offset:4096
    ds_read_b64_tr_b16 v[82:83], v8 offset:5120
    ds_read_b64_tr_b16 v[84:85], v15 offset:4096
    ds_read_b64_tr_b16 v[86:87], v15 offset:5120
    s_waitcnt lgkmcnt(4)
    v_mfma_f32_32x32x16_bf16 v[16:31], v[88:91], v[136:139], v[16:31]
    s_add_u32 m0, s31, 18432
    s_add_u32 s35, s32, 129024
    v_mfma_f32_32x32x16_bf16 v[32:47], v[88:91], v[140:143], v[32:47]
    buffer_load_dwordx4 v4, s[8:11], s35 offen lds
    buffer_load_dwordx4 v5, s[8:11], s35 offen offset:1024 lds
    v_mfma_f32_32x32x16_bf16 v[48:63], v[92:95], v[136:139], v[48:63]
    s_mov_b32 s44, 8192
    buffer_load_dwordx4 v[200:203], v6, s[12:15], s44 offen offset:1024
    v_mfma_f32_32x32x16_bf16 v[64:79], v[92:95], v[140:143], v[64:79]
    buffer_load_dwordx4 v[204:207], v7, s[12:15], s44 offen offset:1024
    s_waitcnt vmcnt(24)
    ds_read_b64_tr_b16 v[88:89], v8 offset:6144
    ds_read_b64_tr_b16 v[90:91], v8 offset:7168
    ds_read_b64_tr_b16 v[92:93], v15 offset:6144
    ds_read_b64_tr_b16 v[94:95], v15 offset:7168
    s_waitcnt lgkmcnt(4)
    v_mfma_f32_32x32x16_bf16 v[16:31], v[80:83], v[144:147], v[16:31]
    s_add_u32 m0, s31, 20480
    s_add_u32 s35, s32, 143360
    v_mfma_f32_32x32x16_bf16 v[32:47], v[80:83], v[148:151], v[32:47]
    buffer_load_dwordx4 v4, s[8:11], s35 offen lds
    buffer_load_dwordx4 v5, s[8:11], s35 offen offset:1024 lds
    v_mfma_f32_32x32x16_bf16 v[48:63], v[84:87], v[144:147], v[48:63]
    s_mov_b32 s44, 8192
    buffer_load_dwordx4 v[208:211], v6, s[12:15], s44 offen offset:2048
    v_mfma_f32_32x32x16_bf16 v[64:79], v[84:87], v[148:151], v[64:79]
    buffer_load_dwordx4 v[212:215], v7, s[12:15], s44 offen offset:2048
    s_waitcnt vmcnt(24)
    ds_read_b64_tr_b16 v[80:81], v8 offset:8192
    ds_read_b64_tr_b16 v[82:83], v8 offset:9216
    ds_read_b64_tr_b16 v[84:85], v15 offset:8192
    ds_read_b64_tr_b16 v[86:87], v15 offset:9216
    s_waitcnt lgkmcnt(4)
    v_mfma_f32_32x32x16_bf16 v[16:31], v[88:91], v[152:155], v[16:31]
    s_add_u32 m0, s31, 22528
    s_add_u32 s35, s32, 157696
    v_mfma_f32_32x32x16_bf16 v[32:47], v[88:91], v[156:159], v[32:47]
    buffer_load_dwordx4 v4, s[8:11], s35 offen lds
    buffer_load_dwordx4 v5, s[8:11], s35 offen offset:1024 lds
    v_mfma_f32_32x32x16_bf16 v[48:63], v[92:95], v[152:155], v[48:63]
    s_mov_b32 s44, 8192
    buffer_load_dwordx4 v[216:219], v6, s[12:15], s44 offen offset:3072
    v_mfma_f32_32x32x16_bf16 v[64:79], v[92:95], v[156:159], v[64:79]
    buffer_load_dwordx4 v[220:223], v7, s[12:15], s44 offen offset:3072
    s_waitcnt vmcnt(24)
    ds_read_b64_tr_b16 v[88:89], v8 offset:10240
    ds_read_b64_tr_b16 v[90:91], v8 offset:11264
    ds_read_b64_tr_b16 v[92:93], v15 offset:10240
    ds_read_b64_tr_b16 v[94:95], v15 offset:11264
    s_waitcnt lgkmcnt(4)
    v_mfma_f32_32x32x16_bf16 v[16:31], v[80:83], v[160:163], v[16:31]
    s_add_u32 m0, s31, 24576
    s_add_u32 s35, s32, 172032
    v_mfma_f32_32x32x16_bf16 v[32:47], v[80:83], v[164:167], v[32:47]
    buffer_load_dwordx4 v4, s[8:11], s35 offen lds
    buffer_load_dwordx4 v5, s[8:11], s35 offen offset:1024 lds
    v_mfma_f32_32x32x16_bf16 v[48:63], v[84:87], v[160:163], v[48:63]
    s_mov_b32 s44, 12288
    buffer_load_dwordx4 v[224:227], v6, s[12:15], s44 offen offset:0
    v_mfma_f32_32x32x16_bf16 v[64:79], v[84:87], v[164:167], v[64:79]
    buffer_load_dwordx4 v[228:231], v7, s[12:15], s44 offen offset:0
    s_waitcnt vmcnt(24)
    ds_read_b64_tr_b16 v[80:81], v8 offset:12288
    ds_read_b64_tr_b16 v[82:83], v8 offset:13312
    ds_read_b64_tr_b16 v[84:85], v15 offset:12288
    ds_read_b64_tr_b16 v[86:87], v15 offset:13312
    s_waitcnt lgkmcnt(4)
    v_mfma_f32_32x32x16_bf16 v[16:31], v[88:91], v[168:171], v[16:31]
    s_add_u32 m0, s31, 26624
    s_add_u32 s35, s32, 186368
    v_mfma_f32_32x32x16_bf16 v[32:47], v[88:91], v[172:175], v[32:47]
    buffer_load_dwordx4 v4, s[8:11], s35 offen lds
    buffer_load_dwordx4 v5, s[8:11], s35 offen offset:1024 lds
    v_mfma_f32_32x32x16_bf16 v[48:63], v[92:95], v[168:171], v[48:63]
    s_mov_b32 s44, 12288
    buffer_load_dwordx4 v[232:235], v6, s[12:15], s44 offen offset:1024
    v_mfma_f32_32x32x16_bf16 v[64:79], v[92:95], v[172:175], v[64:79]
    buffer_load_dwordx4 v[236:239], v7, s[12:15], s44 offen offset:1024
    s_waitcnt vmcnt(24)
    ds_read_b64_tr_b16 v[88:89], v8 offset:14336
    ds_read_b64_tr_b16 v[90:91], v8 offset:15360
    ds_read_b64_tr_b16 v[92:93], v15 offset:14336
    ds_read_b64_tr_b16 v[94:95], v15 offset:15360
    s_waitcnt lgkmcnt(4)
    v_mfma_f32_32x32x16_bf16 v[16:31], v[80:83], v[176:179], v[16:31]
    s_add_u32 m0, s31, 28672
    s_add_u32 s35, s32, 200704
    v_mfma_f32_32x32x16_bf16 v[32:47], v[80:83], v[180:183], v[32:47]
    buffer_load_dwordx4 v4, s[8:11], s35 offen lds
    buffer_load_dwordx4 v5, s[8:11], s35 offen offset:1024 lds
    v_mfma_f32_32x32x16_bf16 v[48:63], v[84:87], v[176:179], v[48:63]
    s_mov_b32 s44, 12288
    buffer_load_dwordx4 v[240:243], v6, s[12:15], s44 offen offset:2048
    v_mfma_f32_32x32x16_bf16 v[64:79], v[84:87], v[180:183], v[64:79]
    buffer_load_dwordx4 v[244:247], v7, s[12:15], s44 offen offset:2048
    s_waitcnt vmcnt(24)
    ds_read_b64_tr_b16 v[80:81], v8 offset:16384
    ds_read_b64_tr_b16 v[82:83], v8 offset:17408
    ds_read_b64_tr_b16 v[84:85], v15 offset:16384
    ds_read_b64_tr_b16 v[86:87], v15 offset:17408
    s_waitcnt lgkmcnt(4)
    v_mfma_f32_32x32x16_bf16 v[16:31], v[88:91], v[184:187], v[16:31]
    s_add_u32 m0, s31, 30720
    s_add_u32 s35, s32, 215040
    v_mfma_f32_32x32x16_bf16 v[32:47], v[88:91], v[188:191], v[32:47]
    buffer_load_dwordx4 v4, s[8:11], s35 offen lds
    buffer_load_dwordx4 v5, s[8:11], s35 offen offset:1024 lds
    v_mfma_f32_32x32x16_bf16 v[48:63], v[92:95], v[184:187], v[48:63]
    s_mov_b32 s44, 12288
    buffer_load_dwordx4 v[248:251], v6, s[12:15], s44 offen offset:3072
    v_mfma_f32_32x32x16_bf16 v[64:79], v[92:95], v[188:191], v[64:79]
    buffer_load_dwordx4 v[252:255], v7, s[12:15], s44 offen offset:3072
    s_waitcnt vmcnt(24)
    ds_read_b64_tr_b16 v[88:89], v8 offset:18432
    ds_read_b64_tr_b16 v[90:91], v8 offset:19456
    ds_read_b64_tr_b16 v[92:93], v15 offset:18432
    ds_read_b64_tr_b16 v[94:95], v15 offset:19456
    s_waitcnt lgkmcnt(4)
    v_mfma_f32_32x32x16_bf16 v[16:31], v[80:83], v[192:195], v[16:31]
    s_add_u32 m0, s31, 0
    s_add_u32 s35, s32, 229376
    v_mfma_f32_32x32x16_bf16 v[32:47], v[80:83], v[196:199], v[32:47]
    buffer_load_dwordx4 v4, s[8:11], s35 offen lds
    buffer_load_dwordx4 v5, s[8:11], s35 offen offset:1024 lds
    v_mfma_f32_32x32x16_bf16 v[48:63], v[84:87], v[192:195], v[48:63]
    s_mov_b32 s44, 16384
    buffer_load_dwordx4 v[128:131], v6, s[12:15], s44 offen offset:0
    v_mfma_f32_32x32x16_bf16 v[64:79], v[84:87], v[196:199], v[64:79]
    buffer_load_dwordx4 v[132:135], v7, s[12:15], s44 offen offset:0
    s_waitcnt vmcnt(24)
    ds_read_b64_tr_b16 v[80:81], v8 offset:20480
    ds_read_b64_tr_b16 v[82:83], v8 offset:21504
    ds_read_b64_tr_b16 v[84:85], v15 offset:20480
    ds_read_b64_tr_b16 v[86:87], v15 offset:21504
    s_waitcnt lgkmcnt(4)
    v_mfma_f32_32x32x16_bf16 v[16:31], v[88:91], v[200:203], v[16:31]
    s_add_u32 m0, s31, 2048
    s_add_u32 s35, s32, 243712
    v_mfma_f32_32x32x16_bf16 v[32:47], v[88:91], v[204:207], v[32:47]
    buffer_load_dwordx4 v4, s[8:11], s35 offen lds
    buffer_load_dwordx4 v5, s[8:11], s35 offen offset:1024 lds
    v_mfma_f32_32x32x16_bf16 v[48:63], v[92:95], v[200:203], v[48:63]
    s_mov_b32 s44, 16384
    buffer_load_dwordx4 v[136:139], v6, s[12:15], s44 offen offset:1024
    v_mfma_f32_32x32x16_bf16 v[64:79], v[92:95], v[204:207], v[64:79]
    buffer_load_dwordx4 v[140:143], v7, s[12:15], s44 offen offset:1024
    s_waitcnt vmcnt(24)
    ds_read_b64_tr_b16 v[88:89], v8 offset:22528
    ds_read_b64_tr_b16 v[90:91], v8 offset:23552
    ds_read_b64_tr_b16 v[92:93], v15 offset:22528
    ds_read_b64_tr_b16 v[94:95], v15 offset:23552
    s_waitcnt lgkmcnt(4)
    v_mfma_f32_32x32x16_bf16 v[16:31], v[80:83], v[208:211], v[16:31]
    s_add_u32 m0, s31, 4096
    s_add_u32 s35, s32, 258048
    v_mfma_f32_32x32x16_bf16 v[32:47], v[80:83], v[212:215], v[32:47]
    buffer_load_dwordx4 v4, s[8:11], s35 offen lds
    buffer_load_dwordx4 v5, s[8:11], s35 offen offset:1024 lds
    v_mfma_f32_32x32x16_bf16 v[48:63], v[84:87], v[208:211], v[48:63]
    s_mov_b32 s44, 16384
    buffer_load_dwordx4 v[144:147], v6, s[12:15], s44 offen offset:2048
    v_mfma_f32_32x32x16_bf16 v[64:79], v[84:87], v[212:215], v[64:79]
    buffer_load_dwordx4 v[148:151], v7, s[12:15], s44 offen offset:2048
    s_waitcnt vmcnt(24)
    ds_read_b64_tr_b16 v[80:81], v8 offset:24576
    ds_read_b64_tr_b16 v[82:83], v8 offset:25600
    ds_read_b64_tr_b16 v[84:85], v15 offset:24576
    ds_read_b64_tr_b16 v[86:87], v15 offset:25600
    s_waitcnt lgkmcnt(4)
    v_mfma_f32_32x32x16_bf16 v[16:31], v[88:91], v[216:219], v[16:31]
    s_add_u32 m0, s31, 6144
    s_add_u32 s35, s32, 272384
    v_mfma_f32_32x32x16_bf16 v[32:47], v[88:91], v[220:223], v[32:47]
    buffer_load_dwordx4 v4, s[8:11], s35 offen lds
    buffer_load_dwordx4 v5, s[8:11], s35 offen offset:1024 lds
    v_mfma_f32_32x32x16_bf16 v[48:63], v[92:95], v[216:219], v[48:63]
    s_mov_b32 s44, 16384
    buffer_load_dwordx4 v[152:155], v6, s[12:15], s44 offen offset:3072
    v_mfma_f32_32x32x16_bf16 v[64:79], v[92:95], v[220:223], v[64:79]
    buffer_load_dwordx4 v[156:159], v7, s[12:15], s44 offen offset:3072
    s_waitcnt vmcnt(24)
    ds_read_b64_tr_b16 v[88:89], v8 offset:26624
    ds_read_b64_tr_b16 v[90:91], v8 offset:27648
    ds_read_b64_tr_b16 v[92:93], v15 offset:26624
    ds_read_b64_tr_b16 v[94:95], v15 offset:27648
    s_waitcnt lgkmcnt(4)
    v_mfma_f32_32x32x16_bf16 v[16:31], v[80:83], v[224:227], v[16:31]
    s_add_u32 m0, s31, 8192
    s_add_u32 s35, s32, 286720
    v_mfma_f32_32x32x16_bf16 v[32:47], v[80:83], v[228:231], v[32:47]
    buffer_load_dwordx4 v4, s[8:11], s35 offen lds
    buffer_load_dwordx4 v5, s[8:11], s35 offen offset:1024 lds
    v_mfma_f32_32x32x16_bf16 v[48:63], v[84:87], v[224:227], v[48:63]
    s_mov_b32 s44, 20480
    buffer_load_dwordx4 v[160:163], v6, s[12:15], s44 offen offset:0
    v_mfma_f32_32x32x16_bf16 v[64:79], v[84:87], v[228:231], v[64:79]
    buffer_load_dwordx4 v[164:167], v7, s[12:15], s44 offen offset:0
    s_waitcnt vmcnt(24)
    ds_read_b64_tr_b16 v[80:81], v8 offset:28672
    ds_read_b64_tr_b16 v[82:83], v8 offset:29696
    ds_read_b64_tr_b16 v[84:85], v15 offset:28672
    ds_read_b64_tr_b16 v[86:87], v15 offset:29696
    s_waitcnt lgkmcnt(4)
    v_mfma_f32_32x32x16_bf16 v[16:31], v[88:91], v[232:235], v[16:31]
    s_add_u32 m0, s31, 10240
    s_add_u32 s35, s32, 301056
    v_mfma_f32_32x32x16_bf16 v[32:47], v[88:91], v[236:239], v[32:47]
    buffer_load_dwordx4 v4, s[8:11], s35 offen lds
    buffer_load_dwordx4 v5, s[8:11], s35 offen offset:1024 lds
    v_mfma_f32_32x32x16_bf16 v[48:63], v[92:95], v[232:235], v[48:63]
    s_mov_b32 s44, 20480
    buffer_load_dwordx4 v[168:171], v6, s[12:15], s44 offen offset:1024
    v_mfma_f32_32x32x16_bf16 v[64:79], v[92:95], v[236:239], v[64:79]
    buffer_load_dwordx4 v[172:175], v7, s[12:15], s44 offen offset:1024
    s_waitcnt vmcnt(24)
    ds_read_b64_tr_b16 v[88:89], v8 offset:30720
    ds_read_b64_tr_b16 v[90:91], v8 offset:31744
    ds_read_b64_tr_b16 v[92:93], v15 offset:30720
    ds_read_b64_tr_b16 v[94:95], v15 offset:31744
    s_waitcnt lgkmcnt(4)
    v_mfma_f32_32x32x16_bf16 v[16:31], v[80:83], v[240:243], v[16:31]
    s_add_u32 m0, s31, 12288
    s_add_u32 s35, s32, 315392
    v_mfma_f32_32x32x16_bf16 v[32:47], v[80:83], v[244:247], v[32:47]
    buffer_load_dwordx4 v4, s[8:11], s35 offen lds
    buffer_load_dwordx4 v5, s[8:11], s35 offen offset:1024 lds
    v_mfma_f32_32x32x16_bf16 v[48:63], v[84:87], v[240:243], v[48:63]
    s_mov_b32 s44, 20480
    buffer_load_dwordx4 v[176:179], v6, s[12:15], s44 offen offset:2048
    v_mfma_f32_32x32x16_bf16 v[64:79], v[84:87], v[244:247], v[64:79]
    buffer_load_dwordx4 v[180:183], v7, s[12:15], s44 offen offset:2048
    s_waitcnt vmcnt(24)
    ds_read_b64_tr_b16 v[80:81], v8 offset:0
    ds_read_b64_tr_b16 v[82:83], v8 offset:1024
    ds_read_b64_tr_b16 v[84:85], v15 offset:0
    ds_read_b64_tr_b16 v[86:87], v15 offset:1024
    s_waitcnt lgkmcnt(4)
    v_mfma_f32_32x32x16_bf16 v[16:31], v[88:91], v[248:251], v[16:31]
    s_add_u32 m0, s31, 14336
    s_add_u32 s35, s32, 329728
    v_mfma_f32_32x32x16_bf16 v[32:47], v[88:91], v[252:255], v[32:47]
    buffer_load_dwordx4 v4, s[8:11], s35 offen lds
    buffer_load_dwordx4 v5, s[8:11], s35 offen offset:1024 lds
    v_mfma_f32_32x32x16_bf16 v[48:63], v[92:95], v[248:251], v[48:63]
    s_mov_b32 s44, 20480
    buffer_load_dwordx4 v[184:187], v6, s[12:15], s44 offen offset:3072
    v_mfma_f32_32x32x16_bf16 v[64:79], v[92:95], v[252:255], v[64:79]
    buffer_load_dwordx4 v[188:191], v7, s[12:15], s44 offen offset:3072
    s_waitcnt vmcnt(24)
    ds_read_b64_tr_b16 v[88:89], v8 offset:2048
    ds_read_b64_tr_b16 v[90:91], v8 offset:3072
    ds_read_b64_tr_b16 v[92:93], v15 offset:2048
    ds_read_b64_tr_b16 v[94:95], v15 offset:3072
    s_waitcnt lgkmcnt(4)
    v_mfma_f32_32x32x16_bf16 v[16:31], v[80:83], v[128:131], v[16:31]
    s_add_u32 m0, s31, 16384
    s_add_u32 s35, s32, 344064
    v_mfma_f32_32x32x16_bf16 v[32:47], v[80:83], v[132:135], v[32:47]
    buffer_load_dwordx4 v4, s[8:11], s35 offen lds
    buffer_load_dwordx4 v5, s[8:11], s35 offen offset:1024 lds
    v_mfma_f32_32x32x16_bf16 v[48:63], v[84:87], v[128:131], v[48:63]
    s_mov_b32 s44, 24576
    buffer_load_dwordx4 v[192:195], v6, s[12:15], s44 offen offset:0
    v_mfma_f32_32x32x16_bf16 v[64:79], v[84:87], v[132:135], v[64:79]
    buffer_load_dwordx4 v[196:199], v7, s[12:15], s44 offen offset:0
    s_waitcnt vmcnt(24)
    ds_read_b64_tr_b16 v[80:81], v8 offset:4096
    ds_read_b64_tr_b16 v[82:83], v8 offset:5120
    ds_read_b64_tr_b16 v[84:85], v15 offset:4096
    ds_read_b64_tr_b16 v[86:87], v15 offset:5120
    s_waitcnt lgkmcnt(4)
    v_mfma_f32_32x32x16_bf16 v[16:31], v[88:91], v[136:139], v[16:31]
    s_add_u32 m0, s31, 18432
    s_add_u32 s35, s32, 358400
    v_mfma_f32_32x32x16_bf16 v[32:47], v[88:91], v[140:143], v[32:47]
    buffer_load_dwordx4 v4, s[8:11], s35 offen lds
    buffer_load_dwordx4 v5, s[8:11], s35 offen offset:1024 lds
    v_mfma_f32_32x32x16_bf16 v[48:63], v[92:95], v[136:139], v[48:63]
    s_mov_b32 s44, 24576
    buffer_load_dwordx4 v[200:203], v6, s[12:15], s44 offen offset:1024
    v_mfma_f32_32x32x16_bf16 v[64:79], v[92:95], v[140:143], v[64:79]
    buffer_load_dwordx4 v[204:207], v7, s[12:15], s44 offen offset:1024
    s_waitcnt vmcnt(24)
    ds_read_b64_tr_b16 v[88:89], v8 offset:6144
    ds_read_b64_tr_b16 v[90:91], v8 offset:7168
    ds_read_b64_tr_b16 v[92:93], v15 offset:6144
    ds_read_b64_tr_b16 v[94:95], v15 offset:7168
    s_waitcnt lgkmcnt(4)
    v_mfma_f32_32x32x16_bf16 v[16:31], v[80:83], v[144:147], v[16:31]
    s_add_u32 m0, s31, 20480
    s_add_u32 s35, s32, 372736
    v_mfma_f32_32x32x16_bf16 v[32:47], v[80:83], v[148:151], v[32:47]
    buffer_load_dwordx4 v4, s[8:11], s35 offen lds
    buffer_load_dwordx4 v5, s[8:11], s35 offen offset:1024 lds
    v_mfma_f32_32x32x16_bf16 v[48:63], v[84:87], v[144:147], v[48:63]
    s_mov_b32 s44, 24576
    buffer_load_dwordx4 v[208:211], v6, s[12:15], s44 offen offset:2048
    v_mfma_f32_32x32x16_bf16 v[64:79], v[84:87], v[148:151], v[64:79]
    buffer_load_dwordx4 v[212:215], v7, s[12:15], s44 offen offset:2048
    s_waitcnt vmcnt(24)
    ds_read_b64_tr_b16 v[80:81], v8 offset:8192
    ds_read_b64_tr_b16 v[82:83], v8 offset:9216
    ds_read_b64_tr_b16 v[84:85], v15 offset:8192
    ds_read_b64_tr_b16 v[86:87], v15 offset:9216
    s_waitcnt lgkmcnt(4)
    v_mfma_f32_32x32x16_bf16 v[16:31], v[88:91], v[152:155], v[16:31]
    s_add_u32 m0, s31, 22528
    s_add_u32 s35, s32, 387072
    v_mfma_f32_32x32x16_bf16 v[32:47], v[88:91], v[156:159], v[32:47]
    buffer_load_dwordx4 v4, s[8:11], s35 offen lds
    buffer_load_dwordx4 v5, s[8:11], s35 offen offset:1024 lds
    v_mfma_f32_32x32x16_bf16 v[48:63], v[92:95], v[152:155], v[48:63]
    s_mov_b32 s44, 24576
    buffer_load_dwordx4 v[216:219], v6, s[12:15], s44 offen offset:3072
    v_mfma_f32_32x32x16_bf16 v[64:79], v[92:95], v[156:159], v[64:79]
    buffer_load_dwordx4 v[220:223], v7, s[12:15], s44 offen offset:3072
    s_waitcnt vmcnt(24)
    ds_read_b64_tr_b16 v[88:89], v8 offset:10240
    ds_read_b64_tr_b16 v[90:91], v8 offset:11264
    ds_read_b64_tr_b16 v[92:93], v15 offset:10240
    ds_read_b64_tr_b16 v[94:95], v15 offset:11264
    s_waitcnt lgkmcnt(4)
    v_mfma_f32_32x32x16_bf16 v[16:31], v[80:83], v[160:163], v[16:31]
    v_mfma_f32_32x32x16_bf16 v[32:47], v[80:83], v[164:167], v[32:47]
    v_mfma_f32_32x32x16_bf16 v[48:63], v[84:87], v[160:163], v[48:63]
    v_mfma_f32_32x32x16_bf16 v[64:79], v[84:87], v[164:167], v[64:79]
    s_waitcnt vmcnt(20)
    ds_read_b64_tr_b16 v[80:81], v8 offset:12288
    ds_read_b64_tr_b16 v[82:83], v8 offset:13312
    ds_read_b64_tr_b16 v[84:85], v15 offset:12288
    ds_read_b64_tr_b16 v[86:87], v15 offset:13312
    s_waitcnt lgkmcnt(4)
    v_mfma_f32_32x32x16_bf16 v[16:31], v[88:91], v[168:171], v[16:31]
    v_mfma_f32_32x32x16_bf16 v[32:47], v[88:91], v[172:175], v[32:47]
    v_mfma_f32_32x32x16_bf16 v[48:63], v[92:95], v[168:171], v[48:63]
    v_mfma_f32_32x32x16_bf16 v[64:79], v[92:95], v[172:175], v[64:79]
    s_waitcnt vmcnt(16)
    ds_read_b64_tr_b16 v[88:89], v8 offset:14336
    ds_read_b64_tr_b16 v[90:91], v8 offset:15360
    ds_read_b64_tr_b16 v[92:93], v15 offset:14336
    ds_read_b64_tr_b16 v[94:95], v15 offset:15360
    s_waitcnt lgkmcnt(4)
    v_mfma_f32_32x32x16_bf16 v[16:31], v[80:83], v[176:179], v[16:31]
    v_mfma_f32_32x32x16_bf16 v[32:47], v[80:83], v[180:183], v[32:47]
    v_mfma_f32_32x32x16_bf16 v[48:63], v[84:87], v[176:179], v[48:63]
    v_mfma_f32_32x32x16_bf16 v[64:79], v[84:87], v[180:183], v[64:79]
    s_waitcnt vmcnt(12)
    ds_read_b64_tr_b16 v[80:81], v8 offset:16384
    ds_read_b64_tr_b16 v[82:83], v8 offset:17408
    ds_read_b64_tr_b16 v[84:85], v15 offset:16384
    ds_read_b64_tr_b16 v[86:87], v15 offset:17408
    s_waitcnt lgkmcnt(4)
    v_mfma_f32_32x32x16_bf16 v[16:31], v[88:91], v[184:187], v[16:31]
    v_mfma_f32_32x32x16_bf16 v[32:47], v[88:91], v[188:191], v[32:47]
    v_mfma_f32_32x32x16_bf16 v[48:63], v[92:95], v[184:187], v[48:63]
    v_mfma_f32_32x32x16_bf16 v[64:79], v[92:95], v[188:191], v[64:79]
    s_waitcnt vmcnt(8)
    ds_read_b64_tr_b16 v[88:89], v8 offset:18432
    ds_read_b64_tr_b16 v[90:91], v8 offset:19456
    ds_read_b64_tr_b16 v[92:93], v15 offset:18432
    ds_read_b64_tr_b16 v[94:95], v15 offset:19456
    s_waitcnt lgkmcnt(4)
    v_mfma_f32_32x32x16_bf16 v[16:31], v[80:83], v[192:195], v[16:31]
    v_mfma_f32_32x32x16_bf16 v[32:47], v[80:83], v[196:199], v[32:47]
    v_mfma_f32_32x32x16_bf16 v[48:63], v[84:87], v[192:195], v[48:63]
    v_mfma_f32_32x32x16_bf16 v[64:79], v[84:87], v[196:199], v[64:79]
    s_waitcnt vmcnt(4)
    ds_read_b64_tr_b16 v[80:81], v8 offset:20480
    ds_read_b64_tr_b16 v[82:83], v8 offset:21504
    ds_read_b64_tr_b16 v[84:85], v15 offset:20480
    ds_read_b64_tr_b16 v[86:87], v15 offset:21504
    s_waitcnt lgkmcnt(4)
    v_mfma_f32_32x32x16_bf16 v[16:31], v[88:91], v[200:203], v[16:31]
    v_mfma_f32_32x32x16_bf16 v[32:47], v[88:91], v[204:207], v[32:47]
    v_mfma_f32_32x32x16_bf16 v[48:63], v[92:95], v[200:203], v[48:63]
    v_mfma_f32_32x32x16_bf16 v[64:79], v[92:95], v[204:207], v[64:79]
    s_waitcnt vmcnt(0)
    ds_read_b64_tr_b16 v[88:89], v8 offset:22528
    ds_read_b64_tr_b16 v[90:91], v8 offset:23552
    ds_read_b64_tr_b16 v[92:93], v15 offset:22528
    ds_read_b64_tr_b16 v[94:95], v15 offset:23552
    s_waitcnt lgkmcnt(4)
    v_mfma_f32_32x32x16_bf16 v[16:31], v[80:83], v[208:211], v[16:31]
    v_mfma_f32_32x32x16_bf16 v[32:47], v[80:83], v[212:215], v[32:47]
    v_mfma_f32_32x32x16_bf16 v[48:63], v[84:87], v[208:211], v[48:63]
    v_mfma_f32_32x32x16_bf16 v[64:79], v[84:87], v[212:215], v[64:79]
    s_waitcnt lgkmcnt(0)
    v_mfma_f32_32x32x16_bf16 v[16:31], v[88:91], v[216:219], v[16:31]
    v_mfma_f32_32x32x16_bf16 v[32:47], v[88:91], v[220:223], v[32:47]
    v_mfma_f32_32x32x16_bf16 v[48:63], v[92:95], v[216:219], v[48:63]
    v_mfma_f32_32x32x16_bf16 v[64:79], v[92:95], v[220:223], v[64:79]
    s_nop 15
    s_barrier
    s_lshl_b32 s33, s28, 12
    v_add_u32 v11, s33, v6
    ds_write_b128 v11, v[16:19] offset:0
    ds_write_b128 v11, v[20:23] offset:1024
    ds_write_b128 v11, v[24:27] offset:2048
    ds_write_b128 v11, v[28:31] offset:3072
    ds_write_b128 v11, v[48:51] offset:16384
    ds_write_b128 v11, v[52:55] offset:17408
    ds_write_b128 v11, v[56:59] offset:18432
    ds_write_b128 v11, v[60:63] offset:19456
    ds_write_b128 v11, v[32:35] offset:32768
    ds_write_b128 v11, v[36:39] offset:33792
    ds_write_b128 v11, v[40:43] offset:34816
    ds_write_b128 v11, v[44:47] offset:35840
    ds_write_b128 v11, v[64:67] offset:49152
    ds_write_b128 v11, v[68:71] offset:50176
    ds_write_b128 v11, v[72:75] offset:51200
    ds_write_b128 v11, v[76:79] offset:52224
    s_waitcnt lgkmcnt(0)
    s_barrier
    s_lshl_b32 s33, s28, 14
    v_add_u32 v11, s33, v6
    ds_read_b128 v[16:19], v11 offset:0
    ds_read_b128 v[20:23], v11 offset:1024
    ds_read_b128 v[24:27], v11 offset:2048
    ds_read_b128 v[28:31], v11 offset:3072
    ds_read_b128 v[32:35], v11 offset:4096
    ds_read_b128 v[36:39], v11 offset:5120
    ds_read_b128 v[40:43], v11 offset:6144
    ds_read_b128 v[44:47], v11 offset:7168
    ds_read_b128 v[48:51], v11 offset:8192
    ds_read_b128 v[52:55], v11 offset:9216
    ds_read_b128 v[56:59], v11 offset:10240
    ds_read_b128 v[60:63], v11 offset:11264
    ds_read_b128 v[64:67], v11 offset:12288
    ds_read_b128 v[68:71], v11 offset:13312
    ds_read_b128 v[72:75], v11 offset:14336
    ds_read_b128 v[76:79], v11 offset:15360
    s_waitcnt lgkmcnt(0)
    v_add_f32 v16, v16, v32
    v_add_f32 v48, v48, v64
    v_add_f32 v17, v17, v33
    v_add_f32 v49, v49, v65
    v_add_f32 v18, v18, v34
    v_add_f32 v50, v50, v66
    v_add_f32 v19, v19, v35
    v_add_f32 v51, v51, v67
    v_add_f32 v20, v20, v36
    v_add_f32 v52, v52, v68
    v_add_f32 v21, v21, v37
    v_add_f32 v53, v53, v69
    v_add_f32 v22, v22, v38
    v_add_f32 v54, v54, v70
    v_add_f32 v23, v23, v39
    v_add_f32 v55, v55, v71
    v_add_f32 v24, v24, v40
    v_add_f32 v56, v56, v72
    v_add_f32 v25, v25, v41
    v_add_f32 v57, v57, v73
    v_add_f32 v26, v26, v42
    v_add_f32 v58, v58, v74
    v_add_f32 v27, v27, v43
    v_add_f32 v59, v59, v75
    v_add_f32 v28, v28, v44
    v_add_f32 v60, v60, v76
    v_add_f32 v29, v29, v45
    v_add_f32 v61, v61, v77
    v_add_f32 v30, v30, v46
    v_add_f32 v62, v62, v78
    v_add_f32 v31, v31, v47
    v_add_f32 v63, v63, v79
    v_add_f32 v16, v16, v48
    v_add_f32 v17, v17, v49
    v_add_f32 v18, v18, v50
    v_add_f32 v19, v19, v51
    v_add_f32 v20, v20, v52
    v_add_f32 v21, v21, v53
    v_add_f32 v22, v22, v54
    v_add_f32 v23, v23, v55
    v_add_f32 v24, v24, v56
    v_add_f32 v25, v25, v57
    v_add_f32 v26, v26, v58
    v_add_f32 v27, v27, v59
    v_add_f32 v28, v28, v60
    v_add_f32 v29, v29, v61
    v_add_f32 v30, v30, v62
    v_add_f32 v31, v31, v63
    v_lshlrev_b32 v128, 16, v96
    v_and_b32 v129, 0xffff0000, v96
    v_lshlrev_b32 v130, 16, v97
    v_and_b32 v131, 0xffff0000, v97
    v_lshlrev_b32 v132, 16, v98
    v_and_b32 v133, 0xffff0000, v98
    v_lshlrev_b32 v134, 16, v99
    v_and_b32 v135, 0xffff0000, v99
    v_lshlrev_b32 v136, 16, v100
    v_and_b32 v137, 0xffff0000, v100
    v_lshlrev_b32 v138, 16, v101
    v_and_b32 v139, 0xffff0000, v101
    v_lshlrev_b32 v140, 16, v102
    v_and_b32 v141, 0xffff0000, v102
    v_lshlrev_b32 v142, 16, v103
    v_and_b32 v143, 0xffff0000, v103
    v_fma_f32 v16, v16, v104, v128
    v_fma_f32 v17, v17, v105, v129
    v_fma_f32 v18, v18, v106, v130
    v_fma_f32 v19, v19, v107, v131
    v_fma_f32 v20, v20, v108, v132
    v_fma_f32 v21, v21, v109, v133
    v_fma_f32 v22, v22, v110, v134
    v_fma_f32 v23, v23, v111, v135
    v_fma_f32 v24, v24, v112, v136
    v_fma_f32 v25, v25, v113, v137
    v_fma_f32 v26, v26, v114, v138
    v_fma_f32 v27, v27, v115, v139
    v_fma_f32 v28, v28, v116, v140
    v_fma_f32 v29, v29, v117, v141
    v_fma_f32 v30, v30, v118, v142
    v_fma_f32 v31, v31, v119, v143
    v_cvt_pk_bf16_f32 v80, v16, v17
    v_cvt_pk_bf16_f32 v81, v18, v19
    v_cvt_pk_bf16_f32 v82, v20, v21
    v_cvt_pk_bf16_f32 v83, v22, v23
    v_cvt_pk_bf16_f32 v84, v24, v25
    v_cvt_pk_bf16_f32 v85, v26, v27
    v_cvt_pk_bf16_f32 v86, v28, v29
    v_cvt_pk_bf16_f32 v87, v30, v31
    s_mov_b32 s20, s40
    s_and_b32 s21, s41, 0xffff
    s_mov_b32 s22, 1835008
    s_mov_b32 s23, 0x00020000
    v_and_b32 v3, 31, v1
    v_lshrrev_b32 v2, 5, v1
    v_mul_u32_u24 v10, 896, v3
    v_lshl_add_u32 v10, v2, 3, v10
    s_mul_i32 s50, s47, 28672
    s_lshl_b32 s51, s48, 6
    s_add_u32 s50, s50, s51
    buffer_store_dwordx2 v[80:81], v10, s[20:23], s50 offen offset:0
    buffer_store_dwordx2 v[82:83], v10, s[20:23], s50 offen offset:16
    buffer_store_dwordx2 v[84:85], v10, s[20:23], s50 offen offset:32
    buffer_store_dwordx2 v[86:87], v10, s[20:23], s50 offen offset:48
K4_END:
    s_endpgm
CODE_END:
    s_endpgm
.section .rodata,"a"
.p2align 6
.amdhsa_kernel k0_mod_kernel
  .amdhsa_next_free_vgpr 96
  .amdhsa_next_free_sgpr 48
  .amdhsa_accum_offset 96
  .amdhsa_group_segment_fixed_size 0
  .amdhsa_kernarg_size 104
  .amdhsa_user_sgpr_count 2
  .amdhsa_user_sgpr_kernarg_segment_ptr 1
  .amdhsa_system_sgpr_workgroup_id_x 1
.end_amdhsa_kernel

.p2align 6
.amdhsa_kernel k1_attn_kernel
  .amdhsa_next_free_vgpr 512
  .amdhsa_next_free_sgpr 100
  .amdhsa_accum_offset 256
  .amdhsa_group_segment_fixed_size 0
  .amdhsa_kernarg_size 104
  .amdhsa_user_sgpr_count 2
  .amdhsa_user_sgpr_kernarg_segment_ptr 1
  .amdhsa_system_sgpr_workgroup_id_x 1
.end_amdhsa_kernel

.p2align 6
.amdhsa_kernel k2_reduce_kernel
  .amdhsa_next_free_vgpr 96
  .amdhsa_next_free_sgpr 48
  .amdhsa_accum_offset 96
  .amdhsa_group_segment_fixed_size 0
  .amdhsa_kernarg_size 104
  .amdhsa_user_sgpr_count 2
  .amdhsa_user_sgpr_kernarg_segment_ptr 1
  .amdhsa_system_sgpr_workgroup_id_x 1
.end_amdhsa_kernel

.p2align 6
.amdhsa_kernel k3_mlp1_kernel
  .amdhsa_next_free_vgpr 256
  .amdhsa_next_free_sgpr 100
  .amdhsa_accum_offset 256
  .amdhsa_group_segment_fixed_size 0
  .amdhsa_kernarg_size 104
  .amdhsa_user_sgpr_count 2
  .amdhsa_user_sgpr_kernarg_segment_ptr 1
  .amdhsa_system_sgpr_workgroup_id_x 1
.end_amdhsa_kernel

.p2align 6
.amdhsa_kernel k4_mlp2_kernel
  .amdhsa_next_free_vgpr 256
  .amdhsa_next_free_sgpr 100
  .amdhsa_accum_offset 256
  .amdhsa_group_segment_fixed_size 0
  .amdhsa_kernarg_size 104
  .amdhsa_user_sgpr_count 2
  .amdhsa_user_sgpr_kernarg_segment_ptr 1
  .amdhsa_system_sgpr_workgroup_id_x 1
.end_amdhsa_kernel
```
